```python
import torch

def _softmax(x, axis=-1):
    return torch.softmax(x, dim=axis)

def _gelu(x):
    return torch.nn.functional.gelu(x, approximate='tanh')

def _silu(x):
    return torch.nn.functional.silu(x)

def _sigmoid(x):
    return torch.sigmoid(x)

def _layernorm(x, axis=-1, eps=1e-05):
    m = x.mean(dim=axis, keepdim=True)
    v = x.var(dim=axis, keepdim=True, unbiased=False)
    return (x - m) / torch.sqrt(v + eps)

def _scatter_add(tgt, idx, src, axis=0):
    return tgt.clone().index_add_(axis, idx, src)

def _segment_sum(src, seg, n):
    out = torch.zeros((n,) + src.shape[1:], dtype=src.dtype)
    return out.index_add_(0, seg, src)

def _pad(x, pw):
    flat = tuple((v for pair in reversed(pw) for v in pair))
    return torch.nn.functional.pad(x, flat)
kernel_name = 'sequential_preLN__memory_aug_recurrent_mem_tr__mixer_gmlp__prompt'

def setup_inputs():

    _w = lambda a: (lambda t: t.to(torch.bfloat16) if t.is_floating_point() else t)(torch.as_tensor(a))

    def _A_setup():
        B, S, Dm = (1, 2048, 640)
        H, Dh = (32, 192)
        M, seg = (8, 32)
        seg = min(seg, S)
        S = S // seg * seg
        return {'x': _w((lambda *s: torch.randn(*s, dtype=torch.bfloat16) * 0.05)(B, S, Dm)), 'mem0': _w((lambda *s: torch.randn(*s, dtype=torch.bfloat16) * 0.2)(B, M, Dm)), 'Wq': _w((lambda *s: torch.randn(*s, dtype=torch.bfloat16) * 1.6)(Dm, H, Dh) * Dm ** (-0.5)), 'Wk': _w((lambda *s: torch.randn(*s, dtype=torch.bfloat16) * 1.6)(Dm, H, Dh) * Dm ** (-0.5)), 'Wv': _w((lambda *s: torch.randn(*s, dtype=torch.bfloat16) * 0.2)(Dm, H, Dh) * Dm ** (-0.5)), 'Wo': _w((lambda *s: torch.randn(*s, dtype=torch.bfloat16) * 0.2)(H, Dh, Dm) * (H * Dh) ** (-0.5)), 'seg_len': seg}
    _A_in = _A_setup()

    def _B_setup():
        B, S, D, F = (1, 2048, 640, 1536)
        Fh = F // 2
        return {'x': _w((lambda *s: torch.randn(*s, dtype=torch.bfloat16) * 0.05)(B, S, D)), 'w_in': _w((lambda *s: torch.randn(*s, dtype=torch.bfloat16) * 0.4)(D, 2 * Fh)), 'w_sp': _w(0.01 * (lambda *s: torch.randn(*s, dtype=torch.bfloat16) * 0.4)(S, S)), 'b_sp': _w(1.0 + 0.01 * (lambda *s: torch.randn(*s, dtype=torch.bfloat16) * 0.05)(S)), 'w_out': _w((lambda *s: torch.randn(*s, dtype=torch.bfloat16) * 0.05)(Fh, D))}
    _B_in = _B_setup()
    return {'A_x': _A_in['x'], 'A_mem0': _A_in['mem0'], 'A_Wq': _A_in['Wq'], 'A_Wk': _A_in['Wk'], 'A_Wv': _A_in['Wv'], 'A_Wo': _A_in['Wo'], 'A_seg_len': _A_in['seg_len'], 'B_x': _B_in['x'], 'B_w_in': _B_in['w_in'], 'B_w_sp': _B_in['w_sp'], 'B_b_sp': _B_in['b_sp'], 'B_w_out': _B_in['w_out']}

def reference(A_x, A_mem0, A_Wq, A_Wk, A_Wv, A_Wo, A_seg_len, B_x, B_w_in, B_w_sp, B_b_sp, B_w_out):

    def _A_ref(x, mem0, Wq, Wk, Wv, Wo, seg_len):
        B, S, Dm = x.shape
        H, Dh = (Wq.shape[1], Wq.shape[2])
        M = mem0.shape[1]
        scale = Dh ** (-0.5)
        n_seg = S // seg_len
        L = M + seg_len
        idx = torch.arange(L)
        mask = (idx[:, None] < M) | (idx[:, None] >= idx[None, :])
        mem = mem0
        outs = []
        for s in range(n_seg):
            xs = x[:, s * seg_len:(s + 1) * seg_len, :].clone()
            h = torch.concatenate([mem, xs], axis=1)
            q = torch.einsum('btd,dhe->bhte', h, Wq)
            k = torch.einsum('btd,dhe->bhte', h, Wk)
            v = torch.einsum('btd,dhe->bhte', h, Wv)
            scores = torch.einsum('bhqe,bhke->bhqk', q, k) * scale
            scores = torch.where(mask[None, None], scores, -1000000000.0)
            p = _softmax(scores, axis=-1)
            o = torch.einsum('bhqk,bhke->bhqe', p, v)
            o = torch.einsum('bhte,hed->btd', o, Wo)
            mem = o[:, :M, :].clone()
            outs.append(o[:, M:, :])
        return torch.concatenate(outs, axis=1)

    def _B_ref(x, w_in, w_sp, b_sp, w_out):
        B, S, D = x.shape
        F = w_in.shape[-1]
        Fh = F // 2
        z = _gelu(torch.einsum('bsd,df->bsf', x, w_in))
        z1 = z[..., :Fh].clone()
        z2 = _layernorm(z[..., Fh:], axis=-1)
        g = torch.einsum('ts,bsf->btf', w_sp, z2) + b_sp[None, :, None]
        return torch.einsum('bsf,fd->bsd', z1 * g, w_out)
    x = A_x
    h = x + _A_ref(_layernorm(x, axis=-1), A_mem0, A_Wq, A_Wk, A_Wv, A_Wo, A_seg_len)
    h2 = h + _B_ref(_layernorm(h, axis=-1), B_w_in, B_w_sp, B_b_sp, B_w_out)
    return h2
```

```asm
; @launch grid=(256,1,1) block=(256,1,1) lds=163840
.amdgcn_target "amdgcn-amd-amdhsa--gfx950"
.text
.globl sequential_preLN__memory_aug_recurrent_mem_tr__mixer_gmlp__prompt_kernel
.type sequential_preLN__memory_aug_recurrent_mem_tr__mixer_gmlp__prompt_kernel,@function
.p2align 8
sequential_preLN__memory_aug_recurrent_mem_tr__mixer_gmlp__prompt_kernel:
  s_cmp_ge_u32 s2, 256
  s_cbranch_scc1 mega_done
  s_load_dwordx2 s[4:5], s[0:1], 112
  s_load_dwordx2 s[90:91], s[0:1], 104
  s_load_dwordx2 s[16:17], s[0:1], 0
  s_getreg_b32 s9, hwreg(HW_REG_XCC_ID)
  s_and_b32 s9, s9, 15
  s_and_b32 s8, s9, 7
  v_lshrrev_b32 v1, 6, v0
  s_nop 0
  v_readfirstlane_b32 s3, v1
  v_and_b32 v0, 63, v0
  s_mov_b32 s11, 0
  s_mov_b32 s6, 0x10000000
  s_mov_b32 s7, 0x20000
  s_waitcnt lgkmcnt(0)
  v_mov_b32 v1, 0
  s_mov_b32 s19, -1
  s_cmp_ge_u32 s2, 16
  s_cbranch_scc1 mega_nocal
  s_cmp_lg_u32 s3, 3
  s_cbranch_scc1 mega_calj
  s_mov_b64 exec, 1
  s_lshl_b32 s12, s2, 8
  s_add_u32 s12, s12, 2082816
  v_mov_b32 v2, s12
  v_add_u32 v3, 8192, v2
  s_mov_b32 s20, 0
  global_store_dword v2, v1, s[4:5] sc1
  global_store_dword v3, v1, s[4:5] sc1
  s_waitcnt vmcnt(0)
  global_store_dword v2, v1, s[4:5] sc1
  global_store_dword v3, v1, s[4:5] sc1
  s_waitcnt vmcnt(1)
  s_memtime s[12:13]
  s_waitcnt vmcnt(0)
  s_memtime s[14:15]
  s_waitcnt lgkmcnt(0)
  s_sub_u32 s14, s14, s12
  s_min_u32 s14, s14, 320
  s_add_u32 s20, s20, s14
  global_store_dword v3, v1, s[4:5] sc1
  global_store_dword v2, v1, s[4:5] sc1
  s_waitcnt vmcnt(1)
  s_memtime s[12:13]
  s_waitcnt vmcnt(0)
  s_memtime s[14:15]
  s_waitcnt lgkmcnt(0)
  s_sub_u32 s14, s14, s12
  s_min_u32 s14, s14, 320
  s_sub_u32 s20, s20, s14
  s_sub_u32 s14, 0, s20
  s_bitcmp1_b32 s9, 2
  s_cselect_b32 s20, s14, s20
  s_add_u32 s20, s20, 16779264
  v_mov_b32 v2, 136
  v_mov_b32 v4, s20
  global_atomic_add v2, v4, s[90:91]
  s_mov_b64 exec, -1
mega_calj:
  s_barrier
  s_branch mega_noln
mega_nocal:
  s_cmp_lg_u32 s3, 1
  s_cbranch_scc1 mega_nocw
  s_sub_u32 s12, s2, 16
  s_cmp_ge_u32 s12, 16
  s_cbranch_scc1 mega_nocw
  s_getpc_b64 s[20:21]
mega_pc:
  s_lshr_b32 s12, s12, 3
  s_lshl_b32 s12, s12, 13
  v_lshlrev_b32 v2, 7, v0
  v_add_u32 v2, s12, v2
  s_mov_b32 s13, mega_code_end-mega_pc-4
  v_min_u32 v3, s13, v2
  global_load_dword v8, v3, s[20:21]
  v_add_u32 v2, 16384, v2
  v_min_u32 v3, s13, v2
  global_load_dword v8, v3, s[20:21]
  v_add_u32 v2, 16384, v2
  v_min_u32 v3, s13, v2
  global_load_dword v8, v3, s[20:21]
  v_add_u32 v2, 16384, v2
  v_min_u32 v3, s13, v2
  global_load_dword v8, v3, s[20:21]
  v_add_u32 v2, 16384, v2
  v_min_u32 v3, s13, v2
  global_load_dword v8, v3, s[20:21]
  v_add_u32 v2, 16384, v2
  v_min_u32 v3, s13, v2
  global_load_dword v8, v3, s[20:21]
  v_add_u32 v2, 16384, v2
  v_min_u32 v3, s13, v2
  global_load_dword v8, v3, s[20:21]
  v_add_u32 v2, 16384, v2
  v_min_u32 v3, s13, v2
  global_load_dword v8, v3, s[20:21]
  v_add_u32 v2, 16384, v2
  s_waitcnt vmcnt(0)
mega_nocw:
  s_cmp_eq_u32 s3, 3
  s_cselect_b32 s19, s2, -1
  s_sub_u32 s12, s2, 32
  s_cmp_lt_u32 s12, 16
  s_cselect_b32 s12, s12, -1
  s_cmp_eq_u32 s3, 2
  s_cselect_b32 s19, s12, s19
  s_cmp_eq_u32 s19, -1
  s_cbranch_scc1 mega_noln
  v_and_b32 v2, 7, v0
  v_lshrrev_b32 v3, 3, v0
  v_mul_u32_u24 v4, 1280, v2
  v_lshl_add_u32 v4, v3, 4, v4
  s_mul_i32 s12, s19, 10240
  v_add_u32 v4, s12, v4
  global_load_dwordx4 v[16:19], v4, s[16:17] offset:0
  global_load_dwordx4 v[20:23], v4, s[16:17] offset:128
  global_load_dwordx4 v[24:27], v4, s[16:17] offset:256
  global_load_dwordx4 v[28:31], v4, s[16:17] offset:384
  global_load_dwordx4 v[32:35], v4, s[16:17] offset:512
  global_load_dwordx4 v[36:39], v4, s[16:17] offset:640
  global_load_dwordx4 v[40:43], v4, s[16:17] offset:768
  global_load_dwordx4 v[44:47], v4, s[16:17] offset:896
  global_load_dwordx4 v[48:51], v4, s[16:17] offset:1024
  global_load_dwordx4 v[52:55], v4, s[16:17] offset:1152
  v_lshlrev_b32 v5, 4, v2
  v_lshl_add_u32 v5, v3, 8, v5
  s_lshr_b32 s12, s19, 1
  s_mul_i32 s12, s12, 20480
  s_and_b32 s13, s19, 1
  s_lshl_b32 s13, s13, 7
  s_add_u32 s12, s12, s13
  s_add_u32 s12, s12, 3145728
  v_mov_b32 v6, 0
  v_mov_b32 v7, 0
  s_waitcnt vmcnt(9)
  v_lshlrev_b32 v56, 16, v16
  v_and_b32 v57, 0xffff0000, v16
  v_pk_add_f32 v[6:7], v[6:7], v[56:57]
  v_lshlrev_b32 v58, 16, v17
  v_and_b32 v59, 0xffff0000, v17
  v_pk_add_f32 v[6:7], v[6:7], v[58:59]
  v_lshlrev_b32 v60, 16, v18
  v_and_b32 v61, 0xffff0000, v18
  v_pk_add_f32 v[6:7], v[6:7], v[60:61]
  v_lshlrev_b32 v62, 16, v19
  v_and_b32 v63, 0xffff0000, v19
  v_pk_add_f32 v[6:7], v[6:7], v[62:63]
  s_waitcnt vmcnt(8)
  v_lshlrev_b32 v64, 16, v20
  v_and_b32 v65, 0xffff0000, v20
  v_pk_add_f32 v[6:7], v[6:7], v[64:65]
  v_lshlrev_b32 v66, 16, v21
  v_and_b32 v67, 0xffff0000, v21
  v_pk_add_f32 v[6:7], v[6:7], v[66:67]
  v_lshlrev_b32 v68, 16, v22
  v_and_b32 v69, 0xffff0000, v22
  v_pk_add_f32 v[6:7], v[6:7], v[68:69]
  v_lshlrev_b32 v70, 16, v23
  v_and_b32 v71, 0xffff0000, v23
  v_pk_add_f32 v[6:7], v[6:7], v[70:71]
  s_waitcnt vmcnt(7)
  v_lshlrev_b32 v72, 16, v24
  v_and_b32 v73, 0xffff0000, v24
  v_pk_add_f32 v[6:7], v[6:7], v[72:73]
  v_lshlrev_b32 v74, 16, v25
  v_and_b32 v75, 0xffff0000, v25
  v_pk_add_f32 v[6:7], v[6:7], v[74:75]
  v_lshlrev_b32 v76, 16, v26
  v_and_b32 v77, 0xffff0000, v26
  v_pk_add_f32 v[6:7], v[6:7], v[76:77]
  v_lshlrev_b32 v78, 16, v27
  v_and_b32 v79, 0xffff0000, v27
  v_pk_add_f32 v[6:7], v[6:7], v[78:79]
  s_waitcnt vmcnt(6)
  v_lshlrev_b32 v80, 16, v28
  v_and_b32 v81, 0xffff0000, v28
  v_pk_add_f32 v[6:7], v[6:7], v[80:81]
  v_lshlrev_b32 v82, 16, v29
  v_and_b32 v83, 0xffff0000, v29
  v_pk_add_f32 v[6:7], v[6:7], v[82:83]
  v_lshlrev_b32 v84, 16, v30
  v_and_b32 v85, 0xffff0000, v30
  v_pk_add_f32 v[6:7], v[6:7], v[84:85]
  v_lshlrev_b32 v86, 16, v31
  v_and_b32 v87, 0xffff0000, v31
  v_pk_add_f32 v[6:7], v[6:7], v[86:87]
  s_waitcnt vmcnt(5)
  v_lshlrev_b32 v88, 16, v32
  v_and_b32 v89, 0xffff0000, v32
  v_pk_add_f32 v[6:7], v[6:7], v[88:89]
  v_lshlrev_b32 v90, 16, v33
  v_and_b32 v91, 0xffff0000, v33
  v_pk_add_f32 v[6:7], v[6:7], v[90:91]
  v_lshlrev_b32 v92, 16, v34
  v_and_b32 v93, 0xffff0000, v34
  v_pk_add_f32 v[6:7], v[6:7], v[92:93]
  v_lshlrev_b32 v94, 16, v35
  v_and_b32 v95, 0xffff0000, v35
  v_pk_add_f32 v[6:7], v[6:7], v[94:95]
  s_waitcnt vmcnt(4)
  v_lshlrev_b32 v96, 16, v36
  v_and_b32 v97, 0xffff0000, v36
  v_pk_add_f32 v[6:7], v[6:7], v[96:97]
  v_lshlrev_b32 v98, 16, v37
  v_and_b32 v99, 0xffff0000, v37
  v_pk_add_f32 v[6:7], v[6:7], v[98:99]
  v_lshlrev_b32 v100, 16, v38
  v_and_b32 v101, 0xffff0000, v38
  v_pk_add_f32 v[6:7], v[6:7], v[100:101]
  v_lshlrev_b32 v102, 16, v39
  v_and_b32 v103, 0xffff0000, v39
  v_pk_add_f32 v[6:7], v[6:7], v[102:103]
  s_waitcnt vmcnt(3)
  v_lshlrev_b32 v104, 16, v40
  v_and_b32 v105, 0xffff0000, v40
  v_pk_add_f32 v[6:7], v[6:7], v[104:105]
  v_lshlrev_b32 v106, 16, v41
  v_and_b32 v107, 0xffff0000, v41
  v_pk_add_f32 v[6:7], v[6:7], v[106:107]
  v_lshlrev_b32 v108, 16, v42
  v_and_b32 v109, 0xffff0000, v42
  v_pk_add_f32 v[6:7], v[6:7], v[108:109]
  v_lshlrev_b32 v110, 16, v43
  v_and_b32 v111, 0xffff0000, v43
  v_pk_add_f32 v[6:7], v[6:7], v[110:111]
  s_waitcnt vmcnt(2)
  v_lshlrev_b32 v112, 16, v44
  v_and_b32 v113, 0xffff0000, v44
  v_pk_add_f32 v[6:7], v[6:7], v[112:113]
  v_lshlrev_b32 v114, 16, v45
  v_and_b32 v115, 0xffff0000, v45
  v_pk_add_f32 v[6:7], v[6:7], v[114:115]
  v_lshlrev_b32 v116, 16, v46
  v_and_b32 v117, 0xffff0000, v46
  v_pk_add_f32 v[6:7], v[6:7], v[116:117]
  v_lshlrev_b32 v118, 16, v47
  v_and_b32 v119, 0xffff0000, v47
  v_pk_add_f32 v[6:7], v[6:7], v[118:119]
  s_waitcnt vmcnt(1)
  v_lshlrev_b32 v120, 16, v48
  v_and_b32 v121, 0xffff0000, v48
  v_pk_add_f32 v[6:7], v[6:7], v[120:121]
  v_lshlrev_b32 v122, 16, v49
  v_and_b32 v123, 0xffff0000, v49
  v_pk_add_f32 v[6:7], v[6:7], v[122:123]
  v_lshlrev_b32 v124, 16, v50
  v_and_b32 v125, 0xffff0000, v50
  v_pk_add_f32 v[6:7], v[6:7], v[124:125]
  v_lshlrev_b32 v126, 16, v51
  v_and_b32 v127, 0xffff0000, v51
  v_pk_add_f32 v[6:7], v[6:7], v[126:127]
  s_waitcnt vmcnt(0)
  v_lshlrev_b32 v128, 16, v52
  v_and_b32 v129, 0xffff0000, v52
  v_pk_add_f32 v[6:7], v[6:7], v[128:129]
  v_lshlrev_b32 v130, 16, v53
  v_and_b32 v131, 0xffff0000, v53
  v_pk_add_f32 v[6:7], v[6:7], v[130:131]
  v_lshlrev_b32 v132, 16, v54
  v_and_b32 v133, 0xffff0000, v54
  v_pk_add_f32 v[6:7], v[6:7], v[132:133]
  v_lshlrev_b32 v134, 16, v55
  v_and_b32 v135, 0xffff0000, v55
  v_pk_add_f32 v[6:7], v[6:7], v[134:135]
  v_add_f32 v6, v6, v7
  s_nop 1
  v_add_f32_dpp v6, v6, v6 row_ror:8 row_mask:0xf bank_mask:0xf
  v_mov_b32 v7, v6
  s_nop 1
  v_permlane16_swap_b32 v6, v7
  v_add_f32 v6, v6, v7
  v_mov_b32 v7, v6
  s_nop 1
  v_permlane32_swap_b32 v6, v7
  v_add_f32 v6, v6, v7
  v_mul_f32 v6, 0xbacccccd, v6
  v_mov_b32 v8, 0
  v_mov_b32 v9, 0
  v_pk_add_f32 v[56:57], v[56:57], v[6:7] op_sel_hi:[1,0]
  v_pk_fma_f32 v[8:9], v[56:57], v[56:57], v[8:9]
  v_pk_add_f32 v[58:59], v[58:59], v[6:7] op_sel_hi:[1,0]
  v_pk_fma_f32 v[8:9], v[58:59], v[58:59], v[8:9]
  v_pk_add_f32 v[60:61], v[60:61], v[6:7] op_sel_hi:[1,0]
  v_pk_fma_f32 v[8:9], v[60:61], v[60:61], v[8:9]
  v_pk_add_f32 v[62:63], v[62:63], v[6:7] op_sel_hi:[1,0]
  v_pk_fma_f32 v[8:9], v[62:63], v[62:63], v[8:9]
  v_pk_add_f32 v[64:65], v[64:65], v[6:7] op_sel_hi:[1,0]
  v_pk_fma_f32 v[8:9], v[64:65], v[64:65], v[8:9]
  v_pk_add_f32 v[66:67], v[66:67], v[6:7] op_sel_hi:[1,0]
  v_pk_fma_f32 v[8:9], v[66:67], v[66:67], v[8:9]
  v_pk_add_f32 v[68:69], v[68:69], v[6:7] op_sel_hi:[1,0]
  v_pk_fma_f32 v[8:9], v[68:69], v[68:69], v[8:9]
  v_pk_add_f32 v[70:71], v[70:71], v[6:7] op_sel_hi:[1,0]
  v_pk_fma_f32 v[8:9], v[70:71], v[70:71], v[8:9]
  v_pk_add_f32 v[72:73], v[72:73], v[6:7] op_sel_hi:[1,0]
  v_pk_fma_f32 v[8:9], v[72:73], v[72:73], v[8:9]
  v_pk_add_f32 v[74:75], v[74:75], v[6:7] op_sel_hi:[1,0]
  v_pk_fma_f32 v[8:9], v[74:75], v[74:75], v[8:9]
  v_pk_add_f32 v[76:77], v[76:77], v[6:7] op_sel_hi:[1,0]
  v_pk_fma_f32 v[8:9], v[76:77], v[76:77], v[8:9]
  v_pk_add_f32 v[78:79], v[78:79], v[6:7] op_sel_hi:[1,0]
  v_pk_fma_f32 v[8:9], v[78:79], v[78:79], v[8:9]
  v_pk_add_f32 v[80:81], v[80:81], v[6:7] op_sel_hi:[1,0]
  v_pk_fma_f32 v[8:9], v[80:81], v[80:81], v[8:9]
  v_pk_add_f32 v[82:83], v[82:83], v[6:7] op_sel_hi:[1,0]
  v_pk_fma_f32 v[8:9], v[82:83], v[82:83], v[8:9]
  v_pk_add_f32 v[84:85], v[84:85], v[6:7] op_sel_hi:[1,0]
  v_pk_fma_f32 v[8:9], v[84:85], v[84:85], v[8:9]
  v_pk_add_f32 v[86:87], v[86:87], v[6:7] op_sel_hi:[1,0]
  v_pk_fma_f32 v[8:9], v[86:87], v[86:87], v[8:9]
  v_pk_add_f32 v[88:89], v[88:89], v[6:7] op_sel_hi:[1,0]
  v_pk_fma_f32 v[8:9], v[88:89], v[88:89], v[8:9]
  v_pk_add_f32 v[90:91], v[90:91], v[6:7] op_sel_hi:[1,0]
  v_pk_fma_f32 v[8:9], v[90:91], v[90:91], v[8:9]
  v_pk_add_f32 v[92:93], v[92:93], v[6:7] op_sel_hi:[1,0]
  v_pk_fma_f32 v[8:9], v[92:93], v[92:93], v[8:9]
  v_pk_add_f32 v[94:95], v[94:95], v[6:7] op_sel_hi:[1,0]
  v_pk_fma_f32 v[8:9], v[94:95], v[94:95], v[8:9]
  v_pk_add_f32 v[96:97], v[96:97], v[6:7] op_sel_hi:[1,0]
  v_pk_fma_f32 v[8:9], v[96:97], v[96:97], v[8:9]
  v_pk_add_f32 v[98:99], v[98:99], v[6:7] op_sel_hi:[1,0]
  v_pk_fma_f32 v[8:9], v[98:99], v[98:99], v[8:9]
  v_pk_add_f32 v[100:101], v[100:101], v[6:7] op_sel_hi:[1,0]
  v_pk_fma_f32 v[8:9], v[100:101], v[100:101], v[8:9]
  v_pk_add_f32 v[102:103], v[102:103], v[6:7] op_sel_hi:[1,0]
  v_pk_fma_f32 v[8:9], v[102:103], v[102:103], v[8:9]
  v_pk_add_f32 v[104:105], v[104:105], v[6:7] op_sel_hi:[1,0]
  v_pk_fma_f32 v[8:9], v[104:105], v[104:105], v[8:9]
  v_pk_add_f32 v[106:107], v[106:107], v[6:7] op_sel_hi:[1,0]
  v_pk_fma_f32 v[8:9], v[106:107], v[106:107], v[8:9]
  v_pk_add_f32 v[108:109], v[108:109], v[6:7] op_sel_hi:[1,0]
  v_pk_fma_f32 v[8:9], v[108:109], v[108:109], v[8:9]
  v_pk_add_f32 v[110:111], v[110:111], v[6:7] op_sel_hi:[1,0]
  v_pk_fma_f32 v[8:9], v[110:111], v[110:111], v[8:9]
  v_pk_add_f32 v[112:113], v[112:113], v[6:7] op_sel_hi:[1,0]
  v_pk_fma_f32 v[8:9], v[112:113], v[112:113], v[8:9]
  v_pk_add_f32 v[114:115], v[114:115], v[6:7] op_sel_hi:[1,0]
  v_pk_fma_f32 v[8:9], v[114:115], v[114:115], v[8:9]
  v_pk_add_f32 v[116:117], v[116:117], v[6:7] op_sel_hi:[1,0]
  v_pk_fma_f32 v[8:9], v[116:117], v[116:117], v[8:9]
  v_pk_add_f32 v[118:119], v[118:119], v[6:7] op_sel_hi:[1,0]
  v_pk_fma_f32 v[8:9], v[118:119], v[118:119], v[8:9]
  v_pk_add_f32 v[120:121], v[120:121], v[6:7] op_sel_hi:[1,0]
  v_pk_fma_f32 v[8:9], v[120:121], v[120:121], v[8:9]
  v_pk_add_f32 v[122:123], v[122:123], v[6:7] op_sel_hi:[1,0]
  v_pk_fma_f32 v[8:9], v[122:123], v[122:123], v[8:9]
  v_pk_add_f32 v[124:125], v[124:125], v[6:7] op_sel_hi:[1,0]
  v_pk_fma_f32 v[8:9], v[124:125], v[124:125], v[8:9]
  v_pk_add_f32 v[126:127], v[126:127], v[6:7] op_sel_hi:[1,0]
  v_pk_fma_f32 v[8:9], v[126:127], v[126:127], v[8:9]
  v_pk_add_f32 v[128:129], v[128:129], v[6:7] op_sel_hi:[1,0]
  v_pk_fma_f32 v[8:9], v[128:129], v[128:129], v[8:9]
  v_pk_add_f32 v[130:131], v[130:131], v[6:7] op_sel_hi:[1,0]
  v_pk_fma_f32 v[8:9], v[130:131], v[130:131], v[8:9]
  v_pk_add_f32 v[132:133], v[132:133], v[6:7] op_sel_hi:[1,0]
  v_pk_fma_f32 v[8:9], v[132:133], v[132:133], v[8:9]
  v_pk_add_f32 v[134:135], v[134:135], v[6:7] op_sel_hi:[1,0]
  v_pk_fma_f32 v[8:9], v[134:135], v[134:135], v[8:9]
  v_add_f32 v8, v8, v9
  s_nop 1
  v_add_f32_dpp v8, v8, v8 row_ror:8 row_mask:0xf bank_mask:0xf
  v_mov_b32 v9, v8
  s_nop 1
  v_permlane16_swap_b32 v8, v9
  v_add_f32 v8, v8, v9
  v_mov_b32 v9, v8
  s_nop 1
  v_permlane32_swap_b32 v8, v9
  v_add_f32 v8, v8, v9
  v_mov_b32 v10, 0x3727c5ac
  v_fmac_f32 v10, 0x3acccccd, v8
  v_rsq_f32 v10, v10
  s_nop 0
  v_pk_mul_f32 v[56:57], v[56:57], v[10:11] op_sel_hi:[1,0]
  v_cvt_pk_bf16_f32 v16, v56, v57
  v_pk_mul_f32 v[58:59], v[58:59], v[10:11] op_sel_hi:[1,0]
  v_cvt_pk_bf16_f32 v17, v58, v59
  v_pk_mul_f32 v[60:61], v[60:61], v[10:11] op_sel_hi:[1,0]
  v_cvt_pk_bf16_f32 v18, v60, v61
  v_pk_mul_f32 v[62:63], v[62:63], v[10:11] op_sel_hi:[1,0]
  v_cvt_pk_bf16_f32 v19, v62, v63
  buffer_store_dwordx4 v[16:19], v5, s[4:7], s12 offen offset:0 sc1
  v_pk_mul_f32 v[64:65], v[64:65], v[10:11] op_sel_hi:[1,0]
  v_cvt_pk_bf16_f32 v20, v64, v65
  v_pk_mul_f32 v[66:67], v[66:67], v[10:11] op_sel_hi:[1,0]
  v_cvt_pk_bf16_f32 v21, v66, v67
  v_pk_mul_f32 v[68:69], v[68:69], v[10:11] op_sel_hi:[1,0]
  v_cvt_pk_bf16_f32 v22, v68, v69
  v_pk_mul_f32 v[70:71], v[70:71], v[10:11] op_sel_hi:[1,0]
  v_cvt_pk_bf16_f32 v23, v70, v71
  buffer_store_dwordx4 v[20:23], v5, s[4:7], s12 offen offset:2048 sc1
  s_add_u32 s12, s12, 4096
  v_pk_mul_f32 v[72:73], v[72:73], v[10:11] op_sel_hi:[1,0]
  v_cvt_pk_bf16_f32 v24, v72, v73
  v_pk_mul_f32 v[74:75], v[74:75], v[10:11] op_sel_hi:[1,0]
  v_cvt_pk_bf16_f32 v25, v74, v75
  v_pk_mul_f32 v[76:77], v[76:77], v[10:11] op_sel_hi:[1,0]
  v_cvt_pk_bf16_f32 v26, v76, v77
  v_pk_mul_f32 v[78:79], v[78:79], v[10:11] op_sel_hi:[1,0]
  v_cvt_pk_bf16_f32 v27, v78, v79
  buffer_store_dwordx4 v[24:27], v5, s[4:7], s12 offen offset:0 sc1
  v_pk_mul_f32 v[80:81], v[80:81], v[10:11] op_sel_hi:[1,0]
  v_cvt_pk_bf16_f32 v28, v80, v81
  v_pk_mul_f32 v[82:83], v[82:83], v[10:11] op_sel_hi:[1,0]
  v_cvt_pk_bf16_f32 v29, v82, v83
  v_pk_mul_f32 v[84:85], v[84:85], v[10:11] op_sel_hi:[1,0]
  v_cvt_pk_bf16_f32 v30, v84, v85
  v_pk_mul_f32 v[86:87], v[86:87], v[10:11] op_sel_hi:[1,0]
  v_cvt_pk_bf16_f32 v31, v86, v87
  buffer_store_dwordx4 v[28:31], v5, s[4:7], s12 offen offset:2048 sc1
  s_add_u32 s12, s12, 4096
  v_pk_mul_f32 v[88:89], v[88:89], v[10:11] op_sel_hi:[1,0]
  v_cvt_pk_bf16_f32 v32, v88, v89
  v_pk_mul_f32 v[90:91], v[90:91], v[10:11] op_sel_hi:[1,0]
  v_cvt_pk_bf16_f32 v33, v90, v91
  v_pk_mul_f32 v[92:93], v[92:93], v[10:11] op_sel_hi:[1,0]
  v_cvt_pk_bf16_f32 v34, v92, v93
  v_pk_mul_f32 v[94:95], v[94:95], v[10:11] op_sel_hi:[1,0]
  v_cvt_pk_bf16_f32 v35, v94, v95
  buffer_store_dwordx4 v[32:35], v5, s[4:7], s12 offen offset:0 sc1
  v_pk_mul_f32 v[96:97], v[96:97], v[10:11] op_sel_hi:[1,0]
  v_cvt_pk_bf16_f32 v36, v96, v97
  v_pk_mul_f32 v[98:99], v[98:99], v[10:11] op_sel_hi:[1,0]
  v_cvt_pk_bf16_f32 v37, v98, v99
  v_pk_mul_f32 v[100:101], v[100:101], v[10:11] op_sel_hi:[1,0]
  v_cvt_pk_bf16_f32 v38, v100, v101
  v_pk_mul_f32 v[102:103], v[102:103], v[10:11] op_sel_hi:[1,0]
  v_cvt_pk_bf16_f32 v39, v102, v103
  buffer_store_dwordx4 v[36:39], v5, s[4:7], s12 offen offset:2048 sc1
  s_add_u32 s12, s12, 4096
  v_pk_mul_f32 v[104:105], v[104:105], v[10:11] op_sel_hi:[1,0]
  v_cvt_pk_bf16_f32 v40, v104, v105
  v_pk_mul_f32 v[106:107], v[106:107], v[10:11] op_sel_hi:[1,0]
  v_cvt_pk_bf16_f32 v41, v106, v107
  v_pk_mul_f32 v[108:109], v[108:109], v[10:11] op_sel_hi:[1,0]
  v_cvt_pk_bf16_f32 v42, v108, v109
  v_pk_mul_f32 v[110:111], v[110:111], v[10:11] op_sel_hi:[1,0]
  v_cvt_pk_bf16_f32 v43, v110, v111
  buffer_store_dwordx4 v[40:43], v5, s[4:7], s12 offen offset:0 sc1
  v_pk_mul_f32 v[112:113], v[112:113], v[10:11] op_sel_hi:[1,0]
  v_cvt_pk_bf16_f32 v44, v112, v113
  v_pk_mul_f32 v[114:115], v[114:115], v[10:11] op_sel_hi:[1,0]
  v_cvt_pk_bf16_f32 v45, v114, v115
  v_pk_mul_f32 v[116:117], v[116:117], v[10:11] op_sel_hi:[1,0]
  v_cvt_pk_bf16_f32 v46, v116, v117
  v_pk_mul_f32 v[118:119], v[118:119], v[10:11] op_sel_hi:[1,0]
  v_cvt_pk_bf16_f32 v47, v118, v119
  buffer_store_dwordx4 v[44:47], v5, s[4:7], s12 offen offset:2048 sc1
  s_add_u32 s12, s12, 4096
  v_pk_mul_f32 v[120:121], v[120:121], v[10:11] op_sel_hi:[1,0]
  v_cvt_pk_bf16_f32 v48, v120, v121
  v_pk_mul_f32 v[122:123], v[122:123], v[10:11] op_sel_hi:[1,0]
  v_cvt_pk_bf16_f32 v49, v122, v123
  v_pk_mul_f32 v[124:125], v[124:125], v[10:11] op_sel_hi:[1,0]
  v_cvt_pk_bf16_f32 v50, v124, v125
  v_pk_mul_f32 v[126:127], v[126:127], v[10:11] op_sel_hi:[1,0]
  v_cvt_pk_bf16_f32 v51, v126, v127
  buffer_store_dwordx4 v[48:51], v5, s[4:7], s12 offen offset:0 sc1
  v_pk_mul_f32 v[128:129], v[128:129], v[10:11] op_sel_hi:[1,0]
  v_cvt_pk_bf16_f32 v52, v128, v129
  v_pk_mul_f32 v[130:131], v[130:131], v[10:11] op_sel_hi:[1,0]
  v_cvt_pk_bf16_f32 v53, v130, v131
  v_pk_mul_f32 v[132:133], v[132:133], v[10:11] op_sel_hi:[1,0]
  v_cvt_pk_bf16_f32 v54, v132, v133
  v_pk_mul_f32 v[134:135], v[134:135], v[10:11] op_sel_hi:[1,0]
  v_cvt_pk_bf16_f32 v55, v134, v135
  buffer_store_dwordx4 v[52:55], v5, s[4:7], s12 offen offset:2048 sc1
  s_add_u32 s12, s12, 4096
mega_noln:
  s_cmp_lg_u32 s3, 0
  s_cbranch_scc1 mega_t1
  s_mov_b64 exec, 1
  v_mov_b32 v3, 1
  s_mov_b32 s12, 0
mega_tk:
  s_cmp_eq_u32 s8, s9
  s_cbranch_scc1 mega_home
  v_mov_b32 v2, 72
  global_store_dword v2, v3, s[90:91] sc1
  s_waitcnt vmcnt(0)
mega_home:
  s_and_b32 s14, s8, 3
  s_lshl_b32 s14, s14, 6
  s_and_b32 s15, s8, 4
  s_add_u32 s14, s14, s15
  v_mov_b32 v2, s14
  global_atomic_add v4, v2, v3, s[90:91] sc0
  s_waitcnt vmcnt(0)
  v_readfirstlane_b32 s14, v4
  s_nop 0
  s_cmp_lt_u32 s14, 32
  s_cbranch_scc1 mega_got
  s_add_u32 s8, s8, 1
  s_and_b32 s8, s8, 7
  s_add_u32 s12, s12, 1
  s_cmp_lt_u32 s12, 8
  s_cbranch_scc1 mega_tk
mega_got:
  v_mov_b32 v5, s8
  ds_write_b64 v1, v[4:5]
  s_waitcnt lgkmcnt(0)
  s_mov_b64 exec, -1
mega_t1:
  s_barrier
  ds_read_b64 v[4:5], v1
  s_waitcnt lgkmcnt(0)
  v_readfirstlane_b32 s2, v4
  v_readfirstlane_b32 s8, v5
  s_cmp_eq_u32 s19, -1
  s_cbranch_scc1 mega_noln2
  s_and_b32 s18, s19, 3
  s_lshl_b32 s18, s18, 6
  s_add_u32 s18, s18, 16
  v_mov_b32 v2, s18
  v_mov_b32 v3, 1
  s_mov_b64 exec, 1
  s_waitcnt vmcnt(0)
  global_atomic_add v2, v3, s[90:91]
  s_mov_b64 exec, -1
mega_noln2:
  s_barrier
  s_cmp_ge_u32 s2, 32
  s_cbranch_scc1 mega_done
  s_cmp_ge_u32 s8, 4
  s_cbranch_scc1 mega_hi
  s_cmp_ge_u32 s2, 26
  s_cbranch_scc1 mega_ln2
  s_and_b32 s9, s2, 7
  s_cmp_ge_u32 s2, 16
  s_cbranch_scc1 mega_R
  s_cmp_ge_u32 s2, 8
  s_cbranch_scc1 mega_B
  s_branch mega_A
mega_hi:
  s_cmp_ge_u32 s2, 26
  s_cbranch_scc1 mega_win
  s_cmp_ge_u32 s2, 18
  s_cbranch_scc1 mega_U
  s_mul_hi_u32 s22, s2, 715827883
  s_mul_i32 s23, s22, 6
  s_sub_u32 s23, s2, s23
  s_sub_u32 s22, 2, s22
  s_sub_u32 s20, s8, 4
  s_mul_i32 s20, s20, 6
  s_add_u32 s23, s23, s20
  s_mul_i32 s30, s22, 24
  s_add_u32 s30, s30, s23
  s_lshl_b32 s30, s30, 7
  s_add_u32 s30, s30, 83968
  s_cmp_eq_u32 s22, 2
  s_cselect_b32 s24, 26624, 0
  s_add_u32 s30, s30, s24
  s_lshl_b32 s24, s22, 3
  s_add_u32 s24, s24, 16
  s_load_dwordx2 s[32:33], s[0:1], s24
  s_lshl_b32 s25, s23, 2
  s_add_u32 s25, s25, s3
  s_lshl_b32 s26, s25, 7
  s_mul_hi_u32 s27, s25, 1431655766
  s_mul_i32 s28, s27, 3
  s_sub_u32 s28, s25, s28
  s_mul_i32 s27, s27, 12288
  s_lshl_b32 s28, s28, 11
  s_add_u32 s27, s27, s28
  s_mul_i32 s28, s22, 25165824
  s_add_u32 s27, s27, s28
  s_add_u32 s27, s27, 6291456
  s_waitcnt lgkmcnt(0)
  s_add_u32 s32, s32, s26
  s_addc_u32 s33, s33, 0
  s_mov_b32 s34, s27
  s_add_u32 s35, s28, 31457280
  s_add_u32 s36, s4, 3145728
  s_addc_u32 s37, s5, 0
  s_mov_b32 s16, 64
  v_lshlrev_b32 v2, 4, v0
  s_mul_i32 s18, s3, 10240
  v_add_u32 v3, s18, v2
  s_mov_b32 s19, 0
  s_mul_i32 s12, s3, 24576
  s_add_u32 s12, s12, 65536
  v_lshrrev_b32 v7, 3, v0
  s_mov_b32 s13, 12288
  v_mul_lo_u32 v4, v7, s13
  v_lshlrev_b32 v7, 1, v7
  v_and_b32 v7, 4, v7
  v_and_b32 v5, 7, v0
  v_xor_b32 v7, v7, v5
  v_lshl_add_u32 v4, v7, 4, v4
  v_lshrrev_b32 v7, 4, v0
  v_lshlrev_b32 v5, 10, v7
  v_bfe_u32 v7, v0, 2, 2
  v_lshl_add_u32 v5, v7, 7, v5
  v_lshlrev_b32 v7, 1, v7
  v_and_b32 v7, 4, v7
  v_and_b32 v6, 3, v0
  v_add_u32 v7, v7, v6
  v_lshl_add_u32 v5, v7, 4, v5
  v_xor_b32 v6, 64, v5
  v_add_u32 v5, s12, v5
  v_add_u32 v6, s12, v6
  s_add_u32 m0, s12, 0
  s_nop 0
  global_load_lds_dwordx4 v4, s[32:33]
  s_add_u32 s32, s32, 98304
  s_addc_u32 s33, s33, 0
  s_add_u32 m0, s12, 1024
  s_nop 0
  global_load_lds_dwordx4 v4, s[32:33]
  s_add_u32 s32, s32, 98304
  s_addc_u32 s33, s33, 0
  s_add_u32 m0, s12, 2048
  s_nop 0
  global_load_lds_dwordx4 v4, s[32:33]
  s_add_u32 s32, s32, 98304
  s_addc_u32 s33, s33, 0
  s_add_u32 m0, s12, 3072
  s_nop 0
  global_load_lds_dwordx4 v4, s[32:33]
  s_add_u32 s32, s32, 98304
  s_addc_u32 s33, s33, 0
  s_add_u32 m0, s12, 4096
  s_nop 0
  global_load_lds_dwordx4 v4, s[32:33]
  s_add_u32 s32, s32, 98304
  s_addc_u32 s33, s33, 0
  s_add_u32 m0, s12, 5120
  s_nop 0
  global_load_lds_dwordx4 v4, s[32:33]
  s_add_u32 s32, s32, 98304
  s_addc_u32 s33, s33, 0
  s_add_u32 m0, s12, 6144
  s_nop 0
  global_load_lds_dwordx4 v4, s[32:33]
  s_add_u32 s32, s32, 98304
  s_addc_u32 s33, s33, 0
  s_add_u32 m0, s12, 7168
  s_nop 0
  global_load_lds_dwordx4 v4, s[32:33]
  s_add_u32 s32, s32, 98304
  s_addc_u32 s33, s33, 0
  s_add_u32 m0, s12, 8192
  s_nop 0
  global_load_lds_dwordx4 v4, s[32:33]
  s_add_u32 s32, s32, 98304
  s_addc_u32 s33, s33, 0
  s_add_u32 m0, s12, 9216
  s_nop 0
  global_load_lds_dwordx4 v4, s[32:33]
  s_add_u32 s32, s32, 98304
  s_addc_u32 s33, s33, 0
  s_add_u32 m0, s12, 10240
  s_nop 0
  global_load_lds_dwordx4 v4, s[32:33]
  s_add_u32 s32, s32, 98304
  s_addc_u32 s33, s33, 0
  s_add_u32 m0, s12, 11264
  s_nop 0
  global_load_lds_dwordx4 v4, s[32:33]
  s_add_u32 s32, s32, 98304
  s_addc_u32 s33, s33, 0
  s_add_u32 m0, s12, 12288
  s_nop 0
  global_load_lds_dwordx4 v4, s[32:33]
  s_add_u32 s32, s32, 98304
  s_addc_u32 s33, s33, 0
  s_add_u32 m0, s12, 13312
  s_nop 0
  global_load_lds_dwordx4 v4, s[32:33]
  s_add_u32 s32, s32, 98304
  s_addc_u32 s33, s33, 0
  s_add_u32 m0, s12, 14336
  s_nop 0
  global_load_lds_dwordx4 v4, s[32:33]
  s_add_u32 s32, s32, 98304
  s_addc_u32 s33, s33, 0
  s_add_u32 m0, s12, 15360
  s_nop 0
  global_load_lds_dwordx4 v4, s[32:33]
  s_add_u32 s32, s32, 98304
  s_addc_u32 s33, s33, 0
  s_add_u32 m0, s12, 16384
  s_nop 0
  global_load_lds_dwordx4 v4, s[32:33]
  s_add_u32 s32, s32, 98304
  s_addc_u32 s33, s33, 0
  s_add_u32 m0, s12, 17408
  s_nop 0
  global_load_lds_dwordx4 v4, s[32:33]
  s_add_u32 s32, s32, 98304
  s_addc_u32 s33, s33, 0
  s_add_u32 m0, s12, 18432
  s_nop 0
  global_load_lds_dwordx4 v4, s[32:33]
  s_add_u32 s32, s32, 98304
  s_addc_u32 s33, s33, 0
  s_add_u32 m0, s12, 19456
  s_nop 0
  global_load_lds_dwordx4 v4, s[32:33]
  s_add_u32 s32, s32, 98304
  s_addc_u32 s33, s33, 0
  s_add_u32 m0, s12, 20480
  s_nop 0
  global_load_lds_dwordx4 v4, s[32:33]
  s_add_u32 s32, s32, 98304
  s_addc_u32 s33, s33, 0
  s_add_u32 m0, s12, 21504
  s_nop 0
  global_load_lds_dwordx4 v4, s[32:33]
  s_add_u32 s32, s32, 98304
  s_addc_u32 s33, s33, 0
  s_add_u32 m0, s12, 22528
  s_nop 0
  global_load_lds_dwordx4 v4, s[32:33]
  s_add_u32 s32, s32, 98304
  s_addc_u32 s33, s33, 0
  s_add_u32 m0, s12, 23552
  s_nop 0
  global_load_lds_dwordx4 v4, s[32:33]
  s_add_u32 s32, s32, 98304
  s_addc_u32 s33, s33, 0
  s_waitcnt vmcnt(16)
  ds_read_b64_tr_b16 a[0:1], v5 offset:0
  ds_read_b64_tr_b16 a[2:3], v5 offset:512
  ds_read_b64_tr_b16 a[4:5], v5 offset:8
  ds_read_b64_tr_b16 a[6:7], v5 offset:520
  ds_read_b64_tr_b16 a[8:9], v6 offset:0
  ds_read_b64_tr_b16 a[10:11], v6 offset:512
  ds_read_b64_tr_b16 a[12:13], v6 offset:8
  ds_read_b64_tr_b16 a[14:15], v6 offset:520
  ds_read_b64_tr_b16 a[16:17], v5 offset:4096
  ds_read_b64_tr_b16 a[18:19], v5 offset:4608
  ds_read_b64_tr_b16 a[20:21], v5 offset:4104
  ds_read_b64_tr_b16 a[22:23], v5 offset:4616
  ds_read_b64_tr_b16 a[24:25], v6 offset:4096
  ds_read_b64_tr_b16 a[26:27], v6 offset:4608
  ds_read_b64_tr_b16 a[28:29], v6 offset:4104
  ds_read_b64_tr_b16 a[30:31], v6 offset:4616
  s_waitcnt lgkmcnt(0)
  s_add_u32 m0, s12, 0
  s_nop 0
  global_load_lds_dwordx4 v4, s[32:33]
  s_add_u32 s32, s32, 98304
  s_addc_u32 s33, s33, 0
  s_add_u32 m0, s12, 1024
  s_nop 0
  global_load_lds_dwordx4 v4, s[32:33]
  s_add_u32 s32, s32, 98304
  s_addc_u32 s33, s33, 0
  s_add_u32 m0, s12, 2048
  s_nop 0
  global_load_lds_dwordx4 v4, s[32:33]
  s_add_u32 s32, s32, 98304
  s_addc_u32 s33, s33, 0
  s_add_u32 m0, s12, 3072
  s_nop 0
  global_load_lds_dwordx4 v4, s[32:33]
  s_add_u32 s32, s32, 98304
  s_addc_u32 s33, s33, 0
  s_add_u32 m0, s12, 4096
  s_nop 0
  global_load_lds_dwordx4 v4, s[32:33]
  s_add_u32 s32, s32, 98304
  s_addc_u32 s33, s33, 0
  s_add_u32 m0, s12, 5120
  s_nop 0
  global_load_lds_dwordx4 v4, s[32:33]
  s_add_u32 s32, s32, 98304
  s_addc_u32 s33, s33, 0
  s_add_u32 m0, s12, 6144
  s_nop 0
  global_load_lds_dwordx4 v4, s[32:33]
  s_add_u32 s32, s32, 98304
  s_addc_u32 s33, s33, 0
  s_add_u32 m0, s12, 7168
  s_nop 0
  global_load_lds_dwordx4 v4, s[32:33]
  s_add_u32 s32, s32, 98304
  s_addc_u32 s33, s33, 0
  s_waitcnt vmcnt(16)
  ds_read_b64_tr_b16 a[32:33], v5 offset:8192
  ds_read_b64_tr_b16 a[34:35], v5 offset:8704
  ds_read_b64_tr_b16 a[36:37], v5 offset:8200
  ds_read_b64_tr_b16 a[38:39], v5 offset:8712
  ds_read_b64_tr_b16 a[40:41], v6 offset:8192
  ds_read_b64_tr_b16 a[42:43], v6 offset:8704
  ds_read_b64_tr_b16 a[44:45], v6 offset:8200
  ds_read_b64_tr_b16 a[46:47], v6 offset:8712
  ds_read_b64_tr_b16 a[48:49], v5 offset:12288
  ds_read_b64_tr_b16 a[50:51], v5 offset:12800
  ds_read_b64_tr_b16 a[52:53], v5 offset:12296
  ds_read_b64_tr_b16 a[54:55], v5 offset:12808
  ds_read_b64_tr_b16 a[56:57], v6 offset:12288
  ds_read_b64_tr_b16 a[58:59], v6 offset:12800
  ds_read_b64_tr_b16 a[60:61], v6 offset:12296
  ds_read_b64_tr_b16 a[62:63], v6 offset:12808
  s_waitcnt lgkmcnt(0)
  s_add_u32 m0, s12, 8192
  s_nop 0
  global_load_lds_dwordx4 v4, s[32:33]
  s_add_u32 s32, s32, 98304
  s_addc_u32 s33, s33, 0
  s_add_u32 m0, s12, 9216
  s_nop 0
  global_load_lds_dwordx4 v4, s[32:33]
  s_add_u32 s32, s32, 98304
  s_addc_u32 s33, s33, 0
  s_add_u32 m0, s12, 10240
  s_nop 0
  global_load_lds_dwordx4 v4, s[32:33]
  s_add_u32 s32, s32, 98304
  s_addc_u32 s33, s33, 0
  s_add_u32 m0, s12, 11264
  s_nop 0
  global_load_lds_dwordx4 v4, s[32:33]
  s_add_u32 s32, s32, 98304
  s_addc_u32 s33, s33, 0
  s_add_u32 m0, s12, 12288
  s_nop 0
  global_load_lds_dwordx4 v4, s[32:33]
  s_add_u32 s32, s32, 98304
  s_addc_u32 s33, s33, 0
  s_add_u32 m0, s12, 13312
  s_nop 0
  global_load_lds_dwordx4 v4, s[32:33]
  s_add_u32 s32, s32, 98304
  s_addc_u32 s33, s33, 0
  s_add_u32 m0, s12, 14336
  s_nop 0
  global_load_lds_dwordx4 v4, s[32:33]
  s_add_u32 s32, s32, 98304
  s_addc_u32 s33, s33, 0
  s_add_u32 m0, s12, 15360
  s_nop 0
  global_load_lds_dwordx4 v4, s[32:33]
  s_add_u32 s32, s32, 98304
  s_addc_u32 s33, s33, 0
  s_waitcnt vmcnt(16)
  ds_read_b64_tr_b16 a[64:65], v5 offset:16384
  ds_read_b64_tr_b16 a[66:67], v5 offset:16896
  ds_read_b64_tr_b16 a[68:69], v5 offset:16392
  ds_read_b64_tr_b16 a[70:71], v5 offset:16904
  ds_read_b64_tr_b16 a[72:73], v6 offset:16384
  ds_read_b64_tr_b16 a[74:75], v6 offset:16896
  ds_read_b64_tr_b16 a[76:77], v6 offset:16392
  ds_read_b64_tr_b16 a[78:79], v6 offset:16904
  ds_read_b64_tr_b16 a[80:81], v5 offset:20480
  ds_read_b64_tr_b16 a[82:83], v5 offset:20992
  ds_read_b64_tr_b16 a[84:85], v5 offset:20488
  ds_read_b64_tr_b16 a[86:87], v5 offset:21000
  ds_read_b64_tr_b16 a[88:89], v6 offset:20480
  ds_read_b64_tr_b16 a[90:91], v6 offset:20992
  ds_read_b64_tr_b16 a[92:93], v6 offset:20488
  ds_read_b64_tr_b16 a[94:95], v6 offset:21000
  s_waitcnt lgkmcnt(0)
  s_add_u32 m0, s12, 16384
  s_nop 0
  global_load_lds_dwordx4 v4, s[32:33]
  s_add_u32 s32, s32, 98304
  s_addc_u32 s33, s33, 0
  s_add_u32 m0, s12, 17408
  s_nop 0
  global_load_lds_dwordx4 v4, s[32:33]
  s_add_u32 s32, s32, 98304
  s_addc_u32 s33, s33, 0
  s_add_u32 m0, s12, 18432
  s_nop 0
  global_load_lds_dwordx4 v4, s[32:33]
  s_add_u32 s32, s32, 98304
  s_addc_u32 s33, s33, 0
  s_add_u32 m0, s12, 19456
  s_nop 0
  global_load_lds_dwordx4 v4, s[32:33]
  s_add_u32 s32, s32, 98304
  s_addc_u32 s33, s33, 0
  s_add_u32 m0, s12, 20480
  s_nop 0
  global_load_lds_dwordx4 v4, s[32:33]
  s_add_u32 s32, s32, 98304
  s_addc_u32 s33, s33, 0
  s_add_u32 m0, s12, 21504
  s_nop 0
  global_load_lds_dwordx4 v4, s[32:33]
  s_add_u32 s32, s32, 98304
  s_addc_u32 s33, s33, 0
  s_add_u32 m0, s12, 22528
  s_nop 0
  global_load_lds_dwordx4 v4, s[32:33]
  s_add_u32 s32, s32, 98304
  s_addc_u32 s33, s33, 0
  s_add_u32 m0, s12, 23552
  s_nop 0
  global_load_lds_dwordx4 v4, s[32:33]
  s_add_u32 s32, s32, 98304
  s_addc_u32 s33, s33, 0
  s_waitcnt vmcnt(16)
  ds_read_b64_tr_b16 a[96:97], v5 offset:0
  ds_read_b64_tr_b16 a[98:99], v5 offset:512
  ds_read_b64_tr_b16 a[100:101], v5 offset:8
  ds_read_b64_tr_b16 a[102:103], v5 offset:520
  ds_read_b64_tr_b16 a[104:105], v6 offset:0
  ds_read_b64_tr_b16 a[106:107], v6 offset:512
  ds_read_b64_tr_b16 a[108:109], v6 offset:8
  ds_read_b64_tr_b16 a[110:111], v6 offset:520
  ds_read_b64_tr_b16 a[112:113], v5 offset:4096
  ds_read_b64_tr_b16 a[114:115], v5 offset:4608
  ds_read_b64_tr_b16 a[116:117], v5 offset:4104
  ds_read_b64_tr_b16 a[118:119], v5 offset:4616
  ds_read_b64_tr_b16 a[120:121], v6 offset:4096
  ds_read_b64_tr_b16 a[122:123], v6 offset:4608
  ds_read_b64_tr_b16 a[124:125], v6 offset:4104
  ds_read_b64_tr_b16 a[126:127], v6 offset:4616
  v_lshrrev_b32 v16, 2, v2
  v_mov_b32 v17, 0
  s_mov_b32 exec_lo, 0x00030003
  s_mov_b32 exec_hi, 0x00030003
  v_mov_b32 v17, 32
  s_mov_b32 exec_lo, 0x00100010
  s_mov_b32 exec_hi, 0x00100010
  v_mov_b32 v17, 64
  s_mov_b64 exec, 4
  v_mov_b32 v17, 56
  s_mov_b32 exec_lo, 0
  s_mov_b32 exec_hi, 4
  v_mov_b32 v17, 268435456
  s_mov_b64 exec, -1
  global_load_dword v18, v16, s[90:91] sc1
  s_waitcnt lgkmcnt(0)
  s_add_u32 m0, s12, 0
  s_nop 0
  global_load_lds_dwordx4 v4, s[32:33]
  s_add_u32 s32, s32, 98304
  s_addc_u32 s33, s33, 0
  s_add_u32 m0, s12, 1024
  s_nop 0
  global_load_lds_dwordx4 v4, s[32:33]
  s_add_u32 s32, s32, 98304
  s_addc_u32 s33, s33, 0
  s_add_u32 m0, s12, 2048
  s_nop 0
  global_load_lds_dwordx4 v4, s[32:33]
  s_add_u32 s32, s32, 98304
  s_addc_u32 s33, s33, 0
  s_add_u32 m0, s12, 3072
  s_nop 0
  global_load_lds_dwordx4 v4, s[32:33]
  s_add_u32 s32, s32, 98304
  s_addc_u32 s33, s33, 0
  s_add_u32 m0, s12, 4096
  s_nop 0
  global_load_lds_dwordx4 v4, s[32:33]
  s_add_u32 s32, s32, 98304
  s_addc_u32 s33, s33, 0
  s_add_u32 m0, s12, 5120
  s_nop 0
  global_load_lds_dwordx4 v4, s[32:33]
  s_add_u32 s32, s32, 98304
  s_addc_u32 s33, s33, 0
  s_add_u32 m0, s12, 6144
  s_nop 0
  global_load_lds_dwordx4 v4, s[32:33]
  s_add_u32 s32, s32, 98304
  s_addc_u32 s33, s33, 0
  s_add_u32 m0, s12, 7168
  s_nop 0
  global_load_lds_dwordx4 v4, s[32:33]
  s_add_u32 s32, s32, 98304
  s_addc_u32 s33, s33, 0
  s_waitcnt vmcnt(16)
  ds_read_b64_tr_b16 a[128:129], v5 offset:8192
  ds_read_b64_tr_b16 a[130:131], v5 offset:8704
  ds_read_b64_tr_b16 a[132:133], v5 offset:8200
  ds_read_b64_tr_b16 a[134:135], v5 offset:8712
  ds_read_b64_tr_b16 a[136:137], v6 offset:8192
  ds_read_b64_tr_b16 a[138:139], v6 offset:8704
  ds_read_b64_tr_b16 a[140:141], v6 offset:8200
  ds_read_b64_tr_b16 a[142:143], v6 offset:8712
  ds_read_b64_tr_b16 a[144:145], v5 offset:12288
  ds_read_b64_tr_b16 a[146:147], v5 offset:12800
  ds_read_b64_tr_b16 a[148:149], v5 offset:12296
  ds_read_b64_tr_b16 a[150:151], v5 offset:12808
  ds_read_b64_tr_b16 a[152:153], v6 offset:12288
  ds_read_b64_tr_b16 a[154:155], v6 offset:12800
  ds_read_b64_tr_b16 a[156:157], v6 offset:12296
  ds_read_b64_tr_b16 a[158:159], v6 offset:12808
  s_waitcnt lgkmcnt(0)
  s_add_u32 m0, s12, 8192
  s_nop 0
  global_load_lds_dwordx4 v4, s[32:33]
  s_add_u32 s32, s32, 98304
  s_addc_u32 s33, s33, 0
  s_add_u32 m0, s12, 9216
  s_nop 0
  global_load_lds_dwordx4 v4, s[32:33]
  s_add_u32 s32, s32, 98304
  s_addc_u32 s33, s33, 0
  s_add_u32 m0, s12, 10240
  s_nop 0
  global_load_lds_dwordx4 v4, s[32:33]
  s_add_u32 s32, s32, 98304
  s_addc_u32 s33, s33, 0
  s_add_u32 m0, s12, 11264
  s_nop 0
  global_load_lds_dwordx4 v4, s[32:33]
  s_add_u32 s32, s32, 98304
  s_addc_u32 s33, s33, 0
  s_add_u32 m0, s12, 12288
  s_nop 0
  global_load_lds_dwordx4 v4, s[32:33]
  s_add_u32 s32, s32, 98304
  s_addc_u32 s33, s33, 0
  s_add_u32 m0, s12, 13312
  s_nop 0
  global_load_lds_dwordx4 v4, s[32:33]
  s_add_u32 s32, s32, 98304
  s_addc_u32 s33, s33, 0
  s_add_u32 m0, s12, 14336
  s_nop 0
  global_load_lds_dwordx4 v4, s[32:33]
  s_add_u32 s32, s32, 98304
  s_addc_u32 s33, s33, 0
  s_add_u32 m0, s12, 15360
  s_nop 0
  global_load_lds_dwordx4 v4, s[32:33]
  s_add_u32 s32, s32, 98304
  s_addc_u32 s33, s33, 0
  s_waitcnt vmcnt(16)
  ds_read_b64_tr_b16 a[160:161], v5 offset:16384
  ds_read_b64_tr_b16 a[162:163], v5 offset:16896
  ds_read_b64_tr_b16 a[164:165], v5 offset:16392
  ds_read_b64_tr_b16 a[166:167], v5 offset:16904
  ds_read_b64_tr_b16 a[168:169], v6 offset:16384
  ds_read_b64_tr_b16 a[170:171], v6 offset:16896
  ds_read_b64_tr_b16 a[172:173], v6 offset:16392
  ds_read_b64_tr_b16 a[174:175], v6 offset:16904
  ds_read_b64_tr_b16 a[176:177], v5 offset:20480
  ds_read_b64_tr_b16 a[178:179], v5 offset:20992
  ds_read_b64_tr_b16 a[180:181], v5 offset:20488
  ds_read_b64_tr_b16 a[182:183], v5 offset:21000
  ds_read_b64_tr_b16 a[184:185], v6 offset:20480
  ds_read_b64_tr_b16 a[186:187], v6 offset:20992
  ds_read_b64_tr_b16 a[188:189], v6 offset:20488
  ds_read_b64_tr_b16 a[190:191], v6 offset:21000
  s_waitcnt lgkmcnt(0)
  s_add_u32 m0, s12, 16384
  s_nop 0
  global_load_lds_dwordx4 v4, s[32:33]
  s_add_u32 s32, s32, 98304
  s_addc_u32 s33, s33, 0
  s_add_u32 m0, s12, 17408
  s_nop 0
  global_load_lds_dwordx4 v4, s[32:33]
  s_add_u32 s32, s32, 98304
  s_addc_u32 s33, s33, 0
  s_add_u32 m0, s12, 18432
  s_nop 0
  global_load_lds_dwordx4 v4, s[32:33]
  s_add_u32 s32, s32, 98304
  s_addc_u32 s33, s33, 0
  s_add_u32 m0, s12, 19456
  s_nop 0
  global_load_lds_dwordx4 v4, s[32:33]
  s_add_u32 s32, s32, 98304
  s_addc_u32 s33, s33, 0
  s_add_u32 m0, s12, 20480
  s_nop 0
  global_load_lds_dwordx4 v4, s[32:33]
  s_add_u32 s32, s32, 98304
  s_addc_u32 s33, s33, 0
  s_add_u32 m0, s12, 21504
  s_nop 0
  global_load_lds_dwordx4 v4, s[32:33]
  s_add_u32 s32, s32, 98304
  s_addc_u32 s33, s33, 0
  s_add_u32 m0, s12, 22528
  s_nop 0
  global_load_lds_dwordx4 v4, s[32:33]
  s_add_u32 s32, s32, 98304
  s_addc_u32 s33, s33, 0
  s_add_u32 m0, s12, 23552
  s_nop 0
  global_load_lds_dwordx4 v4, s[32:33]
  s_add_u32 s32, s32, 98304
  s_addc_u32 s33, s33, 0
  s_waitcnt vmcnt(16)
  ds_read_b64_tr_b16 a[192:193], v5 offset:0
  ds_read_b64_tr_b16 a[194:195], v5 offset:512
  ds_read_b64_tr_b16 a[196:197], v5 offset:8
  ds_read_b64_tr_b16 a[198:199], v5 offset:520
  ds_read_b64_tr_b16 a[200:201], v6 offset:0
  ds_read_b64_tr_b16 a[202:203], v6 offset:512
  ds_read_b64_tr_b16 a[204:205], v6 offset:8
  ds_read_b64_tr_b16 a[206:207], v6 offset:520
  ds_read_b64_tr_b16 a[208:209], v5 offset:4096
  ds_read_b64_tr_b16 a[210:211], v5 offset:4608
  ds_read_b64_tr_b16 a[212:213], v5 offset:4104
  ds_read_b64_tr_b16 a[214:215], v5 offset:4616
  ds_read_b64_tr_b16 a[216:217], v6 offset:4096
  ds_read_b64_tr_b16 a[218:219], v6 offset:4608
  ds_read_b64_tr_b16 a[220:221], v6 offset:4104
  ds_read_b64_tr_b16 a[222:223], v6 offset:4616
  s_waitcnt lgkmcnt(0)
  s_add_u32 m0, s12, 0
  s_nop 0
  global_load_lds_dwordx4 v4, s[32:33]
  s_add_u32 s32, s32, 98304
  s_addc_u32 s33, s33, 0
  s_add_u32 m0, s12, 1024
  s_nop 0
  global_load_lds_dwordx4 v4, s[32:33]
  s_add_u32 s32, s32, 98304
  s_addc_u32 s33, s33, 0
  s_add_u32 m0, s12, 2048
  s_nop 0
  global_load_lds_dwordx4 v4, s[32:33]
  s_add_u32 s32, s32, 98304
  s_addc_u32 s33, s33, 0
  s_add_u32 m0, s12, 3072
  s_nop 0
  global_load_lds_dwordx4 v4, s[32:33]
  s_add_u32 s32, s32, 98304
  s_addc_u32 s33, s33, 0
  s_add_u32 m0, s12, 4096
  s_nop 0
  global_load_lds_dwordx4 v4, s[32:33]
  s_add_u32 s32, s32, 98304
  s_addc_u32 s33, s33, 0
  s_add_u32 m0, s12, 5120
  s_nop 0
  global_load_lds_dwordx4 v4, s[32:33]
  s_add_u32 s32, s32, 98304
  s_addc_u32 s33, s33, 0
  s_add_u32 m0, s12, 6144
  s_nop 0
  global_load_lds_dwordx4 v4, s[32:33]
  s_add_u32 s32, s32, 98304
  s_addc_u32 s33, s33, 0
  s_add_u32 m0, s12, 7168
  s_nop 0
  global_load_lds_dwordx4 v4, s[32:33]
  s_add_u32 s32, s32, 98304
  s_addc_u32 s33, s33, 0
  v_cmp_gt_u32 vcc, v17, v18
  s_cbranch_vccnz x0_3
  s_add_u32 m0, s18, 0
  s_nop 0
  global_load_lds_dwordx4 v3, s[36:37] offset:0
  global_load_lds_dwordx4 v3, s[36:37] offset:1024
  global_load_lds_dwordx4 v3, s[36:37] offset:2048
  global_load_lds_dwordx4 v3, s[36:37] offset:3072
  s_add_u32 s36, s36, 4096
  s_addc_u32 s37, s37, 0
  s_add_u32 m0, s18, 4096
  s_nop 0
  global_load_lds_dwordx4 v3, s[36:37] offset:0
  global_load_lds_dwordx4 v3, s[36:37] offset:1024
  global_load_lds_dwordx4 v3, s[36:37] offset:2048
  global_load_lds_dwordx4 v3, s[36:37] offset:3072
  s_add_u32 s36, s36, 4096
  s_addc_u32 s37, s37, 0
  s_add_u32 m0, s18, 8192
  s_nop 0
  global_load_lds_dwordx4 v3, s[36:37] offset:0
  global_load_lds_dwordx4 v3, s[36:37] offset:1024
  s_add_u32 s36, s36, 32768
  s_addc_u32 s37, s37, 0
  s_mov_b32 s19, 1
x0_3:
  s_waitcnt vmcnt(16)
  ds_read_b64_tr_b16 a[224:225], v5 offset:8192
  ds_read_b64_tr_b16 a[226:227], v5 offset:8704
  ds_read_b64_tr_b16 a[228:229], v5 offset:8200
  ds_read_b64_tr_b16 a[230:231], v5 offset:8712
  ds_read_b64_tr_b16 a[232:233], v6 offset:8192
  ds_read_b64_tr_b16 a[234:235], v6 offset:8704
  ds_read_b64_tr_b16 a[236:237], v6 offset:8200
  ds_read_b64_tr_b16 a[238:239], v6 offset:8712
  ds_read_b64_tr_b16 a[240:241], v5 offset:12288
  ds_read_b64_tr_b16 a[242:243], v5 offset:12800
  ds_read_b64_tr_b16 a[244:245], v5 offset:12296
  ds_read_b64_tr_b16 a[246:247], v5 offset:12808
  ds_read_b64_tr_b16 a[248:249], v6 offset:12288
  ds_read_b64_tr_b16 a[250:251], v6 offset:12800
  ds_read_b64_tr_b16 a[252:253], v6 offset:12296
  ds_read_b64_tr_b16 a[254:255], v6 offset:12808
  s_waitcnt vmcnt(8)
  ds_read_b64_tr_b16 v[192:193], v5 offset:16384
  ds_read_b64_tr_b16 v[194:195], v5 offset:16896
  ds_read_b64_tr_b16 v[196:197], v5 offset:16392
  ds_read_b64_tr_b16 v[198:199], v5 offset:16904
  ds_read_b64_tr_b16 v[200:201], v6 offset:16384
  ds_read_b64_tr_b16 v[202:203], v6 offset:16896
  ds_read_b64_tr_b16 v[204:205], v6 offset:16392
  ds_read_b64_tr_b16 v[206:207], v6 offset:16904
  ds_read_b64_tr_b16 v[208:209], v5 offset:20480
  ds_read_b64_tr_b16 v[210:211], v5 offset:20992
  ds_read_b64_tr_b16 v[212:213], v5 offset:20488
  ds_read_b64_tr_b16 v[214:215], v5 offset:21000
  ds_read_b64_tr_b16 v[216:217], v6 offset:20480
  ds_read_b64_tr_b16 v[218:219], v6 offset:20992
  ds_read_b64_tr_b16 v[220:221], v6 offset:20488
  ds_read_b64_tr_b16 v[222:223], v6 offset:21000
  s_waitcnt vmcnt(0)
  ds_read_b64_tr_b16 v[224:225], v5 offset:0
  ds_read_b64_tr_b16 v[226:227], v5 offset:512
  ds_read_b64_tr_b16 v[228:229], v5 offset:8
  ds_read_b64_tr_b16 v[230:231], v5 offset:520
  ds_read_b64_tr_b16 v[232:233], v6 offset:0
  ds_read_b64_tr_b16 v[234:235], v6 offset:512
  ds_read_b64_tr_b16 v[236:237], v6 offset:8
  ds_read_b64_tr_b16 v[238:239], v6 offset:520
  ds_read_b64_tr_b16 v[240:241], v5 offset:4096
  ds_read_b64_tr_b16 v[242:243], v5 offset:4608
  ds_read_b64_tr_b16 v[244:245], v5 offset:4104
  ds_read_b64_tr_b16 v[246:247], v5 offset:4616
  ds_read_b64_tr_b16 v[248:249], v6 offset:4096
  ds_read_b64_tr_b16 v[250:251], v6 offset:4608
  ds_read_b64_tr_b16 v[252:253], v6 offset:4104
  ds_read_b64_tr_b16 v[254:255], v6 offset:4616
  s_waitcnt lgkmcnt(0)
  s_cmp_lg_u32 s19, 0
  s_cbranch_scc1 proj_x0
  v_lshrrev_b32 v16, 2, v2
  v_mov_b32 v17, 0
  s_mov_b32 exec_lo, 0x00030003
  s_mov_b32 exec_hi, 0x00030003
  v_mov_b32 v17, 32
  s_mov_b32 exec_lo, 0x00100010
  s_mov_b32 exec_hi, 0x00100010
  v_mov_b32 v17, 64
  s_mov_b64 exec, 4
  v_mov_b32 v17, 56
  s_mov_b32 exec_lo, 0
  s_mov_b32 exec_hi, 4
  v_mov_b32 v17, 268435456
  s_mov_b64 exec, -1
  s_branch isync_5
isync_4:
  s_sleep 4
  s_add_u32 s11, s11, 1
  s_cmp_gt_u32 s11, 131072
  s_cbranch_scc1 mega_done
isync_5:
  global_load_dword v18, v16, s[90:91] sc1
  s_waitcnt vmcnt(0)
  v_cmp_gt_u32 vcc, v17, v18
  s_cbranch_vccnz isync_4
  v_readlane_b32 s66, v18, 34
  s_nop 0
  s_cmp_lt_u32 s66, 268468224
  s_cselect_b32 s66, 0, 8192
  s_add_u32 m0, s18, 0
  s_nop 0
  global_load_lds_dwordx4 v3, s[36:37] offset:0
  global_load_lds_dwordx4 v3, s[36:37] offset:1024
  global_load_lds_dwordx4 v3, s[36:37] offset:2048
  global_load_lds_dwordx4 v3, s[36:37] offset:3072
  s_add_u32 s36, s36, 4096
  s_addc_u32 s37, s37, 0
  s_add_u32 m0, s18, 4096
  s_nop 0
  global_load_lds_dwordx4 v3, s[36:37] offset:0
  global_load_lds_dwordx4 v3, s[36:37] offset:1024
  global_load_lds_dwordx4 v3, s[36:37] offset:2048
  global_load_lds_dwordx4 v3, s[36:37] offset:3072
  s_add_u32 s36, s36, 4096
  s_addc_u32 s37, s37, 0
  s_add_u32 m0, s18, 8192
  s_nop 0
  global_load_lds_dwordx4 v3, s[36:37] offset:0
  global_load_lds_dwordx4 v3, s[36:37] offset:1024
  s_add_u32 s36, s36, 32768
  s_addc_u32 s37, s37, 0
proj_x0:
  v_readlane_b32 s66, v18, 34
  s_nop 0
  s_cmp_lt_u32 s66, 268468224
  s_cselect_b32 s66, 0, 8192
  s_add_u32 s30, s30, s66
  v_lshlrev_b32 v9, 4, v0
  s_mul_i32 s12, s3, 10240
  v_add_u32 v8, s12, v9
  v_add_u32 v10, 40960, v9
  s_barrier
  s_add_u32 s12, s12, 40960
  s_add_u32 m0, s12, 0
  s_nop 0
  global_load_lds_dwordx4 v8, s[36:37] offset:0
  global_load_lds_dwordx4 v8, s[36:37] offset:1024
  global_load_lds_dwordx4 v8, s[36:37] offset:2048
  global_load_lds_dwordx4 v8, s[36:37] offset:3072
  s_add_u32 s36, s36, 4096
  s_addc_u32 s37, s37, 0
  s_add_u32 m0, s12, 4096
  s_nop 0
  global_load_lds_dwordx4 v8, s[36:37] offset:0
  global_load_lds_dwordx4 v8, s[36:37] offset:1024
  global_load_lds_dwordx4 v8, s[36:37] offset:2048
  global_load_lds_dwordx4 v8, s[36:37] offset:3072
  s_add_u32 s36, s36, 4096
  s_addc_u32 s37, s37, 0
  s_add_u32 m0, s12, 8192
  s_nop 0
  global_load_lds_dwordx4 v8, s[36:37] offset:0
  global_load_lds_dwordx4 v8, s[36:37] offset:1024
  s_add_u32 s36, s36, 32768
  s_addc_u32 s37, s37, 0
  s_add_u32 s12, s12, 40960
  s_mov_b32 s13, 1
  s_waitcnt vmcnt(10)
  s_barrier
  ds_read_b128 v[64:67], v9 offset:0
  ds_read_b128 v[68:71], v9 offset:1024
  ds_read_b128 v[72:75], v9 offset:2048
  s_mov_b32 s14, 0
proj_loop:
  ds_read_b128 v[76:79], v9 offset:3072
  s_waitcnt lgkmcnt(3)
  v_mfma_f32_16x16x32_bf16 v[128:131], a[0:3], v[64:67], 0
  v_mfma_f32_16x16x32_bf16 v[132:135], a[4:7], v[64:67], 0
  v_mfma_f32_16x16x32_bf16 v[136:139], a[8:11], v[64:67], 0
  v_mfma_f32_16x16x32_bf16 v[140:143], a[12:15], v[64:67], 0
  ds_read_b128 v[64:67], v9 offset:4096
  s_waitcnt lgkmcnt(3)
  v_mfma_f32_16x16x32_bf16 v[128:131], a[16:19], v[68:71], v[128:131]
  v_mfma_f32_16x16x32_bf16 v[132:135], a[20:23], v[68:71], v[132:135]
  v_mfma_f32_16x16x32_bf16 v[136:139], a[24:27], v[68:71], v[136:139]
  v_cvt_pk_bf16_f32 v176, v144, v145
  v_mfma_f32_16x16x32_bf16 v[140:143], a[28:31], v[68:71], v[140:143]
  v_cvt_pk_bf16_f32 v177, v146, v147
  ds_read_b128 v[68:71], v9 offset:5120
  s_waitcnt lgkmcnt(3)
  v_mfma_f32_16x16x32_bf16 v[128:131], a[32:35], v[72:75], v[128:131]
  v_cvt_pk_bf16_f32 v178, v148, v149
  v_mfma_f32_16x16x32_bf16 v[132:135], a[36:39], v[72:75], v[132:135]
  v_cvt_pk_bf16_f32 v179, v150, v151
  v_mfma_f32_16x16x32_bf16 v[136:139], a[40:43], v[72:75], v[136:139]
  v_cvt_pk_bf16_f32 v180, v152, v153
  v_mfma_f32_16x16x32_bf16 v[140:143], a[44:47], v[72:75], v[140:143]
  v_cvt_pk_bf16_f32 v181, v154, v155
  ds_read_b128 v[72:75], v9 offset:6144
  s_waitcnt lgkmcnt(3)
  v_mfma_f32_16x16x32_bf16 v[128:131], a[48:51], v[76:79], v[128:131]
  v_cvt_pk_bf16_f32 v182, v156, v157
  v_mfma_f32_16x16x32_bf16 v[132:135], a[52:55], v[76:79], v[132:135]
  v_cvt_pk_bf16_f32 v183, v158, v159
  v_mfma_f32_16x16x32_bf16 v[136:139], a[56:59], v[76:79], v[136:139]
  s_cmp_eq_u32 s14, 0
  s_cbranch_scc1 skip_6
  s_add_u32 s34, s34, 6144
  buffer_store_dwordx4 v[176:179], v2, s[4:7], s34 offen sc1
skip_6:
  v_mfma_f32_16x16x32_bf16 v[140:143], a[60:63], v[76:79], v[140:143]
  ds_read_b128 v[76:79], v9 offset:7168
  s_waitcnt lgkmcnt(3)
  v_mfma_f32_16x16x32_bf16 v[128:131], a[64:67], v[64:67], v[128:131]
  v_mfma_f32_16x16x32_bf16 v[132:135], a[68:71], v[64:67], v[132:135]
  v_mfma_f32_16x16x32_bf16 v[136:139], a[72:75], v[64:67], v[136:139]
  v_mfma_f32_16x16x32_bf16 v[140:143], a[76:79], v[64:67], v[140:143]
  ds_read_b128 v[64:67], v9 offset:8192
  s_waitcnt lgkmcnt(3)
  v_mfma_f32_16x16x32_bf16 v[128:131], a[80:83], v[68:71], v[128:131]
  s_cmp_eq_u32 s14, 0
  s_cbranch_scc1 skip_7
  buffer_store_dwordx4 v[180:183], v2, s[4:7], s34 offen offset:1024 sc1
  s_add_u32 s34, s34, 387072
skip_7:
  v_mfma_f32_16x16x32_bf16 v[132:135], a[84:87], v[68:71], v[132:135]
  v_mfma_f32_16x16x32_bf16 v[136:139], a[88:91], v[68:71], v[136:139]
  v_mfma_f32_16x16x32_bf16 v[140:143], a[92:95], v[68:71], v[140:143]
  ds_read_b128 v[68:71], v9 offset:9216
  s_waitcnt lgkmcnt(3)
  v_mfma_f32_16x16x32_bf16 v[128:131], a[96:99], v[72:75], v[128:131]
  v_mfma_f32_16x16x32_bf16 v[132:135], a[100:103], v[72:75], v[132:135]
  v_mfma_f32_16x16x32_bf16 v[136:139], a[104:107], v[72:75], v[136:139]
  v_mfma_f32_16x16x32_bf16 v[140:143], a[108:111], v[72:75], v[140:143]
  ds_read_b128 v[72:75], v9 offset:10240
  s_waitcnt lgkmcnt(3)
  v_mfma_f32_16x16x32_bf16 v[128:131], a[112:115], v[76:79], v[128:131]
  v_mfma_f32_16x16x32_bf16 v[132:135], a[116:119], v[76:79], v[132:135]
  v_mfma_f32_16x16x32_bf16 v[136:139], a[120:123], v[76:79], v[136:139]
  v_mfma_f32_16x16x32_bf16 v[140:143], a[124:127], v[76:79], v[140:143]
  ds_read_b128 v[76:79], v9 offset:11264
  s_waitcnt lgkmcnt(3)
  v_mfma_f32_16x16x32_bf16 v[128:131], a[128:131], v[64:67], v[128:131]
  v_mfma_f32_16x16x32_bf16 v[132:135], a[132:135], v[64:67], v[132:135]
  v_mfma_f32_16x16x32_bf16 v[136:139], a[136:139], v[64:67], v[136:139]
  v_mfma_f32_16x16x32_bf16 v[140:143], a[140:143], v[64:67], v[140:143]
  ds_read_b128 v[64:67], v9 offset:12288
  s_waitcnt lgkmcnt(3)
  v_mfma_f32_16x16x32_bf16 v[128:131], a[144:147], v[68:71], v[128:131]
  v_mfma_f32_16x16x32_bf16 v[132:135], a[148:151], v[68:71], v[132:135]
  v_mfma_f32_16x16x32_bf16 v[136:139], a[152:155], v[68:71], v[136:139]
  v_mfma_f32_16x16x32_bf16 v[140:143], a[156:159], v[68:71], v[140:143]
  ds_read_b128 v[68:71], v9 offset:13312
  s_waitcnt lgkmcnt(3)
  v_mfma_f32_16x16x32_bf16 v[128:131], a[160:163], v[72:75], v[128:131]
  v_mfma_f32_16x16x32_bf16 v[132:135], a[164:167], v[72:75], v[132:135]
  v_mfma_f32_16x16x32_bf16 v[136:139], a[168:171], v[72:75], v[136:139]
  v_mfma_f32_16x16x32_bf16 v[140:143], a[172:175], v[72:75], v[140:143]
  ds_read_b128 v[72:75], v9 offset:14336
  s_waitcnt lgkmcnt(3)
  v_mfma_f32_16x16x32_bf16 v[128:131], a[176:179], v[76:79], v[128:131]
  v_mfma_f32_16x16x32_bf16 v[132:135], a[180:183], v[76:79], v[132:135]
  v_mfma_f32_16x16x32_bf16 v[136:139], a[184:187], v[76:79], v[136:139]
  v_mfma_f32_16x16x32_bf16 v[140:143], a[188:191], v[76:79], v[140:143]
  ds_read_b128 v[76:79], v9 offset:15360
  s_waitcnt lgkmcnt(3)
  v_mfma_f32_16x16x32_bf16 v[128:131], a[192:195], v[64:67], v[128:131]
  v_mfma_f32_16x16x32_bf16 v[132:135], a[196:199], v[64:67], v[132:135]
  v_mfma_f32_16x16x32_bf16 v[136:139], a[200:203], v[64:67], v[136:139]
  v_mfma_f32_16x16x32_bf16 v[140:143], a[204:207], v[64:67], v[140:143]
  ds_read_b128 v[64:67], v9 offset:16384
  s_waitcnt lgkmcnt(3)
  v_mfma_f32_16x16x32_bf16 v[128:131], a[208:211], v[68:71], v[128:131]
  v_mfma_f32_16x16x32_bf16 v[132:135], a[212:215], v[68:71], v[132:135]
  v_mfma_f32_16x16x32_bf16 v[136:139], a[216:219], v[68:71], v[136:139]
  v_mfma_f32_16x16x32_bf16 v[140:143], a[220:223], v[68:71], v[140:143]
  ds_read_b128 v[68:71], v9 offset:17408
  s_waitcnt lgkmcnt(3)
  v_mfma_f32_16x16x32_bf16 v[128:131], a[224:227], v[72:75], v[128:131]
  v_mfma_f32_16x16x32_bf16 v[132:135], a[228:231], v[72:75], v[132:135]
  v_mfma_f32_16x16x32_bf16 v[136:139], a[232:235], v[72:75], v[136:139]
  v_mfma_f32_16x16x32_bf16 v[140:143], a[236:239], v[72:75], v[140:143]
  ds_read_b128 v[72:75], v9 offset:18432
  s_waitcnt lgkmcnt(3)
  v_mfma_f32_16x16x32_bf16 v[128:131], a[240:243], v[76:79], v[128:131]
  v_mfma_f32_16x16x32_bf16 v[132:135], a[244:247], v[76:79], v[132:135]
  v_mfma_f32_16x16x32_bf16 v[136:139], a[248:251], v[76:79], v[136:139]
  v_mfma_f32_16x16x32_bf16 v[140:143], a[252:255], v[76:79], v[140:143]
  ds_read_b128 v[76:79], v9 offset:19456
  s_waitcnt lgkmcnt(3)
  v_mfma_f32_16x16x32_bf16 v[128:131], v[192:195], v[64:67], v[128:131]
  v_mfma_f32_16x16x32_bf16 v[132:135], v[196:199], v[64:67], v[132:135]
  v_mfma_f32_16x16x32_bf16 v[136:139], v[200:203], v[64:67], v[136:139]
  v_mfma_f32_16x16x32_bf16 v[140:143], v[204:207], v[64:67], v[140:143]
  ds_read_b128 v[64:67], v9 offset:20480
  s_waitcnt lgkmcnt(3)
  v_mfma_f32_16x16x32_bf16 v[128:131], v[208:211], v[68:71], v[128:131]
  v_mfma_f32_16x16x32_bf16 v[132:135], v[212:215], v[68:71], v[132:135]
  v_mfma_f32_16x16x32_bf16 v[136:139], v[216:219], v[68:71], v[136:139]
  v_mfma_f32_16x16x32_bf16 v[140:143], v[220:223], v[68:71], v[140:143]
  ds_read_b128 v[68:71], v9 offset:21504
  s_waitcnt lgkmcnt(3)
  v_mfma_f32_16x16x32_bf16 v[128:131], v[224:227], v[72:75], v[128:131]
  v_mfma_f32_16x16x32_bf16 v[132:135], v[228:231], v[72:75], v[132:135]
  v_mfma_f32_16x16x32_bf16 v[136:139], v[232:235], v[72:75], v[136:139]
  v_mfma_f32_16x16x32_bf16 v[140:143], v[236:239], v[72:75], v[140:143]
  ds_read_b128 v[72:75], v9 offset:22528
  s_waitcnt lgkmcnt(3)
  v_mfma_f32_16x16x32_bf16 v[128:131], v[240:243], v[76:79], v[128:131]
  v_mfma_f32_16x16x32_bf16 v[132:135], v[244:247], v[76:79], v[132:135]
  v_mfma_f32_16x16x32_bf16 v[136:139], v[248:251], v[76:79], v[136:139]
  v_mfma_f32_16x16x32_bf16 v[140:143], v[252:255], v[76:79], v[140:143]
  s_waitcnt vmcnt(0)
  s_barrier
  s_sub_u32 s17, 64, s16
  s_cmp_lg_u32 s3, 0
  s_cbranch_scc1 w0_8
  v_mov_b32 v12, s17
  s_mov_b64 exec, 1
  buffer_store_dword v12, off, s[4:7], s30 sc1
  s_mov_b64 exec, -1
w0_8:
  ds_read_b128 v[76:79], v9 offset:23552
  s_waitcnt lgkmcnt(3)
  v_mfma_f32_16x16x32_bf16 v[144:147], a[0:3], v[64:67], 0
  v_mfma_f32_16x16x32_bf16 v[148:151], a[4:7], v[64:67], 0
  v_mfma_f32_16x16x32_bf16 v[152:155], a[8:11], v[64:67], 0
  v_mfma_f32_16x16x32_bf16 v[156:159], a[12:15], v[64:67], 0
  s_add_u32 m0, s12, 0
  s_nop 0
  global_load_lds_dwordx4 v8, s[36:37] offset:0
  ds_read_b128 v[64:67], v9 offset:24576
  s_waitcnt lgkmcnt(3)
  v_mfma_f32_16x16x32_bf16 v[144:147], a[16:19], v[68:71], v[144:147]
  v_mfma_f32_16x16x32_bf16 v[148:151], a[20:23], v[68:71], v[148:151]
  v_mfma_f32_16x16x32_bf16 v[152:155], a[24:27], v[68:71], v[152:155]
  v_cvt_pk_bf16_f32 v176, v128, v129
  v_mfma_f32_16x16x32_bf16 v[156:159], a[28:31], v[68:71], v[156:159]
  v_cvt_pk_bf16_f32 v177, v130, v131
  ds_read_b128 v[68:71], v9 offset:25600
  s_waitcnt lgkmcnt(3)
  v_mfma_f32_16x16x32_bf16 v[144:147], a[32:35], v[72:75], v[144:147]
  v_cvt_pk_bf16_f32 v178, v132, v133
  v_mfma_f32_16x16x32_bf16 v[148:151], a[36:39], v[72:75], v[148:151]
  v_cvt_pk_bf16_f32 v179, v134, v135
  v_mfma_f32_16x16x32_bf16 v[152:155], a[40:43], v[72:75], v[152:155]
  v_cvt_pk_bf16_f32 v180, v136, v137
  v_mfma_f32_16x16x32_bf16 v[156:159], a[44:47], v[72:75], v[156:159]
  v_cvt_pk_bf16_f32 v181, v138, v139
  global_load_lds_dwordx4 v8, s[36:37] offset:1024
  ds_read_b128 v[72:75], v9 offset:26624
  s_waitcnt lgkmcnt(3)
  v_mfma_f32_16x16x32_bf16 v[144:147], a[48:51], v[76:79], v[144:147]
  v_cvt_pk_bf16_f32 v182, v140, v141
  v_mfma_f32_16x16x32_bf16 v[148:151], a[52:55], v[76:79], v[148:151]
  v_cvt_pk_bf16_f32 v183, v142, v143
  v_mfma_f32_16x16x32_bf16 v[152:155], a[56:59], v[76:79], v[152:155]
  buffer_store_dwordx4 v[176:179], v2, s[4:7], s34 offen sc1
  v_mfma_f32_16x16x32_bf16 v[156:159], a[60:63], v[76:79], v[156:159]
  ds_read_b128 v[76:79], v9 offset:27648
  s_waitcnt lgkmcnt(3)
  v_mfma_f32_16x16x32_bf16 v[144:147], a[64:67], v[64:67], v[144:147]
  v_mfma_f32_16x16x32_bf16 v[148:151], a[68:71], v[64:67], v[148:151]
  v_mfma_f32_16x16x32_bf16 v[152:155], a[72:75], v[64:67], v[152:155]
  v_mfma_f32_16x16x32_bf16 v[156:159], a[76:79], v[64:67], v[156:159]
  global_load_lds_dwordx4 v8, s[36:37] offset:2048
  ds_read_b128 v[64:67], v9 offset:28672
  s_waitcnt lgkmcnt(3)
  v_mfma_f32_16x16x32_bf16 v[144:147], a[80:83], v[68:71], v[144:147]
  buffer_store_dwordx4 v[180:183], v2, s[4:7], s34 offen offset:1024 sc1
  v_mfma_f32_16x16x32_bf16 v[148:151], a[84:87], v[68:71], v[148:151]
  v_mfma_f32_16x16x32_bf16 v[152:155], a[88:91], v[68:71], v[152:155]
  v_mfma_f32_16x16x32_bf16 v[156:159], a[92:95], v[68:71], v[156:159]
  ds_read_b128 v[68:71], v9 offset:29696
  s_waitcnt lgkmcnt(3)
  v_mfma_f32_16x16x32_bf16 v[144:147], a[96:99], v[72:75], v[144:147]
  v_mfma_f32_16x16x32_bf16 v[148:151], a[100:103], v[72:75], v[148:151]
  v_mfma_f32_16x16x32_bf16 v[152:155], a[104:107], v[72:75], v[152:155]
  v_mfma_f32_16x16x32_bf16 v[156:159], a[108:111], v[72:75], v[156:159]
  global_load_lds_dwordx4 v8, s[36:37] offset:3072
  s_add_u32 s36, s36, 4096
  s_addc_u32 s37, s37, 0
  ds_read_b128 v[72:75], v9 offset:30720
  s_waitcnt lgkmcnt(3)
  v_mfma_f32_16x16x32_bf16 v[144:147], a[112:115], v[76:79], v[144:147]
  v_mfma_f32_16x16x32_bf16 v[148:151], a[116:119], v[76:79], v[148:151]
  v_mfma_f32_16x16x32_bf16 v[152:155], a[120:123], v[76:79], v[152:155]
  v_mfma_f32_16x16x32_bf16 v[156:159], a[124:127], v[76:79], v[156:159]
  ds_read_b128 v[76:79], v9 offset:31744
  s_waitcnt lgkmcnt(3)
  v_mfma_f32_16x16x32_bf16 v[144:147], a[128:131], v[64:67], v[144:147]
  v_mfma_f32_16x16x32_bf16 v[148:151], a[132:135], v[64:67], v[148:151]
  v_mfma_f32_16x16x32_bf16 v[152:155], a[136:139], v[64:67], v[152:155]
  v_mfma_f32_16x16x32_bf16 v[156:159], a[140:143], v[64:67], v[156:159]
  s_add_u32 m0, s12, 4096
  s_nop 0
  global_load_lds_dwordx4 v8, s[36:37] offset:0
  ds_read_b128 v[64:67], v9 offset:32768
  s_waitcnt lgkmcnt(3)
  v_mfma_f32_16x16x32_bf16 v[144:147], a[144:147], v[68:71], v[144:147]
  v_mfma_f32_16x16x32_bf16 v[148:151], a[148:151], v[68:71], v[148:151]
  v_mfma_f32_16x16x32_bf16 v[152:155], a[152:155], v[68:71], v[152:155]
  v_mfma_f32_16x16x32_bf16 v[156:159], a[156:159], v[68:71], v[156:159]
  ds_read_b128 v[68:71], v9 offset:33792
  s_waitcnt lgkmcnt(3)
  v_mfma_f32_16x16x32_bf16 v[144:147], a[160:163], v[72:75], v[144:147]
  v_mfma_f32_16x16x32_bf16 v[148:151], a[164:167], v[72:75], v[148:151]
  v_mfma_f32_16x16x32_bf16 v[152:155], a[168:171], v[72:75], v[152:155]
  v_mfma_f32_16x16x32_bf16 v[156:159], a[172:175], v[72:75], v[156:159]
  global_load_lds_dwordx4 v8, s[36:37] offset:1024
  ds_read_b128 v[72:75], v9 offset:34816
  s_waitcnt lgkmcnt(3)
  v_mfma_f32_16x16x32_bf16 v[144:147], a[176:179], v[76:79], v[144:147]
  v_mfma_f32_16x16x32_bf16 v[148:151], a[180:183], v[76:79], v[148:151]
  v_mfma_f32_16x16x32_bf16 v[152:155], a[184:187], v[76:79], v[152:155]
  v_mfma_f32_16x16x32_bf16 v[156:159], a[188:191], v[76:79], v[156:159]
  ds_read_b128 v[76:79], v9 offset:35840
  s_waitcnt lgkmcnt(3)
  v_mfma_f32_16x16x32_bf16 v[144:147], a[192:195], v[64:67], v[144:147]
  v_mfma_f32_16x16x32_bf16 v[148:151], a[196:199], v[64:67], v[148:151]
  v_mfma_f32_16x16x32_bf16 v[152:155], a[200:203], v[64:67], v[152:155]
  v_mfma_f32_16x16x32_bf16 v[156:159], a[204:207], v[64:67], v[156:159]
  global_load_lds_dwordx4 v8, s[36:37] offset:2048
  ds_read_b128 v[64:67], v9 offset:36864
  s_waitcnt lgkmcnt(3)
  v_mfma_f32_16x16x32_bf16 v[144:147], a[208:211], v[68:71], v[144:147]
  v_mfma_f32_16x16x32_bf16 v[148:151], a[212:215], v[68:71], v[148:151]
  v_mfma_f32_16x16x32_bf16 v[152:155], a[216:219], v[68:71], v[152:155]
  v_mfma_f32_16x16x32_bf16 v[156:159], a[220:223], v[68:71], v[156:159]
  ds_read_b128 v[68:71], v9 offset:37888
  s_waitcnt lgkmcnt(3)
  v_mfma_f32_16x16x32_bf16 v[144:147], a[224:227], v[72:75], v[144:147]
  v_mfma_f32_16x16x32_bf16 v[148:151], a[228:231], v[72:75], v[148:151]
  v_mfma_f32_16x16x32_bf16 v[152:155], a[232:235], v[72:75], v[152:155]
  v_mfma_f32_16x16x32_bf16 v[156:159], a[236:239], v[72:75], v[156:159]
  global_load_lds_dwordx4 v8, s[36:37] offset:3072
  s_add_u32 s36, s36, 4096
  s_addc_u32 s37, s37, 0
  ds_read_b128 v[72:75], v9 offset:38912
  s_waitcnt lgkmcnt(3)
  v_mfma_f32_16x16x32_bf16 v[144:147], a[240:243], v[76:79], v[144:147]
  v_mfma_f32_16x16x32_bf16 v[148:151], a[244:247], v[76:79], v[148:151]
  v_mfma_f32_16x16x32_bf16 v[152:155], a[248:251], v[76:79], v[152:155]
  v_mfma_f32_16x16x32_bf16 v[156:159], a[252:255], v[76:79], v[156:159]
  ds_read_b128 v[76:79], v9 offset:39936
  s_waitcnt lgkmcnt(3)
  v_mfma_f32_16x16x32_bf16 v[144:147], v[192:195], v[64:67], v[144:147]
  v_mfma_f32_16x16x32_bf16 v[148:151], v[196:199], v[64:67], v[148:151]
  v_mfma_f32_16x16x32_bf16 v[152:155], v[200:203], v[64:67], v[152:155]
  v_mfma_f32_16x16x32_bf16 v[156:159], v[204:207], v[64:67], v[156:159]
  s_add_u32 m0, s12, 8192
  s_nop 0
  global_load_lds_dwordx4 v8, s[36:37] offset:0
  ds_read_b128 v[64:67], v10 offset:0
  s_waitcnt lgkmcnt(3)
  v_mfma_f32_16x16x32_bf16 v[144:147], v[208:211], v[68:71], v[144:147]
  v_mfma_f32_16x16x32_bf16 v[148:151], v[212:215], v[68:71], v[148:151]
  v_mfma_f32_16x16x32_bf16 v[152:155], v[216:219], v[68:71], v[152:155]
  v_mfma_f32_16x16x32_bf16 v[156:159], v[220:223], v[68:71], v[156:159]
  ds_read_b128 v[68:71], v10 offset:1024
  s_waitcnt lgkmcnt(3)
  v_mfma_f32_16x16x32_bf16 v[144:147], v[224:227], v[72:75], v[144:147]
  v_mfma_f32_16x16x32_bf16 v[148:151], v[228:231], v[72:75], v[148:151]
  v_mfma_f32_16x16x32_bf16 v[152:155], v[232:235], v[72:75], v[152:155]
  v_mfma_f32_16x16x32_bf16 v[156:159], v[236:239], v[72:75], v[156:159]
  global_load_lds_dwordx4 v8, s[36:37] offset:1024
  s_add_u32 s36, s36, 32768
  s_addc_u32 s37, s37, 0
  ds_read_b128 v[72:75], v10 offset:2048
  s_waitcnt lgkmcnt(3)
  v_mfma_f32_16x16x32_bf16 v[144:147], v[240:243], v[76:79], v[144:147]
  v_mfma_f32_16x16x32_bf16 v[148:151], v[244:247], v[76:79], v[148:151]
  v_mfma_f32_16x16x32_bf16 v[152:155], v[248:251], v[76:79], v[152:155]
  v_mfma_f32_16x16x32_bf16 v[156:159], v[252:255], v[76:79], v[156:159]
  s_add_u32 s13, s13, 1
  s_cmp_eq_u32 s13, 3
  s_cselect_b32 s13, 0, s13
  v_mov_b32 v9, v10
  s_mul_i32 s14, s13, 40960
  v_lshlrev_b32 v10, 4, v0
  v_add_u32 v10, s14, v10
  s_add_u32 s12, s12, 40960
  s_cmp_eq_u32 s13, 2
  s_cselect_b32 s14, 122880, 0
  s_sub_u32 s12, s12, s14
  s_mov_b32 s14, 1
  s_sub_u32 s16, s16, 1
  s_cmp_lg_u32 s16, 0
  s_cbranch_scc1 proj_loop
  v_cvt_pk_bf16_f32 v176, v144, v145
  v_cvt_pk_bf16_f32 v177, v146, v147
  v_cvt_pk_bf16_f32 v178, v148, v149
  v_cvt_pk_bf16_f32 v179, v150, v151
  v_cvt_pk_bf16_f32 v180, v152, v153
  v_cvt_pk_bf16_f32 v181, v154, v155
  v_cvt_pk_bf16_f32 v182, v156, v157
  v_cvt_pk_bf16_f32 v183, v158, v159
  s_add_u32 s34, s34, 6144
  buffer_store_dwordx4 v[176:179], v2, s[4:7], s34 offen sc1
  buffer_store_dwordx4 v[180:183], v2, s[4:7], s34 offen offset:1024 sc1
  s_add_u32 s34, s34, 387072
  s_waitcnt lgkmcnt(0)
  s_waitcnt vmcnt(0)
  s_barrier
  s_sub_u32 s17, 64, s16
  s_cmp_lg_u32 s3, 0
  s_cbranch_scc1 w0_9
  v_mov_b32 v12, s17
  s_mov_b64 exec, 1
  buffer_store_dword v12, off, s[4:7], s30 sc1
  s_mov_b64 exec, -1
w0_9:
  s_mov_b32 s51, 0
  s_branch mega_sp
mega_U:
  s_load_dwordx2 s[32:33], s[0:1], 40
  s_sub_u32 s20, s8, 4
  s_lshl_b32 s20, s20, 3
  s_add_u32 s20, s20, s2
  s_sub_u32 s20, s20, 18
  s_lshl_b32 s30, s20, 7
  s_add_u32 s30, s30, 149504
  s_mul_i32 s22, s20, 245760
  s_mul_i32 s23, s3, 320
  s_add_u32 s22, s22, s23
  s_mul_i32 s23, s20, 12288
  s_add_u32 s23, s23, 56623104
  s_mul_i32 s24, s20, 40960
  s_mul_i32 s25, s3, 10240
  s_add_u32 s24, s24, s25
  s_add_u32 s24, s24, 81788928
  s_mul_i32 s25, s20, 192
  v_and_b32 v3, 1, v0
  v_mul_u32_u24 v3, 191, v3
  v_add_u32 v3, s25, v3
  v_lshrrev_b32 v3, 8, v3
  v_lshlrev_b32 v3, 7, v3
  v_add_u32 v3, 116736, v3
  s_waitcnt lgkmcnt(0)
  s_add_u32 s32, s32, s22
  s_addc_u32 s33, s33, 0
  s_xor_b32 s14, s8, 4
  s_lshl_b32 s14, s14, 3
  s_and_b32 s15, s2, 7
  s_add_u32 s14, s14, s15
  s_mul_i32 s12, s14, 49152
  s_mul_i32 s13, s3, 12288
  s_add_u32 s12, s12, s13
  s_add_u32 s12, s12, 218103808
  v_lshlrev_b32 v2, 4, v0
  v_mov_b32 v16, -1
  v_mov_b32 v17, -1
  v_mov_b32 v18, -1
  v_mov_b32 v19, -1
  buffer_store_dwordx4 v[16:19], v2, s[4:7], s12 offen offset:0 sc1
  buffer_store_dwordx4 v[16:19], v2, s[4:7], s12 offen offset:1024 sc1
  buffer_store_dwordx4 v[16:19], v2, s[4:7], s12 offen offset:2048 sc1
  buffer_store_dwordx4 v[16:19], v2, s[4:7], s12 offen offset:3072 sc1
  s_add_u32 s12, s12, 4096
  buffer_store_dwordx4 v[16:19], v2, s[4:7], s12 offen offset:0 sc1
  buffer_store_dwordx4 v[16:19], v2, s[4:7], s12 offen offset:1024 sc1
  buffer_store_dwordx4 v[16:19], v2, s[4:7], s12 offen offset:2048 sc1
  buffer_store_dwordx4 v[16:19], v2, s[4:7], s12 offen offset:3072 sc1
  s_add_u32 s12, s12, 4096
  buffer_store_dwordx4 v[16:19], v2, s[4:7], s12 offen offset:0 sc1
  buffer_store_dwordx4 v[16:19], v2, s[4:7], s12 offen offset:1024 sc1
  buffer_store_dwordx4 v[16:19], v2, s[4:7], s12 offen offset:2048 sc1
  buffer_store_dwordx4 v[16:19], v2, s[4:7], s12 offen offset:3072 sc1
  s_add_u32 s12, s12, 4096
  s_load_dwordx4 s[12:15], s[0:1], 16
  v_cmp_le_u32 vcc, 24, v0
  s_nop 1
  v_cndmask_b32 v24, 0, 1, vcc
  v_mul_u32_u24 v24, 9216, v24
  v_lshl_add_u32 v24, v0, 7, v24
  s_sub_u32 s16, s2, 18
  s_lshl_b32 s16, s16, 2
  s_add_u32 s16, s16, s3
  s_mul_i32 s16, s16, 24576
  s_sub_u32 s17, s8, 4
  s_mul_i32 s17, s17, 3072
  s_add_u32 s16, s16, s17
  s_add_u32 s16, s16, 786432
  s_waitcnt lgkmcnt(0)
  s_mov_b32 exec_hi, 0xffff
  s_add_u32 s12, s12, s16
  s_addc_u32 s13, s13, 0
  s_add_u32 s14, s14, s16
  s_addc_u32 s15, s15, 0
  global_load_dword v26, v24, s[14:15]
  global_load_dword v26, v24, s[12:13]
  s_add_u32 s12, s12, 1572864
  s_addc_u32 s13, s13, 0
  s_add_u32 s14, s14, 1572864
  s_addc_u32 s15, s15, 0
  global_load_dword v26, v24, s[14:15]
  global_load_dword v26, v24, s[12:13]
  s_add_u32 s12, s12, 1572864
  s_addc_u32 s13, s13, 0
  s_add_u32 s14, s14, 1572864
  s_addc_u32 s15, s15, 0
  global_load_dword v26, v24, s[14:15]
  global_load_dword v26, v24, s[12:13]
  s_mov_b64 exec, -1
  s_waitcnt vmcnt(0)
  v_lshrrev_b32 v16, 2, v2
  v_mov_b32 v17, 0
  s_mov_b32 exec_lo, 0x00030003
  s_mov_b32 exec_hi, 0x00030003
  v_mov_b32 v17, 32
  s_mov_b32 exec_lo, 0x00100010
  s_mov_b32 exec_hi, 0x00100010
  v_mov_b32 v17, 64
  s_mov_b64 exec, 4
  v_mov_b32 v17, 56
  s_mov_b32 exec_lo, 0
  s_mov_b32 exec_hi, 4
  v_mov_b32 v17, 268435456
  s_mov_b64 exec, -1
  s_branch isync_11
isync_10:
  s_sleep 4
  s_add_u32 s11, s11, 1
  s_cmp_gt_u32 s11, 131072
  s_cbranch_scc1 mega_done
isync_11:
  global_load_dword v18, v16, s[90:91] sc1
  s_waitcnt vmcnt(0)
  v_cmp_gt_u32 vcc, v17, v18
  s_cbranch_vccnz isync_10
  v_readlane_b32 s66, v18, 34
  s_nop 0
  s_cmp_lt_u32 s66, 268468224
  s_cselect_b32 s66, 0, 8192
  global_load_dword v18, v16, s[90:91] sc1
  s_waitcnt vmcnt(0)
  v_readlane_b32 s51, v18, 18
  v_lshrrev_b32 v7, 4, v0
  v_lshlrev_b32 v6, 3, v7
  v_bfe_u32 v7, v0, 2, 2
  v_add_u32 v6, v6, v7
  v_mul_u32_u24 v6, 320, v6
  v_and_b32 v7, 3, v0
  v_lshl_add_u32 v6, v7, 3, v6
  s_mul_i32 s12, s3, 40960
  v_add_u32 v6, s12, v6
  v_mul_u32_u24 v5, 3277, v0
  v_lshrrev_b32 v5, 16, v5
  s_mov_b32 s13, 960
  v_mul_lo_u32 v4, v5, s13
  v_lshl_add_u32 v4, v0, 4, v4
  s_mov_b32 exec_lo, 0xffffffff
  s_mov_b32 exec_hi, 0xfffffff
  s_add_u32 m0, s12, 0
  s_nop 0
  global_load_lds_dwordx4 v4, s[32:33]
  s_add_u32 s32, s32, 3840
  s_addc_u32 s33, s33, 0
  s_add_u32 m0, s12, 960
  s_nop 0
  global_load_lds_dwordx4 v4, s[32:33]
  s_add_u32 s32, s32, 3840
  s_addc_u32 s33, s33, 0
  s_add_u32 m0, s12, 1920
  s_nop 0
  global_load_lds_dwordx4 v4, s[32:33]
  s_add_u32 s32, s32, 3840
  s_addc_u32 s33, s33, 0
  s_add_u32 m0, s12, 2880
  s_nop 0
  global_load_lds_dwordx4 v4, s[32:33]
  s_add_u32 s32, s32, 3840
  s_addc_u32 s33, s33, 0
  s_add_u32 m0, s12, 3840
  s_nop 0
  global_load_lds_dwordx4 v4, s[32:33]
  s_add_u32 s32, s32, 3840
  s_addc_u32 s33, s33, 0
  s_add_u32 m0, s12, 4800
  s_nop 0
  global_load_lds_dwordx4 v4, s[32:33]
  s_add_u32 s32, s32, 3840
  s_addc_u32 s33, s33, 0
  s_add_u32 m0, s12, 5760
  s_nop 0
  global_load_lds_dwordx4 v4, s[32:33]
  s_add_u32 s32, s32, 3840
  s_addc_u32 s33, s33, 0
  s_add_u32 m0, s12, 6720
  s_nop 0
  global_load_lds_dwordx4 v4, s[32:33]
  s_add_u32 s32, s32, 3840
  s_addc_u32 s33, s33, 0
  s_add_u32 m0, s12, 7680
  s_nop 0
  global_load_lds_dwordx4 v4, s[32:33]
  s_add_u32 s32, s32, 3840
  s_addc_u32 s33, s33, 0
  s_add_u32 m0, s12, 8640
  s_nop 0
  global_load_lds_dwordx4 v4, s[32:33]
  s_add_u32 s32, s32, 3840
  s_addc_u32 s33, s33, 0
  s_mov_b32 exec_lo, 0xffffffff
  s_mov_b32 exec_hi, 0xff
  s_add_u32 m0, s12, 9600
  s_nop 0
  global_load_lds_dwordx4 v4, s[32:33]
  s_add_u32 s32, s32, 2560
  s_addc_u32 s33, s33, 0
  s_mov_b64 exec, -1
  s_mov_b32 exec_lo, 0xffffffff
  s_mov_b32 exec_hi, 0xfffffff
  s_add_u32 m0, s12, 10240
  s_nop 0
  global_load_lds_dwordx4 v4, s[32:33]
  s_add_u32 s32, s32, 3840
  s_addc_u32 s33, s33, 0
  s_add_u32 m0, s12, 11200
  s_nop 0
  global_load_lds_dwordx4 v4, s[32:33]
  s_add_u32 s32, s32, 3840
  s_addc_u32 s33, s33, 0
  s_add_u32 m0, s12, 12160
  s_nop 0
  global_load_lds_dwordx4 v4, s[32:33]
  s_add_u32 s32, s32, 3840
  s_addc_u32 s33, s33, 0
  s_add_u32 m0, s12, 13120
  s_nop 0
  global_load_lds_dwordx4 v4, s[32:33]
  s_add_u32 s32, s32, 3840
  s_addc_u32 s33, s33, 0
  s_add_u32 m0, s12, 14080
  s_nop 0
  global_load_lds_dwordx4 v4, s[32:33]
  s_add_u32 s32, s32, 3840
  s_addc_u32 s33, s33, 0
  s_add_u32 m0, s12, 15040
  s_nop 0
  global_load_lds_dwordx4 v4, s[32:33]
  s_add_u32 s32, s32, 3840
  s_addc_u32 s33, s33, 0
  s_add_u32 m0, s12, 16000
  s_nop 0
  global_load_lds_dwordx4 v4, s[32:33]
  s_add_u32 s32, s32, 3840
  s_addc_u32 s33, s33, 0
  s_add_u32 m0, s12, 16960
  s_nop 0
  global_load_lds_dwordx4 v4, s[32:33]
  s_add_u32 s32, s32, 3840
  s_addc_u32 s33, s33, 0
  s_add_u32 m0, s12, 17920
  s_nop 0
  global_load_lds_dwordx4 v4, s[32:33]
  s_add_u32 s32, s32, 3840
  s_addc_u32 s33, s33, 0
  s_add_u32 m0, s12, 18880
  s_nop 0
  global_load_lds_dwordx4 v4, s[32:33]
  s_add_u32 s32, s32, 3840
  s_addc_u32 s33, s33, 0
  s_mov_b32 exec_lo, 0xffffffff
  s_mov_b32 exec_hi, 0xff
  s_add_u32 m0, s12, 19840
  s_nop 0
  global_load_lds_dwordx4 v4, s[32:33]
  s_add_u32 s32, s32, 2560
  s_addc_u32 s33, s33, 0
  s_mov_b64 exec, -1
  s_mov_b32 exec_lo, 0xffffffff
  s_mov_b32 exec_hi, 0xfffffff
  s_add_u32 m0, s12, 20480
  s_nop 0
  global_load_lds_dwordx4 v4, s[32:33]
  s_add_u32 s32, s32, 3840
  s_addc_u32 s33, s33, 0
  s_add_u32 m0, s12, 21440
  s_nop 0
  global_load_lds_dwordx4 v4, s[32:33]
  s_add_u32 s32, s32, 3840
  s_addc_u32 s33, s33, 0
  s_add_u32 m0, s12, 22400
  s_nop 0
  global_load_lds_dwordx4 v4, s[32:33]
  s_add_u32 s32, s32, 3840
  s_addc_u32 s33, s33, 0
  s_add_u32 m0, s12, 23360
  s_nop 0
  global_load_lds_dwordx4 v4, s[32:33]
  s_add_u32 s32, s32, 3840
  s_addc_u32 s33, s33, 0
  s_add_u32 m0, s12, 24320
  s_nop 0
  global_load_lds_dwordx4 v4, s[32:33]
  s_add_u32 s32, s32, 3840
  s_addc_u32 s33, s33, 0
  s_add_u32 m0, s12, 25280
  s_nop 0
  global_load_lds_dwordx4 v4, s[32:33]
  s_add_u32 s32, s32, 3840
  s_addc_u32 s33, s33, 0
  s_add_u32 m0, s12, 26240
  s_nop 0
  global_load_lds_dwordx4 v4, s[32:33]
  s_add_u32 s32, s32, 3840
  s_addc_u32 s33, s33, 0
  s_add_u32 m0, s12, 27200
  s_nop 0
  global_load_lds_dwordx4 v4, s[32:33]
  s_add_u32 s32, s32, 3840
  s_addc_u32 s33, s33, 0
  s_add_u32 m0, s12, 28160
  s_nop 0
  global_load_lds_dwordx4 v4, s[32:33]
  s_add_u32 s32, s32, 3840
  s_addc_u32 s33, s33, 0
  s_add_u32 m0, s12, 29120
  s_nop 0
  global_load_lds_dwordx4 v4, s[32:33]
  s_add_u32 s32, s32, 3840
  s_addc_u32 s33, s33, 0
  s_mov_b32 exec_lo, 0xffffffff
  s_mov_b32 exec_hi, 0xff
  s_add_u32 m0, s12, 30080
  s_nop 0
  global_load_lds_dwordx4 v4, s[32:33]
  s_add_u32 s32, s32, 2560
  s_addc_u32 s33, s33, 0
  s_mov_b64 exec, -1
  s_mov_b32 exec_lo, 0xffffffff
  s_mov_b32 exec_hi, 0xfffffff
  s_add_u32 m0, s12, 30720
  s_nop 0
  global_load_lds_dwordx4 v4, s[32:33]
  s_add_u32 s32, s32, 3840
  s_addc_u32 s33, s33, 0
  s_add_u32 m0, s12, 31680
  s_nop 0
  global_load_lds_dwordx4 v4, s[32:33]
  s_add_u32 s32, s32, 3840
  s_addc_u32 s33, s33, 0
  s_add_u32 m0, s12, 32640
  s_nop 0
  global_load_lds_dwordx4 v4, s[32:33]
  s_add_u32 s32, s32, 3840
  s_addc_u32 s33, s33, 0
  s_add_u32 m0, s12, 33600
  s_nop 0
  global_load_lds_dwordx4 v4, s[32:33]
  s_add_u32 s32, s32, 3840
  s_addc_u32 s33, s33, 0
  s_add_u32 m0, s12, 34560
  s_nop 0
  global_load_lds_dwordx4 v4, s[32:33]
  s_add_u32 s32, s32, 3840
  s_addc_u32 s33, s33, 0
  s_add_u32 m0, s12, 35520
  s_nop 0
  global_load_lds_dwordx4 v4, s[32:33]
  s_add_u32 s32, s32, 3840
  s_addc_u32 s33, s33, 0
  s_add_u32 m0, s12, 36480
  s_nop 0
  global_load_lds_dwordx4 v4, s[32:33]
  s_add_u32 s32, s32, 3840
  s_addc_u32 s33, s33, 0
  s_add_u32 m0, s12, 37440
  s_nop 0
  global_load_lds_dwordx4 v4, s[32:33]
  s_add_u32 s32, s32, 3840
  s_addc_u32 s33, s33, 0
  s_add_u32 m0, s12, 38400
  s_nop 0
  global_load_lds_dwordx4 v4, s[32:33]
  s_add_u32 s32, s32, 3840
  s_addc_u32 s33, s33, 0
  s_add_u32 m0, s12, 39360
  s_nop 0
  global_load_lds_dwordx4 v4, s[32:33]
  s_add_u32 s32, s32, 3840
  s_addc_u32 s33, s33, 0
  s_mov_b32 exec_lo, 0xffffffff
  s_mov_b32 exec_hi, 0xff
  s_add_u32 m0, s12, 40320
  s_nop 0
  global_load_lds_dwordx4 v4, s[32:33]
  s_add_u32 s32, s32, 2560
  s_addc_u32 s33, s33, 0
  s_mov_b64 exec, -1
  s_waitcnt vmcnt(33)
  ds_read_b64_tr_b16 a[0:1], v6 offset:0
  ds_read_b64_tr_b16 a[2:3], v6 offset:1280
  ds_read_b64_tr_b16 a[24:25], v6 offset:32
  ds_read_b64_tr_b16 a[26:27], v6 offset:1312
  ds_read_b64_tr_b16 a[48:49], v6 offset:64
  ds_read_b64_tr_b16 a[50:51], v6 offset:1344
  ds_read_b64_tr_b16 a[72:73], v6 offset:96
  ds_read_b64_tr_b16 a[74:75], v6 offset:1376
  ds_read_b64_tr_b16 a[96:97], v6 offset:128
  ds_read_b64_tr_b16 a[98:99], v6 offset:1408
  ds_read_b64_tr_b16 a[120:121], v6 offset:160
  ds_read_b64_tr_b16 a[122:123], v6 offset:1440
  ds_read_b64_tr_b16 a[144:145], v6 offset:192
  ds_read_b64_tr_b16 a[146:147], v6 offset:1472
  ds_read_b64_tr_b16 a[168:169], v6 offset:224
  ds_read_b64_tr_b16 a[170:171], v6 offset:1504
  ds_read_b64_tr_b16 a[192:193], v6 offset:256
  ds_read_b64_tr_b16 a[194:195], v6 offset:1536
  ds_read_b64_tr_b16 a[216:217], v6 offset:288
  ds_read_b64_tr_b16 a[218:219], v6 offset:1568
  s_waitcnt lgkmcnt(0)
  s_mov_b32 exec_lo, 0xffffffff
  s_mov_b32 exec_hi, 0xfffffff
  s_add_u32 m0, s12, 0
  s_nop 0
  global_load_lds_dwordx4 v4, s[32:33]
  s_add_u32 s32, s32, 3840
  s_addc_u32 s33, s33, 0
  s_add_u32 m0, s12, 960
  s_nop 0
  global_load_lds_dwordx4 v4, s[32:33]
  s_add_u32 s32, s32, 3840
  s_addc_u32 s33, s33, 0
  s_add_u32 m0, s12, 1920
  s_nop 0
  global_load_lds_dwordx4 v4, s[32:33]
  s_add_u32 s32, s32, 3840
  s_addc_u32 s33, s33, 0
  s_add_u32 m0, s12, 2880
  s_nop 0
  global_load_lds_dwordx4 v4, s[32:33]
  s_add_u32 s32, s32, 3840
  s_addc_u32 s33, s33, 0
  s_add_u32 m0, s12, 3840
  s_nop 0
  global_load_lds_dwordx4 v4, s[32:33]
  s_add_u32 s32, s32, 3840
  s_addc_u32 s33, s33, 0
  s_add_u32 m0, s12, 4800
  s_nop 0
  global_load_lds_dwordx4 v4, s[32:33]
  s_add_u32 s32, s32, 3840
  s_addc_u32 s33, s33, 0
  s_add_u32 m0, s12, 5760
  s_nop 0
  global_load_lds_dwordx4 v4, s[32:33]
  s_add_u32 s32, s32, 3840
  s_addc_u32 s33, s33, 0
  s_add_u32 m0, s12, 6720
  s_nop 0
  global_load_lds_dwordx4 v4, s[32:33]
  s_add_u32 s32, s32, 3840
  s_addc_u32 s33, s33, 0
  s_add_u32 m0, s12, 7680
  s_nop 0
  global_load_lds_dwordx4 v4, s[32:33]
  s_add_u32 s32, s32, 3840
  s_addc_u32 s33, s33, 0
  s_add_u32 m0, s12, 8640
  s_nop 0
  global_load_lds_dwordx4 v4, s[32:33]
  s_add_u32 s32, s32, 3840
  s_addc_u32 s33, s33, 0
  s_mov_b32 exec_lo, 0xffffffff
  s_mov_b32 exec_hi, 0xff
  s_add_u32 m0, s12, 9600
  s_nop 0
  global_load_lds_dwordx4 v4, s[32:33]
  s_add_u32 s32, s32, 2560
  s_addc_u32 s33, s33, 0
  s_mov_b64 exec, -1
  s_waitcnt vmcnt(33)
  ds_read_b64_tr_b16 a[4:5], v6 offset:10240
  ds_read_b64_tr_b16 a[6:7], v6 offset:11520
  ds_read_b64_tr_b16 a[28:29], v6 offset:10272
  ds_read_b64_tr_b16 a[30:31], v6 offset:11552
  ds_read_b64_tr_b16 a[52:53], v6 offset:10304
  ds_read_b64_tr_b16 a[54:55], v6 offset:11584
  ds_read_b64_tr_b16 a[76:77], v6 offset:10336
  ds_read_b64_tr_b16 a[78:79], v6 offset:11616
  ds_read_b64_tr_b16 a[100:101], v6 offset:10368
  ds_read_b64_tr_b16 a[102:103], v6 offset:11648
  ds_read_b64_tr_b16 a[124:125], v6 offset:10400
  ds_read_b64_tr_b16 a[126:127], v6 offset:11680
  ds_read_b64_tr_b16 a[148:149], v6 offset:10432
  ds_read_b64_tr_b16 a[150:151], v6 offset:11712
  ds_read_b64_tr_b16 a[172:173], v6 offset:10464
  ds_read_b64_tr_b16 a[174:175], v6 offset:11744
  ds_read_b64_tr_b16 a[196:197], v6 offset:10496
  ds_read_b64_tr_b16 a[198:199], v6 offset:11776
  ds_read_b64_tr_b16 a[220:221], v6 offset:10528
  ds_read_b64_tr_b16 a[222:223], v6 offset:11808
  s_waitcnt lgkmcnt(0)
  s_mov_b32 exec_lo, 0xffffffff
  s_mov_b32 exec_hi, 0xfffffff
  s_add_u32 m0, s12, 10240
  s_nop 0
  global_load_lds_dwordx4 v4, s[32:33]
  s_add_u32 s32, s32, 3840
  s_addc_u32 s33, s33, 0
  s_add_u32 m0, s12, 11200
  s_nop 0
  global_load_lds_dwordx4 v4, s[32:33]
  s_add_u32 s32, s32, 3840
  s_addc_u32 s33, s33, 0
  s_add_u32 m0, s12, 12160
  s_nop 0
  global_load_lds_dwordx4 v4, s[32:33]
  s_add_u32 s32, s32, 3840
  s_addc_u32 s33, s33, 0
  s_add_u32 m0, s12, 13120
  s_nop 0
  global_load_lds_dwordx4 v4, s[32:33]
  s_add_u32 s32, s32, 3840
  s_addc_u32 s33, s33, 0
  s_add_u32 m0, s12, 14080
  s_nop 0
  global_load_lds_dwordx4 v4, s[32:33]
  s_add_u32 s32, s32, 3840
  s_addc_u32 s33, s33, 0
  s_add_u32 m0, s12, 15040
  s_nop 0
  global_load_lds_dwordx4 v4, s[32:33]
  s_add_u32 s32, s32, 3840
  s_addc_u32 s33, s33, 0
  s_add_u32 m0, s12, 16000
  s_nop 0
  global_load_lds_dwordx4 v4, s[32:33]
  s_add_u32 s32, s32, 3840
  s_addc_u32 s33, s33, 0
  s_add_u32 m0, s12, 16960
  s_nop 0
  global_load_lds_dwordx4 v4, s[32:33]
  s_add_u32 s32, s32, 3840
  s_addc_u32 s33, s33, 0
  s_add_u32 m0, s12, 17920
  s_nop 0
  global_load_lds_dwordx4 v4, s[32:33]
  s_add_u32 s32, s32, 3840
  s_addc_u32 s33, s33, 0
  s_add_u32 m0, s12, 18880
  s_nop 0
  global_load_lds_dwordx4 v4, s[32:33]
  s_add_u32 s32, s32, 3840
  s_addc_u32 s33, s33, 0
  s_mov_b32 exec_lo, 0xffffffff
  s_mov_b32 exec_hi, 0xff
  s_add_u32 m0, s12, 19840
  s_nop 0
  global_load_lds_dwordx4 v4, s[32:33]
  s_add_u32 s32, s32, 2560
  s_addc_u32 s33, s33, 0
  s_mov_b64 exec, -1
  s_waitcnt vmcnt(33)
  ds_read_b64_tr_b16 a[8:9], v6 offset:20480
  ds_read_b64_tr_b16 a[10:11], v6 offset:21760
  ds_read_b64_tr_b16 a[32:33], v6 offset:20512
  ds_read_b64_tr_b16 a[34:35], v6 offset:21792
  ds_read_b64_tr_b16 a[56:57], v6 offset:20544
  ds_read_b64_tr_b16 a[58:59], v6 offset:21824
  ds_read_b64_tr_b16 a[80:81], v6 offset:20576
  ds_read_b64_tr_b16 a[82:83], v6 offset:21856
  ds_read_b64_tr_b16 a[104:105], v6 offset:20608
  ds_read_b64_tr_b16 a[106:107], v6 offset:21888
  ds_read_b64_tr_b16 a[128:129], v6 offset:20640
  ds_read_b64_tr_b16 a[130:131], v6 offset:21920
  ds_read_b64_tr_b16 a[152:153], v6 offset:20672
  ds_read_b64_tr_b16 a[154:155], v6 offset:21952
  ds_read_b64_tr_b16 a[176:177], v6 offset:20704
  ds_read_b64_tr_b16 a[178:179], v6 offset:21984
  ds_read_b64_tr_b16 a[200:201], v6 offset:20736
  ds_read_b64_tr_b16 a[202:203], v6 offset:22016
  ds_read_b64_tr_b16 a[224:225], v6 offset:20768
  ds_read_b64_tr_b16 a[226:227], v6 offset:22048
  s_waitcnt lgkmcnt(0)
  s_waitcnt vmcnt(22)
  ds_read_b64_tr_b16 a[12:13], v6 offset:30720
  ds_read_b64_tr_b16 a[14:15], v6 offset:32000
  ds_read_b64_tr_b16 a[36:37], v6 offset:30752
  ds_read_b64_tr_b16 a[38:39], v6 offset:32032
  ds_read_b64_tr_b16 a[60:61], v6 offset:30784
  ds_read_b64_tr_b16 a[62:63], v6 offset:32064
  ds_read_b64_tr_b16 a[84:85], v6 offset:30816
  ds_read_b64_tr_b16 a[86:87], v6 offset:32096
  ds_read_b64_tr_b16 a[108:109], v6 offset:30848
  ds_read_b64_tr_b16 a[110:111], v6 offset:32128
  ds_read_b64_tr_b16 a[132:133], v6 offset:30880
  ds_read_b64_tr_b16 a[134:135], v6 offset:32160
  ds_read_b64_tr_b16 a[156:157], v6 offset:30912
  ds_read_b64_tr_b16 a[158:159], v6 offset:32192
  ds_read_b64_tr_b16 a[180:181], v6 offset:30944
  ds_read_b64_tr_b16 a[182:183], v6 offset:32224
  ds_read_b64_tr_b16 a[204:205], v6 offset:30976
  ds_read_b64_tr_b16 a[206:207], v6 offset:32256
  ds_read_b64_tr_b16 a[228:229], v6 offset:31008
  ds_read_b64_tr_b16 a[230:231], v6 offset:32288
  s_waitcnt lgkmcnt(0)
  s_waitcnt vmcnt(11)
  ds_read_b64_tr_b16 a[16:17], v6 offset:0
  ds_read_b64_tr_b16 a[18:19], v6 offset:1280
  ds_read_b64_tr_b16 a[40:41], v6 offset:32
  ds_read_b64_tr_b16 a[42:43], v6 offset:1312
  ds_read_b64_tr_b16 a[64:65], v6 offset:64
  ds_read_b64_tr_b16 a[66:67], v6 offset:1344
  ds_read_b64_tr_b16 a[88:89], v6 offset:96
  ds_read_b64_tr_b16 a[90:91], v6 offset:1376
  ds_read_b64_tr_b16 a[112:113], v6 offset:128
  ds_read_b64_tr_b16 a[114:115], v6 offset:1408
  ds_read_b64_tr_b16 a[136:137], v6 offset:160
  ds_read_b64_tr_b16 a[138:139], v6 offset:1440
  ds_read_b64_tr_b16 a[160:161], v6 offset:192
  ds_read_b64_tr_b16 a[162:163], v6 offset:1472
  ds_read_b64_tr_b16 a[184:185], v6 offset:224
  ds_read_b64_tr_b16 a[186:187], v6 offset:1504
  ds_read_b64_tr_b16 a[208:209], v6 offset:256
  ds_read_b64_tr_b16 a[210:211], v6 offset:1536
  ds_read_b64_tr_b16 a[232:233], v6 offset:288
  ds_read_b64_tr_b16 a[234:235], v6 offset:1568
  s_waitcnt lgkmcnt(0)
  s_waitcnt vmcnt(0)
  ds_read_b64_tr_b16 a[20:21], v6 offset:10240
  ds_read_b64_tr_b16 a[22:23], v6 offset:11520
  ds_read_b64_tr_b16 a[44:45], v6 offset:10272
  ds_read_b64_tr_b16 a[46:47], v6 offset:11552
  ds_read_b64_tr_b16 a[68:69], v6 offset:10304
  ds_read_b64_tr_b16 a[70:71], v6 offset:11584
  ds_read_b64_tr_b16 a[92:93], v6 offset:10336
  ds_read_b64_tr_b16 a[94:95], v6 offset:11616
  ds_read_b64_tr_b16 a[116:117], v6 offset:10368
  ds_read_b64_tr_b16 a[118:119], v6 offset:11648
  ds_read_b64_tr_b16 a[140:141], v6 offset:10400
  ds_read_b64_tr_b16 a[142:143], v6 offset:11680
  ds_read_b64_tr_b16 a[164:165], v6 offset:10432
  ds_read_b64_tr_b16 a[166:167], v6 offset:11712
  ds_read_b64_tr_b16 a[188:189], v6 offset:10464
  ds_read_b64_tr_b16 a[190:191], v6 offset:11744
  ds_read_b64_tr_b16 a[212:213], v6 offset:10496
  ds_read_b64_tr_b16 a[214:215], v6 offset:11776
  ds_read_b64_tr_b16 a[236:237], v6 offset:10528
  ds_read_b64_tr_b16 a[238:239], v6 offset:11808
  s_waitcnt lgkmcnt(0)
  v_lshlrev_b32 v2, 4, v0
  s_lshl_b32 s12, s3, 2
  s_add_u32 s30, s30, s12
  s_cmp_lg_u32 s51, 0
  s_cselect_b32 s51, 2, 1
  s_add_u32 s30, s30, s66
  v_lshlrev_b32 v8, 4, v0
  s_mov_b32 s16, 0
  s_mov_b32 s18, 0
u_loop:
  s_cmp_lg_u32 s18, 0
  s_cbranch_scc1 u_12
  s_waitcnt vmcnt(0)
  s_cmp_eq_u32 s16, 0
  s_cbranch_scc1 u_15
  v_mov_b32 v9, s16
  s_mov_b64 exec, 1
  buffer_store_dword v9, off, s[4:7], s30 sc1
  s_mov_b64 exec, -1
u_15:
  s_add_u32 s17, s16, 1
  s_branch wf_17
wf_16:
  s_sleep 2
  s_add_u32 s11, s11, 1
  s_cmp_gt_u32 s11, 131072
  s_cbranch_scc1 mega_done
wf_17:
  buffer_load_dword v9, v3, s[4:7], s66 offen sc1
  s_waitcnt vmcnt(0)
  v_cmp_gt_u32 vcc, s17, v9
  s_cbranch_vccnz wf_16
  s_add_u32 s12, s23, 0
  buffer_load_dwordx4 v[64:67], v8, s[4:7], s12 offen offset:0
  buffer_load_dwordx4 v[68:71], v8, s[4:7], s12 offen offset:1024
  buffer_load_dwordx4 v[72:75], v8, s[4:7], s12 offen offset:2048
  buffer_load_dwordx4 v[76:79], v8, s[4:7], s12 offen offset:3072
  s_add_u32 s12, s23, 4096
  buffer_load_dwordx4 v[80:83], v8, s[4:7], s12 offen offset:0
  buffer_load_dwordx4 v[84:87], v8, s[4:7], s12 offen offset:1024
  buffer_load_dwordx4 v[88:91], v8, s[4:7], s12 offen offset:2048
  buffer_load_dwordx4 v[92:95], v8, s[4:7], s12 offen offset:3072
  s_add_u32 s12, s23, 8192
  buffer_load_dwordx4 v[96:99], v8, s[4:7], s12 offen offset:0
  buffer_load_dwordx4 v[100:103], v8, s[4:7], s12 offen offset:1024
  buffer_load_dwordx4 v[104:107], v8, s[4:7], s12 offen offset:2048
  buffer_load_dwordx4 v[108:111], v8, s[4:7], s12 offen offset:3072
  s_add_u32 s23, s23, 393216
  s_waitcnt vmcnt(0)
  s_branch u_13
u_12:
  s_waitcnt vmcnt(9)
  s_cmp_lt_u32 s16, 4
  s_cselect_b32 s18, 2, s18
  s_cmp_eq_u32 s18, 1
  s_cbranch_scc1 u_13
  s_waitcnt vmcnt(0)
  v_mov_b32 v9, s16
  s_mov_b64 exec, 1
  buffer_store_dword v9, off, s[4:7], s30 sc1
  s_mov_b64 exec, -1
u_13:
  buffer_load_dword v10, v3, s[4:7], s66 offen sc1
  s_add_u32 s17, s16, 2
  v_mfma_f32_16x16x32_bf16 v[160:163], v[64:67], a[0:3], 0
  v_mfma_f32_16x16x32_bf16 v[164:167], v[88:91], a[0:3], 0
  v_mfma_f32_16x16x32_bf16 v[160:163], v[68:71], a[4:7], v[160:163]
  v_mfma_f32_16x16x32_bf16 v[164:167], v[92:95], a[4:7], v[164:167]
  v_mfma_f32_16x16x32_bf16 v[160:163], v[72:75], a[8:11], v[160:163]
  v_mfma_f32_16x16x32_bf16 v[164:167], v[96:99], a[8:11], v[164:167]
  v_mfma_f32_16x16x32_bf16 v[160:163], v[76:79], a[12:15], v[160:163]
  v_mfma_f32_16x16x32_bf16 v[164:167], v[100:103], a[12:15], v[164:167]
  v_mfma_f32_16x16x32_bf16 v[160:163], v[80:83], a[16:19], v[160:163]
  v_mfma_f32_16x16x32_bf16 v[164:167], v[104:107], a[16:19], v[164:167]
  v_mfma_f32_16x16x32_bf16 v[160:163], v[84:87], a[20:23], v[160:163]
  v_mfma_f32_16x16x32_bf16 v[164:167], v[108:111], a[20:23], v[164:167]
  v_mfma_f32_16x16x32_bf16 v[168:171], v[64:67], a[24:27], 0
  v_mfma_f32_16x16x32_bf16 v[172:175], v[88:91], a[24:27], 0
  v_mfma_f32_16x16x32_bf16 v[168:171], v[68:71], a[28:31], v[168:171]
  v_mfma_f32_16x16x32_bf16 v[172:175], v[92:95], a[28:31], v[172:175]
  v_mfma_f32_16x16x32_bf16 v[168:171], v[72:75], a[32:35], v[168:171]
  v_cvt_pk_bf16_f32 v176, v160, v161
  v_mfma_f32_16x16x32_bf16 v[172:175], v[96:99], a[32:35], v[172:175]
  v_cvt_pk_bf16_f32 v177, v162, v163
  v_mfma_f32_16x16x32_bf16 v[168:171], v[76:79], a[36:39], v[168:171]
  v_cvt_pk_bf16_f32 v178, v164, v165
  v_mfma_f32_16x16x32_bf16 v[172:175], v[100:103], a[36:39], v[172:175]
  v_cvt_pk_bf16_f32 v179, v166, v167
  v_mfma_f32_16x16x32_bf16 v[168:171], v[80:83], a[40:43], v[168:171]
  buffer_store_dwordx4 v[176:179], v8, s[4:7], s24 offen offset:0 sc1
  v_mfma_f32_16x16x32_bf16 v[172:175], v[104:107], a[40:43], v[172:175]
  v_mfma_f32_16x16x32_bf16 v[168:171], v[84:87], a[44:47], v[168:171]
  v_mfma_f32_16x16x32_bf16 v[172:175], v[108:111], a[44:47], v[172:175]
  v_mfma_f32_16x16x32_bf16 v[160:163], v[64:67], a[48:51], 0
  v_mfma_f32_16x16x32_bf16 v[164:167], v[88:91], a[48:51], 0
  v_mfma_f32_16x16x32_bf16 v[160:163], v[68:71], a[52:55], v[160:163]
  v_mfma_f32_16x16x32_bf16 v[164:167], v[92:95], a[52:55], v[164:167]
  v_mfma_f32_16x16x32_bf16 v[160:163], v[72:75], a[56:59], v[160:163]
  v_cvt_pk_bf16_f32 v180, v168, v169
  v_mfma_f32_16x16x32_bf16 v[164:167], v[96:99], a[56:59], v[164:167]
  v_cvt_pk_bf16_f32 v181, v170, v171
  v_mfma_f32_16x16x32_bf16 v[160:163], v[76:79], a[60:63], v[160:163]
  v_cvt_pk_bf16_f32 v182, v172, v173
  v_mfma_f32_16x16x32_bf16 v[164:167], v[100:103], a[60:63], v[164:167]
  v_cvt_pk_bf16_f32 v183, v174, v175
  v_mfma_f32_16x16x32_bf16 v[160:163], v[80:83], a[64:67], v[160:163]
  buffer_store_dwordx4 v[180:183], v8, s[4:7], s24 offen offset:1024 sc1
  v_mfma_f32_16x16x32_bf16 v[164:167], v[104:107], a[64:67], v[164:167]
  v_mfma_f32_16x16x32_bf16 v[160:163], v[84:87], a[68:71], v[160:163]
  v_mfma_f32_16x16x32_bf16 v[164:167], v[108:111], a[68:71], v[164:167]
  s_waitcnt vmcnt(2)
  v_mov_b32 v9, s16
  s_mov_b64 exec, 1
  buffer_store_dword v9, off, s[4:7], s30 sc1
  s_mov_b64 exec, -1
  s_mov_b32 s18, 0
  v_cmp_gt_u32 vcc, s17, v10
  s_cbranch_vccnz u_14
  s_add_u32 s12, s23, 0
  buffer_load_dwordx4 v[112:115], v8, s[4:7], s12 offen offset:0
  buffer_load_dwordx4 v[116:119], v8, s[4:7], s12 offen offset:1024
  buffer_load_dwordx4 v[120:123], v8, s[4:7], s12 offen offset:2048
  buffer_load_dwordx4 v[124:127], v8, s[4:7], s12 offen offset:3072
  s_add_u32 s12, s23, 4096
  buffer_load_dwordx4 v[128:131], v8, s[4:7], s12 offen offset:0
  buffer_load_dwordx4 v[132:135], v8, s[4:7], s12 offen offset:1024
  buffer_load_dwordx4 v[136:139], v8, s[4:7], s12 offen offset:2048
  buffer_load_dwordx4 v[140:143], v8, s[4:7], s12 offen offset:3072
  s_add_u32 s12, s23, 8192
  buffer_load_dwordx4 v[144:147], v8, s[4:7], s12 offen offset:0
  buffer_load_dwordx4 v[148:151], v8, s[4:7], s12 offen offset:1024
  buffer_load_dwordx4 v[152:155], v8, s[4:7], s12 offen offset:2048
  buffer_load_dwordx4 v[156:159], v8, s[4:7], s12 offen offset:3072
  s_add_u32 s23, s23, 393216
  s_mov_b32 s18, 1
u_14:
  v_mfma_f32_16x16x32_bf16 v[168:171], v[64:67], a[72:75], 0
  v_mfma_f32_16x16x32_bf16 v[172:175], v[88:91], a[72:75], 0
  v_mfma_f32_16x16x32_bf16 v[168:171], v[68:71], a[76:79], v[168:171]
  v_mfma_f32_16x16x32_bf16 v[172:175], v[92:95], a[76:79], v[172:175]
  v_mfma_f32_16x16x32_bf16 v[168:171], v[72:75], a[80:83], v[168:171]
  v_cvt_pk_bf16_f32 v176, v160, v161
  v_mfma_f32_16x16x32_bf16 v[172:175], v[96:99], a[80:83], v[172:175]
  v_cvt_pk_bf16_f32 v177, v162, v163
  v_mfma_f32_16x16x32_bf16 v[168:171], v[76:79], a[84:87], v[168:171]
  v_cvt_pk_bf16_f32 v178, v164, v165
  v_mfma_f32_16x16x32_bf16 v[172:175], v[100:103], a[84:87], v[172:175]
  v_cvt_pk_bf16_f32 v179, v166, v167
  v_mfma_f32_16x16x32_bf16 v[168:171], v[80:83], a[88:91], v[168:171]
  buffer_store_dwordx4 v[176:179], v8, s[4:7], s24 offen offset:2048 sc1
  v_mfma_f32_16x16x32_bf16 v[172:175], v[104:107], a[88:91], v[172:175]
  v_mfma_f32_16x16x32_bf16 v[168:171], v[84:87], a[92:95], v[168:171]
  v_mfma_f32_16x16x32_bf16 v[172:175], v[108:111], a[92:95], v[172:175]
  v_mfma_f32_16x16x32_bf16 v[160:163], v[64:67], a[96:99], 0
  v_mfma_f32_16x16x32_bf16 v[164:167], v[88:91], a[96:99], 0
  v_mfma_f32_16x16x32_bf16 v[160:163], v[68:71], a[100:103], v[160:163]
  v_mfma_f32_16x16x32_bf16 v[164:167], v[92:95], a[100:103], v[164:167]
  v_mfma_f32_16x16x32_bf16 v[160:163], v[72:75], a[104:107], v[160:163]
  v_cvt_pk_bf16_f32 v180, v168, v169
  v_mfma_f32_16x16x32_bf16 v[164:167], v[96:99], a[104:107], v[164:167]
  v_cvt_pk_bf16_f32 v181, v170, v171
  v_mfma_f32_16x16x32_bf16 v[160:163], v[76:79], a[108:111], v[160:163]
  v_cvt_pk_bf16_f32 v182, v172, v173
  v_mfma_f32_16x16x32_bf16 v[164:167], v[100:103], a[108:111], v[164:167]
  v_cvt_pk_bf16_f32 v183, v174, v175
  v_mfma_f32_16x16x32_bf16 v[160:163], v[80:83], a[112:115], v[160:163]
  buffer_store_dwordx4 v[180:183], v8, s[4:7], s24 offen offset:3072 sc1
  s_add_u32 s24, s24, 4096
  v_mfma_f32_16x16x32_bf16 v[164:167], v[104:107], a[112:115], v[164:167]
  v_mfma_f32_16x16x32_bf16 v[160:163], v[84:87], a[116:119], v[160:163]
  v_mfma_f32_16x16x32_bf16 v[164:167], v[108:111], a[116:119], v[164:167]
  v_mfma_f32_16x16x32_bf16 v[168:171], v[64:67], a[120:123], 0
  v_mfma_f32_16x16x32_bf16 v[172:175], v[88:91], a[120:123], 0
  v_mfma_f32_16x16x32_bf16 v[168:171], v[68:71], a[124:127], v[168:171]
  v_mfma_f32_16x16x32_bf16 v[172:175], v[92:95], a[124:127], v[172:175]
  v_mfma_f32_16x16x32_bf16 v[168:171], v[72:75], a[128:131], v[168:171]
  v_cvt_pk_bf16_f32 v176, v160, v161
  v_mfma_f32_16x16x32_bf16 v[172:175], v[96:99], a[128:131], v[172:175]
  v_cvt_pk_bf16_f32 v177, v162, v163
  v_mfma_f32_16x16x32_bf16 v[168:171], v[76:79], a[132:135], v[168:171]
  v_cvt_pk_bf16_f32 v178, v164, v165
  v_mfma_f32_16x16x32_bf16 v[172:175], v[100:103], a[132:135], v[172:175]
  v_cvt_pk_bf16_f32 v179, v166, v167
  v_mfma_f32_16x16x32_bf16 v[168:171], v[80:83], a[136:139], v[168:171]
  buffer_store_dwordx4 v[176:179], v8, s[4:7], s24 offen offset:0 sc1
  v_mfma_f32_16x16x32_bf16 v[172:175], v[104:107], a[136:139], v[172:175]
  v_mfma_f32_16x16x32_bf16 v[168:171], v[84:87], a[140:143], v[168:171]
  v_mfma_f32_16x16x32_bf16 v[172:175], v[108:111], a[140:143], v[172:175]
  buffer_load_dword v10, v3, s[4:7], s66 offen sc1
  v_mfma_f32_16x16x32_bf16 v[160:163], v[64:67], a[144:147], 0
  v_mfma_f32_16x16x32_bf16 v[164:167], v[88:91], a[144:147], 0
  v_mfma_f32_16x16x32_bf16 v[160:163], v[68:71], a[148:151], v[160:163]
  v_mfma_f32_16x16x32_bf16 v[164:167], v[92:95], a[148:151], v[164:167]
  v_mfma_f32_16x16x32_bf16 v[160:163], v[72:75], a[152:155], v[160:163]
  v_cvt_pk_bf16_f32 v180, v168, v169
  v_mfma_f32_16x16x32_bf16 v[164:167], v[96:99], a[152:155], v[164:167]
  v_cvt_pk_bf16_f32 v181, v170, v171
  v_mfma_f32_16x16x32_bf16 v[160:163], v[76:79], a[156:159], v[160:163]
  v_cvt_pk_bf16_f32 v182, v172, v173
  v_mfma_f32_16x16x32_bf16 v[164:167], v[100:103], a[156:159], v[164:167]
  v_cvt_pk_bf16_f32 v183, v174, v175
  v_mfma_f32_16x16x32_bf16 v[160:163], v[80:83], a[160:163], v[160:163]
  buffer_store_dwordx4 v[180:183], v8, s[4:7], s24 offen offset:1024 sc1
  v_mfma_f32_16x16x32_bf16 v[164:167], v[104:107], a[160:163], v[164:167]
  v_mfma_f32_16x16x32_bf16 v[160:163], v[84:87], a[164:167], v[160:163]
  v_mfma_f32_16x16x32_bf16 v[164:167], v[108:111], a[164:167], v[164:167]
  v_mfma_f32_16x16x32_bf16 v[168:171], v[64:67], a[168:171], 0
  v_mfma_f32_16x16x32_bf16 v[172:175], v[88:91], a[168:171], 0
  v_mfma_f32_16x16x32_bf16 v[168:171], v[68:71], a[172:175], v[168:171]
  v_mfma_f32_16x16x32_bf16 v[172:175], v[92:95], a[172:175], v[172:175]
  v_mfma_f32_16x16x32_bf16 v[168:171], v[72:75], a[176:179], v[168:171]
  v_cvt_pk_bf16_f32 v176, v160, v161
  v_mfma_f32_16x16x32_bf16 v[172:175], v[96:99], a[176:179], v[172:175]
  v_cvt_pk_bf16_f32 v177, v162, v163
  v_mfma_f32_16x16x32_bf16 v[168:171], v[76:79], a[180:183], v[168:171]
  v_cvt_pk_bf16_f32 v178, v164, v165
  v_mfma_f32_16x16x32_bf16 v[172:175], v[100:103], a[180:183], v[172:175]
  v_cvt_pk_bf16_f32 v179, v166, v167
  v_mfma_f32_16x16x32_bf16 v[168:171], v[80:83], a[184:187], v[168:171]
  buffer_store_dwordx4 v[176:179], v8, s[4:7], s24 offen offset:2048 sc1
  v_mfma_f32_16x16x32_bf16 v[172:175], v[104:107], a[184:187], v[172:175]
  v_mfma_f32_16x16x32_bf16 v[168:171], v[84:87], a[188:191], v[168:171]
  v_mfma_f32_16x16x32_bf16 v[172:175], v[108:111], a[188:191], v[172:175]
  v_mfma_f32_16x16x32_bf16 v[160:163], v[64:67], a[192:195], 0
  v_mfma_f32_16x16x32_bf16 v[164:167], v[88:91], a[192:195], 0
  v_mfma_f32_16x16x32_bf16 v[160:163], v[68:71], a[196:199], v[160:163]
  v_mfma_f32_16x16x32_bf16 v[164:167], v[92:95], a[196:199], v[164:167]
  v_mfma_f32_16x16x32_bf16 v[160:163], v[72:75], a[200:203], v[160:163]
  v_cvt_pk_bf16_f32 v180, v168, v169
  v_mfma_f32_16x16x32_bf16 v[164:167], v[96:99], a[200:203], v[164:167]
  v_cvt_pk_bf16_f32 v181, v170, v171
  v_mfma_f32_16x16x32_bf16 v[160:163], v[76:79], a[204:207], v[160:163]
  v_cvt_pk_bf16_f32 v182, v172, v173
  v_mfma_f32_16x16x32_bf16 v[164:167], v[100:103], a[204:207], v[164:167]
  v_cvt_pk_bf16_f32 v183, v174, v175
  v_mfma_f32_16x16x32_bf16 v[160:163], v[80:83], a[208:211], v[160:163]
  buffer_store_dwordx4 v[180:183], v8, s[4:7], s24 offen offset:3072 sc1
  s_add_u32 s24, s24, 4096
  v_mfma_f32_16x16x32_bf16 v[164:167], v[104:107], a[208:211], v[164:167]
  v_mfma_f32_16x16x32_bf16 v[160:163], v[84:87], a[212:215], v[160:163]
  v_mfma_f32_16x16x32_bf16 v[164:167], v[108:111], a[212:215], v[164:167]
  s_cmp_lg_u32 s18, 0
  s_cbranch_scc1 u_18
  s_waitcnt vmcnt(3)
  v_cmp_gt_u32 vcc, s17, v10
  s_cbranch_vccnz u_18
  s_add_u32 s12, s23, 0
  buffer_load_dwordx4 v[112:115], v8, s[4:7], s12 offen offset:0
  buffer_load_dwordx4 v[116:119], v8, s[4:7], s12 offen offset:1024
  buffer_load_dwordx4 v[120:123], v8, s[4:7], s12 offen offset:2048
  buffer_load_dwordx4 v[124:127], v8, s[4:7], s12 offen offset:3072
  s_add_u32 s12, s23, 4096
  buffer_load_dwordx4 v[128:131], v8, s[4:7], s12 offen offset:0
  buffer_load_dwordx4 v[132:135], v8, s[4:7], s12 offen offset:1024
  buffer_load_dwordx4 v[136:139], v8, s[4:7], s12 offen offset:2048
  buffer_load_dwordx4 v[140:143], v8, s[4:7], s12 offen offset:3072
  s_add_u32 s12, s23, 8192
  buffer_load_dwordx4 v[144:147], v8, s[4:7], s12 offen offset:0
  buffer_load_dwordx4 v[148:151], v8, s[4:7], s12 offen offset:1024
  buffer_load_dwordx4 v[152:155], v8, s[4:7], s12 offen offset:2048
  buffer_load_dwordx4 v[156:159], v8, s[4:7], s12 offen offset:3072
  s_add_u32 s23, s23, 393216
  s_mov_b32 s18, 2
u_18:
  v_mfma_f32_16x16x32_bf16 v[168:171], v[64:67], a[216:219], 0
  v_mfma_f32_16x16x32_bf16 v[172:175], v[88:91], a[216:219], 0
  v_mfma_f32_16x16x32_bf16 v[168:171], v[68:71], a[220:223], v[168:171]
  v_mfma_f32_16x16x32_bf16 v[172:175], v[92:95], a[220:223], v[172:175]
  v_mfma_f32_16x16x32_bf16 v[168:171], v[72:75], a[224:227], v[168:171]
  v_cvt_pk_bf16_f32 v176, v160, v161
  v_mfma_f32_16x16x32_bf16 v[172:175], v[96:99], a[224:227], v[172:175]
  v_cvt_pk_bf16_f32 v177, v162, v163
  v_mfma_f32_16x16x32_bf16 v[168:171], v[76:79], a[228:231], v[168:171]
  v_cvt_pk_bf16_f32 v178, v164, v165
  v_mfma_f32_16x16x32_bf16 v[172:175], v[100:103], a[228:231], v[172:175]
  v_cvt_pk_bf16_f32 v179, v166, v167
  v_mfma_f32_16x16x32_bf16 v[168:171], v[80:83], a[232:235], v[168:171]
  buffer_store_dwordx4 v[176:179], v8, s[4:7], s24 offen offset:0 sc1
  v_mfma_f32_16x16x32_bf16 v[172:175], v[104:107], a[232:235], v[172:175]
  v_mfma_f32_16x16x32_bf16 v[168:171], v[84:87], a[236:239], v[168:171]
  v_mfma_f32_16x16x32_bf16 v[172:175], v[108:111], a[236:239], v[172:175]
  s_nop 4
  v_cvt_pk_bf16_f32 v180, v168, v169
  v_cvt_pk_bf16_f32 v181, v170, v171
  s_nop 0
  v_cvt_pk_bf16_f32 v182, v172, v173
  v_cvt_pk_bf16_f32 v183, v174, v175
  buffer_store_dwordx4 v[180:183], v8, s[4:7], s24 offen offset:1024 sc1
  s_add_u32 s24, s24, 1302528
  s_add_u32 s16, s16, 1
  s_cmp_lg_u32 s18, 0
  s_cbranch_scc1 u_19
  s_waitcnt vmcnt(0)
  s_cmp_eq_u32 s16, 0
  s_cbranch_scc1 u_22
  v_mov_b32 v9, s16
  s_mov_b64 exec, 1
  buffer_store_dword v9, off, s[4:7], s30 sc1
  s_mov_b64 exec, -1
u_22:
  s_add_u32 s17, s16, 1
  s_branch wf_24
wf_23:
  s_sleep 2
  s_add_u32 s11, s11, 1
  s_cmp_gt_u32 s11, 131072
  s_cbranch_scc1 mega_done
wf_24:
  buffer_load_dword v9, v3, s[4:7], s66 offen sc1
  s_waitcnt vmcnt(0)
  v_cmp_gt_u32 vcc, s17, v9
  s_cbranch_vccnz wf_23
  s_add_u32 s12, s23, 0
  buffer_load_dwordx4 v[112:115], v8, s[4:7], s12 offen offset:0
  buffer_load_dwordx4 v[116:119], v8, s[4:7], s12 offen offset:1024
  buffer_load_dwordx4 v[120:123], v8, s[4:7], s12 offen offset:2048
  buffer_load_dwordx4 v[124:127], v8, s[4:7], s12 offen offset:3072
  s_add_u32 s12, s23, 4096
  buffer_load_dwordx4 v[128:131], v8, s[4:7], s12 offen offset:0
  buffer_load_dwordx4 v[132:135], v8, s[4:7], s12 offen offset:1024
  buffer_load_dwordx4 v[136:139], v8, s[4:7], s12 offen offset:2048
  buffer_load_dwordx4 v[140:143], v8, s[4:7], s12 offen offset:3072
  s_add_u32 s12, s23, 8192
  buffer_load_dwordx4 v[144:147], v8, s[4:7], s12 offen offset:0
  buffer_load_dwordx4 v[148:151], v8, s[4:7], s12 offen offset:1024
  buffer_load_dwordx4 v[152:155], v8, s[4:7], s12 offen offset:2048
  buffer_load_dwordx4 v[156:159], v8, s[4:7], s12 offen offset:3072
  s_add_u32 s23, s23, 393216
  s_waitcnt vmcnt(0)
  s_branch u_20
u_19:
  s_waitcnt vmcnt(9)
  s_cmp_lt_u32 s16, 4
  s_cselect_b32 s18, 2, s18
  s_cmp_eq_u32 s18, 1
  s_cbranch_scc1 u_20
  s_waitcnt vmcnt(0)
  v_mov_b32 v9, s16
  s_mov_b64 exec, 1
  buffer_store_dword v9, off, s[4:7], s30 sc1
  s_mov_b64 exec, -1
u_20:
  buffer_load_dword v10, v3, s[4:7], s66 offen sc1
  s_add_u32 s17, s16, 2
  v_mfma_f32_16x16x32_bf16 v[160:163], v[112:115], a[0:3], 0
  v_mfma_f32_16x16x32_bf16 v[164:167], v[136:139], a[0:3], 0
  v_mfma_f32_16x16x32_bf16 v[160:163], v[116:119], a[4:7], v[160:163]
  v_mfma_f32_16x16x32_bf16 v[164:167], v[140:143], a[4:7], v[164:167]
  v_mfma_f32_16x16x32_bf16 v[160:163], v[120:123], a[8:11], v[160:163]
  v_mfma_f32_16x16x32_bf16 v[164:167], v[144:147], a[8:11], v[164:167]
  v_mfma_f32_16x16x32_bf16 v[160:163], v[124:127], a[12:15], v[160:163]
  v_mfma_f32_16x16x32_bf16 v[164:167], v[148:151], a[12:15], v[164:167]
  v_mfma_f32_16x16x32_bf16 v[160:163], v[128:131], a[16:19], v[160:163]
  v_mfma_f32_16x16x32_bf16 v[164:167], v[152:155], a[16:19], v[164:167]
  v_mfma_f32_16x16x32_bf16 v[160:163], v[132:135], a[20:23], v[160:163]
  v_mfma_f32_16x16x32_bf16 v[164:167], v[156:159], a[20:23], v[164:167]
  v_mfma_f32_16x16x32_bf16 v[168:171], v[112:115], a[24:27], 0
  v_mfma_f32_16x16x32_bf16 v[172:175], v[136:139], a[24:27], 0
  v_mfma_f32_16x16x32_bf16 v[168:171], v[116:119], a[28:31], v[168:171]
  v_mfma_f32_16x16x32_bf16 v[172:175], v[140:143], a[28:31], v[172:175]
  v_mfma_f32_16x16x32_bf16 v[168:171], v[120:123], a[32:35], v[168:171]
  v_cvt_pk_bf16_f32 v176, v160, v161
  v_mfma_f32_16x16x32_bf16 v[172:175], v[144:147], a[32:35], v[172:175]
  v_cvt_pk_bf16_f32 v177, v162, v163
  v_mfma_f32_16x16x32_bf16 v[168:171], v[124:127], a[36:39], v[168:171]
  v_cvt_pk_bf16_f32 v178, v164, v165
  v_mfma_f32_16x16x32_bf16 v[172:175], v[148:151], a[36:39], v[172:175]
  v_cvt_pk_bf16_f32 v179, v166, v167
  v_mfma_f32_16x16x32_bf16 v[168:171], v[128:131], a[40:43], v[168:171]
  buffer_store_dwordx4 v[176:179], v8, s[4:7], s24 offen offset:0 sc1
  v_mfma_f32_16x16x32_bf16 v[172:175], v[152:155], a[40:43], v[172:175]
  v_mfma_f32_16x16x32_bf16 v[168:171], v[132:135], a[44:47], v[168:171]
  v_mfma_f32_16x16x32_bf16 v[172:175], v[156:159], a[44:47], v[172:175]
  v_mfma_f32_16x16x32_bf16 v[160:163], v[112:115], a[48:51], 0
  v_mfma_f32_16x16x32_bf16 v[164:167], v[136:139], a[48:51], 0
  v_mfma_f32_16x16x32_bf16 v[160:163], v[116:119], a[52:55], v[160:163]
  v_mfma_f32_16x16x32_bf16 v[164:167], v[140:143], a[52:55], v[164:167]
  v_mfma_f32_16x16x32_bf16 v[160:163], v[120:123], a[56:59], v[160:163]
  v_cvt_pk_bf16_f32 v180, v168, v169
  v_mfma_f32_16x16x32_bf16 v[164:167], v[144:147], a[56:59], v[164:167]
  v_cvt_pk_bf16_f32 v181, v170, v171
  v_mfma_f32_16x16x32_bf16 v[160:163], v[124:127], a[60:63], v[160:163]
  v_cvt_pk_bf16_f32 v182, v172, v173
  v_mfma_f32_16x16x32_bf16 v[164:167], v[148:151], a[60:63], v[164:167]
  v_cvt_pk_bf16_f32 v183, v174, v175
  v_mfma_f32_16x16x32_bf16 v[160:163], v[128:131], a[64:67], v[160:163]
  buffer_store_dwordx4 v[180:183], v8, s[4:7], s24 offen offset:1024 sc1
  v_mfma_f32_16x16x32_bf16 v[164:167], v[152:155], a[64:67], v[164:167]
  v_mfma_f32_16x16x32_bf16 v[160:163], v[132:135], a[68:71], v[160:163]
  v_mfma_f32_16x16x32_bf16 v[164:167], v[156:159], a[68:71], v[164:167]
  s_waitcnt vmcnt(2)
  v_mov_b32 v9, s16
  s_mov_b64 exec, 1
  buffer_store_dword v9, off, s[4:7], s30 sc1
  s_mov_b64 exec, -1
  s_mov_b32 s18, 0
  v_cmp_gt_u32 vcc, s17, v10
  s_cbranch_vccnz u_21
  s_add_u32 s12, s23, 0
  buffer_load_dwordx4 v[64:67], v8, s[4:7], s12 offen offset:0
  buffer_load_dwordx4 v[68:71], v8, s[4:7], s12 offen offset:1024
  buffer_load_dwordx4 v[72:75], v8, s[4:7], s12 offen offset:2048
  buffer_load_dwordx4 v[76:79], v8, s[4:7], s12 offen offset:3072
  s_add_u32 s12, s23, 4096
  buffer_load_dwordx4 v[80:83], v8, s[4:7], s12 offen offset:0
  buffer_load_dwordx4 v[84:87], v8, s[4:7], s12 offen offset:1024
  buffer_load_dwordx4 v[88:91], v8, s[4:7], s12 offen offset:2048
  buffer_load_dwordx4 v[92:95], v8, s[4:7], s12 offen offset:3072
  s_add_u32 s12, s23, 8192
  buffer_load_dwordx4 v[96:99], v8, s[4:7], s12 offen offset:0
  buffer_load_dwordx4 v[100:103], v8, s[4:7], s12 offen offset:1024
  buffer_load_dwordx4 v[104:107], v8, s[4:7], s12 offen offset:2048
  buffer_load_dwordx4 v[108:111], v8, s[4:7], s12 offen offset:3072
  s_add_u32 s23, s23, 393216
  s_mov_b32 s18, 1
u_21:
  v_mfma_f32_16x16x32_bf16 v[168:171], v[112:115], a[72:75], 0
  v_mfma_f32_16x16x32_bf16 v[172:175], v[136:139], a[72:75], 0
  v_mfma_f32_16x16x32_bf16 v[168:171], v[116:119], a[76:79], v[168:171]
  v_mfma_f32_16x16x32_bf16 v[172:175], v[140:143], a[76:79], v[172:175]
  v_mfma_f32_16x16x32_bf16 v[168:171], v[120:123], a[80:83], v[168:171]
  v_cvt_pk_bf16_f32 v176, v160, v161
  v_mfma_f32_16x16x32_bf16 v[172:175], v[144:147], a[80:83], v[172:175]
  v_cvt_pk_bf16_f32 v177, v162, v163
  v_mfma_f32_16x16x32_bf16 v[168:171], v[124:127], a[84:87], v[168:171]
  v_cvt_pk_bf16_f32 v178, v164, v165
  v_mfma_f32_16x16x32_bf16 v[172:175], v[148:151], a[84:87], v[172:175]
  v_cvt_pk_bf16_f32 v179, v166, v167
  v_mfma_f32_16x16x32_bf16 v[168:171], v[128:131], a[88:91], v[168:171]
  buffer_store_dwordx4 v[176:179], v8, s[4:7], s24 offen offset:2048 sc1
  v_mfma_f32_16x16x32_bf16 v[172:175], v[152:155], a[88:91], v[172:175]
  v_mfma_f32_16x16x32_bf16 v[168:171], v[132:135], a[92:95], v[168:171]
  v_mfma_f32_16x16x32_bf16 v[172:175], v[156:159], a[92:95], v[172:175]
  v_mfma_f32_16x16x32_bf16 v[160:163], v[112:115], a[96:99], 0
  v_mfma_f32_16x16x32_bf16 v[164:167], v[136:139], a[96:99], 0
  v_mfma_f32_16x16x32_bf16 v[160:163], v[116:119], a[100:103], v[160:163]
  v_mfma_f32_16x16x32_bf16 v[164:167], v[140:143], a[100:103], v[164:167]
  v_mfma_f32_16x16x32_bf16 v[160:163], v[120:123], a[104:107], v[160:163]
  v_cvt_pk_bf16_f32 v180, v168, v169
  v_mfma_f32_16x16x32_bf16 v[164:167], v[144:147], a[104:107], v[164:167]
  v_cvt_pk_bf16_f32 v181, v170, v171
  v_mfma_f32_16x16x32_bf16 v[160:163], v[124:127], a[108:111], v[160:163]
  v_cvt_pk_bf16_f32 v182, v172, v173
  v_mfma_f32_16x16x32_bf16 v[164:167], v[148:151], a[108:111], v[164:167]
  v_cvt_pk_bf16_f32 v183, v174, v175
  v_mfma_f32_16x16x32_bf16 v[160:163], v[128:131], a[112:115], v[160:163]
  buffer_store_dwordx4 v[180:183], v8, s[4:7], s24 offen offset:3072 sc1
  s_add_u32 s24, s24, 4096
  v_mfma_f32_16x16x32_bf16 v[164:167], v[152:155], a[112:115], v[164:167]
  v_mfma_f32_16x16x32_bf16 v[160:163], v[132:135], a[116:119], v[160:163]
  v_mfma_f32_16x16x32_bf16 v[164:167], v[156:159], a[116:119], v[164:167]
  v_mfma_f32_16x16x32_bf16 v[168:171], v[112:115], a[120:123], 0
  v_mfma_f32_16x16x32_bf16 v[172:175], v[136:139], a[120:123], 0
  v_mfma_f32_16x16x32_bf16 v[168:171], v[116:119], a[124:127], v[168:171]
  v_mfma_f32_16x16x32_bf16 v[172:175], v[140:143], a[124:127], v[172:175]
  v_mfma_f32_16x16x32_bf16 v[168:171], v[120:123], a[128:131], v[168:171]
  v_cvt_pk_bf16_f32 v176, v160, v161
  v_mfma_f32_16x16x32_bf16 v[172:175], v[144:147], a[128:131], v[172:175]
  v_cvt_pk_bf16_f32 v177, v162, v163
  v_mfma_f32_16x16x32_bf16 v[168:171], v[124:127], a[132:135], v[168:171]
  v_cvt_pk_bf16_f32 v178, v164, v165
  v_mfma_f32_16x16x32_bf16 v[172:175], v[148:151], a[132:135], v[172:175]
  v_cvt_pk_bf16_f32 v179, v166, v167
  v_mfma_f32_16x16x32_bf16 v[168:171], v[128:131], a[136:139], v[168:171]
  buffer_store_dwordx4 v[176:179], v8, s[4:7], s24 offen offset:0 sc1
  v_mfma_f32_16x16x32_bf16 v[172:175], v[152:155], a[136:139], v[172:175]
  v_mfma_f32_16x16x32_bf16 v[168:171], v[132:135], a[140:143], v[168:171]
  v_mfma_f32_16x16x32_bf16 v[172:175], v[156:159], a[140:143], v[172:175]
  buffer_load_dword v10, v3, s[4:7], s66 offen sc1
  v_mfma_f32_16x16x32_bf16 v[160:163], v[112:115], a[144:147], 0
  v_mfma_f32_16x16x32_bf16 v[164:167], v[136:139], a[144:147], 0
  v_mfma_f32_16x16x32_bf16 v[160:163], v[116:119], a[148:151], v[160:163]
  v_mfma_f32_16x16x32_bf16 v[164:167], v[140:143], a[148:151], v[164:167]
  v_mfma_f32_16x16x32_bf16 v[160:163], v[120:123], a[152:155], v[160:163]
  v_cvt_pk_bf16_f32 v180, v168, v169
  v_mfma_f32_16x16x32_bf16 v[164:167], v[144:147], a[152:155], v[164:167]
  v_cvt_pk_bf16_f32 v181, v170, v171
  v_mfma_f32_16x16x32_bf16 v[160:163], v[124:127], a[156:159], v[160:163]
  v_cvt_pk_bf16_f32 v182, v172, v173
  v_mfma_f32_16x16x32_bf16 v[164:167], v[148:151], a[156:159], v[164:167]
  v_cvt_pk_bf16_f32 v183, v174, v175
  v_mfma_f32_16x16x32_bf16 v[160:163], v[128:131], a[160:163], v[160:163]
  buffer_store_dwordx4 v[180:183], v8, s[4:7], s24 offen offset:1024 sc1
  v_mfma_f32_16x16x32_bf16 v[164:167], v[152:155], a[160:163], v[164:167]
  v_mfma_f32_16x16x32_bf16 v[160:163], v[132:135], a[164:167], v[160:163]
  v_mfma_f32_16x16x32_bf16 v[164:167], v[156:159], a[164:167], v[164:167]
  v_mfma_f32_16x16x32_bf16 v[168:171], v[112:115], a[168:171], 0
  v_mfma_f32_16x16x32_bf16 v[172:175], v[136:139], a[168:171], 0
  v_mfma_f32_16x16x32_bf16 v[168:171], v[116:119], a[172:175], v[168:171]
  v_mfma_f32_16x16x32_bf16 v[172:175], v[140:143], a[172:175], v[172:175]
  v_mfma_f32_16x16x32_bf16 v[168:171], v[120:123], a[176:179], v[168:171]
  v_cvt_pk_bf16_f32 v176, v160, v161
  v_mfma_f32_16x16x32_bf16 v[172:175], v[144:147], a[176:179], v[172:175]
  v_cvt_pk_bf16_f32 v177, v162, v163
  v_mfma_f32_16x16x32_bf16 v[168:171], v[124:127], a[180:183], v[168:171]
  v_cvt_pk_bf16_f32 v178, v164, v165
  v_mfma_f32_16x16x32_bf16 v[172:175], v[148:151], a[180:183], v[172:175]
  v_cvt_pk_bf16_f32 v179, v166, v167
  v_mfma_f32_16x16x32_bf16 v[168:171], v[128:131], a[184:187], v[168:171]
  buffer_store_dwordx4 v[176:179], v8, s[4:7], s24 offen offset:2048 sc1
  v_mfma_f32_16x16x32_bf16 v[172:175], v[152:155], a[184:187], v[172:175]
  v_mfma_f32_16x16x32_bf16 v[168:171], v[132:135], a[188:191], v[168:171]
  v_mfma_f32_16x16x32_bf16 v[172:175], v[156:159], a[188:191], v[172:175]
  v_mfma_f32_16x16x32_bf16 v[160:163], v[112:115], a[192:195], 0
  v_mfma_f32_16x16x32_bf16 v[164:167], v[136:139], a[192:195], 0
  v_mfma_f32_16x16x32_bf16 v[160:163], v[116:119], a[196:199], v[160:163]
  v_mfma_f32_16x16x32_bf16 v[164:167], v[140:143], a[196:199], v[164:167]
  v_mfma_f32_16x16x32_bf16 v[160:163], v[120:123], a[200:203], v[160:163]
  v_cvt_pk_bf16_f32 v180, v168, v169
  v_mfma_f32_16x16x32_bf16 v[164:167], v[144:147], a[200:203], v[164:167]
  v_cvt_pk_bf16_f32 v181, v170, v171
  v_mfma_f32_16x16x32_bf16 v[160:163], v[124:127], a[204:207], v[160:163]
  v_cvt_pk_bf16_f32 v182, v172, v173
  v_mfma_f32_16x16x32_bf16 v[164:167], v[148:151], a[204:207], v[164:167]
  v_cvt_pk_bf16_f32 v183, v174, v175
  v_mfma_f32_16x16x32_bf16 v[160:163], v[128:131], a[208:211], v[160:163]
  buffer_store_dwordx4 v[180:183], v8, s[4:7], s24 offen offset:3072 sc1
  s_add_u32 s24, s24, 4096
  v_mfma_f32_16x16x32_bf16 v[164:167], v[152:155], a[208:211], v[164:167]
  v_mfma_f32_16x16x32_bf16 v[160:163], v[132:135], a[212:215], v[160:163]
  v_mfma_f32_16x16x32_bf16 v[164:167], v[156:159], a[212:215], v[164:167]
  s_cmp_lg_u32 s18, 0
  s_cbranch_scc1 u_25
  s_waitcnt vmcnt(3)
  v_cmp_gt_u32 vcc, s17, v10
  s_cbranch_vccnz u_25
  s_add_u32 s12, s23, 0
  buffer_load_dwordx4 v[64:67], v8, s[4:7], s12 offen offset:0
  buffer_load_dwordx4 v[68:71], v8, s[4:7], s12 offen offset:1024
  buffer_load_dwordx4 v[72:75], v8, s[4:7], s12 offen offset:2048
  buffer_load_dwordx4 v[76:79], v8, s[4:7], s12 offen offset:3072
  s_add_u32 s12, s23, 4096
  buffer_load_dwordx4 v[80:83], v8, s[4:7], s12 offen offset:0
  buffer_load_dwordx4 v[84:87], v8, s[4:7], s12 offen offset:1024
  buffer_load_dwordx4 v[88:91], v8, s[4:7], s12 offen offset:2048
  buffer_load_dwordx4 v[92:95], v8, s[4:7], s12 offen offset:3072
  s_add_u32 s12, s23, 8192
  buffer_load_dwordx4 v[96:99], v8, s[4:7], s12 offen offset:0
  buffer_load_dwordx4 v[100:103], v8, s[4:7], s12 offen offset:1024
  buffer_load_dwordx4 v[104:107], v8, s[4:7], s12 offen offset:2048
  buffer_load_dwordx4 v[108:111], v8, s[4:7], s12 offen offset:3072
  s_add_u32 s23, s23, 393216
  s_mov_b32 s18, 2
u_25:
  v_mfma_f32_16x16x32_bf16 v[168:171], v[112:115], a[216:219], 0
  v_mfma_f32_16x16x32_bf16 v[172:175], v[136:139], a[216:219], 0
  v_mfma_f32_16x16x32_bf16 v[168:171], v[116:119], a[220:223], v[168:171]
  v_mfma_f32_16x16x32_bf16 v[172:175], v[140:143], a[220:223], v[172:175]
  v_mfma_f32_16x16x32_bf16 v[168:171], v[120:123], a[224:227], v[168:171]
  v_cvt_pk_bf16_f32 v176, v160, v161
  v_mfma_f32_16x16x32_bf16 v[172:175], v[144:147], a[224:227], v[172:175]
  v_cvt_pk_bf16_f32 v177, v162, v163
  v_mfma_f32_16x16x32_bf16 v[168:171], v[124:127], a[228:231], v[168:171]
  v_cvt_pk_bf16_f32 v178, v164, v165
  v_mfma_f32_16x16x32_bf16 v[172:175], v[148:151], a[228:231], v[172:175]
  v_cvt_pk_bf16_f32 v179, v166, v167
  v_mfma_f32_16x16x32_bf16 v[168:171], v[128:131], a[232:235], v[168:171]
  buffer_store_dwordx4 v[176:179], v8, s[4:7], s24 offen offset:0 sc1
  v_mfma_f32_16x16x32_bf16 v[172:175], v[152:155], a[232:235], v[172:175]
  v_mfma_f32_16x16x32_bf16 v[168:171], v[132:135], a[236:239], v[168:171]
  v_mfma_f32_16x16x32_bf16 v[172:175], v[156:159], a[236:239], v[172:175]
  s_nop 4
  v_cvt_pk_bf16_f32 v180, v168, v169
  v_cvt_pk_bf16_f32 v181, v170, v171
  s_nop 0
  v_cvt_pk_bf16_f32 v182, v172, v173
  v_cvt_pk_bf16_f32 v183, v174, v175
  buffer_store_dwordx4 v[180:183], v8, s[4:7], s24 offen offset:1024 sc1
  s_add_u32 s24, s24, 1302528
  s_add_u32 s16, s16, 1
  s_cmp_lt_u32 s16, 64
  s_cbranch_scc1 u_loop
  s_waitcnt vmcnt(0)
  v_mov_b32 v9, s16
  s_mov_b64 exec, 1
  buffer_store_dword v9, off, s[4:7], s30 sc1
  s_mov_b64 exec, -1
mega_sp:
  s_lshr_b32 s40, s2, 3
  s_load_dwordx2 s[12:13], s[0:1], 88
  s_mul_i32 s14, s3, 245760
  s_mul_i32 s15, s40, 320
  s_add_u32 s14, s14, s15
  v_lshrrev_b32 v7, 4, v0
  v_lshlrev_b32 v6, 3, v7
  v_bfe_u32 v7, v0, 2, 2
  v_add_u32 v6, v6, v7
  v_mul_u32_u24 v6, 320, v6
  v_and_b32 v7, 3, v0
  v_lshl_add_u32 v6, v7, 4, v6
  s_waitcnt lgkmcnt(0)
  s_add_u32 s12, s12, s14
  s_addc_u32 s13, s13, 0
  s_mul_i32 s14, s3, 40960
  v_add_u32 v6, s14, v6
  v_mul_u32_u24 v5, 3277, v0
  v_lshrrev_b32 v5, 16, v5
  s_mov_b32 s15, 960
  v_mul_lo_u32 v4, v5, s15
  v_lshl_add_u32 v4, v0, 4, v4
  s_mov_b32 exec_lo, 0xffffffff
  s_mov_b32 exec_hi, 0xfffffff
  s_add_u32 m0, s14, 0
  s_nop 0
  global_load_lds_dwordx4 v4, s[12:13]
  s_add_u32 s12, s12, 3840
  s_addc_u32 s13, s13, 0
  s_add_u32 m0, s14, 960
  s_nop 0
  global_load_lds_dwordx4 v4, s[12:13]
  s_add_u32 s12, s12, 3840
  s_addc_u32 s13, s13, 0
  s_add_u32 m0, s14, 1920
  s_nop 0
  global_load_lds_dwordx4 v4, s[12:13]
  s_add_u32 s12, s12, 3840
  s_addc_u32 s13, s13, 0
  s_add_u32 m0, s14, 2880
  s_nop 0
  global_load_lds_dwordx4 v4, s[12:13]
  s_add_u32 s12, s12, 3840
  s_addc_u32 s13, s13, 0
  s_add_u32 m0, s14, 3840
  s_nop 0
  global_load_lds_dwordx4 v4, s[12:13]
  s_add_u32 s12, s12, 3840
  s_addc_u32 s13, s13, 0
  s_add_u32 m0, s14, 4800
  s_nop 0
  global_load_lds_dwordx4 v4, s[12:13]
  s_add_u32 s12, s12, 3840
  s_addc_u32 s13, s13, 0
  s_add_u32 m0, s14, 5760
  s_nop 0
  global_load_lds_dwordx4 v4, s[12:13]
  s_add_u32 s12, s12, 3840
  s_addc_u32 s13, s13, 0
  s_add_u32 m0, s14, 6720
  s_nop 0
  global_load_lds_dwordx4 v4, s[12:13]
  s_add_u32 s12, s12, 3840
  s_addc_u32 s13, s13, 0
  s_add_u32 m0, s14, 7680
  s_nop 0
  global_load_lds_dwordx4 v4, s[12:13]
  s_add_u32 s12, s12, 3840
  s_addc_u32 s13, s13, 0
  s_add_u32 m0, s14, 8640
  s_nop 0
  global_load_lds_dwordx4 v4, s[12:13]
  s_add_u32 s12, s12, 3840
  s_addc_u32 s13, s13, 0
  s_mov_b32 exec_lo, 0xffffffff
  s_mov_b32 exec_hi, 0xff
  s_add_u32 m0, s14, 9600
  s_nop 0
  global_load_lds_dwordx4 v4, s[12:13]
  s_add_u32 s12, s12, 2560
  s_addc_u32 s13, s13, 0
  s_mov_b64 exec, -1
  s_mov_b32 exec_lo, 0xffffffff
  s_mov_b32 exec_hi, 0xfffffff
  s_add_u32 m0, s14, 10240
  s_nop 0
  global_load_lds_dwordx4 v4, s[12:13]
  s_add_u32 s12, s12, 3840
  s_addc_u32 s13, s13, 0
  s_add_u32 m0, s14, 11200
  s_nop 0
  global_load_lds_dwordx4 v4, s[12:13]
  s_add_u32 s12, s12, 3840
  s_addc_u32 s13, s13, 0
  s_add_u32 m0, s14, 12160
  s_nop 0
  global_load_lds_dwordx4 v4, s[12:13]
  s_add_u32 s12, s12, 3840
  s_addc_u32 s13, s13, 0
  s_add_u32 m0, s14, 13120
  s_nop 0
  global_load_lds_dwordx4 v4, s[12:13]
  s_add_u32 s12, s12, 3840
  s_addc_u32 s13, s13, 0
  s_add_u32 m0, s14, 14080
  s_nop 0
  global_load_lds_dwordx4 v4, s[12:13]
  s_add_u32 s12, s12, 3840
  s_addc_u32 s13, s13, 0
  s_add_u32 m0, s14, 15040
  s_nop 0
  global_load_lds_dwordx4 v4, s[12:13]
  s_add_u32 s12, s12, 3840
  s_addc_u32 s13, s13, 0
  s_add_u32 m0, s14, 16000
  s_nop 0
  global_load_lds_dwordx4 v4, s[12:13]
  s_add_u32 s12, s12, 3840
  s_addc_u32 s13, s13, 0
  s_add_u32 m0, s14, 16960
  s_nop 0
  global_load_lds_dwordx4 v4, s[12:13]
  s_add_u32 s12, s12, 3840
  s_addc_u32 s13, s13, 0
  s_add_u32 m0, s14, 17920
  s_nop 0
  global_load_lds_dwordx4 v4, s[12:13]
  s_add_u32 s12, s12, 3840
  s_addc_u32 s13, s13, 0
  s_add_u32 m0, s14, 18880
  s_nop 0
  global_load_lds_dwordx4 v4, s[12:13]
  s_add_u32 s12, s12, 3840
  s_addc_u32 s13, s13, 0
  s_mov_b32 exec_lo, 0xffffffff
  s_mov_b32 exec_hi, 0xff
  s_add_u32 m0, s14, 19840
  s_nop 0
  global_load_lds_dwordx4 v4, s[12:13]
  s_add_u32 s12, s12, 2560
  s_addc_u32 s13, s13, 0
  s_mov_b64 exec, -1
  s_mov_b32 exec_lo, 0xffffffff
  s_mov_b32 exec_hi, 0xfffffff
  s_add_u32 m0, s14, 20480
  s_nop 0
  global_load_lds_dwordx4 v4, s[12:13]
  s_add_u32 s12, s12, 3840
  s_addc_u32 s13, s13, 0
  s_add_u32 m0, s14, 21440
  s_nop 0
  global_load_lds_dwordx4 v4, s[12:13]
  s_add_u32 s12, s12, 3840
  s_addc_u32 s13, s13, 0
  s_add_u32 m0, s14, 22400
  s_nop 0
  global_load_lds_dwordx4 v4, s[12:13]
  s_add_u32 s12, s12, 3840
  s_addc_u32 s13, s13, 0
  s_add_u32 m0, s14, 23360
  s_nop 0
  global_load_lds_dwordx4 v4, s[12:13]
  s_add_u32 s12, s12, 3840
  s_addc_u32 s13, s13, 0
  s_add_u32 m0, s14, 24320
  s_nop 0
  global_load_lds_dwordx4 v4, s[12:13]
  s_add_u32 s12, s12, 3840
  s_addc_u32 s13, s13, 0
  s_add_u32 m0, s14, 25280
  s_nop 0
  global_load_lds_dwordx4 v4, s[12:13]
  s_add_u32 s12, s12, 3840
  s_addc_u32 s13, s13, 0
  s_add_u32 m0, s14, 26240
  s_nop 0
  global_load_lds_dwordx4 v4, s[12:13]
  s_add_u32 s12, s12, 3840
  s_addc_u32 s13, s13, 0
  s_add_u32 m0, s14, 27200
  s_nop 0
  global_load_lds_dwordx4 v4, s[12:13]
  s_add_u32 s12, s12, 3840
  s_addc_u32 s13, s13, 0
  s_add_u32 m0, s14, 28160
  s_nop 0
  global_load_lds_dwordx4 v4, s[12:13]
  s_add_u32 s12, s12, 3840
  s_addc_u32 s13, s13, 0
  s_add_u32 m0, s14, 29120
  s_nop 0
  global_load_lds_dwordx4 v4, s[12:13]
  s_add_u32 s12, s12, 3840
  s_addc_u32 s13, s13, 0
  s_mov_b32 exec_lo, 0xffffffff
  s_mov_b32 exec_hi, 0xff
  s_add_u32 m0, s14, 30080
  s_nop 0
  global_load_lds_dwordx4 v4, s[12:13]
  s_add_u32 s12, s12, 2560
  s_addc_u32 s13, s13, 0
  s_mov_b64 exec, -1
  s_mov_b32 exec_lo, 0xffffffff
  s_mov_b32 exec_hi, 0xfffffff
  s_add_u32 m0, s14, 30720
  s_nop 0
  global_load_lds_dwordx4 v4, s[12:13]
  s_add_u32 s12, s12, 3840
  s_addc_u32 s13, s13, 0
  s_add_u32 m0, s14, 31680
  s_nop 0
  global_load_lds_dwordx4 v4, s[12:13]
  s_add_u32 s12, s12, 3840
  s_addc_u32 s13, s13, 0
  s_add_u32 m0, s14, 32640
  s_nop 0
  global_load_lds_dwordx4 v4, s[12:13]
  s_add_u32 s12, s12, 3840
  s_addc_u32 s13, s13, 0
  s_add_u32 m0, s14, 33600
  s_nop 0
  global_load_lds_dwordx4 v4, s[12:13]
  s_add_u32 s12, s12, 3840
  s_addc_u32 s13, s13, 0
  s_add_u32 m0, s14, 34560
  s_nop 0
  global_load_lds_dwordx4 v4, s[12:13]
  s_add_u32 s12, s12, 3840
  s_addc_u32 s13, s13, 0
  s_add_u32 m0, s14, 35520
  s_nop 0
  global_load_lds_dwordx4 v4, s[12:13]
  s_add_u32 s12, s12, 3840
  s_addc_u32 s13, s13, 0
  s_add_u32 m0, s14, 36480
  s_nop 0
  global_load_lds_dwordx4 v4, s[12:13]
  s_add_u32 s12, s12, 3840
  s_addc_u32 s13, s13, 0
  s_add_u32 m0, s14, 37440
  s_nop 0
  global_load_lds_dwordx4 v4, s[12:13]
  s_add_u32 s12, s12, 3840
  s_addc_u32 s13, s13, 0
  s_add_u32 m0, s14, 38400
  s_nop 0
  global_load_lds_dwordx4 v4, s[12:13]
  s_add_u32 s12, s12, 3840
  s_addc_u32 s13, s13, 0
  s_add_u32 m0, s14, 39360
  s_nop 0
  global_load_lds_dwordx4 v4, s[12:13]
  s_add_u32 s12, s12, 3840
  s_addc_u32 s13, s13, 0
  s_mov_b32 exec_lo, 0xffffffff
  s_mov_b32 exec_hi, 0xff
  s_add_u32 m0, s14, 40320
  s_nop 0
  global_load_lds_dwordx4 v4, s[12:13]
  s_add_u32 s12, s12, 2560
  s_addc_u32 s13, s13, 0
  s_mov_b64 exec, -1
  s_waitcnt vmcnt(33)
  ds_read_b64_tr_b16 a[0:1], v6 offset:0
  ds_read_b64_tr_b16 a[2:3], v6 offset:1280
  ds_read_b64_tr_b16 a[24:25], v6 offset:8
  ds_read_b64_tr_b16 a[26:27], v6 offset:1288
  ds_read_b64_tr_b16 a[48:49], v6 offset:64
  ds_read_b64_tr_b16 a[50:51], v6 offset:1344
  ds_read_b64_tr_b16 a[72:73], v6 offset:72
  ds_read_b64_tr_b16 a[74:75], v6 offset:1352
  ds_read_b64_tr_b16 a[96:97], v6 offset:128
  ds_read_b64_tr_b16 a[98:99], v6 offset:1408
  ds_read_b64_tr_b16 a[120:121], v6 offset:136
  ds_read_b64_tr_b16 a[122:123], v6 offset:1416
  ds_read_b64_tr_b16 a[144:145], v6 offset:192
  ds_read_b64_tr_b16 a[146:147], v6 offset:1472
  ds_read_b64_tr_b16 a[168:169], v6 offset:200
  ds_read_b64_tr_b16 a[170:171], v6 offset:1480
  ds_read_b64_tr_b16 a[192:193], v6 offset:256
  ds_read_b64_tr_b16 a[194:195], v6 offset:1536
  ds_read_b64_tr_b16 a[216:217], v6 offset:264
  ds_read_b64_tr_b16 a[218:219], v6 offset:1544
  s_waitcnt lgkmcnt(0)
  s_mov_b32 exec_lo, 0xffffffff
  s_mov_b32 exec_hi, 0xfffffff
  s_add_u32 m0, s14, 0
  s_nop 0
  global_load_lds_dwordx4 v4, s[12:13]
  s_add_u32 s12, s12, 3840
  s_addc_u32 s13, s13, 0
  s_add_u32 m0, s14, 960
  s_nop 0
  global_load_lds_dwordx4 v4, s[12:13]
  s_add_u32 s12, s12, 3840
  s_addc_u32 s13, s13, 0
  s_add_u32 m0, s14, 1920
  s_nop 0
  global_load_lds_dwordx4 v4, s[12:13]
  s_add_u32 s12, s12, 3840
  s_addc_u32 s13, s13, 0
  s_add_u32 m0, s14, 2880
  s_nop 0
  global_load_lds_dwordx4 v4, s[12:13]
  s_add_u32 s12, s12, 3840
  s_addc_u32 s13, s13, 0
  s_add_u32 m0, s14, 3840
  s_nop 0
  global_load_lds_dwordx4 v4, s[12:13]
  s_add_u32 s12, s12, 3840
  s_addc_u32 s13, s13, 0
  s_add_u32 m0, s14, 4800
  s_nop 0
  global_load_lds_dwordx4 v4, s[12:13]
  s_add_u32 s12, s12, 3840
  s_addc_u32 s13, s13, 0
  s_add_u32 m0, s14, 5760
  s_nop 0
  global_load_lds_dwordx4 v4, s[12:13]
  s_add_u32 s12, s12, 3840
  s_addc_u32 s13, s13, 0
  s_add_u32 m0, s14, 6720
  s_nop 0
  global_load_lds_dwordx4 v4, s[12:13]
  s_add_u32 s12, s12, 3840
  s_addc_u32 s13, s13, 0
  s_add_u32 m0, s14, 7680
  s_nop 0
  global_load_lds_dwordx4 v4, s[12:13]
  s_add_u32 s12, s12, 3840
  s_addc_u32 s13, s13, 0
  s_add_u32 m0, s14, 8640
  s_nop 0
  global_load_lds_dwordx4 v4, s[12:13]
  s_add_u32 s12, s12, 3840
  s_addc_u32 s13, s13, 0
  s_mov_b32 exec_lo, 0xffffffff
  s_mov_b32 exec_hi, 0xff
  s_add_u32 m0, s14, 9600
  s_nop 0
  global_load_lds_dwordx4 v4, s[12:13]
  s_add_u32 s12, s12, 2560
  s_addc_u32 s13, s13, 0
  s_mov_b64 exec, -1
  s_waitcnt vmcnt(33)
  ds_read_b64_tr_b16 a[4:5], v6 offset:10240
  ds_read_b64_tr_b16 a[6:7], v6 offset:11520
  ds_read_b64_tr_b16 a[28:29], v6 offset:10248
  ds_read_b64_tr_b16 a[30:31], v6 offset:11528
  ds_read_b64_tr_b16 a[52:53], v6 offset:10304
  ds_read_b64_tr_b16 a[54:55], v6 offset:11584
  ds_read_b64_tr_b16 a[76:77], v6 offset:10312
  ds_read_b64_tr_b16 a[78:79], v6 offset:11592
  ds_read_b64_tr_b16 a[100:101], v6 offset:10368
  ds_read_b64_tr_b16 a[102:103], v6 offset:11648
  ds_read_b64_tr_b16 a[124:125], v6 offset:10376
  ds_read_b64_tr_b16 a[126:127], v6 offset:11656
  ds_read_b64_tr_b16 a[148:149], v6 offset:10432
  ds_read_b64_tr_b16 a[150:151], v6 offset:11712
  ds_read_b64_tr_b16 a[172:173], v6 offset:10440
  ds_read_b64_tr_b16 a[174:175], v6 offset:11720
  ds_read_b64_tr_b16 a[196:197], v6 offset:10496
  ds_read_b64_tr_b16 a[198:199], v6 offset:11776
  ds_read_b64_tr_b16 a[220:221], v6 offset:10504
  ds_read_b64_tr_b16 a[222:223], v6 offset:11784
  s_waitcnt lgkmcnt(0)
  s_mov_b32 exec_lo, 0xffffffff
  s_mov_b32 exec_hi, 0xfffffff
  s_add_u32 m0, s14, 10240
  s_nop 0
  global_load_lds_dwordx4 v4, s[12:13]
  s_add_u32 s12, s12, 3840
  s_addc_u32 s13, s13, 0
  s_add_u32 m0, s14, 11200
  s_nop 0
  global_load_lds_dwordx4 v4, s[12:13]
  s_add_u32 s12, s12, 3840
  s_addc_u32 s13, s13, 0
  s_add_u32 m0, s14, 12160
  s_nop 0
  global_load_lds_dwordx4 v4, s[12:13]
  s_add_u32 s12, s12, 3840
  s_addc_u32 s13, s13, 0
  s_add_u32 m0, s14, 13120
  s_nop 0
  global_load_lds_dwordx4 v4, s[12:13]
  s_add_u32 s12, s12, 3840
  s_addc_u32 s13, s13, 0
  s_add_u32 m0, s14, 14080
  s_nop 0
  global_load_lds_dwordx4 v4, s[12:13]
  s_add_u32 s12, s12, 3840
  s_addc_u32 s13, s13, 0
  s_add_u32 m0, s14, 15040
  s_nop 0
  global_load_lds_dwordx4 v4, s[12:13]
  s_add_u32 s12, s12, 3840
  s_addc_u32 s13, s13, 0
  s_add_u32 m0, s14, 16000
  s_nop 0
  global_load_lds_dwordx4 v4, s[12:13]
  s_add_u32 s12, s12, 3840
  s_addc_u32 s13, s13, 0
  s_add_u32 m0, s14, 16960
  s_nop 0
  global_load_lds_dwordx4 v4, s[12:13]
  s_add_u32 s12, s12, 3840
  s_addc_u32 s13, s13, 0
  s_add_u32 m0, s14, 17920
  s_nop 0
  global_load_lds_dwordx4 v4, s[12:13]
  s_add_u32 s12, s12, 3840
  s_addc_u32 s13, s13, 0
  s_add_u32 m0, s14, 18880
  s_nop 0
  global_load_lds_dwordx4 v4, s[12:13]
  s_add_u32 s12, s12, 3840
  s_addc_u32 s13, s13, 0
  s_mov_b32 exec_lo, 0xffffffff
  s_mov_b32 exec_hi, 0xff
  s_add_u32 m0, s14, 19840
  s_nop 0
  global_load_lds_dwordx4 v4, s[12:13]
  s_add_u32 s12, s12, 2560
  s_addc_u32 s13, s13, 0
  s_mov_b64 exec, -1
  s_waitcnt vmcnt(33)
  ds_read_b64_tr_b16 a[8:9], v6 offset:20480
  ds_read_b64_tr_b16 a[10:11], v6 offset:21760
  ds_read_b64_tr_b16 a[32:33], v6 offset:20488
  ds_read_b64_tr_b16 a[34:35], v6 offset:21768
  ds_read_b64_tr_b16 a[56:57], v6 offset:20544
  ds_read_b64_tr_b16 a[58:59], v6 offset:21824
  ds_read_b64_tr_b16 a[80:81], v6 offset:20552
  ds_read_b64_tr_b16 a[82:83], v6 offset:21832
  ds_read_b64_tr_b16 a[104:105], v6 offset:20608
  ds_read_b64_tr_b16 a[106:107], v6 offset:21888
  ds_read_b64_tr_b16 a[128:129], v6 offset:20616
  ds_read_b64_tr_b16 a[130:131], v6 offset:21896
  ds_read_b64_tr_b16 a[152:153], v6 offset:20672
  ds_read_b64_tr_b16 a[154:155], v6 offset:21952
  ds_read_b64_tr_b16 a[176:177], v6 offset:20680
  ds_read_b64_tr_b16 a[178:179], v6 offset:21960
  ds_read_b64_tr_b16 a[200:201], v6 offset:20736
  ds_read_b64_tr_b16 a[202:203], v6 offset:22016
  ds_read_b64_tr_b16 a[224:225], v6 offset:20744
  ds_read_b64_tr_b16 a[226:227], v6 offset:22024
  s_waitcnt lgkmcnt(0)
  s_waitcnt vmcnt(22)
  ds_read_b64_tr_b16 a[12:13], v6 offset:30720
  ds_read_b64_tr_b16 a[14:15], v6 offset:32000
  ds_read_b64_tr_b16 a[36:37], v6 offset:30728
  ds_read_b64_tr_b16 a[38:39], v6 offset:32008
  ds_read_b64_tr_b16 a[60:61], v6 offset:30784
  ds_read_b64_tr_b16 a[62:63], v6 offset:32064
  ds_read_b64_tr_b16 a[84:85], v6 offset:30792
  ds_read_b64_tr_b16 a[86:87], v6 offset:32072
  ds_read_b64_tr_b16 a[108:109], v6 offset:30848
  ds_read_b64_tr_b16 a[110:111], v6 offset:32128
  ds_read_b64_tr_b16 a[132:133], v6 offset:30856
  ds_read_b64_tr_b16 a[134:135], v6 offset:32136
  ds_read_b64_tr_b16 a[156:157], v6 offset:30912
  ds_read_b64_tr_b16 a[158:159], v6 offset:32192
  ds_read_b64_tr_b16 a[180:181], v6 offset:30920
  ds_read_b64_tr_b16 a[182:183], v6 offset:32200
  ds_read_b64_tr_b16 a[204:205], v6 offset:30976
  ds_read_b64_tr_b16 a[206:207], v6 offset:32256
  ds_read_b64_tr_b16 a[228:229], v6 offset:30984
  ds_read_b64_tr_b16 a[230:231], v6 offset:32264
  s_waitcnt lgkmcnt(0)
  s_waitcnt vmcnt(11)
  ds_read_b64_tr_b16 a[16:17], v6 offset:0
  ds_read_b64_tr_b16 a[18:19], v6 offset:1280
  ds_read_b64_tr_b16 a[40:41], v6 offset:8
  ds_read_b64_tr_b16 a[42:43], v6 offset:1288
  ds_read_b64_tr_b16 a[64:65], v6 offset:64
  ds_read_b64_tr_b16 a[66:67], v6 offset:1344
  ds_read_b64_tr_b16 a[88:89], v6 offset:72
  ds_read_b64_tr_b16 a[90:91], v6 offset:1352
  ds_read_b64_tr_b16 a[112:113], v6 offset:128
  ds_read_b64_tr_b16 a[114:115], v6 offset:1408
  ds_read_b64_tr_b16 a[136:137], v6 offset:136
  ds_read_b64_tr_b16 a[138:139], v6 offset:1416
  ds_read_b64_tr_b16 a[160:161], v6 offset:192
  ds_read_b64_tr_b16 a[162:163], v6 offset:1472
  ds_read_b64_tr_b16 a[184:185], v6 offset:200
  ds_read_b64_tr_b16 a[186:187], v6 offset:1480
  ds_read_b64_tr_b16 a[208:209], v6 offset:256
  ds_read_b64_tr_b16 a[210:211], v6 offset:1536
  ds_read_b64_tr_b16 a[232:233], v6 offset:264
  ds_read_b64_tr_b16 a[234:235], v6 offset:1544
  s_waitcnt lgkmcnt(0)
  s_waitcnt vmcnt(0)
  ds_read_b64_tr_b16 a[20:21], v6 offset:10240
  ds_read_b64_tr_b16 a[22:23], v6 offset:11520
  ds_read_b64_tr_b16 a[44:45], v6 offset:10248
  ds_read_b64_tr_b16 a[46:47], v6 offset:11528
  ds_read_b64_tr_b16 a[68:69], v6 offset:10304
  ds_read_b64_tr_b16 a[70:71], v6 offset:11584
  ds_read_b64_tr_b16 a[92:93], v6 offset:10312
  ds_read_b64_tr_b16 a[94:95], v6 offset:11592
  ds_read_b64_tr_b16 a[116:117], v6 offset:10368
  ds_read_b64_tr_b16 a[118:119], v6 offset:11648
  ds_read_b64_tr_b16 a[140:141], v6 offset:10376
  ds_read_b64_tr_b16 a[142:143], v6 offset:11656
  ds_read_b64_tr_b16 a[164:165], v6 offset:10432
  ds_read_b64_tr_b16 a[166:167], v6 offset:11712
  ds_read_b64_tr_b16 a[188:189], v6 offset:10440
  ds_read_b64_tr_b16 a[190:191], v6 offset:11720
  ds_read_b64_tr_b16 a[212:213], v6 offset:10496
  ds_read_b64_tr_b16 a[214:215], v6 offset:11776
  ds_read_b64_tr_b16 a[236:237], v6 offset:10504
  ds_read_b64_tr_b16 a[238:239], v6 offset:11784
  s_waitcnt lgkmcnt(0)
  s_cmp_ge_u32 s2, 24
  s_cbranch_scc1 mega_out
  s_mov_b32 s41, 0
  s_mov_b32 s52, 1
  s_branch mega_out3
mega_ret1:
  s_mul_hi_u32 s30, s2, 715827883
  s_mul_i32 s31, s30, 6
  s_sub_u32 s31, s2, s31
  s_sub_u32 s32, s8, 4
  s_lshl_b32 s33, s32, 2
  s_add_u32 s30, s30, s33
  s_mul_i32 s32, s32, 24
  s_add_u32 s32, s32, s2
  s_lshl_b32 s32, s32, 6
  s_add_u32 s32, s32, 182272
  s_add_u32 s32, s32, s66
  s_load_dwordx2 s[12:13], s[0:1], 72
  s_load_dwordx2 s[20:21], s[0:1], 80
  v_lshlrev_b32 v2, 4, v0
  v_bfe_u32 v8, v0, 2, 2
  v_lshlrev_b32 v9, 3, v8
  v_and_b32 v8, 3, v0
  v_add_u32 v9, v9, v8
  v_lshlrev_b32 v10, 12, v9
  v_lshrrev_b32 v8, 4, v0
  v_lshl_add_u32 v10, v8, 4, v10
  v_add_u32 v11, 16384, v10
  s_lshl_b32 s17, s30, 2
  s_add_u32 s17, s17, s3
  s_lshl_b32 s17, s17, 17
  s_lshr_b32 s22, s3, 1
  s_and_b32 s23, s3, 1
  s_lshl_b32 s24, s30, 1
  s_add_u32 s24, s24, s22
  s_lshl_b32 s25, s24, 7
  v_lshlrev_b32 v9, 1, v9
  v_add_u32 v9, s25, v9
  s_waitcnt lgkmcnt(0)
  s_add_u32 s12, s12, s17
  s_addc_u32 s13, s13, 0
  global_load_ushort v12, v9, s[20:21] offset:0
  global_load_ushort v13, v9, s[20:21] offset:8
  global_load_ushort v14, v9, s[20:21] offset:64
  global_load_ushort v15, v9, s[20:21] offset:72
  s_lshl_b32 s14, s31, 2
  s_add_u32 s14, s14, s3
  s_lshl_b32 s14, s14, 11
  s_add_u32 s14, s14, 203423744
  s_lshl_b32 s16, s3, 11
  s_lshl_b32 s17, s22, 12
  v_add_u32 v4, s17, v2
  s_lshl_b32 s17, s23, 12
  s_add_u32 s17, s17, 8192
  v_add_u32 v3, s17, v2
  v_and_b32 v6, 1, v0
  v_mul_u32_u24 v5, 1536, v6
  s_lshl_b32 s17, s31, 7
  s_add_u32 s17, s17, 120576
  v_add_u32 v5, s17, v5
  s_mul_i32 s26, s24, 98304
  s_lshl_b32 s27, s31, 12
  s_add_u32 s26, s26, s27
  s_lshl_b32 s27, s23, 11
  s_add_u32 s26, s26, s27
  s_mov_b32 s15, 0
  s_waitcnt vmcnt(0)
  v_lshlrev_b32 v12, 16, v12
  v_mov_b32 v48, v12
  v_mov_b32 v49, v12
  v_mov_b32 v50, v12
  v_mov_b32 v51, v12
  v_mov_b32 v52, v12
  v_mov_b32 v53, v12
  v_mov_b32 v54, v12
  v_mov_b32 v55, v12
  v_mov_b32 v56, v12
  v_mov_b32 v57, v12
  v_mov_b32 v58, v12
  v_mov_b32 v59, v12
  v_mov_b32 v60, v12
  v_mov_b32 v61, v12
  v_mov_b32 v62, v12
  v_mov_b32 v63, v12
  v_lshlrev_b32 v13, 16, v13
  v_mov_b32 v64, v13
  v_mov_b32 v65, v13
  v_mov_b32 v66, v13
  v_mov_b32 v67, v13
  v_mov_b32 v68, v13
  v_mov_b32 v69, v13
  v_mov_b32 v70, v13
  v_mov_b32 v71, v13
  v_mov_b32 v72, v13
  v_mov_b32 v73, v13
  v_mov_b32 v74, v13
  v_mov_b32 v75, v13
  v_mov_b32 v76, v13
  v_mov_b32 v77, v13
  v_mov_b32 v78, v13
  v_mov_b32 v79, v13
  v_lshlrev_b32 v14, 16, v14
  v_mov_b32 v80, v14
  v_mov_b32 v81, v14
  v_mov_b32 v82, v14
  v_mov_b32 v83, v14
  v_mov_b32 v84, v14
  v_mov_b32 v85, v14
  v_mov_b32 v86, v14
  v_mov_b32 v87, v14
  v_mov_b32 v88, v14
  v_mov_b32 v89, v14
  v_mov_b32 v90, v14
  v_mov_b32 v91, v14
  v_mov_b32 v92, v14
  v_mov_b32 v93, v14
  v_mov_b32 v94, v14
  v_mov_b32 v95, v14
  v_lshlrev_b32 v15, 16, v15
  v_mov_b32 v96, v15
  v_mov_b32 v97, v15
  v_mov_b32 v98, v15
  v_mov_b32 v99, v15
  v_mov_b32 v100, v15
  v_mov_b32 v101, v15
  v_mov_b32 v102, v15
  v_mov_b32 v103, v15
  v_mov_b32 v104, v15
  v_mov_b32 v105, v15
  v_mov_b32 v106, v15
  v_mov_b32 v107, v15
  v_mov_b32 v108, v15
  v_mov_b32 v109, v15
  v_mov_b32 v110, v15
  v_mov_b32 v111, v15
  s_mov_b32 s33, 131072
  s_barrier
sp_top:
  s_cmp_gt_u32 s15, 55
  s_cbranch_scc1 sp_one
  s_add_u32 s18, s15, 4
  v_add_u32 v7, s18, v6
  v_and_b32 v7, 1, v7
  v_xor_b32 v7, 1, v7
  v_sub_u32 v7, s18, v7
  buffer_load_dword v8, v5, s[4:7], s66 offen sc1
  s_waitcnt vmcnt(0)
  v_cmp_gt_u32 vcc, v7, v8
  s_nop 0
  s_cmp_eq_u64 vcc, 0
  s_cselect_b32 s19, 1, 0
  s_cmp_le_u32 s18, 59
  s_cselect_b32 s19, s19, 0
  v_mov_b32 v8, s19
  s_xor_b32 s33, s33, 4
  v_mov_b32 v9, s33
  s_cmp_lg_u32 s3, 0
  s_cbranch_scc1 sp_nba
  ds_write_b32 v9, v8
  s_waitcnt lgkmcnt(0)
sp_nba:
  s_barrier
  ds_read_b32 v8, v9
  s_waitcnt lgkmcnt(0)
  v_readfirstlane_b32 s19, v8
  s_nop 0
  s_cmp_eq_u32 s19, 0
  s_cbranch_scc1 sp_one
  s_add_u32 m0, s16, 0
  s_nop 0
  global_load_lds_dwordx4 v10, s[12:13]
  s_add_u32 m0, s16, 1024
  s_nop 0
  global_load_lds_dwordx4 v11, s[12:13]
  s_add_u32 s12, s12, 64
  s_addc_u32 s13, s13, 0
  s_add_u32 m0, s16, 8192
  s_nop 0
  buffer_load_dwordx4 v2, s[4:7], s14 offen offset:0 lds
  buffer_load_dwordx4 v2, s[4:7], s14 offen offset:1024 lds
  s_add_u32 s14, s14, 49152
  s_add_u32 m0, s16, 16384
  s_nop 0
  global_load_lds_dwordx4 v10, s[12:13]
  s_add_u32 m0, s16, 17408
  s_nop 0
  global_load_lds_dwordx4 v11, s[12:13]
  s_add_u32 s12, s12, 64
  s_addc_u32 s13, s13, 0
  s_add_u32 m0, s16, 24576
  s_nop 0
  buffer_load_dwordx4 v2, s[4:7], s14 offen offset:0 lds
  buffer_load_dwordx4 v2, s[4:7], s14 offen offset:1024 lds
  s_add_u32 s14, s14, 49152
  s_add_u32 m0, s16, 32768
  s_nop 0
  global_load_lds_dwordx4 v10, s[12:13]
  s_add_u32 m0, s16, 33792
  s_nop 0
  global_load_lds_dwordx4 v11, s[12:13]
  s_add_u32 s12, s12, 64
  s_addc_u32 s13, s13, 0
  s_add_u32 m0, s16, 40960
  s_nop 0
  buffer_load_dwordx4 v2, s[4:7], s14 offen offset:0 lds
  buffer_load_dwordx4 v2, s[4:7], s14 offen offset:1024 lds
  s_add_u32 s14, s14, 49152
  s_add_u32 m0, s16, 49152
  s_nop 0
  global_load_lds_dwordx4 v10, s[12:13]
  s_add_u32 m0, s16, 50176
  s_nop 0
  global_load_lds_dwordx4 v11, s[12:13]
  s_add_u32 s12, s12, 64
  s_addc_u32 s13, s13, 0
  s_add_u32 m0, s16, 57344
  s_nop 0
  buffer_load_dwordx4 v2, s[4:7], s14 offen offset:0 lds
  buffer_load_dwordx4 v2, s[4:7], s14 offen offset:1024 lds
  s_add_u32 s14, s14, 49152
  s_xor_b32 s16, s16, 65536
sp_bulk:
  s_add_u32 s18, s15, 8
  v_add_u32 v7, s18, v6
  v_and_b32 v7, 1, v7
  v_xor_b32 v7, 1, v7
  v_sub_u32 v7, s18, v7
  buffer_load_dword v8, v5, s[4:7], s66 offen sc1
  s_waitcnt vmcnt(0)
  v_cmp_gt_u32 vcc, v7, v8
  s_nop 0
  s_cmp_eq_u64 vcc, 0
  s_cselect_b32 s19, 1, 0
  s_cmp_le_u32 s18, 59
  s_cselect_b32 s19, s19, 0
  v_mov_b32 v8, s19
  s_xor_b32 s33, s33, 4
  v_mov_b32 v9, s33
  s_cmp_lg_u32 s3, 0
  s_cbranch_scc1 sp_nbb
  ds_write_b32 v9, v8
  s_waitcnt lgkmcnt(0)
sp_nbb:
  s_barrier
  ds_read_b32 v8, v9
  s_waitcnt lgkmcnt(0)
  v_readfirstlane_b32 s19, v8
  s_nop 0
  s_cmp_eq_u32 s19, 0
  s_cbranch_scc1 sp_nn
  s_add_u32 m0, s16, 0
  s_nop 0
  global_load_lds_dwordx4 v10, s[12:13]
  s_add_u32 m0, s16, 1024
  s_nop 0
  global_load_lds_dwordx4 v11, s[12:13]
  s_add_u32 s12, s12, 64
  s_addc_u32 s13, s13, 0
  s_add_u32 m0, s16, 8192
  s_nop 0
  buffer_load_dwordx4 v2, s[4:7], s14 offen offset:0 lds
  buffer_load_dwordx4 v2, s[4:7], s14 offen offset:1024 lds
  s_add_u32 s14, s14, 49152
  s_add_u32 m0, s16, 16384
  s_nop 0
  global_load_lds_dwordx4 v10, s[12:13]
  s_add_u32 m0, s16, 17408
  s_nop 0
  global_load_lds_dwordx4 v11, s[12:13]
  s_add_u32 s12, s12, 64
  s_addc_u32 s13, s13, 0
  s_add_u32 m0, s16, 24576
  s_nop 0
  buffer_load_dwordx4 v2, s[4:7], s14 offen offset:0 lds
  buffer_load_dwordx4 v2, s[4:7], s14 offen offset:1024 lds
  s_add_u32 s14, s14, 49152
  s_add_u32 m0, s16, 32768
  s_nop 0
  global_load_lds_dwordx4 v10, s[12:13]
  s_add_u32 m0, s16, 33792
  s_nop 0
  global_load_lds_dwordx4 v11, s[12:13]
  s_add_u32 s12, s12, 64
  s_addc_u32 s13, s13, 0
  s_add_u32 m0, s16, 40960
  s_nop 0
  buffer_load_dwordx4 v2, s[4:7], s14 offen offset:0 lds
  buffer_load_dwordx4 v2, s[4:7], s14 offen offset:1024 lds
  s_add_u32 s14, s14, 49152
  s_add_u32 m0, s16, 49152
  s_nop 0
  global_load_lds_dwordx4 v10, s[12:13]
  s_add_u32 m0, s16, 50176
  s_nop 0
  global_load_lds_dwordx4 v11, s[12:13]
  s_add_u32 s12, s12, 64
  s_addc_u32 s13, s13, 0
  s_add_u32 m0, s16, 57344
  s_nop 0
  buffer_load_dwordx4 v2, s[4:7], s14 offen offset:0 lds
  buffer_load_dwordx4 v2, s[4:7], s14 offen offset:1024 lds
  s_add_u32 s14, s14, 49152
  s_xor_b32 s16, s16, 65536
sp_nn:
  ds_read_b128 v[32:35], v4 offset:0
  ds_read_b128 v[36:39], v4 offset:1024
  ds_read_b128 v[40:43], v4 offset:2048
  ds_read_b128 v[44:47], v4 offset:3072
  ds_read_b128 v[16:19], v3 offset:0
  ds_read_b128 v[20:23], v3 offset:1024
  ds_read_b128 v[24:27], v3 offset:2048
  ds_read_b128 v[28:31], v3 offset:3072
  s_waitcnt lgkmcnt(3)
  v_mfma_f32_16x16x32_bf16 v[48:51], v[16:19], v[32:35], v[48:51]
  v_mfma_f32_16x16x32_bf16 v[64:67], v[16:19], v[36:39], v[64:67]
  v_mfma_f32_16x16x32_bf16 v[80:83], v[16:19], v[40:43], v[80:83]
  v_mfma_f32_16x16x32_bf16 v[96:99], v[16:19], v[44:47], v[96:99]
  ds_read_b128 v[224:227], v4 offset:16384
  ds_read_b128 v[228:231], v4 offset:17408
  ds_read_b128 v[232:235], v4 offset:18432
  ds_read_b128 v[236:239], v4 offset:19456
  ds_read_b128 v[240:243], v3 offset:16384
  ds_read_b128 v[244:247], v3 offset:17408
  ds_read_b128 v[248:251], v3 offset:18432
  ds_read_b128 v[252:255], v3 offset:19456
  s_waitcnt lgkmcnt(10)
  v_mfma_f32_16x16x32_bf16 v[52:55], v[20:23], v[32:35], v[52:55]
  v_mfma_f32_16x16x32_bf16 v[68:71], v[20:23], v[36:39], v[68:71]
  v_mfma_f32_16x16x32_bf16 v[84:87], v[20:23], v[40:43], v[84:87]
  v_mfma_f32_16x16x32_bf16 v[100:103], v[20:23], v[44:47], v[100:103]
  s_waitcnt lgkmcnt(9)
  v_mfma_f32_16x16x32_bf16 v[56:59], v[24:27], v[32:35], v[56:59]
  v_mfma_f32_16x16x32_bf16 v[72:75], v[24:27], v[36:39], v[72:75]
  v_mfma_f32_16x16x32_bf16 v[88:91], v[24:27], v[40:43], v[88:91]
  v_mfma_f32_16x16x32_bf16 v[104:107], v[24:27], v[44:47], v[104:107]
  s_waitcnt lgkmcnt(8)
  v_mfma_f32_16x16x32_bf16 v[60:63], v[28:31], v[32:35], v[60:63]
  v_mfma_f32_16x16x32_bf16 v[76:79], v[28:31], v[36:39], v[76:79]
  v_mfma_f32_16x16x32_bf16 v[92:95], v[28:31], v[40:43], v[92:95]
  v_mfma_f32_16x16x32_bf16 v[108:111], v[28:31], v[44:47], v[108:111]
  s_waitcnt lgkmcnt(3)
  v_mfma_f32_16x16x32_bf16 v[48:51], v[240:243], v[224:227], v[48:51]
  v_mfma_f32_16x16x32_bf16 v[64:67], v[240:243], v[228:231], v[64:67]
  v_mfma_f32_16x16x32_bf16 v[80:83], v[240:243], v[232:235], v[80:83]
  v_mfma_f32_16x16x32_bf16 v[96:99], v[240:243], v[236:239], v[96:99]
  ds_read_b128 v[32:35], v4 offset:32768
  ds_read_b128 v[36:39], v4 offset:33792
  ds_read_b128 v[40:43], v4 offset:34816
  ds_read_b128 v[44:47], v4 offset:35840
  ds_read_b128 v[16:19], v3 offset:32768
  ds_read_b128 v[20:23], v3 offset:33792
  ds_read_b128 v[24:27], v3 offset:34816
  ds_read_b128 v[28:31], v3 offset:35840
  s_waitcnt lgkmcnt(10)
  v_mfma_f32_16x16x32_bf16 v[52:55], v[244:247], v[224:227], v[52:55]
  v_mfma_f32_16x16x32_bf16 v[68:71], v[244:247], v[228:231], v[68:71]
  v_mfma_f32_16x16x32_bf16 v[84:87], v[244:247], v[232:235], v[84:87]
  v_mfma_f32_16x16x32_bf16 v[100:103], v[244:247], v[236:239], v[100:103]
  s_waitcnt lgkmcnt(9)
  v_mfma_f32_16x16x32_bf16 v[56:59], v[248:251], v[224:227], v[56:59]
  v_mfma_f32_16x16x32_bf16 v[72:75], v[248:251], v[228:231], v[72:75]
  v_mfma_f32_16x16x32_bf16 v[88:91], v[248:251], v[232:235], v[88:91]
  v_mfma_f32_16x16x32_bf16 v[104:107], v[248:251], v[236:239], v[104:107]
  s_waitcnt lgkmcnt(8)
  v_mfma_f32_16x16x32_bf16 v[60:63], v[252:255], v[224:227], v[60:63]
  v_mfma_f32_16x16x32_bf16 v[76:79], v[252:255], v[228:231], v[76:79]
  v_mfma_f32_16x16x32_bf16 v[92:95], v[252:255], v[232:235], v[92:95]
  v_mfma_f32_16x16x32_bf16 v[108:111], v[252:255], v[236:239], v[108:111]
  s_waitcnt lgkmcnt(3)
  v_mfma_f32_16x16x32_bf16 v[48:51], v[16:19], v[32:35], v[48:51]
  v_mfma_f32_16x16x32_bf16 v[64:67], v[16:19], v[36:39], v[64:67]
  v_mfma_f32_16x16x32_bf16 v[80:83], v[16:19], v[40:43], v[80:83]
  v_mfma_f32_16x16x32_bf16 v[96:99], v[16:19], v[44:47], v[96:99]
  ds_read_b128 v[224:227], v4 offset:49152
  ds_read_b128 v[228:231], v4 offset:50176
  ds_read_b128 v[232:235], v4 offset:51200
  ds_read_b128 v[236:239], v4 offset:52224
  ds_read_b128 v[240:243], v3 offset:49152
  ds_read_b128 v[244:247], v3 offset:50176
  ds_read_b128 v[248:251], v3 offset:51200
  ds_read_b128 v[252:255], v3 offset:52224
  s_waitcnt lgkmcnt(10)
  v_mfma_f32_16x16x32_bf16 v[52:55], v[20:23], v[32:35], v[52:55]
  v_mfma_f32_16x16x32_bf16 v[68:71], v[20:23], v[36:39], v[68:71]
  v_mfma_f32_16x16x32_bf16 v[84:87], v[20:23], v[40:43], v[84:87]
  v_mfma_f32_16x16x32_bf16 v[100:103], v[20:23], v[44:47], v[100:103]
  s_waitcnt lgkmcnt(9)
  v_mfma_f32_16x16x32_bf16 v[56:59], v[24:27], v[32:35], v[56:59]
  v_mfma_f32_16x16x32_bf16 v[72:75], v[24:27], v[36:39], v[72:75]
  v_mfma_f32_16x16x32_bf16 v[88:91], v[24:27], v[40:43], v[88:91]
  v_mfma_f32_16x16x32_bf16 v[104:107], v[24:27], v[44:47], v[104:107]
  s_waitcnt lgkmcnt(8)
  v_mfma_f32_16x16x32_bf16 v[60:63], v[28:31], v[32:35], v[60:63]
  v_mfma_f32_16x16x32_bf16 v[76:79], v[28:31], v[36:39], v[76:79]
  v_mfma_f32_16x16x32_bf16 v[92:95], v[28:31], v[40:43], v[92:95]
  v_mfma_f32_16x16x32_bf16 v[108:111], v[28:31], v[44:47], v[108:111]
  s_waitcnt lgkmcnt(3)
  v_mfma_f32_16x16x32_bf16 v[48:51], v[240:243], v[224:227], v[48:51]
  v_mfma_f32_16x16x32_bf16 v[64:67], v[240:243], v[228:231], v[64:67]
  v_mfma_f32_16x16x32_bf16 v[80:83], v[240:243], v[232:235], v[80:83]
  v_mfma_f32_16x16x32_bf16 v[96:99], v[240:243], v[236:239], v[96:99]
  s_waitcnt lgkmcnt(2)
  v_mfma_f32_16x16x32_bf16 v[52:55], v[244:247], v[224:227], v[52:55]
  v_mfma_f32_16x16x32_bf16 v[68:71], v[244:247], v[228:231], v[68:71]
  v_mfma_f32_16x16x32_bf16 v[84:87], v[244:247], v[232:235], v[84:87]
  v_mfma_f32_16x16x32_bf16 v[100:103], v[244:247], v[236:239], v[100:103]
  s_waitcnt lgkmcnt(1)
  v_mfma_f32_16x16x32_bf16 v[56:59], v[248:251], v[224:227], v[56:59]
  v_mfma_f32_16x16x32_bf16 v[72:75], v[248:251], v[228:231], v[72:75]
  v_mfma_f32_16x16x32_bf16 v[88:91], v[248:251], v[232:235], v[88:91]
  v_mfma_f32_16x16x32_bf16 v[104:107], v[248:251], v[236:239], v[104:107]
  s_waitcnt lgkmcnt(0)
  v_mfma_f32_16x16x32_bf16 v[60:63], v[252:255], v[224:227], v[60:63]
  v_mfma_f32_16x16x32_bf16 v[76:79], v[252:255], v[228:231], v[76:79]
  v_mfma_f32_16x16x32_bf16 v[92:95], v[252:255], v[232:235], v[92:95]
  v_mfma_f32_16x16x32_bf16 v[108:111], v[252:255], v[236:239], v[108:111]
  v_xor_b32 v3, 65536, v3
  v_xor_b32 v4, 65536, v4
  s_add_u32 s15, s15, 4
  s_cmp_lg_u32 s19, 0
  s_cbranch_scc1 sp_bulk
sp_one:
  s_barrier
  s_add_u32 m0, s16, 0
  s_nop 0
  global_load_lds_dwordx4 v10, s[12:13]
  s_add_u32 m0, s16, 1024
  s_nop 0
  global_load_lds_dwordx4 v11, s[12:13]
  s_add_u32 s12, s12, 64
  s_addc_u32 s13, s13, 0
  s_add_u32 s18, s15, 1
  v_add_u32 v7, s18, v6
  v_and_b32 v7, 1, v7
  v_xor_b32 v7, 1, v7
  v_sub_u32 v7, s18, v7
  s_branch sp_27
sp_26:
  s_sleep 2
  s_add_u32 s11, s11, 1
  s_cmp_gt_u32 s11, 131072
  s_cbranch_scc1 mega_done
sp_27:
  buffer_load_dword v8, v5, s[4:7], s66 offen sc1
  s_waitcnt vmcnt(0)
  v_cmp_gt_u32 vcc, v7, v8
  s_cbranch_vccnz sp_26
  s_add_u32 m0, s16, 8192
  s_nop 0
  buffer_load_dwordx4 v2, s[4:7], s14 offen offset:0 lds
  buffer_load_dwordx4 v2, s[4:7], s14 offen offset:1024 lds
  s_add_u32 s14, s14, 49152
  s_waitcnt vmcnt(0)
  s_barrier
  ds_read_b128 v[32:35], v4 offset:0
  ds_read_b128 v[36:39], v4 offset:1024
  ds_read_b128 v[40:43], v4 offset:2048
  ds_read_b128 v[44:47], v4 offset:3072
  ds_read_b128 v[16:19], v3 offset:0
  ds_read_b128 v[20:23], v3 offset:1024
  ds_read_b128 v[24:27], v3 offset:2048
  ds_read_b128 v[28:31], v3 offset:3072
  s_waitcnt lgkmcnt(3)
  v_mfma_f32_16x16x32_bf16 v[48:51], v[16:19], v[32:35], v[48:51]
  v_mfma_f32_16x16x32_bf16 v[64:67], v[16:19], v[36:39], v[64:67]
  v_mfma_f32_16x16x32_bf16 v[80:83], v[16:19], v[40:43], v[80:83]
  v_mfma_f32_16x16x32_bf16 v[96:99], v[16:19], v[44:47], v[96:99]
  s_waitcnt lgkmcnt(2)
  v_mfma_f32_16x16x32_bf16 v[52:55], v[20:23], v[32:35], v[52:55]
  v_mfma_f32_16x16x32_bf16 v[68:71], v[20:23], v[36:39], v[68:71]
  v_mfma_f32_16x16x32_bf16 v[84:87], v[20:23], v[40:43], v[84:87]
  v_mfma_f32_16x16x32_bf16 v[100:103], v[20:23], v[44:47], v[100:103]
  s_waitcnt lgkmcnt(1)
  v_mfma_f32_16x16x32_bf16 v[56:59], v[24:27], v[32:35], v[56:59]
  v_mfma_f32_16x16x32_bf16 v[72:75], v[24:27], v[36:39], v[72:75]
  v_mfma_f32_16x16x32_bf16 v[88:91], v[24:27], v[40:43], v[88:91]
  v_mfma_f32_16x16x32_bf16 v[104:107], v[24:27], v[44:47], v[104:107]
  s_waitcnt lgkmcnt(0)
  v_mfma_f32_16x16x32_bf16 v[60:63], v[28:31], v[32:35], v[60:63]
  v_mfma_f32_16x16x32_bf16 v[76:79], v[28:31], v[36:39], v[76:79]
  v_mfma_f32_16x16x32_bf16 v[92:95], v[28:31], v[40:43], v[92:95]
  v_mfma_f32_16x16x32_bf16 v[108:111], v[28:31], v[44:47], v[108:111]
  s_add_u32 s15, s15, 1
  s_cmp_lt_u32 s15, 62
  s_cbranch_scc1 sp_top
  s_add_u32 s27, s26, 207618048
  v_cvt_pk_bf16_f32 v160, v48, v49
  v_cvt_pk_bf16_f32 v161, v50, v51
  v_cvt_pk_bf16_f32 v162, v52, v53
  v_cvt_pk_bf16_f32 v163, v54, v55
  buffer_store_dwordx4 v[160:163], v2, s[4:7], s27 offen offset:0 sc1
  v_cvt_pk_bf16_f32 v164, v56, v57
  v_cvt_pk_bf16_f32 v165, v58, v59
  v_cvt_pk_bf16_f32 v166, v60, v61
  v_cvt_pk_bf16_f32 v167, v62, v63
  buffer_store_dwordx4 v[164:167], v2, s[4:7], s27 offen offset:1024 sc1
  s_add_u32 s27, s27, 24576
  v_cvt_pk_bf16_f32 v168, v64, v65
  v_cvt_pk_bf16_f32 v169, v66, v67
  v_cvt_pk_bf16_f32 v170, v68, v69
  v_cvt_pk_bf16_f32 v171, v70, v71
  buffer_store_dwordx4 v[168:171], v2, s[4:7], s27 offen offset:0 sc1
  v_cvt_pk_bf16_f32 v172, v72, v73
  v_cvt_pk_bf16_f32 v173, v74, v75
  v_cvt_pk_bf16_f32 v174, v76, v77
  v_cvt_pk_bf16_f32 v175, v78, v79
  buffer_store_dwordx4 v[172:175], v2, s[4:7], s27 offen offset:1024 sc1
  s_add_u32 s27, s27, 24576
  v_cvt_pk_bf16_f32 v176, v80, v81
  v_cvt_pk_bf16_f32 v177, v82, v83
  v_cvt_pk_bf16_f32 v178, v84, v85
  v_cvt_pk_bf16_f32 v179, v86, v87
  buffer_store_dwordx4 v[176:179], v2, s[4:7], s27 offen offset:0 sc1
  v_cvt_pk_bf16_f32 v180, v88, v89
  v_cvt_pk_bf16_f32 v181, v90, v91
  v_cvt_pk_bf16_f32 v182, v92, v93
  v_cvt_pk_bf16_f32 v183, v94, v95
  buffer_store_dwordx4 v[180:183], v2, s[4:7], s27 offen offset:1024 sc1
  s_add_u32 s27, s27, 24576
  v_cvt_pk_bf16_f32 v184, v96, v97
  v_cvt_pk_bf16_f32 v185, v98, v99
  v_cvt_pk_bf16_f32 v186, v100, v101
  v_cvt_pk_bf16_f32 v187, v102, v103
  buffer_store_dwordx4 v[184:187], v2, s[4:7], s27 offen offset:0 sc1
  v_cvt_pk_bf16_f32 v188, v104, v105
  v_cvt_pk_bf16_f32 v189, v106, v107
  v_cvt_pk_bf16_f32 v190, v108, v109
  v_cvt_pk_bf16_f32 v191, v110, v111
  buffer_store_dwordx4 v[188:191], v2, s[4:7], s27 offen offset:1024 sc1
  s_mov_b32 s19, 1
  s_waitcnt vmcnt(0)
  s_barrier
  s_cmp_lg_u32 s3, 0
  s_cbranch_scc1 sp_29
  v_mov_b32 v8, s19
  s_mov_b64 exec, 1
  buffer_store_dword v8, off, s[4:7], s32 sc1
  s_mov_b64 exec, -1
sp_29:
  s_mov_b32 s41, s51
  s_mov_b32 s52, 2
  s_branch mega_out3
mega_out:
  s_mov_b32 s41, 0
mega_out2:
  s_mov_b32 s52, 0
mega_out3:
  s_xor_b32 s40, s8, 4
  s_lshl_b32 s40, s40, 3
  s_and_b32 s12, s2, 7
  s_add_u32 s40, s40, s12
  s_lshl_b32 s40, s40, 2
  s_lshr_b32 s12, s2, 3
  s_add_u32 s40, s40, s12
  s_load_dwordx2 s[20:21], s[0:1], 96
  s_lshr_b32 s12, s40, 2
  s_and_b32 s13, s40, 3
  s_mul_i32 s14, s12, 49152
  s_mul_i32 s15, s3, 6144
  s_add_u32 s14, s14, s15
  s_add_u32 s14, s14, 207618048
  s_add_u32 s15, s14, 4096
  s_add_u32 s16, s14, 24576
  s_add_u32 s17, s16, 4096
  v_lshlrev_b32 v2, 4, v0
  v_bfe_u32 v3, v0, 2, 2
  v_lshlrev_b32 v3, 3, v3
  v_and_b32 v4, 3, v0
  v_add_u32 v3, v3, v4
  v_mul_u32_u24 v3, 1280, v3
  v_lshrrev_b32 v4, 4, v0
  v_lshl_add_u32 v3, v4, 4, v3
  s_mul_i32 s18, s12, 40960
  s_mul_i32 s19, s13, 320
  s_add_u32 s18, s18, s19
  s_and_b32 s22, s3, 1
  s_lshr_b32 s23, s3, 1
  s_mul_i32 s19, s22, 5120
  s_add_u32 s18, s18, s19
  s_lshl_b32 s19, s23, 6
  s_add_u32 s18, s18, s19
  s_mul_i32 s19, s3, 20480
  v_add_u32 v5, s19, v2
  s_lshl_b32 s19, s22, 10
  s_lshl_b32 s24, s23, 12
  s_add_u32 s19, s19, s24
  v_add_u32 v6, s19, v2
  v_add_u32 v7, 40960, v6
  s_lshr_b32 s19, s12, 2
  s_mul_i32 s19, s19, 384
  s_add_u32 s19, s19, 182272
  v_min_u32 v8, 5, v0
  v_lshlrev_b32 v8, 6, v8
  v_add_u32 v8, s19, v8
  s_mov_b32 s19, 1
  s_waitcnt lgkmcnt(0)
  s_add_u32 s20, s20, s18
  s_addc_u32 s21, s21, 0
  s_mul_i32 s18, s12, 40960
  s_mul_i32 s25, s13, 5120
  s_add_u32 s18, s18, s25
  s_lshl_b32 s25, s23, 10
  s_add_u32 s18, s18, s25
  s_lshl_b32 s25, s22, 6
  s_add_u32 s18, s18, s25
  s_add_u32 s18, s18, 192937984
  s_add_u32 s26, s18, 4096
  v_bfe_u32 v11, v0, 3, 1
  v_mul_u32_u24 v11, 20480, v11
  v_bfe_u32 v12, v0, 2, 1
  v_lshl_add_u32 v11, v12, 7, v11
  v_and_b32 v12, 3, v0
  v_lshl_add_u32 v11, v12, 4, v11
  v_bfe_u32 v12, v0, 4, 1
  v_lshl_add_u32 v11, v12, 9, v11
  v_bfe_u32 v12, v0, 5, 1
  v_lshl_add_u32 v11, v12, 3, v11
  s_add_u32 s46, s14, 10485760
  s_add_u32 s47, s15, 10485760
  s_add_u32 s48, s16, 10485760
  s_add_u32 s49, s17, 10485760
  s_cmp_eq_u32 s41, 3
  s_cbranch_scc1 out_light
  v_min_u32 v10, 5, v0
  v_lshlrev_b32 v10, 7, v10
  v_add_u32 v10, 119808, v10
  s_barrier
  s_cmp_eq_u32 s52, 2
  s_cbranch_scc1 out_z1a
  s_load_dwordx2 s[28:29], s[0:1], 72
  v_bfe_u32 v12, v0, 2, 2
  v_lshlrev_b32 v12, 3, v12
  v_and_b32 v13, 3, v0
  v_add_u32 v12, v12, v13
  v_lshlrev_b32 v12, 12, v12
  v_lshl_add_u32 v12, v4, 4, v12
  v_add_u32 v13, 16384, v12
  s_lshl_b32 s25, s12, 17
  s_add_u32 s25, s25, 3968
  s_waitcnt lgkmcnt(0)
  s_add_u32 s28, s28, s25
  s_addc_u32 s29, s29, 0
  global_load_dwordx4 a[240:243], v12, s[28:29] offset:0
  global_load_dwordx4 a[244:247], v13, s[28:29] offset:0
  global_load_dwordx4 a[248:251], v12, s[28:29] offset:64
  global_load_dwordx4 a[252:255], v13, s[28:29] offset:64
  s_cmp_ge_u32 s12, 62
  s_cbranch_scc1 out_z1a
  s_and_b32 s25, s12, 1
  s_mul_i32 s25, s25, 1536
  v_add_u32 v14, s25, v10
  s_add_u32 s25, s12, 1
  s_branch wf_31
wf_30:
  s_sleep 1
  s_add_u32 s11, s11, 1
  s_cmp_gt_u32 s11, 131072
  s_cbranch_scc1 mega_done
wf_31:
  buffer_load_dword v9, v14, s[4:7], s66 offen sc1
  s_waitcnt vmcnt(0)
  v_cmp_gt_u32 vcc, s25, v9
  s_cbranch_vccnz wf_30
  s_add_u32 s42, s14, 4286578688
  s_add_u32 s43, s15, 4286578688
  s_add_u32 s44, s16, 4286578688
  s_add_u32 s45, s17, 4286578688
  buffer_load_dwordx4 v[112:115], v2, s[4:7], s42 offen offset:0
  buffer_load_dwordx4 v[116:119], v2, s[4:7], s44 offen offset:0
  buffer_load_dwordx4 v[120:123], v2, s[4:7], s42 offen offset:1024
  buffer_load_dwordx4 v[124:127], v2, s[4:7], s44 offen offset:1024
  buffer_load_dwordx4 v[128:131], v2, s[4:7], s42 offen offset:2048
  buffer_load_dwordx4 v[132:135], v2, s[4:7], s44 offen offset:2048
  buffer_load_dwordx4 v[136:139], v2, s[4:7], s42 offen offset:3072
  buffer_load_dwordx4 v[140:143], v2, s[4:7], s44 offen offset:3072
  buffer_load_dwordx4 v[144:147], v2, s[4:7], s43 offen offset:0
  buffer_load_dwordx4 v[148:151], v2, s[4:7], s45 offen offset:0
  buffer_load_dwordx4 v[152:155], v2, s[4:7], s43 offen offset:1024
  buffer_load_dwordx4 v[156:159], v2, s[4:7], s45 offen offset:1024
  s_cmp_eq_u32 s52, 1
  s_cbranch_scc1 mega_end
out_z1a:
  s_branch wf_33
wf_32:
  s_sleep 1
  s_add_u32 s11, s11, 1
  s_cmp_gt_u32 s11, 131072
  s_cbranch_scc1 mega_done
wf_33:
  buffer_load_dword v9, v8, s[4:7], s66 offen sc1
  s_waitcnt vmcnt(0)
  v_cmp_gt_u32 vcc, s19, v9
  s_cbranch_vccnz wf_32
  buffer_load_dwordx4 v[160:163], v2, s[4:7], s14 offen offset:0
  buffer_load_dwordx4 v[164:167], v2, s[4:7], s16 offen offset:0
  buffer_load_dwordx4 v[168:171], v2, s[4:7], s14 offen offset:1024
  buffer_load_dwordx4 v[172:175], v2, s[4:7], s16 offen offset:1024
  buffer_load_dwordx4 v[176:179], v2, s[4:7], s14 offen offset:2048
  buffer_load_dwordx4 v[180:183], v2, s[4:7], s16 offen offset:2048
  buffer_load_dwordx4 v[184:187], v2, s[4:7], s14 offen offset:3072
  buffer_load_dwordx4 v[188:191], v2, s[4:7], s16 offen offset:3072
  buffer_load_dwordx4 v[192:195], v2, s[4:7], s15 offen offset:0
  buffer_load_dwordx4 v[196:199], v2, s[4:7], s17 offen offset:0
  buffer_load_dwordx4 v[200:203], v2, s[4:7], s15 offen offset:1024
  buffer_load_dwordx4 v[204:207], v2, s[4:7], s17 offen offset:1024
  s_waitcnt vmcnt(10)
  v_lshlrev_b32 v16, 16, v160
  v_and_b32 v17, 0xffff0000, v160
  v_lshlrev_b32 v18, 16, v161
  v_and_b32 v19, 0xffff0000, v161
  v_lshlrev_b32 v20, 16, v162
  v_and_b32 v21, 0xffff0000, v162
  v_lshlrev_b32 v22, 16, v163
  v_and_b32 v23, 0xffff0000, v163
  v_lshlrev_b32 v24, 16, v164
  v_and_b32 v25, 0xffff0000, v164
  v_lshlrev_b32 v26, 16, v165
  v_and_b32 v27, 0xffff0000, v165
  v_lshlrev_b32 v28, 16, v166
  v_and_b32 v29, 0xffff0000, v166
  v_lshlrev_b32 v30, 16, v167
  v_and_b32 v31, 0xffff0000, v167
  s_waitcnt vmcnt(8)
  v_lshlrev_b32 v32, 16, v168
  v_and_b32 v33, 0xffff0000, v168
  v_lshlrev_b32 v34, 16, v169
  v_and_b32 v35, 0xffff0000, v169
  v_lshlrev_b32 v36, 16, v170
  v_and_b32 v37, 0xffff0000, v170
  v_lshlrev_b32 v38, 16, v171
  v_and_b32 v39, 0xffff0000, v171
  v_lshlrev_b32 v40, 16, v172
  v_and_b32 v41, 0xffff0000, v172
  v_lshlrev_b32 v42, 16, v173
  v_and_b32 v43, 0xffff0000, v173
  v_lshlrev_b32 v44, 16, v174
  v_and_b32 v45, 0xffff0000, v174
  v_lshlrev_b32 v46, 16, v175
  v_and_b32 v47, 0xffff0000, v175
  s_waitcnt vmcnt(6)
  v_lshlrev_b32 v48, 16, v176
  v_and_b32 v49, 0xffff0000, v176
  v_lshlrev_b32 v50, 16, v177
  v_and_b32 v51, 0xffff0000, v177
  v_lshlrev_b32 v52, 16, v178
  v_and_b32 v53, 0xffff0000, v178
  v_lshlrev_b32 v54, 16, v179
  v_and_b32 v55, 0xffff0000, v179
  v_lshlrev_b32 v56, 16, v180
  v_and_b32 v57, 0xffff0000, v180
  v_lshlrev_b32 v58, 16, v181
  v_and_b32 v59, 0xffff0000, v181
  v_lshlrev_b32 v60, 16, v182
  v_and_b32 v61, 0xffff0000, v182
  v_lshlrev_b32 v62, 16, v183
  v_and_b32 v63, 0xffff0000, v183
  s_waitcnt vmcnt(4)
  v_lshlrev_b32 v64, 16, v184
  v_and_b32 v65, 0xffff0000, v184
  v_lshlrev_b32 v66, 16, v185
  v_and_b32 v67, 0xffff0000, v185
  v_lshlrev_b32 v68, 16, v186
  v_and_b32 v69, 0xffff0000, v186
  v_lshlrev_b32 v70, 16, v187
  v_and_b32 v71, 0xffff0000, v187
  v_lshlrev_b32 v72, 16, v188
  v_and_b32 v73, 0xffff0000, v188
  v_lshlrev_b32 v74, 16, v189
  v_and_b32 v75, 0xffff0000, v189
  v_lshlrev_b32 v76, 16, v190
  v_and_b32 v77, 0xffff0000, v190
  v_lshlrev_b32 v78, 16, v191
  v_and_b32 v79, 0xffff0000, v191
  s_waitcnt vmcnt(2)
  v_lshlrev_b32 v80, 16, v192
  v_and_b32 v81, 0xffff0000, v192
  v_lshlrev_b32 v82, 16, v193
  v_and_b32 v83, 0xffff0000, v193
  v_lshlrev_b32 v84, 16, v194
  v_and_b32 v85, 0xffff0000, v194
  v_lshlrev_b32 v86, 16, v195
  v_and_b32 v87, 0xffff0000, v195
  v_lshlrev_b32 v88, 16, v196
  v_and_b32 v89, 0xffff0000, v196
  v_lshlrev_b32 v90, 16, v197
  v_and_b32 v91, 0xffff0000, v197
  v_lshlrev_b32 v92, 16, v198
  v_and_b32 v93, 0xffff0000, v198
  v_lshlrev_b32 v94, 16, v199
  v_and_b32 v95, 0xffff0000, v199
  s_waitcnt vmcnt(0)
  v_lshlrev_b32 v96, 16, v200
  v_and_b32 v97, 0xffff0000, v200
  v_lshlrev_b32 v98, 16, v201
  v_and_b32 v99, 0xffff0000, v201
  v_lshlrev_b32 v100, 16, v202
  v_and_b32 v101, 0xffff0000, v202
  v_lshlrev_b32 v102, 16, v203
  v_and_b32 v103, 0xffff0000, v203
  v_lshlrev_b32 v104, 16, v204
  v_and_b32 v105, 0xffff0000, v204
  v_lshlrev_b32 v106, 16, v205
  v_and_b32 v107, 0xffff0000, v205
  v_lshlrev_b32 v108, 16, v206
  v_and_b32 v109, 0xffff0000, v206
  v_lshlrev_b32 v110, 16, v207
  v_and_b32 v111, 0xffff0000, v207
  v_add_u32 v14, 768, v10
  s_mov_b32 s25, 63
  s_mul_i32 s27, s3, 12288
  s_add_u32 s27, s27, 206471168
  s_add_u32 s28, s27, 4096
  s_add_u32 s29, s27, 8192
  s_branch wf_35
wf_34:
  s_sleep 1
  s_add_u32 s11, s11, 1
  s_cmp_gt_u32 s11, 131072
  s_cbranch_scc1 mega_done
wf_35:
  buffer_load_dword v9, v14, s[4:7], s66 offen sc1
  s_waitcnt vmcnt(0)
  v_cmp_gt_u32 vcc, s25, v9
  s_cbranch_vccnz wf_34
  buffer_load_dwordx4 v[160:163], v2, s[4:7], s27 offen offset:0
  buffer_load_dwordx4 v[164:167], v2, s[4:7], s27 offen offset:1024
  buffer_load_dwordx4 v[168:171], v2, s[4:7], s27 offen offset:2048
  buffer_load_dwordx4 v[172:175], v2, s[4:7], s27 offen offset:3072
  buffer_load_dwordx4 v[176:179], v2, s[4:7], s28 offen offset:0
  buffer_load_dwordx4 v[180:183], v2, s[4:7], s28 offen offset:1024
  buffer_load_dwordx4 v[184:187], v2, s[4:7], s28 offen offset:2048
  buffer_load_dwordx4 v[188:191], v2, s[4:7], s28 offen offset:3072
  buffer_load_dwordx4 v[192:195], v2, s[4:7], s29 offen offset:0
  buffer_load_dwordx4 v[196:199], v2, s[4:7], s29 offen offset:1024
  buffer_load_dwordx4 v[200:203], v2, s[4:7], s29 offen offset:2048
  buffer_load_dwordx4 v[204:207], v2, s[4:7], s29 offen offset:3072
  s_waitcnt vmcnt(11)
  v_mfma_f32_16x16x32_bf16 v[16:19], v[160:163], a[240:243], v[16:19]
  v_mfma_f32_16x16x32_bf16 v[24:27], v[160:163], a[244:247], v[24:27]
  s_waitcnt vmcnt(10)
  v_mfma_f32_16x16x32_bf16 v[20:23], v[164:167], a[240:243], v[20:23]
  v_mfma_f32_16x16x32_bf16 v[28:31], v[164:167], a[244:247], v[28:31]
  s_waitcnt vmcnt(9)
  v_mfma_f32_16x16x32_bf16 v[32:35], v[168:171], a[240:243], v[32:35]
  v_mfma_f32_16x16x32_bf16 v[40:43], v[168:171], a[244:247], v[40:43]
  s_waitcnt vmcnt(8)
  v_mfma_f32_16x16x32_bf16 v[36:39], v[172:175], a[240:243], v[36:39]
  v_mfma_f32_16x16x32_bf16 v[44:47], v[172:175], a[244:247], v[44:47]
  s_waitcnt vmcnt(7)
  v_mfma_f32_16x16x32_bf16 v[48:51], v[176:179], a[240:243], v[48:51]
  v_mfma_f32_16x16x32_bf16 v[56:59], v[176:179], a[244:247], v[56:59]
  s_waitcnt vmcnt(6)
  v_mfma_f32_16x16x32_bf16 v[52:55], v[180:183], a[240:243], v[52:55]
  v_mfma_f32_16x16x32_bf16 v[60:63], v[180:183], a[244:247], v[60:63]
  s_waitcnt vmcnt(5)
  v_mfma_f32_16x16x32_bf16 v[64:67], v[184:187], a[240:243], v[64:67]
  v_mfma_f32_16x16x32_bf16 v[72:75], v[184:187], a[244:247], v[72:75]
  s_waitcnt vmcnt(4)
  v_mfma_f32_16x16x32_bf16 v[68:71], v[188:191], a[240:243], v[68:71]
  v_mfma_f32_16x16x32_bf16 v[76:79], v[188:191], a[244:247], v[76:79]
  s_waitcnt vmcnt(3)
  v_mfma_f32_16x16x32_bf16 v[80:83], v[192:195], a[240:243], v[80:83]
  v_mfma_f32_16x16x32_bf16 v[88:91], v[192:195], a[244:247], v[88:91]
  s_waitcnt vmcnt(2)
  v_mfma_f32_16x16x32_bf16 v[84:87], v[196:199], a[240:243], v[84:87]
  v_mfma_f32_16x16x32_bf16 v[92:95], v[196:199], a[244:247], v[92:95]
  s_waitcnt vmcnt(1)
  v_mfma_f32_16x16x32_bf16 v[96:99], v[200:203], a[240:243], v[96:99]
  v_mfma_f32_16x16x32_bf16 v[104:107], v[200:203], a[244:247], v[104:107]
  s_waitcnt vmcnt(0)
  v_mfma_f32_16x16x32_bf16 v[100:103], v[204:207], a[240:243], v[100:103]
  v_mfma_f32_16x16x32_bf16 v[108:111], v[204:207], a[244:247], v[108:111]
  s_cmp_lt_u32 s12, 62
  s_cbranch_scc1 out_z1b
  s_and_b32 s25, s12, 1
  s_mul_i32 s25, s25, 1536
  v_add_u32 v14, s25, v10
  s_add_u32 s25, s12, 1
  s_branch wf_37
wf_36:
  s_sleep 1
  s_add_u32 s11, s11, 1
  s_cmp_gt_u32 s11, 131072
  s_cbranch_scc1 mega_done
wf_37:
  buffer_load_dword v9, v14, s[4:7], s66 offen sc1
  s_waitcnt vmcnt(0)
  v_cmp_gt_u32 vcc, s25, v9
  s_cbranch_vccnz wf_36
  s_add_u32 s42, s14, 4286578688
  s_add_u32 s43, s15, 4286578688
  s_add_u32 s44, s16, 4286578688
  s_add_u32 s45, s17, 4286578688
  buffer_load_dwordx4 v[112:115], v2, s[4:7], s42 offen offset:0
  buffer_load_dwordx4 v[116:119], v2, s[4:7], s44 offen offset:0
  buffer_load_dwordx4 v[120:123], v2, s[4:7], s42 offen offset:1024
  buffer_load_dwordx4 v[124:127], v2, s[4:7], s44 offen offset:1024
  buffer_load_dwordx4 v[128:131], v2, s[4:7], s42 offen offset:2048
  buffer_load_dwordx4 v[132:135], v2, s[4:7], s44 offen offset:2048
  buffer_load_dwordx4 v[136:139], v2, s[4:7], s42 offen offset:3072
  buffer_load_dwordx4 v[140:143], v2, s[4:7], s44 offen offset:3072
  buffer_load_dwordx4 v[144:147], v2, s[4:7], s43 offen offset:0
  buffer_load_dwordx4 v[148:151], v2, s[4:7], s45 offen offset:0
  buffer_load_dwordx4 v[152:155], v2, s[4:7], s43 offen offset:1024
  buffer_load_dwordx4 v[156:159], v2, s[4:7], s45 offen offset:1024
out_z1b:
  v_add_u32 v14, 2304, v10
  s_mov_b32 s25, 64
  s_mul_i32 s27, s3, 12288
  s_add_u32 s27, s27, 206520320
  s_add_u32 s28, s27, 4096
  s_add_u32 s29, s27, 8192
  s_branch wf_63
wf_62:
  s_sleep 1
  s_add_u32 s11, s11, 1
  s_cmp_gt_u32 s11, 131072
  s_cbranch_scc1 mega_done
wf_63:
  buffer_load_dword v9, v14, s[4:7], s66 offen sc1
  s_waitcnt vmcnt(0)
  v_cmp_gt_u32 vcc, s25, v9
  s_cbranch_vccnz wf_62
  s_mov_b32 vcc_lo, s41
  s_mov_b32 vcc_hi, 0
  buffer_load_dwordx4 v[160:163], v2, s[4:7], s27 offen offset:0
  buffer_load_dwordx4 v[164:167], v2, s[4:7], s27 offen offset:1024
  buffer_load_dwordx4 v[168:171], v2, s[4:7], s27 offen offset:2048
  buffer_load_dwordx4 v[172:175], v2, s[4:7], s27 offen offset:3072
  buffer_load_dwordx4 v[176:179], v2, s[4:7], s28 offen offset:0
  buffer_load_dwordx4 v[180:183], v2, s[4:7], s28 offen offset:1024
  buffer_load_dwordx4 v[184:187], v2, s[4:7], s28 offen offset:2048
  buffer_load_dwordx4 v[188:191], v2, s[4:7], s28 offen offset:3072
  buffer_load_dwordx4 v[192:195], v2, s[4:7], s29 offen offset:0
  buffer_load_dwordx4 v[196:199], v2, s[4:7], s29 offen offset:1024
  buffer_load_dwordx4 v[200:203], v2, s[4:7], s29 offen offset:2048
  buffer_load_dwordx4 v[204:207], v2, s[4:7], s29 offen offset:3072
  s_waitcnt vmcnt(11)
  v_mfma_f32_16x16x32_bf16 v[16:19], v[160:163], a[248:251], v[16:19]
  v_mfma_f32_16x16x32_bf16 v[24:27], v[160:163], a[252:255], v[24:27]
  s_waitcnt vmcnt(10)
  v_mfma_f32_16x16x32_bf16 v[20:23], v[164:167], a[248:251], v[20:23]
  v_mfma_f32_16x16x32_bf16 v[28:31], v[164:167], a[252:255], v[28:31]
  s_waitcnt vmcnt(9)
  v_mfma_f32_16x16x32_bf16 v[32:35], v[168:171], a[248:251], v[32:35]
  v_mfma_f32_16x16x32_bf16 v[40:43], v[168:171], a[252:255], v[40:43]
  s_waitcnt vmcnt(8)
  v_mfma_f32_16x16x32_bf16 v[36:39], v[172:175], a[248:251], v[36:39]
  v_mfma_f32_16x16x32_bf16 v[44:47], v[172:175], a[252:255], v[44:47]
  v_lshlrev_b32 v240, 16, v112
  v_and_b32 v241, 0xffff0000, v112
  v_lshlrev_b32 v242, 16, v113
  v_and_b32 v243, 0xffff0000, v113
  v_lshlrev_b32 v244, 16, v114
  v_and_b32 v245, 0xffff0000, v114
  v_lshlrev_b32 v246, 16, v115
  v_and_b32 v247, 0xffff0000, v115
  v_mul_f32 v240, v240, v16
  v_mul_f32 v241, v241, v17
  v_mul_f32 v242, v242, v18
  v_mul_f32 v243, v243, v19
  v_mul_f32 v244, v244, v20
  v_mul_f32 v245, v245, v21
  v_mul_f32 v246, v246, v22
  v_mul_f32 v247, v247, v23
  v_cvt_pk_bf16_f32 v112, v240, v241
  v_cvt_pk_bf16_f32 v113, v242, v243
  v_cvt_pk_bf16_f32 v114, v244, v245
  v_cvt_pk_bf16_f32 v115, v246, v247
  s_waitcnt vmcnt(7)
  v_mfma_f32_16x16x32_bf16 v[48:51], v[176:179], a[248:251], v[48:51]
  v_mfma_f32_16x16x32_bf16 v[56:59], v[176:179], a[252:255], v[56:59]
  s_cbranch_vccnz gs_38
gs_39:
  v_lshlrev_b32 v248, 16, v116
  v_and_b32 v249, 0xffff0000, v116
  v_lshlrev_b32 v250, 16, v117
  v_and_b32 v251, 0xffff0000, v117
  v_lshlrev_b32 v252, 16, v118
  v_and_b32 v253, 0xffff0000, v118
  v_lshlrev_b32 v254, 16, v119
  v_and_b32 v255, 0xffff0000, v119
  v_mul_f32 v248, v248, v24
  v_mul_f32 v249, v249, v25
  v_mul_f32 v250, v250, v26
  v_mul_f32 v251, v251, v27
  v_mul_f32 v252, v252, v28
  v_mul_f32 v253, v253, v29
  v_mul_f32 v254, v254, v30
  v_mul_f32 v255, v255, v31
  v_cvt_pk_bf16_f32 v116, v248, v249
  v_cvt_pk_bf16_f32 v117, v250, v251
  v_cvt_pk_bf16_f32 v118, v252, v253
  s_waitcnt vmcnt(6)
  v_mfma_f32_16x16x32_bf16 v[52:55], v[180:183], a[248:251], v[52:55]
  v_mfma_f32_16x16x32_bf16 v[60:63], v[180:183], a[252:255], v[60:63]
  v_cvt_pk_bf16_f32 v119, v254, v255
  s_cbranch_vccnz gs_40
gs_41:
  v_lshlrev_b32 v240, 16, v120
  v_and_b32 v241, 0xffff0000, v120
  v_lshlrev_b32 v242, 16, v121
  v_and_b32 v243, 0xffff0000, v121
  v_lshlrev_b32 v244, 16, v122
  v_and_b32 v245, 0xffff0000, v122
  v_lshlrev_b32 v246, 16, v123
  v_and_b32 v247, 0xffff0000, v123
  v_mul_f32 v240, v240, v32
  v_mul_f32 v241, v241, v33
  v_mul_f32 v242, v242, v34
  v_mul_f32 v243, v243, v35
  v_mul_f32 v244, v244, v36
  v_mul_f32 v245, v245, v37
  v_mul_f32 v246, v246, v38
  v_mul_f32 v247, v247, v39
  v_cvt_pk_bf16_f32 v120, v240, v241
  v_cvt_pk_bf16_f32 v121, v242, v243
  s_waitcnt vmcnt(5)
  v_mfma_f32_16x16x32_bf16 v[64:67], v[184:187], a[248:251], v[64:67]
  v_mfma_f32_16x16x32_bf16 v[72:75], v[184:187], a[252:255], v[72:75]
  v_cvt_pk_bf16_f32 v122, v244, v245
  v_cvt_pk_bf16_f32 v123, v246, v247
  s_cbranch_vccnz gs_42
gs_43:
  v_lshlrev_b32 v248, 16, v124
  v_and_b32 v249, 0xffff0000, v124
  v_lshlrev_b32 v250, 16, v125
  v_and_b32 v251, 0xffff0000, v125
  v_lshlrev_b32 v252, 16, v126
  v_and_b32 v253, 0xffff0000, v126
  v_lshlrev_b32 v254, 16, v127
  v_and_b32 v255, 0xffff0000, v127
  v_mul_f32 v248, v248, v40
  v_mul_f32 v249, v249, v41
  v_mul_f32 v250, v250, v42
  v_mul_f32 v251, v251, v43
  v_mul_f32 v252, v252, v44
  v_mul_f32 v253, v253, v45
  v_mul_f32 v254, v254, v46
  v_mul_f32 v255, v255, v47
  v_cvt_pk_bf16_f32 v124, v248, v249
  s_waitcnt vmcnt(4)
  v_mfma_f32_16x16x32_bf16 v[68:71], v[188:191], a[248:251], v[68:71]
  v_mfma_f32_16x16x32_bf16 v[76:79], v[188:191], a[252:255], v[76:79]
  v_cvt_pk_bf16_f32 v125, v250, v251
  v_cvt_pk_bf16_f32 v126, v252, v253
  v_cvt_pk_bf16_f32 v127, v254, v255
  s_cbranch_vccnz gs_44
gs_45:
  v_lshlrev_b32 v240, 16, v128
  v_and_b32 v241, 0xffff0000, v128
  v_lshlrev_b32 v242, 16, v129
  v_and_b32 v243, 0xffff0000, v129
  v_lshlrev_b32 v244, 16, v130
  v_and_b32 v245, 0xffff0000, v130
  v_lshlrev_b32 v246, 16, v131
  v_and_b32 v247, 0xffff0000, v131
  v_mul_f32 v240, v240, v48
  v_mul_f32 v241, v241, v49
  v_mul_f32 v242, v242, v50
  v_mul_f32 v243, v243, v51
  v_mul_f32 v244, v244, v52
  v_mul_f32 v245, v245, v53
  v_mul_f32 v246, v246, v54
  v_mul_f32 v247, v247, v55
  s_waitcnt vmcnt(3)
  v_mfma_f32_16x16x32_bf16 v[80:83], v[192:195], a[248:251], v[80:83]
  v_mfma_f32_16x16x32_bf16 v[88:91], v[192:195], a[252:255], v[88:91]
  v_cvt_pk_bf16_f32 v128, v240, v241
  v_cvt_pk_bf16_f32 v129, v242, v243
  v_cvt_pk_bf16_f32 v130, v244, v245
  v_cvt_pk_bf16_f32 v131, v246, v247
  s_cbranch_vccnz gs_46
gs_47:
  v_lshlrev_b32 v248, 16, v132
  v_and_b32 v249, 0xffff0000, v132
  v_lshlrev_b32 v250, 16, v133
  v_and_b32 v251, 0xffff0000, v133
  v_lshlrev_b32 v252, 16, v134
  v_and_b32 v253, 0xffff0000, v134
  v_lshlrev_b32 v254, 16, v135
  v_and_b32 v255, 0xffff0000, v135
  v_mul_f32 v248, v248, v56
  v_mul_f32 v249, v249, v57
  v_mul_f32 v250, v250, v58
  v_mul_f32 v251, v251, v59
  v_mul_f32 v252, v252, v60
  v_mul_f32 v253, v253, v61
  v_mul_f32 v254, v254, v62
  s_waitcnt vmcnt(2)
  v_mfma_f32_16x16x32_bf16 v[84:87], v[196:199], a[248:251], v[84:87]
  v_mfma_f32_16x16x32_bf16 v[92:95], v[196:199], a[252:255], v[92:95]
  v_mul_f32 v255, v255, v63
  v_cvt_pk_bf16_f32 v132, v248, v249
  v_cvt_pk_bf16_f32 v133, v250, v251
  v_cvt_pk_bf16_f32 v134, v252, v253
  v_cvt_pk_bf16_f32 v135, v254, v255
  s_cbranch_vccnz gs_48
gs_49:
  v_lshlrev_b32 v240, 16, v136
  v_and_b32 v241, 0xffff0000, v136
  v_lshlrev_b32 v242, 16, v137
  v_and_b32 v243, 0xffff0000, v137
  v_lshlrev_b32 v244, 16, v138
  v_and_b32 v245, 0xffff0000, v138
  v_lshlrev_b32 v246, 16, v139
  v_and_b32 v247, 0xffff0000, v139
  v_mul_f32 v240, v240, v64
  v_mul_f32 v241, v241, v65
  v_mul_f32 v242, v242, v66
  v_mul_f32 v243, v243, v67
  v_mul_f32 v244, v244, v68
  v_mul_f32 v245, v245, v69
  s_waitcnt vmcnt(1)
  v_mfma_f32_16x16x32_bf16 v[96:99], v[200:203], a[248:251], v[96:99]
  v_mfma_f32_16x16x32_bf16 v[104:107], v[200:203], a[252:255], v[104:107]
  v_mul_f32 v246, v246, v70
  v_mul_f32 v247, v247, v71
  v_cvt_pk_bf16_f32 v136, v240, v241
  v_cvt_pk_bf16_f32 v137, v242, v243
  v_cvt_pk_bf16_f32 v138, v244, v245
  v_cvt_pk_bf16_f32 v139, v246, v247
  s_cbranch_vccnz gs_50
gs_51:
  v_lshlrev_b32 v248, 16, v140
  v_and_b32 v249, 0xffff0000, v140
  v_lshlrev_b32 v250, 16, v141
  v_and_b32 v251, 0xffff0000, v141
  v_lshlrev_b32 v252, 16, v142
  v_and_b32 v253, 0xffff0000, v142
  v_lshlrev_b32 v254, 16, v143
  v_and_b32 v255, 0xffff0000, v143
  v_mul_f32 v248, v248, v72
  v_mul_f32 v249, v249, v73
  v_mul_f32 v250, v250, v74
  v_mul_f32 v251, v251, v75
  v_mul_f32 v252, v252, v76
  s_waitcnt vmcnt(0)
  v_mfma_f32_16x16x32_bf16 v[100:103], v[204:207], a[248:251], v[100:103]
  v_mfma_f32_16x16x32_bf16 v[108:111], v[204:207], a[252:255], v[108:111]
  v_mul_f32 v253, v253, v77
  v_mul_f32 v254, v254, v78
  v_mul_f32 v255, v255, v79
  v_cvt_pk_bf16_f32 v140, v248, v249
  v_cvt_pk_bf16_f32 v141, v250, v251
  v_cvt_pk_bf16_f32 v142, v252, v253
  v_cvt_pk_bf16_f32 v143, v254, v255
  s_cbranch_vccnz gs_52
gs_53:
  v_lshlrev_b32 v240, 16, v144
  v_and_b32 v241, 0xffff0000, v144
  v_lshlrev_b32 v242, 16, v145
  v_and_b32 v243, 0xffff0000, v145
  v_lshlrev_b32 v244, 16, v146
  v_and_b32 v245, 0xffff0000, v146
  v_lshlrev_b32 v246, 16, v147
  v_and_b32 v247, 0xffff0000, v147
  v_mul_f32 v240, v240, v80
  v_mul_f32 v241, v241, v81
  v_mul_f32 v242, v242, v82
  v_mul_f32 v243, v243, v83
  v_mfma_f32_16x16x32_bf16 v[160:163], a[0:3], v[112:115], 0
  v_mul_f32 v244, v244, v84
  v_mul_f32 v245, v245, v85
  v_mul_f32 v246, v246, v86
  v_mfma_f32_16x16x32_bf16 v[164:167], a[0:3], v[116:119], 0
  v_mul_f32 v247, v247, v87
  v_cvt_pk_bf16_f32 v144, v240, v241
  v_cvt_pk_bf16_f32 v145, v242, v243
  v_mfma_f32_16x16x32_bf16 v[168:171], a[24:27], v[112:115], 0
  v_cvt_pk_bf16_f32 v146, v244, v245
  v_cvt_pk_bf16_f32 v147, v246, v247
  s_cbranch_vccnz gs_54
gs_55:
  v_mfma_f32_16x16x32_bf16 v[172:175], a[24:27], v[116:119], 0
  v_lshlrev_b32 v248, 16, v148
  v_and_b32 v249, 0xffff0000, v148
  v_lshlrev_b32 v250, 16, v149
  v_mfma_f32_16x16x32_bf16 v[176:179], a[48:51], v[112:115], 0
  v_and_b32 v251, 0xffff0000, v149
  v_lshlrev_b32 v252, 16, v150
  v_and_b32 v253, 0xffff0000, v150
  v_mfma_f32_16x16x32_bf16 v[180:183], a[48:51], v[116:119], 0
  v_lshlrev_b32 v254, 16, v151
  v_and_b32 v255, 0xffff0000, v151
  v_mul_f32 v248, v248, v88
  v_mfma_f32_16x16x32_bf16 v[184:187], a[72:75], v[112:115], 0
  v_mul_f32 v249, v249, v89
  v_mul_f32 v250, v250, v90
  v_mul_f32 v251, v251, v91
  v_mfma_f32_16x16x32_bf16 v[188:191], a[72:75], v[116:119], 0
  v_mul_f32 v252, v252, v92
  v_mul_f32 v253, v253, v93
  v_mul_f32 v254, v254, v94
  v_mfma_f32_16x16x32_bf16 v[192:195], a[96:99], v[112:115], 0
  v_mul_f32 v255, v255, v95
  v_cvt_pk_bf16_f32 v148, v248, v249
  v_cvt_pk_bf16_f32 v149, v250, v251
  v_mfma_f32_16x16x32_bf16 v[196:199], a[96:99], v[116:119], 0
  v_cvt_pk_bf16_f32 v150, v252, v253
  v_cvt_pk_bf16_f32 v151, v254, v255
  s_cbranch_vccnz gs_56
gs_57:
  v_mfma_f32_16x16x32_bf16 v[200:203], a[120:123], v[112:115], 0
  v_lshlrev_b32 v240, 16, v152
  v_and_b32 v241, 0xffff0000, v152
  v_lshlrev_b32 v242, 16, v153
  v_mfma_f32_16x16x32_bf16 v[204:207], a[120:123], v[116:119], 0
  v_and_b32 v243, 0xffff0000, v153
  v_lshlrev_b32 v244, 16, v154
  v_and_b32 v245, 0xffff0000, v154
  v_mfma_f32_16x16x32_bf16 v[208:211], a[144:147], v[112:115], 0
  v_lshlrev_b32 v246, 16, v155
  v_and_b32 v247, 0xffff0000, v155
  v_mul_f32 v240, v240, v96
  v_mfma_f32_16x16x32_bf16 v[212:215], a[144:147], v[116:119], 0
  v_mul_f32 v241, v241, v97
  v_mul_f32 v242, v242, v98
  v_mul_f32 v243, v243, v99
  v_mfma_f32_16x16x32_bf16 v[216:219], a[168:171], v[112:115], 0
  v_mul_f32 v244, v244, v100
  v_mul_f32 v245, v245, v101
  v_mul_f32 v246, v246, v102
  v_mfma_f32_16x16x32_bf16 v[220:223], a[168:171], v[116:119], 0
  v_mul_f32 v247, v247, v103
  v_cvt_pk_bf16_f32 v152, v240, v241
  v_cvt_pk_bf16_f32 v153, v242, v243
  v_mfma_f32_16x16x32_bf16 v[224:227], a[192:195], v[112:115], 0
  v_cvt_pk_bf16_f32 v154, v244, v245
  v_cvt_pk_bf16_f32 v155, v246, v247
  s_cbranch_vccnz gs_58
gs_59:
  v_mfma_f32_16x16x32_bf16 v[228:231], a[192:195], v[116:119], 0
  v_lshlrev_b32 v248, 16, v156
  v_and_b32 v249, 0xffff0000, v156
  v_lshlrev_b32 v250, 16, v157
  v_mfma_f32_16x16x32_bf16 v[232:235], a[216:219], v[112:115], 0
  v_and_b32 v251, 0xffff0000, v157
  v_lshlrev_b32 v252, 16, v158
  v_and_b32 v253, 0xffff0000, v158
  v_mfma_f32_16x16x32_bf16 v[236:239], a[216:219], v[116:119], 0
  v_lshlrev_b32 v254, 16, v159
  v_and_b32 v255, 0xffff0000, v159
  v_mul_f32 v248, v248, v104
  v_mfma_f32_16x16x32_bf16 v[160:163], a[4:7], v[120:123], v[160:163]
  v_mul_f32 v249, v249, v105
  v_mul_f32 v250, v250, v106
  v_mul_f32 v251, v251, v107
  v_mfma_f32_16x16x32_bf16 v[164:167], a[4:7], v[124:127], v[164:167]
  v_mul_f32 v252, v252, v108
  v_mul_f32 v253, v253, v109
  v_mul_f32 v254, v254, v110
  v_mfma_f32_16x16x32_bf16 v[168:171], a[28:31], v[120:123], v[168:171]
  v_mul_f32 v255, v255, v111
  v_cvt_pk_bf16_f32 v156, v248, v249
  v_cvt_pk_bf16_f32 v157, v250, v251
  v_mfma_f32_16x16x32_bf16 v[172:175], a[28:31], v[124:127], v[172:175]
  v_cvt_pk_bf16_f32 v158, v252, v253
  v_cvt_pk_bf16_f32 v159, v254, v255
  s_cbranch_vccnz gs_60
gs_61:
  v_mfma_f32_16x16x32_bf16 v[176:179], a[52:55], v[120:123], v[176:179]
  v_mfma_f32_16x16x32_bf16 v[180:183], a[52:55], v[124:127], v[180:183]
  v_mfma_f32_16x16x32_bf16 v[184:187], a[76:79], v[120:123], v[184:187]
  v_mfma_f32_16x16x32_bf16 v[188:191], a[76:79], v[124:127], v[188:191]
  v_mfma_f32_16x16x32_bf16 v[192:195], a[100:103], v[120:123], v[192:195]
  v_mfma_f32_16x16x32_bf16 v[196:199], a[100:103], v[124:127], v[196:199]
  v_mfma_f32_16x16x32_bf16 v[200:203], a[124:127], v[120:123], v[200:203]
  v_mfma_f32_16x16x32_bf16 v[204:207], a[124:127], v[124:127], v[204:207]
  v_mfma_f32_16x16x32_bf16 v[208:211], a[148:151], v[120:123], v[208:211]
  v_mfma_f32_16x16x32_bf16 v[212:215], a[148:151], v[124:127], v[212:215]
  v_mfma_f32_16x16x32_bf16 v[216:219], a[172:175], v[120:123], v[216:219]
  v_mfma_f32_16x16x32_bf16 v[220:223], a[172:175], v[124:127], v[220:223]
  v_mfma_f32_16x16x32_bf16 v[224:227], a[196:199], v[120:123], v[224:227]
  v_mfma_f32_16x16x32_bf16 v[228:231], a[196:199], v[124:127], v[228:231]
  v_mfma_f32_16x16x32_bf16 v[232:235], a[220:223], v[120:123], v[232:235]
  v_mfma_f32_16x16x32_bf16 v[236:239], a[220:223], v[124:127], v[236:239]
  v_mfma_f32_16x16x32_bf16 v[160:163], a[8:11], v[128:131], v[160:163]
  v_mfma_f32_16x16x32_bf16 v[164:167], a[8:11], v[132:135], v[164:167]
  v_mfma_f32_16x16x32_bf16 v[168:171], a[32:35], v[128:131], v[168:171]
  v_mfma_f32_16x16x32_bf16 v[172:175], a[32:35], v[132:135], v[172:175]
  v_mfma_f32_16x16x32_bf16 v[176:179], a[56:59], v[128:131], v[176:179]
  v_mfma_f32_16x16x32_bf16 v[180:183], a[56:59], v[132:135], v[180:183]
  v_mfma_f32_16x16x32_bf16 v[184:187], a[80:83], v[128:131], v[184:187]
  v_mfma_f32_16x16x32_bf16 v[188:191], a[80:83], v[132:135], v[188:191]
  v_mfma_f32_16x16x32_bf16 v[192:195], a[104:107], v[128:131], v[192:195]
  v_mfma_f32_16x16x32_bf16 v[196:199], a[104:107], v[132:135], v[196:199]
  v_mfma_f32_16x16x32_bf16 v[200:203], a[128:131], v[128:131], v[200:203]
  v_mfma_f32_16x16x32_bf16 v[204:207], a[128:131], v[132:135], v[204:207]
  v_mfma_f32_16x16x32_bf16 v[208:211], a[152:155], v[128:131], v[208:211]
  v_mfma_f32_16x16x32_bf16 v[212:215], a[152:155], v[132:135], v[212:215]
  v_mfma_f32_16x16x32_bf16 v[216:219], a[176:179], v[128:131], v[216:219]
  v_mfma_f32_16x16x32_bf16 v[220:223], a[176:179], v[132:135], v[220:223]
  v_mfma_f32_16x16x32_bf16 v[224:227], a[200:203], v[128:131], v[224:227]
  v_mfma_f32_16x16x32_bf16 v[228:231], a[200:203], v[132:135], v[228:231]
  v_mfma_f32_16x16x32_bf16 v[232:235], a[224:227], v[128:131], v[232:235]
  v_mfma_f32_16x16x32_bf16 v[236:239], a[224:227], v[132:135], v[236:239]
out_join:
  buffer_load_dwordx2 v[16:17], v11, s[4:7], s18 offen offset:0
  buffer_load_dwordx2 v[18:19], v11, s[4:7], s18 offen offset:256
  buffer_load_dwordx2 v[20:21], v11, s[4:7], s18 offen offset:2048
  buffer_load_dwordx2 v[22:23], v11, s[4:7], s18 offen offset:2304
  buffer_load_dwordx2 v[24:25], v11, s[4:7], s26 offen offset:0
  buffer_load_dwordx2 v[26:27], v11, s[4:7], s26 offen offset:256
  v_mfma_f32_16x16x32_bf16 v[160:163], a[12:15], v[136:139], v[160:163]
  v_mfma_f32_16x16x32_bf16 v[164:167], a[12:15], v[140:143], v[164:167]
  v_mfma_f32_16x16x32_bf16 v[160:163], a[16:19], v[144:147], v[160:163]
  v_mfma_f32_16x16x32_bf16 v[164:167], a[16:19], v[148:151], v[164:167]
  v_mfma_f32_16x16x32_bf16 v[160:163], a[20:23], v[152:155], v[160:163]
  v_mfma_f32_16x16x32_bf16 v[164:167], a[20:23], v[156:159], v[164:167]
  v_mfma_f32_16x16x32_bf16 v[168:171], a[36:39], v[136:139], v[168:171]
  v_mfma_f32_16x16x32_bf16 v[172:175], a[36:39], v[140:143], v[172:175]
  v_mfma_f32_16x16x32_bf16 v[168:171], a[40:43], v[144:147], v[168:171]
  v_mfma_f32_16x16x32_bf16 v[172:175], a[40:43], v[148:151], v[172:175]
  ds_write_b128 v5, v[160:163] offset:0
  v_mfma_f32_16x16x32_bf16 v[168:171], a[44:47], v[152:155], v[168:171]
  v_mfma_f32_16x16x32_bf16 v[172:175], a[44:47], v[156:159], v[172:175]
  ds_write_b128 v5, v[164:167] offset:1024
  v_mfma_f32_16x16x32_bf16 v[176:179], a[60:63], v[136:139], v[176:179]
  v_mfma_f32_16x16x32_bf16 v[180:183], a[60:63], v[140:143], v[180:183]
  v_mfma_f32_16x16x32_bf16 v[176:179], a[64:67], v[144:147], v[176:179]
  v_mfma_f32_16x16x32_bf16 v[180:183], a[64:67], v[148:151], v[180:183]
  ds_write_b128 v5, v[168:171] offset:2048
  v_mfma_f32_16x16x32_bf16 v[176:179], a[68:71], v[152:155], v[176:179]
  v_mfma_f32_16x16x32_bf16 v[180:183], a[68:71], v[156:159], v[180:183]
  ds_write_b128 v5, v[172:175] offset:3072
  v_mfma_f32_16x16x32_bf16 v[184:187], a[84:87], v[136:139], v[184:187]
  v_mfma_f32_16x16x32_bf16 v[188:191], a[84:87], v[140:143], v[188:191]
  v_mfma_f32_16x16x32_bf16 v[184:187], a[88:91], v[144:147], v[184:187]
  v_mfma_f32_16x16x32_bf16 v[188:191], a[88:91], v[148:151], v[188:191]
  ds_write_b128 v5, v[176:179] offset:4096
  v_mfma_f32_16x16x32_bf16 v[184:187], a[92:95], v[152:155], v[184:187]
  v_mfma_f32_16x16x32_bf16 v[188:191], a[92:95], v[156:159], v[188:191]
  ds_write_b128 v5, v[180:183] offset:5120
  v_mfma_f32_16x16x32_bf16 v[192:195], a[108:111], v[136:139], v[192:195]
  v_mfma_f32_16x16x32_bf16 v[196:199], a[108:111], v[140:143], v[196:199]
  v_mfma_f32_16x16x32_bf16 v[192:195], a[112:115], v[144:147], v[192:195]
  v_mfma_f32_16x16x32_bf16 v[196:199], a[112:115], v[148:151], v[196:199]
  ds_write_b128 v5, v[184:187] offset:6144
  v_mfma_f32_16x16x32_bf16 v[192:195], a[116:119], v[152:155], v[192:195]
  v_mfma_f32_16x16x32_bf16 v[196:199], a[116:119], v[156:159], v[196:199]
  ds_write_b128 v5, v[188:191] offset:7168
  v_mfma_f32_16x16x32_bf16 v[200:203], a[132:135], v[136:139], v[200:203]
  v_mfma_f32_16x16x32_bf16 v[204:207], a[132:135], v[140:143], v[204:207]
  v_mfma_f32_16x16x32_bf16 v[200:203], a[136:139], v[144:147], v[200:203]
  v_mfma_f32_16x16x32_bf16 v[204:207], a[136:139], v[148:151], v[204:207]
  ds_write_b128 v5, v[192:195] offset:8192
  v_mfma_f32_16x16x32_bf16 v[200:203], a[140:143], v[152:155], v[200:203]
  v_mfma_f32_16x16x32_bf16 v[204:207], a[140:143], v[156:159], v[204:207]
  ds_write_b128 v5, v[196:199] offset:9216
  v_mfma_f32_16x16x32_bf16 v[208:211], a[156:159], v[136:139], v[208:211]
  v_mfma_f32_16x16x32_bf16 v[212:215], a[156:159], v[140:143], v[212:215]
  v_mfma_f32_16x16x32_bf16 v[208:211], a[160:163], v[144:147], v[208:211]
  v_mfma_f32_16x16x32_bf16 v[212:215], a[160:163], v[148:151], v[212:215]
  ds_write_b128 v5, v[200:203] offset:10240
  v_mfma_f32_16x16x32_bf16 v[208:211], a[164:167], v[152:155], v[208:211]
  v_mfma_f32_16x16x32_bf16 v[212:215], a[164:167], v[156:159], v[212:215]
  ds_write_b128 v5, v[204:207] offset:11264
  v_mfma_f32_16x16x32_bf16 v[216:219], a[180:183], v[136:139], v[216:219]
  v_mfma_f32_16x16x32_bf16 v[220:223], a[180:183], v[140:143], v[220:223]
  v_mfma_f32_16x16x32_bf16 v[216:219], a[184:187], v[144:147], v[216:219]
  v_mfma_f32_16x16x32_bf16 v[220:223], a[184:187], v[148:151], v[220:223]
  ds_write_b128 v5, v[208:211] offset:12288
  v_mfma_f32_16x16x32_bf16 v[216:219], a[188:191], v[152:155], v[216:219]
  v_mfma_f32_16x16x32_bf16 v[220:223], a[188:191], v[156:159], v[220:223]
  ds_write_b128 v5, v[212:215] offset:13312
  v_mfma_f32_16x16x32_bf16 v[224:227], a[204:207], v[136:139], v[224:227]
  v_mfma_f32_16x16x32_bf16 v[228:231], a[204:207], v[140:143], v[228:231]
  v_mfma_f32_16x16x32_bf16 v[224:227], a[208:211], v[144:147], v[224:227]
  v_mfma_f32_16x16x32_bf16 v[228:231], a[208:211], v[148:151], v[228:231]
  ds_write_b128 v5, v[216:219] offset:14336
  v_mfma_f32_16x16x32_bf16 v[224:227], a[212:215], v[152:155], v[224:227]
  v_mfma_f32_16x16x32_bf16 v[228:231], a[212:215], v[156:159], v[228:231]
  ds_write_b128 v5, v[220:223] offset:15360
  v_mfma_f32_16x16x32_bf16 v[232:235], a[228:231], v[136:139], v[232:235]
  v_mfma_f32_16x16x32_bf16 v[236:239], a[228:231], v[140:143], v[236:239]
  v_mfma_f32_16x16x32_bf16 v[232:235], a[232:235], v[144:147], v[232:235]
  v_mfma_f32_16x16x32_bf16 v[236:239], a[232:235], v[148:151], v[236:239]
  ds_write_b128 v5, v[224:227] offset:16384
  v_mfma_f32_16x16x32_bf16 v[232:235], a[236:239], v[152:155], v[232:235]
  v_mfma_f32_16x16x32_bf16 v[236:239], a[236:239], v[156:159], v[236:239]
  ds_write_b128 v5, v[228:231] offset:17408
  s_nop 3
  ds_write_b128 v5, v[232:235] offset:18432
  s_nop 1
  ds_write_b128 v5, v[236:239] offset:19456
  s_waitcnt vmcnt(0)
  v_lshlrev_b32 v32, 16, v16
  v_and_b32 v33, 0xffff0000, v16
  v_lshlrev_b32 v34, 16, v17
  v_and_b32 v35, 0xffff0000, v17
  v_lshlrev_b32 v36, 16, v18
  v_and_b32 v37, 0xffff0000, v18
  v_lshlrev_b32 v38, 16, v19
  v_and_b32 v39, 0xffff0000, v19
  v_lshlrev_b32 v40, 16, v20
  v_and_b32 v41, 0xffff0000, v20
  v_lshlrev_b32 v42, 16, v21
  v_and_b32 v43, 0xffff0000, v21
  v_lshlrev_b32 v44, 16, v22
  v_and_b32 v45, 0xffff0000, v22
  v_lshlrev_b32 v46, 16, v23
  v_and_b32 v47, 0xffff0000, v23
  v_lshlrev_b32 v48, 16, v24
  v_and_b32 v49, 0xffff0000, v24
  v_lshlrev_b32 v50, 16, v25
  v_and_b32 v51, 0xffff0000, v25
  v_lshlrev_b32 v52, 16, v26
  v_and_b32 v53, 0xffff0000, v26
  v_lshlrev_b32 v54, 16, v27
  v_and_b32 v55, 0xffff0000, v27
  s_waitcnt lgkmcnt(0)
  s_barrier
  ds_read_b128 v[64:67], v6 offset:0
  ds_read_b128 v[68:71], v6 offset:2048
  ds_read_b128 v[72:75], v6 offset:20480
  ds_read_b128 v[76:79], v6 offset:22528
  ds_read_b128 v[80:83], v7 offset:0
  ds_read_b128 v[84:87], v7 offset:2048
  ds_read_b128 v[88:91], v7 offset:20480
  ds_read_b128 v[92:95], v7 offset:22528
  ds_read_b128 v[96:99], v6 offset:8192
  ds_read_b128 v[100:103], v6 offset:10240
  ds_read_b128 v[104:107], v6 offset:28672
  ds_read_b128 v[108:111], v6 offset:30720
  ds_read_b128 v[112:115], v7 offset:8192
  ds_read_b128 v[116:119], v7 offset:10240
  ds_read_b128 v[120:123], v7 offset:28672
  ds_read_b128 v[124:127], v7 offset:30720
  s_waitcnt lgkmcnt(8)
  v_pk_add_f32 v[32:33], v[32:33], v[64:65]
  v_pk_add_f32 v[34:35], v[34:35], v[66:67]
  v_pk_add_f32 v[36:37], v[36:37], v[68:69]
  v_pk_add_f32 v[38:39], v[38:39], v[70:71]
  v_pk_add_f32 v[32:33], v[32:33], v[72:73]
  v_pk_add_f32 v[34:35], v[34:35], v[74:75]
  v_pk_add_f32 v[36:37], v[36:37], v[76:77]
  v_pk_add_f32 v[38:39], v[38:39], v[78:79]
  v_pk_add_f32 v[32:33], v[32:33], v[80:81]
  v_pk_add_f32 v[34:35], v[34:35], v[82:83]
  v_pk_add_f32 v[36:37], v[36:37], v[84:85]
  v_pk_add_f32 v[38:39], v[38:39], v[86:87]
  v_pk_add_f32 v[32:33], v[32:33], v[88:89]
  v_pk_add_f32 v[34:35], v[34:35], v[90:91]
  v_pk_add_f32 v[36:37], v[36:37], v[92:93]
  v_pk_add_f32 v[38:39], v[38:39], v[94:95]
  v_cvt_pk_bf16_f32 v16, v32, v33
  v_cvt_pk_bf16_f32 v17, v34, v35
  v_cvt_pk_bf16_f32 v18, v36, v37
  v_cvt_pk_bf16_f32 v19, v38, v39
  global_store_dwordx4 v3, v[16:19], s[20:21] offset:0
  s_waitcnt lgkmcnt(0)
  s_cmp_ge_u32 s3, 2
  s_cbranch_scc1 o2_64
  ds_read_b128 v[128:131], v6 offset:16384
  ds_read_b128 v[132:135], v6 offset:18432
  ds_read_b128 v[136:139], v6 offset:36864
  ds_read_b128 v[140:143], v6 offset:38912
  ds_read_b128 v[144:147], v7 offset:16384
  ds_read_b128 v[148:151], v7 offset:18432
  ds_read_b128 v[152:155], v7 offset:36864
  ds_read_b128 v[156:159], v7 offset:38912
  v_pk_add_f32 v[40:41], v[40:41], v[96:97]
  v_pk_add_f32 v[42:43], v[42:43], v[98:99]
  v_pk_add_f32 v[44:45], v[44:45], v[100:101]
  v_pk_add_f32 v[46:47], v[46:47], v[102:103]
  v_pk_add_f32 v[40:41], v[40:41], v[104:105]
  v_pk_add_f32 v[42:43], v[42:43], v[106:107]
  v_pk_add_f32 v[44:45], v[44:45], v[108:109]
  v_pk_add_f32 v[46:47], v[46:47], v[110:111]
  v_pk_add_f32 v[40:41], v[40:41], v[112:113]
  v_pk_add_f32 v[42:43], v[42:43], v[114:115]
  v_pk_add_f32 v[44:45], v[44:45], v[116:117]
  v_pk_add_f32 v[46:47], v[46:47], v[118:119]
  v_pk_add_f32 v[40:41], v[40:41], v[120:121]
  v_pk_add_f32 v[42:43], v[42:43], v[122:123]
  v_pk_add_f32 v[44:45], v[44:45], v[124:125]
  v_pk_add_f32 v[46:47], v[46:47], v[126:127]
  v_cvt_pk_bf16_f32 v20, v40, v41
  v_cvt_pk_bf16_f32 v21, v42, v43
  v_cvt_pk_bf16_f32 v22, v44, v45
  v_cvt_pk_bf16_f32 v23, v46, v47
  global_store_dwordx4 v3, v[20:23], s[20:21] offset:128
  s_waitcnt lgkmcnt(0)
  v_pk_add_f32 v[48:49], v[48:49], v[128:129]
  v_pk_add_f32 v[50:51], v[50:51], v[130:131]
  v_pk_add_f32 v[52:53], v[52:53], v[132:133]
  v_pk_add_f32 v[54:55], v[54:55], v[134:135]
  v_pk_add_f32 v[48:49], v[48:49], v[136:137]
  v_pk_add_f32 v[50:51], v[50:51], v[138:139]
  v_pk_add_f32 v[52:53], v[52:53], v[140:141]
  v_pk_add_f32 v[54:55], v[54:55], v[142:143]
  v_pk_add_f32 v[48:49], v[48:49], v[144:145]
  v_pk_add_f32 v[50:51], v[50:51], v[146:147]
  v_pk_add_f32 v[52:53], v[52:53], v[148:149]
  v_pk_add_f32 v[54:55], v[54:55], v[150:151]
  v_pk_add_f32 v[48:49], v[48:49], v[152:153]
  v_pk_add_f32 v[50:51], v[50:51], v[154:155]
  v_pk_add_f32 v[52:53], v[52:53], v[156:157]
  v_pk_add_f32 v[54:55], v[54:55], v[158:159]
  v_cvt_pk_bf16_f32 v24, v48, v49
  v_cvt_pk_bf16_f32 v25, v50, v51
  v_cvt_pk_bf16_f32 v26, v52, v53
  v_cvt_pk_bf16_f32 v27, v54, v55
  global_store_dwordx4 v3, v[24:27], s[20:21] offset:256
  s_branch mega_end
o2_64:
  v_pk_add_f32 v[40:41], v[40:41], v[96:97]
  v_pk_add_f32 v[42:43], v[42:43], v[98:99]
  v_pk_add_f32 v[44:45], v[44:45], v[100:101]
  v_pk_add_f32 v[46:47], v[46:47], v[102:103]
  v_pk_add_f32 v[40:41], v[40:41], v[104:105]
  v_pk_add_f32 v[42:43], v[42:43], v[106:107]
  v_pk_add_f32 v[44:45], v[44:45], v[108:109]
  v_pk_add_f32 v[46:47], v[46:47], v[110:111]
  v_pk_add_f32 v[40:41], v[40:41], v[112:113]
  v_pk_add_f32 v[42:43], v[42:43], v[114:115]
  v_pk_add_f32 v[44:45], v[44:45], v[116:117]
  v_pk_add_f32 v[46:47], v[46:47], v[118:119]
  v_pk_add_f32 v[40:41], v[40:41], v[120:121]
  v_pk_add_f32 v[42:43], v[42:43], v[122:123]
  v_pk_add_f32 v[44:45], v[44:45], v[124:125]
  v_pk_add_f32 v[46:47], v[46:47], v[126:127]
  v_cvt_pk_bf16_f32 v20, v40, v41
  v_cvt_pk_bf16_f32 v21, v42, v43
  v_cvt_pk_bf16_f32 v22, v44, v45
  v_cvt_pk_bf16_f32 v23, v46, v47
  global_store_dwordx4 v3, v[20:23], s[20:21] offset:128
  s_branch mega_end
out_light:
  buffer_load_dwordx4 v[112:115], v2, s[4:7], s46 offen offset:0 sc1
  buffer_load_dwordx4 v[116:119], v2, s[4:7], s48 offen offset:0 sc1
  buffer_load_dwordx4 v[120:123], v2, s[4:7], s46 offen offset:1024 sc1
  buffer_load_dwordx4 v[124:127], v2, s[4:7], s48 offen offset:1024 sc1
  buffer_load_dwordx4 v[128:131], v2, s[4:7], s46 offen offset:2048 sc1
  buffer_load_dwordx4 v[132:135], v2, s[4:7], s48 offen offset:2048 sc1
  buffer_load_dwordx4 v[136:139], v2, s[4:7], s46 offen offset:3072 sc1
  buffer_load_dwordx4 v[140:143], v2, s[4:7], s48 offen offset:3072 sc1
  buffer_load_dwordx4 v[144:147], v2, s[4:7], s47 offen offset:0 sc1
  buffer_load_dwordx4 v[148:151], v2, s[4:7], s49 offen offset:0 sc1
  buffer_load_dwordx4 v[152:155], v2, s[4:7], s47 offen offset:1024 sc1
  buffer_load_dwordx4 v[156:159], v2, s[4:7], s49 offen offset:1024 sc1
  s_barrier
out_lp:
  s_sleep 1
  buffer_load_dwordx4 v[124:127], v2, s[4:7], s48 offen offset:1024 sc1
  s_add_u32 s11, s11, 1
  s_cmp_gt_u32 s11, 131072
  s_cbranch_scc1 mega_done
  s_waitcnt vmcnt(0)
  v_cmp_eq_u32 vcc, -1, v124
  s_cbranch_vccnz out_lp
out_l2:
  buffer_load_dwordx4 v[112:115], v2, s[4:7], s46 offen offset:0 sc1
  buffer_load_dwordx4 v[116:119], v2, s[4:7], s48 offen offset:0 sc1
  buffer_load_dwordx4 v[120:123], v2, s[4:7], s46 offen offset:1024 sc1
  buffer_load_dwordx4 v[124:127], v2, s[4:7], s48 offen offset:1024 sc1
  buffer_load_dwordx4 v[128:131], v2, s[4:7], s46 offen offset:2048 sc1
  buffer_load_dwordx4 v[132:135], v2, s[4:7], s48 offen offset:2048 sc1
  s_add_u32 s11, s11, 1
  s_cmp_gt_u32 s11, 131072
  s_cbranch_scc1 mega_done
  s_waitcnt vmcnt(0)
  v_mov_b32 v9, 0
  v_max3_u32 v9, v9, v112, v116
  v_max3_u32 v9, v9, v120, v124
  v_max3_u32 v9, v9, v128, v132
  v_cmp_eq_u32 vcc, -1, v9
  s_cbranch_vccnz out_l2
out_l3:
  buffer_load_dwordx4 v[136:139], v2, s[4:7], s46 offen offset:3072 sc1
  buffer_load_dwordx4 v[140:143], v2, s[4:7], s48 offen offset:3072 sc1
  buffer_load_dwordx4 v[144:147], v2, s[4:7], s47 offen offset:0 sc1
  buffer_load_dwordx4 v[148:151], v2, s[4:7], s49 offen offset:0 sc1
  buffer_load_dwordx4 v[152:155], v2, s[4:7], s47 offen offset:1024 sc1
  buffer_load_dwordx4 v[156:159], v2, s[4:7], s49 offen offset:1024 sc1
  s_add_u32 s11, s11, 1
  s_cmp_gt_u32 s11, 131072
  s_cbranch_scc1 mega_done
  s_cmp_lg_u32 s41, 3
  s_cbranch_scc1 ol_65
  s_mov_b32 s41, 4
  v_mfma_f32_16x16x32_bf16 v[160:163], a[0:3], v[112:115], 0
  v_mfma_f32_16x16x32_bf16 v[164:167], a[0:3], v[116:119], 0
  v_mfma_f32_16x16x32_bf16 v[168:171], a[24:27], v[112:115], 0
  v_mfma_f32_16x16x32_bf16 v[172:175], a[24:27], v[116:119], 0
  v_mfma_f32_16x16x32_bf16 v[176:179], a[48:51], v[112:115], 0
  v_mfma_f32_16x16x32_bf16 v[180:183], a[48:51], v[116:119], 0
  v_mfma_f32_16x16x32_bf16 v[184:187], a[72:75], v[112:115], 0
  v_mfma_f32_16x16x32_bf16 v[188:191], a[72:75], v[116:119], 0
  v_mfma_f32_16x16x32_bf16 v[192:195], a[96:99], v[112:115], 0
  v_mfma_f32_16x16x32_bf16 v[196:199], a[96:99], v[116:119], 0
  v_mfma_f32_16x16x32_bf16 v[200:203], a[120:123], v[112:115], 0
  v_mfma_f32_16x16x32_bf16 v[204:207], a[120:123], v[116:119], 0
  v_mfma_f32_16x16x32_bf16 v[208:211], a[144:147], v[112:115], 0
  v_mfma_f32_16x16x32_bf16 v[212:215], a[144:147], v[116:119], 0
  v_mfma_f32_16x16x32_bf16 v[216:219], a[168:171], v[112:115], 0
  v_mfma_f32_16x16x32_bf16 v[220:223], a[168:171], v[116:119], 0
  v_mfma_f32_16x16x32_bf16 v[224:227], a[192:195], v[112:115], 0
  v_mfma_f32_16x16x32_bf16 v[228:231], a[192:195], v[116:119], 0
  v_mfma_f32_16x16x32_bf16 v[232:235], a[216:219], v[112:115], 0
  v_mfma_f32_16x16x32_bf16 v[236:239], a[216:219], v[116:119], 0
  v_mfma_f32_16x16x32_bf16 v[160:163], a[4:7], v[120:123], v[160:163]
  v_mfma_f32_16x16x32_bf16 v[164:167], a[4:7], v[124:127], v[164:167]
  v_mfma_f32_16x16x32_bf16 v[168:171], a[28:31], v[120:123], v[168:171]
  v_mfma_f32_16x16x32_bf16 v[172:175], a[28:31], v[124:127], v[172:175]
  v_mfma_f32_16x16x32_bf16 v[176:179], a[52:55], v[120:123], v[176:179]
  v_mfma_f32_16x16x32_bf16 v[180:183], a[52:55], v[124:127], v[180:183]
  v_mfma_f32_16x16x32_bf16 v[184:187], a[76:79], v[120:123], v[184:187]
  v_mfma_f32_16x16x32_bf16 v[188:191], a[76:79], v[124:127], v[188:191]
  v_mfma_f32_16x16x32_bf16 v[192:195], a[100:103], v[120:123], v[192:195]
  v_mfma_f32_16x16x32_bf16 v[196:199], a[100:103], v[124:127], v[196:199]
  v_mfma_f32_16x16x32_bf16 v[200:203], a[124:127], v[120:123], v[200:203]
  v_mfma_f32_16x16x32_bf16 v[204:207], a[124:127], v[124:127], v[204:207]
  v_mfma_f32_16x16x32_bf16 v[208:211], a[148:151], v[120:123], v[208:211]
  v_mfma_f32_16x16x32_bf16 v[212:215], a[148:151], v[124:127], v[212:215]
  v_mfma_f32_16x16x32_bf16 v[216:219], a[172:175], v[120:123], v[216:219]
  v_mfma_f32_16x16x32_bf16 v[220:223], a[172:175], v[124:127], v[220:223]
  v_mfma_f32_16x16x32_bf16 v[224:227], a[196:199], v[120:123], v[224:227]
  v_mfma_f32_16x16x32_bf16 v[228:231], a[196:199], v[124:127], v[228:231]
  v_mfma_f32_16x16x32_bf16 v[232:235], a[220:223], v[120:123], v[232:235]
  v_mfma_f32_16x16x32_bf16 v[236:239], a[220:223], v[124:127], v[236:239]
  v_mfma_f32_16x16x32_bf16 v[160:163], a[8:11], v[128:131], v[160:163]
  v_mfma_f32_16x16x32_bf16 v[164:167], a[8:11], v[132:135], v[164:167]
  v_mfma_f32_16x16x32_bf16 v[168:171], a[32:35], v[128:131], v[168:171]
  v_mfma_f32_16x16x32_bf16 v[172:175], a[32:35], v[132:135], v[172:175]
  v_mfma_f32_16x16x32_bf16 v[176:179], a[56:59], v[128:131], v[176:179]
  v_mfma_f32_16x16x32_bf16 v[180:183], a[56:59], v[132:135], v[180:183]
  v_mfma_f32_16x16x32_bf16 v[184:187], a[80:83], v[128:131], v[184:187]
  v_mfma_f32_16x16x32_bf16 v[188:191], a[80:83], v[132:135], v[188:191]
  v_mfma_f32_16x16x32_bf16 v[192:195], a[104:107], v[128:131], v[192:195]
  v_mfma_f32_16x16x32_bf16 v[196:199], a[104:107], v[132:135], v[196:199]
  v_mfma_f32_16x16x32_bf16 v[200:203], a[128:131], v[128:131], v[200:203]
  v_mfma_f32_16x16x32_bf16 v[204:207], a[128:131], v[132:135], v[204:207]
  v_mfma_f32_16x16x32_bf16 v[208:211], a[152:155], v[128:131], v[208:211]
  v_mfma_f32_16x16x32_bf16 v[212:215], a[152:155], v[132:135], v[212:215]
  v_mfma_f32_16x16x32_bf16 v[216:219], a[176:179], v[128:131], v[216:219]
  v_mfma_f32_16x16x32_bf16 v[220:223], a[176:179], v[132:135], v[220:223]
  v_mfma_f32_16x16x32_bf16 v[224:227], a[200:203], v[128:131], v[224:227]
  v_mfma_f32_16x16x32_bf16 v[228:231], a[200:203], v[132:135], v[228:231]
  v_mfma_f32_16x16x32_bf16 v[232:235], a[224:227], v[128:131], v[232:235]
  v_mfma_f32_16x16x32_bf16 v[236:239], a[224:227], v[132:135], v[236:239]
ol_65:
  s_waitcnt vmcnt(0)
  v_mov_b32 v9, 0
  v_max3_u32 v9, v9, v136, v140
  v_max3_u32 v9, v9, v144, v148
  v_max3_u32 v9, v9, v152, v156
  v_cmp_eq_u32 vcc, -1, v9
  s_cbranch_vccnz out_l3
  s_branch out_join
gs_38:
  v_min_u32 v112, -2, v112
  s_cmp_eq_u32 s41, 2
  s_cbranch_scc1 gs_38s
  buffer_store_dwordx4 v[112:115], v2, s[4:7], s46 offen offset:0
  s_branch gs_39
gs_38s:
  buffer_store_dwordx4 v[112:115], v2, s[4:7], s46 offen offset:0  sc1
  s_branch gs_39
gs_40:
  v_min_u32 v116, -2, v116
  s_cmp_eq_u32 s41, 2
  s_cbranch_scc1 gs_40s
  buffer_store_dwordx4 v[116:119], v2, s[4:7], s48 offen offset:0
  s_branch gs_41
gs_40s:
  buffer_store_dwordx4 v[116:119], v2, s[4:7], s48 offen offset:0  sc1
  s_branch gs_41
gs_42:
  v_min_u32 v120, -2, v120
  s_cmp_eq_u32 s41, 2
  s_cbranch_scc1 gs_42s
  buffer_store_dwordx4 v[120:123], v2, s[4:7], s46 offen offset:1024
  s_branch gs_43
gs_42s:
  buffer_store_dwordx4 v[120:123], v2, s[4:7], s46 offen offset:1024  sc1
  s_branch gs_43
gs_44:
  v_min_u32 v124, -2, v124
  s_cmp_eq_u32 s41, 2
  s_cbranch_scc1 gs_44s
  buffer_store_dwordx4 v[124:127], v2, s[4:7], s48 offen offset:1024
  s_branch gs_45
gs_44s:
  buffer_store_dwordx4 v[124:127], v2, s[4:7], s48 offen offset:1024  sc1
  s_branch gs_45
gs_46:
  v_min_u32 v128, -2, v128
  s_cmp_eq_u32 s41, 2
  s_cbranch_scc1 gs_46s
  buffer_store_dwordx4 v[128:131], v2, s[4:7], s46 offen offset:2048
  s_branch gs_47
gs_46s:
  buffer_store_dwordx4 v[128:131], v2, s[4:7], s46 offen offset:2048  sc1
  s_branch gs_47
gs_48:
  v_min_u32 v132, -2, v132
  s_cmp_eq_u32 s41, 2
  s_cbranch_scc1 gs_48s
  buffer_store_dwordx4 v[132:135], v2, s[4:7], s48 offen offset:2048
  s_branch gs_49
gs_48s:
  buffer_store_dwordx4 v[132:135], v2, s[4:7], s48 offen offset:2048  sc1
  s_branch gs_49
gs_50:
  v_min_u32 v136, -2, v136
  s_cmp_eq_u32 s41, 2
  s_cbranch_scc1 gs_50s
  buffer_store_dwordx4 v[136:139], v2, s[4:7], s46 offen offset:3072
  s_branch gs_51
gs_50s:
  buffer_store_dwordx4 v[136:139], v2, s[4:7], s46 offen offset:3072  sc1
  s_branch gs_51
gs_52:
  v_min_u32 v140, -2, v140
  s_cmp_eq_u32 s41, 2
  s_cbranch_scc1 gs_52s
  buffer_store_dwordx4 v[140:143], v2, s[4:7], s48 offen offset:3072
  s_branch gs_53
gs_52s:
  buffer_store_dwordx4 v[140:143], v2, s[4:7], s48 offen offset:3072  sc1
  s_branch gs_53
gs_54:
  v_min_u32 v144, -2, v144
  s_cmp_eq_u32 s41, 2
  s_cbranch_scc1 gs_54s
  buffer_store_dwordx4 v[144:147], v2, s[4:7], s47 offen offset:0
  s_branch gs_55
gs_54s:
  buffer_store_dwordx4 v[144:147], v2, s[4:7], s47 offen offset:0  sc1
  s_branch gs_55
gs_56:
  v_min_u32 v148, -2, v148
  s_cmp_eq_u32 s41, 2
  s_cbranch_scc1 gs_56s
  buffer_store_dwordx4 v[148:151], v2, s[4:7], s49 offen offset:0
  s_branch gs_57
gs_56s:
  buffer_store_dwordx4 v[148:151], v2, s[4:7], s49 offen offset:0  sc1
  s_branch gs_57
gs_58:
  v_min_u32 v152, -2, v152
  s_cmp_eq_u32 s41, 2
  s_cbranch_scc1 gs_58s
  buffer_store_dwordx4 v[152:155], v2, s[4:7], s47 offen offset:1024
  s_branch gs_59
gs_58s:
  buffer_store_dwordx4 v[152:155], v2, s[4:7], s47 offen offset:1024  sc1
  s_branch gs_59
gs_60:
  v_min_u32 v156, -2, v156
  s_cmp_eq_u32 s41, 2
  s_cbranch_scc1 gs_60s
  buffer_store_dwordx4 v[156:159], v2, s[4:7], s49 offen offset:1024
  s_branch gs_61
gs_60s:
  buffer_store_dwordx4 v[156:159], v2, s[4:7], s49 offen offset:1024  sc1
  s_branch gs_61
mega_end:
  s_cmp_eq_u32 s52, 1
  s_cbranch_scc1 mega_ret1
mega_done:
  s_endpgm
mega_wo:
  s_waitcnt vmcnt(0)
  s_barrier
  s_lshr_b32 s40, s2, 3
  s_load_dwordx2 s[12:13], s[0:1], 88
  s_mul_i32 s14, s3, 245760
  s_mul_i32 s15, s40, 320
  s_add_u32 s14, s14, s15
  v_lshrrev_b32 v7, 4, v0
  v_lshlrev_b32 v6, 3, v7
  v_bfe_u32 v7, v0, 2, 2
  v_add_u32 v6, v6, v7
  v_mul_u32_u24 v6, 320, v6
  v_and_b32 v7, 3, v0
  v_lshl_add_u32 v6, v7, 4, v6
  s_waitcnt lgkmcnt(0)
  s_add_u32 s12, s12, s14
  s_addc_u32 s13, s13, 0
  s_mul_i32 s14, s3, 40960
  v_add_u32 v6, s14, v6
  v_mul_u32_u24 v5, 3277, v0
  v_lshrrev_b32 v5, 16, v5
  s_mov_b32 s15, 960
  v_mul_lo_u32 v4, v5, s15
  v_lshl_add_u32 v4, v0, 4, v4
  s_mov_b32 exec_lo, 0xffffffff
  s_mov_b32 exec_hi, 0xfffffff
  s_add_u32 m0, s14, 0
  s_nop 0
  global_load_lds_dwordx4 v4, s[12:13]
  s_add_u32 s12, s12, 3840
  s_addc_u32 s13, s13, 0
  s_add_u32 m0, s14, 960
  s_nop 0
  global_load_lds_dwordx4 v4, s[12:13]
  s_add_u32 s12, s12, 3840
  s_addc_u32 s13, s13, 0
  s_add_u32 m0, s14, 1920
  s_nop 0
  global_load_lds_dwordx4 v4, s[12:13]
  s_add_u32 s12, s12, 3840
  s_addc_u32 s13, s13, 0
  s_add_u32 m0, s14, 2880
  s_nop 0
  global_load_lds_dwordx4 v4, s[12:13]
  s_add_u32 s12, s12, 3840
  s_addc_u32 s13, s13, 0
  s_add_u32 m0, s14, 3840
  s_nop 0
  global_load_lds_dwordx4 v4, s[12:13]
  s_add_u32 s12, s12, 3840
  s_addc_u32 s13, s13, 0
  s_add_u32 m0, s14, 4800
  s_nop 0
  global_load_lds_dwordx4 v4, s[12:13]
  s_add_u32 s12, s12, 3840
  s_addc_u32 s13, s13, 0
  s_add_u32 m0, s14, 5760
  s_nop 0
  global_load_lds_dwordx4 v4, s[12:13]
  s_add_u32 s12, s12, 3840
  s_addc_u32 s13, s13, 0
  s_add_u32 m0, s14, 6720
  s_nop 0
  global_load_lds_dwordx4 v4, s[12:13]
  s_add_u32 s12, s12, 3840
  s_addc_u32 s13, s13, 0
  s_add_u32 m0, s14, 7680
  s_nop 0
  global_load_lds_dwordx4 v4, s[12:13]
  s_add_u32 s12, s12, 3840
  s_addc_u32 s13, s13, 0
  s_add_u32 m0, s14, 8640
  s_nop 0
  global_load_lds_dwordx4 v4, s[12:13]
  s_add_u32 s12, s12, 3840
  s_addc_u32 s13, s13, 0
  s_mov_b32 exec_lo, 0xffffffff
  s_mov_b32 exec_hi, 0xff
  s_add_u32 m0, s14, 9600
  s_nop 0
  global_load_lds_dwordx4 v4, s[12:13]
  s_add_u32 s12, s12, 2560
  s_addc_u32 s13, s13, 0
  s_mov_b64 exec, -1
  s_mov_b32 exec_lo, 0xffffffff
  s_mov_b32 exec_hi, 0xfffffff
  s_add_u32 m0, s14, 10240
  s_nop 0
  global_load_lds_dwordx4 v4, s[12:13]
  s_add_u32 s12, s12, 3840
  s_addc_u32 s13, s13, 0
  s_add_u32 m0, s14, 11200
  s_nop 0
  global_load_lds_dwordx4 v4, s[12:13]
  s_add_u32 s12, s12, 3840
  s_addc_u32 s13, s13, 0
  s_add_u32 m0, s14, 12160
  s_nop 0
  global_load_lds_dwordx4 v4, s[12:13]
  s_add_u32 s12, s12, 3840
  s_addc_u32 s13, s13, 0
  s_add_u32 m0, s14, 13120
  s_nop 0
  global_load_lds_dwordx4 v4, s[12:13]
  s_add_u32 s12, s12, 3840
  s_addc_u32 s13, s13, 0
  s_add_u32 m0, s14, 14080
  s_nop 0
  global_load_lds_dwordx4 v4, s[12:13]
  s_add_u32 s12, s12, 3840
  s_addc_u32 s13, s13, 0
  s_add_u32 m0, s14, 15040
  s_nop 0
  global_load_lds_dwordx4 v4, s[12:13]
  s_add_u32 s12, s12, 3840
  s_addc_u32 s13, s13, 0
  s_add_u32 m0, s14, 16000
  s_nop 0
  global_load_lds_dwordx4 v4, s[12:13]
  s_add_u32 s12, s12, 3840
  s_addc_u32 s13, s13, 0
  s_add_u32 m0, s14, 16960
  s_nop 0
  global_load_lds_dwordx4 v4, s[12:13]
  s_add_u32 s12, s12, 3840
  s_addc_u32 s13, s13, 0
  s_add_u32 m0, s14, 17920
  s_nop 0
  global_load_lds_dwordx4 v4, s[12:13]
  s_add_u32 s12, s12, 3840
  s_addc_u32 s13, s13, 0
  s_add_u32 m0, s14, 18880
  s_nop 0
  global_load_lds_dwordx4 v4, s[12:13]
  s_add_u32 s12, s12, 3840
  s_addc_u32 s13, s13, 0
  s_mov_b32 exec_lo, 0xffffffff
  s_mov_b32 exec_hi, 0xff
  s_add_u32 m0, s14, 19840
  s_nop 0
  global_load_lds_dwordx4 v4, s[12:13]
  s_add_u32 s12, s12, 2560
  s_addc_u32 s13, s13, 0
  s_mov_b64 exec, -1
  s_mov_b32 exec_lo, 0xffffffff
  s_mov_b32 exec_hi, 0xfffffff
  s_add_u32 m0, s14, 20480
  s_nop 0
  global_load_lds_dwordx4 v4, s[12:13]
  s_add_u32 s12, s12, 3840
  s_addc_u32 s13, s13, 0
  s_add_u32 m0, s14, 21440
  s_nop 0
  global_load_lds_dwordx4 v4, s[12:13]
  s_add_u32 s12, s12, 3840
  s_addc_u32 s13, s13, 0
  s_add_u32 m0, s14, 22400
  s_nop 0
  global_load_lds_dwordx4 v4, s[12:13]
  s_add_u32 s12, s12, 3840
  s_addc_u32 s13, s13, 0
  s_add_u32 m0, s14, 23360
  s_nop 0
  global_load_lds_dwordx4 v4, s[12:13]
  s_add_u32 s12, s12, 3840
  s_addc_u32 s13, s13, 0
  s_add_u32 m0, s14, 24320
  s_nop 0
  global_load_lds_dwordx4 v4, s[12:13]
  s_add_u32 s12, s12, 3840
  s_addc_u32 s13, s13, 0
  s_add_u32 m0, s14, 25280
  s_nop 0
  global_load_lds_dwordx4 v4, s[12:13]
  s_add_u32 s12, s12, 3840
  s_addc_u32 s13, s13, 0
  s_add_u32 m0, s14, 26240
  s_nop 0
  global_load_lds_dwordx4 v4, s[12:13]
  s_add_u32 s12, s12, 3840
  s_addc_u32 s13, s13, 0
  s_add_u32 m0, s14, 27200
  s_nop 0
  global_load_lds_dwordx4 v4, s[12:13]
  s_add_u32 s12, s12, 3840
  s_addc_u32 s13, s13, 0
  s_add_u32 m0, s14, 28160
  s_nop 0
  global_load_lds_dwordx4 v4, s[12:13]
  s_add_u32 s12, s12, 3840
  s_addc_u32 s13, s13, 0
  s_add_u32 m0, s14, 29120
  s_nop 0
  global_load_lds_dwordx4 v4, s[12:13]
  s_add_u32 s12, s12, 3840
  s_addc_u32 s13, s13, 0
  s_mov_b32 exec_lo, 0xffffffff
  s_mov_b32 exec_hi, 0xff
  s_add_u32 m0, s14, 30080
  s_nop 0
  global_load_lds_dwordx4 v4, s[12:13]
  s_add_u32 s12, s12, 2560
  s_addc_u32 s13, s13, 0
  s_mov_b64 exec, -1
  s_mov_b32 exec_lo, 0xffffffff
  s_mov_b32 exec_hi, 0xfffffff
  s_add_u32 m0, s14, 30720
  s_nop 0
  global_load_lds_dwordx4 v4, s[12:13]
  s_add_u32 s12, s12, 3840
  s_addc_u32 s13, s13, 0
  s_add_u32 m0, s14, 31680
  s_nop 0
  global_load_lds_dwordx4 v4, s[12:13]
  s_add_u32 s12, s12, 3840
  s_addc_u32 s13, s13, 0
  s_add_u32 m0, s14, 32640
  s_nop 0
  global_load_lds_dwordx4 v4, s[12:13]
  s_add_u32 s12, s12, 3840
  s_addc_u32 s13, s13, 0
  s_add_u32 m0, s14, 33600
  s_nop 0
  global_load_lds_dwordx4 v4, s[12:13]
  s_add_u32 s12, s12, 3840
  s_addc_u32 s13, s13, 0
  s_add_u32 m0, s14, 34560
  s_nop 0
  global_load_lds_dwordx4 v4, s[12:13]
  s_add_u32 s12, s12, 3840
  s_addc_u32 s13, s13, 0
  s_add_u32 m0, s14, 35520
  s_nop 0
  global_load_lds_dwordx4 v4, s[12:13]
  s_add_u32 s12, s12, 3840
  s_addc_u32 s13, s13, 0
  s_add_u32 m0, s14, 36480
  s_nop 0
  global_load_lds_dwordx4 v4, s[12:13]
  s_add_u32 s12, s12, 3840
  s_addc_u32 s13, s13, 0
  s_add_u32 m0, s14, 37440
  s_nop 0
  global_load_lds_dwordx4 v4, s[12:13]
  s_add_u32 s12, s12, 3840
  s_addc_u32 s13, s13, 0
  s_add_u32 m0, s14, 38400
  s_nop 0
  global_load_lds_dwordx4 v4, s[12:13]
  s_add_u32 s12, s12, 3840
  s_addc_u32 s13, s13, 0
  s_add_u32 m0, s14, 39360
  s_nop 0
  global_load_lds_dwordx4 v4, s[12:13]
  s_add_u32 s12, s12, 3840
  s_addc_u32 s13, s13, 0
  s_mov_b32 exec_lo, 0xffffffff
  s_mov_b32 exec_hi, 0xff
  s_add_u32 m0, s14, 40320
  s_nop 0
  global_load_lds_dwordx4 v4, s[12:13]
  s_add_u32 s12, s12, 2560
  s_addc_u32 s13, s13, 0
  s_mov_b64 exec, -1
  s_waitcnt vmcnt(33)
  ds_read_b64_tr_b16 a[0:1], v6 offset:0
  ds_read_b64_tr_b16 a[2:3], v6 offset:1280
  ds_read_b64_tr_b16 a[24:25], v6 offset:8
  ds_read_b64_tr_b16 a[26:27], v6 offset:1288
  ds_read_b64_tr_b16 a[48:49], v6 offset:64
  ds_read_b64_tr_b16 a[50:51], v6 offset:1344
  ds_read_b64_tr_b16 a[72:73], v6 offset:72
  ds_read_b64_tr_b16 a[74:75], v6 offset:1352
  ds_read_b64_tr_b16 a[96:97], v6 offset:128
  ds_read_b64_tr_b16 a[98:99], v6 offset:1408
  ds_read_b64_tr_b16 a[120:121], v6 offset:136
  ds_read_b64_tr_b16 a[122:123], v6 offset:1416
  ds_read_b64_tr_b16 a[144:145], v6 offset:192
  ds_read_b64_tr_b16 a[146:147], v6 offset:1472
  ds_read_b64_tr_b16 a[168:169], v6 offset:200
  ds_read_b64_tr_b16 a[170:171], v6 offset:1480
  ds_read_b64_tr_b16 a[192:193], v6 offset:256
  ds_read_b64_tr_b16 a[194:195], v6 offset:1536
  ds_read_b64_tr_b16 a[216:217], v6 offset:264
  ds_read_b64_tr_b16 a[218:219], v6 offset:1544
  s_waitcnt lgkmcnt(0)
  s_mov_b32 exec_lo, 0xffffffff
  s_mov_b32 exec_hi, 0xfffffff
  s_add_u32 m0, s14, 0
  s_nop 0
  global_load_lds_dwordx4 v4, s[12:13]
  s_add_u32 s12, s12, 3840
  s_addc_u32 s13, s13, 0
  s_add_u32 m0, s14, 960
  s_nop 0
  global_load_lds_dwordx4 v4, s[12:13]
  s_add_u32 s12, s12, 3840
  s_addc_u32 s13, s13, 0
  s_add_u32 m0, s14, 1920
  s_nop 0
  global_load_lds_dwordx4 v4, s[12:13]
  s_add_u32 s12, s12, 3840
  s_addc_u32 s13, s13, 0
  s_add_u32 m0, s14, 2880
  s_nop 0
  global_load_lds_dwordx4 v4, s[12:13]
  s_add_u32 s12, s12, 3840
  s_addc_u32 s13, s13, 0
  s_add_u32 m0, s14, 3840
  s_nop 0
  global_load_lds_dwordx4 v4, s[12:13]
  s_add_u32 s12, s12, 3840
  s_addc_u32 s13, s13, 0
  s_add_u32 m0, s14, 4800
  s_nop 0
  global_load_lds_dwordx4 v4, s[12:13]
  s_add_u32 s12, s12, 3840
  s_addc_u32 s13, s13, 0
  s_add_u32 m0, s14, 5760
  s_nop 0
  global_load_lds_dwordx4 v4, s[12:13]
  s_add_u32 s12, s12, 3840
  s_addc_u32 s13, s13, 0
  s_add_u32 m0, s14, 6720
  s_nop 0
  global_load_lds_dwordx4 v4, s[12:13]
  s_add_u32 s12, s12, 3840
  s_addc_u32 s13, s13, 0
  s_add_u32 m0, s14, 7680
  s_nop 0
  global_load_lds_dwordx4 v4, s[12:13]
  s_add_u32 s12, s12, 3840
  s_addc_u32 s13, s13, 0
  s_add_u32 m0, s14, 8640
  s_nop 0
  global_load_lds_dwordx4 v4, s[12:13]
  s_add_u32 s12, s12, 3840
  s_addc_u32 s13, s13, 0
  s_mov_b32 exec_lo, 0xffffffff
  s_mov_b32 exec_hi, 0xff
  s_add_u32 m0, s14, 9600
  s_nop 0
  global_load_lds_dwordx4 v4, s[12:13]
  s_add_u32 s12, s12, 2560
  s_addc_u32 s13, s13, 0
  s_mov_b64 exec, -1
  s_waitcnt vmcnt(33)
  ds_read_b64_tr_b16 a[4:5], v6 offset:10240
  ds_read_b64_tr_b16 a[6:7], v6 offset:11520
  ds_read_b64_tr_b16 a[28:29], v6 offset:10248
  ds_read_b64_tr_b16 a[30:31], v6 offset:11528
  ds_read_b64_tr_b16 a[52:53], v6 offset:10304
  ds_read_b64_tr_b16 a[54:55], v6 offset:11584
  ds_read_b64_tr_b16 a[76:77], v6 offset:10312
  ds_read_b64_tr_b16 a[78:79], v6 offset:11592
  ds_read_b64_tr_b16 a[100:101], v6 offset:10368
  ds_read_b64_tr_b16 a[102:103], v6 offset:11648
  ds_read_b64_tr_b16 a[124:125], v6 offset:10376
  ds_read_b64_tr_b16 a[126:127], v6 offset:11656
  ds_read_b64_tr_b16 a[148:149], v6 offset:10432
  ds_read_b64_tr_b16 a[150:151], v6 offset:11712
  ds_read_b64_tr_b16 a[172:173], v6 offset:10440
  ds_read_b64_tr_b16 a[174:175], v6 offset:11720
  ds_read_b64_tr_b16 a[196:197], v6 offset:10496
  ds_read_b64_tr_b16 a[198:199], v6 offset:11776
  ds_read_b64_tr_b16 a[220:221], v6 offset:10504
  ds_read_b64_tr_b16 a[222:223], v6 offset:11784
  s_waitcnt lgkmcnt(0)
  s_mov_b32 exec_lo, 0xffffffff
  s_mov_b32 exec_hi, 0xfffffff
  s_add_u32 m0, s14, 10240
  s_nop 0
  global_load_lds_dwordx4 v4, s[12:13]
  s_add_u32 s12, s12, 3840
  s_addc_u32 s13, s13, 0
  s_add_u32 m0, s14, 11200
  s_nop 0
  global_load_lds_dwordx4 v4, s[12:13]
  s_add_u32 s12, s12, 3840
  s_addc_u32 s13, s13, 0
  s_add_u32 m0, s14, 12160
  s_nop 0
  global_load_lds_dwordx4 v4, s[12:13]
  s_add_u32 s12, s12, 3840
  s_addc_u32 s13, s13, 0
  s_add_u32 m0, s14, 13120
  s_nop 0
  global_load_lds_dwordx4 v4, s[12:13]
  s_add_u32 s12, s12, 3840
  s_addc_u32 s13, s13, 0
  s_add_u32 m0, s14, 14080
  s_nop 0
  global_load_lds_dwordx4 v4, s[12:13]
  s_add_u32 s12, s12, 3840
  s_addc_u32 s13, s13, 0
  s_add_u32 m0, s14, 15040
  s_nop 0
  global_load_lds_dwordx4 v4, s[12:13]
  s_add_u32 s12, s12, 3840
  s_addc_u32 s13, s13, 0
  s_add_u32 m0, s14, 16000
  s_nop 0
  global_load_lds_dwordx4 v4, s[12:13]
  s_add_u32 s12, s12, 3840
  s_addc_u32 s13, s13, 0
  s_add_u32 m0, s14, 16960
  s_nop 0
  global_load_lds_dwordx4 v4, s[12:13]
  s_add_u32 s12, s12, 3840
  s_addc_u32 s13, s13, 0
  s_add_u32 m0, s14, 17920
  s_nop 0
  global_load_lds_dwordx4 v4, s[12:13]
  s_add_u32 s12, s12, 3840
  s_addc_u32 s13, s13, 0
  s_add_u32 m0, s14, 18880
  s_nop 0
  global_load_lds_dwordx4 v4, s[12:13]
  s_add_u32 s12, s12, 3840
  s_addc_u32 s13, s13, 0
  s_mov_b32 exec_lo, 0xffffffff
  s_mov_b32 exec_hi, 0xff
  s_add_u32 m0, s14, 19840
  s_nop 0
  global_load_lds_dwordx4 v4, s[12:13]
  s_add_u32 s12, s12, 2560
  s_addc_u32 s13, s13, 0
  s_mov_b64 exec, -1
  s_waitcnt vmcnt(33)
  ds_read_b64_tr_b16 a[8:9], v6 offset:20480
  ds_read_b64_tr_b16 a[10:11], v6 offset:21760
  ds_read_b64_tr_b16 a[32:33], v6 offset:20488
  ds_read_b64_tr_b16 a[34:35], v6 offset:21768
  ds_read_b64_tr_b16 a[56:57], v6 offset:20544
  ds_read_b64_tr_b16 a[58:59], v6 offset:21824
  ds_read_b64_tr_b16 a[80:81], v6 offset:20552
  ds_read_b64_tr_b16 a[82:83], v6 offset:21832
  ds_read_b64_tr_b16 a[104:105], v6 offset:20608
  ds_read_b64_tr_b16 a[106:107], v6 offset:21888
  ds_read_b64_tr_b16 a[128:129], v6 offset:20616
  ds_read_b64_tr_b16 a[130:131], v6 offset:21896
  ds_read_b64_tr_b16 a[152:153], v6 offset:20672
  ds_read_b64_tr_b16 a[154:155], v6 offset:21952
  ds_read_b64_tr_b16 a[176:177], v6 offset:20680
  ds_read_b64_tr_b16 a[178:179], v6 offset:21960
  ds_read_b64_tr_b16 a[200:201], v6 offset:20736
  ds_read_b64_tr_b16 a[202:203], v6 offset:22016
  ds_read_b64_tr_b16 a[224:225], v6 offset:20744
  ds_read_b64_tr_b16 a[226:227], v6 offset:22024
  s_waitcnt lgkmcnt(0)
  s_waitcnt vmcnt(22)
  ds_read_b64_tr_b16 a[12:13], v6 offset:30720
  ds_read_b64_tr_b16 a[14:15], v6 offset:32000
  ds_read_b64_tr_b16 a[36:37], v6 offset:30728
  ds_read_b64_tr_b16 a[38:39], v6 offset:32008
  ds_read_b64_tr_b16 a[60:61], v6 offset:30784
  ds_read_b64_tr_b16 a[62:63], v6 offset:32064
  ds_read_b64_tr_b16 a[84:85], v6 offset:30792
  ds_read_b64_tr_b16 a[86:87], v6 offset:32072
  ds_read_b64_tr_b16 a[108:109], v6 offset:30848
  ds_read_b64_tr_b16 a[110:111], v6 offset:32128
  ds_read_b64_tr_b16 a[132:133], v6 offset:30856
  ds_read_b64_tr_b16 a[134:135], v6 offset:32136
  ds_read_b64_tr_b16 a[156:157], v6 offset:30912
  ds_read_b64_tr_b16 a[158:159], v6 offset:32192
  ds_read_b64_tr_b16 a[180:181], v6 offset:30920
  ds_read_b64_tr_b16 a[182:183], v6 offset:32200
  ds_read_b64_tr_b16 a[204:205], v6 offset:30976
  ds_read_b64_tr_b16 a[206:207], v6 offset:32256
  ds_read_b64_tr_b16 a[228:229], v6 offset:30984
  ds_read_b64_tr_b16 a[230:231], v6 offset:32264
  s_waitcnt lgkmcnt(0)
  s_waitcnt vmcnt(11)
  ds_read_b64_tr_b16 a[16:17], v6 offset:0
  ds_read_b64_tr_b16 a[18:19], v6 offset:1280
  ds_read_b64_tr_b16 a[40:41], v6 offset:8
  ds_read_b64_tr_b16 a[42:43], v6 offset:1288
  ds_read_b64_tr_b16 a[64:65], v6 offset:64
  ds_read_b64_tr_b16 a[66:67], v6 offset:1344
  ds_read_b64_tr_b16 a[88:89], v6 offset:72
  ds_read_b64_tr_b16 a[90:91], v6 offset:1352
  ds_read_b64_tr_b16 a[112:113], v6 offset:128
  ds_read_b64_tr_b16 a[114:115], v6 offset:1408
  ds_read_b64_tr_b16 a[136:137], v6 offset:136
  ds_read_b64_tr_b16 a[138:139], v6 offset:1416
  ds_read_b64_tr_b16 a[160:161], v6 offset:192
  ds_read_b64_tr_b16 a[162:163], v6 offset:1472
  ds_read_b64_tr_b16 a[184:185], v6 offset:200
  ds_read_b64_tr_b16 a[186:187], v6 offset:1480
  ds_read_b64_tr_b16 a[208:209], v6 offset:256
  ds_read_b64_tr_b16 a[210:211], v6 offset:1536
  ds_read_b64_tr_b16 a[232:233], v6 offset:264
  ds_read_b64_tr_b16 a[234:235], v6 offset:1544
  s_waitcnt lgkmcnt(0)
  s_waitcnt vmcnt(0)
  ds_read_b64_tr_b16 a[20:21], v6 offset:10240
  ds_read_b64_tr_b16 a[22:23], v6 offset:11520
  ds_read_b64_tr_b16 a[44:45], v6 offset:10248
  ds_read_b64_tr_b16 a[46:47], v6 offset:11528
  ds_read_b64_tr_b16 a[68:69], v6 offset:10304
  ds_read_b64_tr_b16 a[70:71], v6 offset:11584
  ds_read_b64_tr_b16 a[92:93], v6 offset:10312
  ds_read_b64_tr_b16 a[94:95], v6 offset:11592
  ds_read_b64_tr_b16 a[116:117], v6 offset:10368
  ds_read_b64_tr_b16 a[118:119], v6 offset:11648
  ds_read_b64_tr_b16 a[140:141], v6 offset:10376
  ds_read_b64_tr_b16 a[142:143], v6 offset:11656
  ds_read_b64_tr_b16 a[164:165], v6 offset:10432
  ds_read_b64_tr_b16 a[166:167], v6 offset:11712
  ds_read_b64_tr_b16 a[188:189], v6 offset:10440
  ds_read_b64_tr_b16 a[190:191], v6 offset:11720
  ds_read_b64_tr_b16 a[212:213], v6 offset:10496
  ds_read_b64_tr_b16 a[214:215], v6 offset:11776
  ds_read_b64_tr_b16 a[236:237], v6 offset:10504
  ds_read_b64_tr_b16 a[238:239], v6 offset:11784
  s_waitcnt lgkmcnt(0)
  s_branch mega_out
mega_ln2:
  s_mul_i32 s24, s8, 6
  s_add_u32 s24, s24, s2
  s_sub_u32 s24, s24, 26
  s_lshl_b32 s30, s24, 7
  s_add_u32 s30, s30, 51200
  s_cmp_ge_u32 s2, 30
  s_cbranch_scc1 mega_ln2j
  s_lshl_b32 s12, s8, 2
  s_add_u32 s12, s12, s2
  s_sub_u32 s12, s12, 26
  s_lshl_b32 s12, s12, 2
  s_add_u32 s12, s12, s3
  s_lshl_b32 s14, s12, 11
  s_add_u32 s14, s14, 212860928
  s_mul_hi_u32 s15, s12, 715827883
  s_mul_i32 s16, s15, 6
  s_sub_u32 s16, s12, s16
  s_min_u32 s15, s15, 5
  s_lshl_b32 s15, s15, 15
  s_lshl_b32 s16, s16, 10
  s_add_u32 s12, s15, s16
  s_add_u32 s12, s12, 18432
  s_add_u32 s13, s12, 8192
  v_lshlrev_b32 v2, 4, v0
  v_mov_b32 v16, 0
  v_mov_b32 v17, 0
  v_mov_b32 v18, 0
  v_mov_b32 v19, 0
  v_mov_b32 v20, -1
  v_mov_b32 v21, -1
  v_mov_b32 v22, -1
  v_mov_b32 v23, -1
  buffer_store_dwordx4 v[16:19], v2, s[4:7], s13 offen offset:0 sc1
  buffer_store_dwordx4 v[16:19], v2, s[4:7], s12 offen offset:0 sc1
  buffer_store_dwordx4 v[20:23], v2, s[4:7], s14 offen offset:0 sc1
  buffer_store_dwordx4 v[20:23], v2, s[4:7], s14 offen offset:1024 sc1
  s_waitcnt vmcnt(0)
  s_barrier
  s_cmp_lg_u32 s3, 0
  s_cbranch_scc1 isk_66
  v_mov_b32 v16, 8
  v_mov_b32 v17, 1
  s_mov_b64 exec, 1
  global_atomic_add v16, v17, s[90:91]
  s_mov_b64 exec, -1
isk_66:
mega_ln2j:
  s_and_b32 s18, s2, 8
  s_lshl_b32 s18, s18, 1
  s_add_u32 s18, s18, 16
  s_load_dwordx4 s[12:15], s[0:1], s18
  s_and_b32 s16, s2, 7
  s_lshl_b32 s17, s8, 3
  s_add_u32 s16, s16, s17
  v_mul_u32_u24 v24, 21846, v0
  v_lshrrev_b32 v24, 16, v24
  v_mul_u32_u24 v25, 3, v24
  v_sub_u32 v25, v0, v25
  v_min_u32 v24, 15, v24
  v_mul_u32_u24 v24, 12288, v24
  v_lshl_add_u32 v24, v25, 7, v24
  s_mul_i32 s17, s16, 384
  s_mul_i32 s19, s3, 196608
  s_add_u32 s17, s17, s19
  s_add_u32 s17, s17, 786432
  s_waitcnt lgkmcnt(0)
  s_mov_b32 exec_hi, 0xffff
  s_add_u32 s12, s12, s17
  s_addc_u32 s13, s13, 0
  global_load_dword v26, v24, s[12:13]
  s_add_u32 s12, s12, 1572864
  s_addc_u32 s13, s13, 0
  global_load_dword v26, v24, s[12:13]
  s_add_u32 s12, s12, 1572864
  s_addc_u32 s13, s13, 0
  global_load_dword v26, v24, s[12:13]
  s_add_u32 s12, s12, 1572864
  s_addc_u32 s13, s13, 0
  global_load_dword v26, v24, s[12:13]
  s_add_u32 s12, s12, 1572864
  s_addc_u32 s13, s13, 0
  global_load_dword v26, v24, s[12:13]
  s_cmp_lg_u32 s18, 16
  s_cbranch_scc1 pf_67
  s_add_u32 s14, s14, s17
  s_addc_u32 s15, s15, 0
  global_load_dword v26, v24, s[14:15]
  s_add_u32 s14, s14, 1572864
  s_addc_u32 s15, s15, 0
  global_load_dword v26, v24, s[14:15]
  s_add_u32 s14, s14, 1572864
  s_addc_u32 s15, s15, 0
  global_load_dword v26, v24, s[14:15]
  s_add_u32 s14, s14, 1572864
  s_addc_u32 s15, s15, 0
  global_load_dword v26, v24, s[14:15]
  s_add_u32 s14, s14, 1572864
  s_addc_u32 s15, s15, 0
  global_load_dword v26, v24, s[14:15]
  s_branch pf_68
pf_67:
  s_mov_b32 exec_hi, 0xff
  v_lshlrev_b32 v24, 7, v0
  s_mul_i32 s17, s16, 245760
  s_mul_i32 s19, s3, 10240
  s_add_u32 s17, s17, s19
  s_add_u32 s17, s17, 40960
  s_add_u32 s14, s14, s17
  s_addc_u32 s15, s15, 0
  global_load_dword v26, v24, s[14:15]
  s_add_u32 s14, s14, 5120
  s_addc_u32 s15, s15, 0
  global_load_dword v26, v24, s[14:15]
  s_add_u32 s14, s14, 76800
  s_addc_u32 s15, s15, 0
  global_load_dword v26, v24, s[14:15]
  s_add_u32 s14, s14, 5120
  s_addc_u32 s15, s15, 0
  global_load_dword v26, v24, s[14:15]
  s_add_u32 s14, s14, 76800
  s_addc_u32 s15, s15, 0
  global_load_dword v26, v24, s[14:15]
  s_add_u32 s14, s14, 5120
  s_addc_u32 s15, s15, 0
  global_load_dword v26, v24, s[14:15]
pf_68:
  s_mov_b64 exec, -1
  s_lshr_b32 s40, s2, 3
  v_lshlrev_b32 v2, 4, v0
  v_lshrrev_b32 v16, 2, v2
  v_mov_b32 v17, 0
  s_mov_b32 exec_lo, 0x00030003
  s_mov_b32 exec_hi, 0x00030003
  v_mov_b32 v17, 32
  s_mov_b32 exec_lo, 0x00100010
  s_mov_b32 exec_hi, 0x00100010
  v_mov_b32 v17, 64
  s_mov_b64 exec, 4
  v_mov_b32 v17, 56
  s_mov_b32 exec_lo, 0
  s_mov_b32 exec_hi, 4
  v_mov_b32 v17, 268435456
  s_mov_b64 exec, -1
  s_branch isync_70
isync_69:
  s_sleep 4
  s_add_u32 s11, s11, 1
  s_cmp_gt_u32 s11, 131072
  s_cbranch_scc1 mega_done
isync_70:
  global_load_dword v18, v16, s[90:91] sc1
  s_waitcnt vmcnt(0)
  v_cmp_gt_u32 vcc, v17, v18
  s_cbranch_vccnz isync_69
  v_readlane_b32 s66, v18, 34
  s_nop 0
  s_cmp_lt_u32 s66, 268468224
  s_cselect_b32 s66, 0, 8192
  s_xor_b32 s31, s66, 8192
  s_xor_b32 s31, s31, 0
  v_mov_b32 v4, 116736
  s_mov_b32 s12, 1
  s_branch wf_72
wf_71:
  s_sleep 8
  s_add_u32 s11, s11, 1
  s_cmp_gt_u32 s11, 131072
  s_cbranch_scc1 mega_done
wf_72:
  buffer_load_dword v5, v4, s[4:7], s66 offen sc1
  s_waitcnt vmcnt(0)
  v_cmp_gt_u32 vcc, s12, v5
  s_cbranch_vccnz wf_71
  s_load_dwordx2 s[12:13], s[0:1], 72
  s_mul_i32 s14, s8, 6
  s_add_u32 s14, s14, s2
  s_sub_u32 s14, s14, 26
  s_lshl_b32 s14, s14, 2
  s_add_u32 s14, s14, s3
  s_lshl_b32 s14, s14, 13
  v_lshlrev_b32 v4, 7, v0
  v_add_u32 v4, s14, v4
  s_waitcnt lgkmcnt(0)
  v_min_u32 v5, 8388480, v4
  global_load_dword v6, v5, s[12:13]
  v_add_u32 v4, 1572864, v4
  v_min_u32 v5, 8388480, v4
  global_load_dword v6, v5, s[12:13]
  v_add_u32 v4, 1572864, v4
  v_min_u32 v5, 8388480, v4
  global_load_dword v6, v5, s[12:13]
  v_add_u32 v4, 1572864, v4
  v_min_u32 v5, 8388480, v4
  global_load_dword v6, v5, s[12:13]
  v_add_u32 v4, 1572864, v4
  v_min_u32 v5, 8388480, v4
  global_load_dword v6, v5, s[12:13]
  v_add_u32 v4, 1572864, v4
  v_min_u32 v5, 8388480, v4
  global_load_dword v6, v5, s[12:13]
  v_add_u32 v4, 1572864, v4
  s_waitcnt vmcnt(0)
  v_mov_b32 v4, 149504
  s_mov_b32 s12, 1
  s_branch wf_74
wf_73:
  s_sleep 20
  s_add_u32 s11, s11, 1
  s_cmp_gt_u32 s11, 131072
  s_cbranch_scc1 mega_done
wf_74:
  buffer_load_dword v5, v4, s[4:7], s66 offen sc1
  s_waitcnt vmcnt(0)
  v_cmp_gt_u32 vcc, s12, v5
  s_cbranch_vccnz wf_73
  s_load_dwordx2 s[12:13], s[0:1], 88
  s_mul_i32 s14, s3, 245760
  s_mul_i32 s15, s40, 320
  s_add_u32 s14, s14, s15
  v_lshrrev_b32 v7, 4, v0
  v_lshlrev_b32 v6, 3, v7
  v_bfe_u32 v7, v0, 2, 2
  v_add_u32 v6, v6, v7
  v_mul_u32_u24 v6, 320, v6
  v_and_b32 v7, 3, v0
  v_lshl_add_u32 v6, v7, 4, v6
  s_waitcnt lgkmcnt(0)
  s_add_u32 s12, s12, s14
  s_addc_u32 s13, s13, 0
  s_mul_i32 s14, s3, 40960
  v_add_u32 v6, s14, v6
  v_mul_u32_u24 v5, 3277, v0
  v_lshrrev_b32 v5, 16, v5
  s_mov_b32 s15, 960
  v_mul_lo_u32 v4, v5, s15
  v_lshl_add_u32 v4, v0, 4, v4
  s_mov_b32 exec_lo, 0xffffffff
  s_mov_b32 exec_hi, 0xfffffff
  s_add_u32 m0, s14, 0
  s_nop 0
  global_load_lds_dwordx4 v4, s[12:13]
  s_add_u32 s12, s12, 3840
  s_addc_u32 s13, s13, 0
  s_add_u32 m0, s14, 960
  s_nop 0
  global_load_lds_dwordx4 v4, s[12:13]
  s_add_u32 s12, s12, 3840
  s_addc_u32 s13, s13, 0
  s_add_u32 m0, s14, 1920
  s_nop 0
  global_load_lds_dwordx4 v4, s[12:13]
  s_add_u32 s12, s12, 3840
  s_addc_u32 s13, s13, 0
  s_add_u32 m0, s14, 2880
  s_nop 0
  global_load_lds_dwordx4 v4, s[12:13]
  s_add_u32 s12, s12, 3840
  s_addc_u32 s13, s13, 0
  s_add_u32 m0, s14, 3840
  s_nop 0
  global_load_lds_dwordx4 v4, s[12:13]
  s_add_u32 s12, s12, 3840
  s_addc_u32 s13, s13, 0
  s_add_u32 m0, s14, 4800
  s_nop 0
  global_load_lds_dwordx4 v4, s[12:13]
  s_add_u32 s12, s12, 3840
  s_addc_u32 s13, s13, 0
  s_add_u32 m0, s14, 5760
  s_nop 0
  global_load_lds_dwordx4 v4, s[12:13]
  s_add_u32 s12, s12, 3840
  s_addc_u32 s13, s13, 0
  s_add_u32 m0, s14, 6720
  s_nop 0
  global_load_lds_dwordx4 v4, s[12:13]
  s_add_u32 s12, s12, 3840
  s_addc_u32 s13, s13, 0
  s_add_u32 m0, s14, 7680
  s_nop 0
  global_load_lds_dwordx4 v4, s[12:13]
  s_add_u32 s12, s12, 3840
  s_addc_u32 s13, s13, 0
  s_add_u32 m0, s14, 8640
  s_nop 0
  global_load_lds_dwordx4 v4, s[12:13]
  s_add_u32 s12, s12, 3840
  s_addc_u32 s13, s13, 0
  s_mov_b32 exec_lo, 0xffffffff
  s_mov_b32 exec_hi, 0xff
  s_add_u32 m0, s14, 9600
  s_nop 0
  global_load_lds_dwordx4 v4, s[12:13]
  s_add_u32 s12, s12, 2560
  s_addc_u32 s13, s13, 0
  s_mov_b64 exec, -1
  s_mov_b32 exec_lo, 0xffffffff
  s_mov_b32 exec_hi, 0xfffffff
  s_add_u32 m0, s14, 10240
  s_nop 0
  global_load_lds_dwordx4 v4, s[12:13]
  s_add_u32 s12, s12, 3840
  s_addc_u32 s13, s13, 0
  s_add_u32 m0, s14, 11200
  s_nop 0
  global_load_lds_dwordx4 v4, s[12:13]
  s_add_u32 s12, s12, 3840
  s_addc_u32 s13, s13, 0
  s_add_u32 m0, s14, 12160
  s_nop 0
  global_load_lds_dwordx4 v4, s[12:13]
  s_add_u32 s12, s12, 3840
  s_addc_u32 s13, s13, 0
  s_add_u32 m0, s14, 13120
  s_nop 0
  global_load_lds_dwordx4 v4, s[12:13]
  s_add_u32 s12, s12, 3840
  s_addc_u32 s13, s13, 0
  s_add_u32 m0, s14, 14080
  s_nop 0
  global_load_lds_dwordx4 v4, s[12:13]
  s_add_u32 s12, s12, 3840
  s_addc_u32 s13, s13, 0
  s_add_u32 m0, s14, 15040
  s_nop 0
  global_load_lds_dwordx4 v4, s[12:13]
  s_add_u32 s12, s12, 3840
  s_addc_u32 s13, s13, 0
  s_add_u32 m0, s14, 16000
  s_nop 0
  global_load_lds_dwordx4 v4, s[12:13]
  s_add_u32 s12, s12, 3840
  s_addc_u32 s13, s13, 0
  s_add_u32 m0, s14, 16960
  s_nop 0
  global_load_lds_dwordx4 v4, s[12:13]
  s_add_u32 s12, s12, 3840
  s_addc_u32 s13, s13, 0
  s_add_u32 m0, s14, 17920
  s_nop 0
  global_load_lds_dwordx4 v4, s[12:13]
  s_add_u32 s12, s12, 3840
  s_addc_u32 s13, s13, 0
  s_add_u32 m0, s14, 18880
  s_nop 0
  global_load_lds_dwordx4 v4, s[12:13]
  s_add_u32 s12, s12, 3840
  s_addc_u32 s13, s13, 0
  s_mov_b32 exec_lo, 0xffffffff
  s_mov_b32 exec_hi, 0xff
  s_add_u32 m0, s14, 19840
  s_nop 0
  global_load_lds_dwordx4 v4, s[12:13]
  s_add_u32 s12, s12, 2560
  s_addc_u32 s13, s13, 0
  s_mov_b64 exec, -1
  s_mov_b32 exec_lo, 0xffffffff
  s_mov_b32 exec_hi, 0xfffffff
  s_add_u32 m0, s14, 20480
  s_nop 0
  global_load_lds_dwordx4 v4, s[12:13]
  s_add_u32 s12, s12, 3840
  s_addc_u32 s13, s13, 0
  s_add_u32 m0, s14, 21440
  s_nop 0
  global_load_lds_dwordx4 v4, s[12:13]
  s_add_u32 s12, s12, 3840
  s_addc_u32 s13, s13, 0
  s_add_u32 m0, s14, 22400
  s_nop 0
  global_load_lds_dwordx4 v4, s[12:13]
  s_add_u32 s12, s12, 3840
  s_addc_u32 s13, s13, 0
  s_add_u32 m0, s14, 23360
  s_nop 0
  global_load_lds_dwordx4 v4, s[12:13]
  s_add_u32 s12, s12, 3840
  s_addc_u32 s13, s13, 0
  s_add_u32 m0, s14, 24320
  s_nop 0
  global_load_lds_dwordx4 v4, s[12:13]
  s_add_u32 s12, s12, 3840
  s_addc_u32 s13, s13, 0
  s_add_u32 m0, s14, 25280
  s_nop 0
  global_load_lds_dwordx4 v4, s[12:13]
  s_add_u32 s12, s12, 3840
  s_addc_u32 s13, s13, 0
  s_add_u32 m0, s14, 26240
  s_nop 0
  global_load_lds_dwordx4 v4, s[12:13]
  s_add_u32 s12, s12, 3840
  s_addc_u32 s13, s13, 0
  s_add_u32 m0, s14, 27200
  s_nop 0
  global_load_lds_dwordx4 v4, s[12:13]
  s_add_u32 s12, s12, 3840
  s_addc_u32 s13, s13, 0
  s_add_u32 m0, s14, 28160
  s_nop 0
  global_load_lds_dwordx4 v4, s[12:13]
  s_add_u32 s12, s12, 3840
  s_addc_u32 s13, s13, 0
  s_add_u32 m0, s14, 29120
  s_nop 0
  global_load_lds_dwordx4 v4, s[12:13]
  s_add_u32 s12, s12, 3840
  s_addc_u32 s13, s13, 0
  s_mov_b32 exec_lo, 0xffffffff
  s_mov_b32 exec_hi, 0xff
  s_add_u32 m0, s14, 30080
  s_nop 0
  global_load_lds_dwordx4 v4, s[12:13]
  s_add_u32 s12, s12, 2560
  s_addc_u32 s13, s13, 0
  s_mov_b64 exec, -1
  s_mov_b32 exec_lo, 0xffffffff
  s_mov_b32 exec_hi, 0xfffffff
  s_add_u32 m0, s14, 30720
  s_nop 0
  global_load_lds_dwordx4 v4, s[12:13]
  s_add_u32 s12, s12, 3840
  s_addc_u32 s13, s13, 0
  s_add_u32 m0, s14, 31680
  s_nop 0
  global_load_lds_dwordx4 v4, s[12:13]
  s_add_u32 s12, s12, 3840
  s_addc_u32 s13, s13, 0
  s_add_u32 m0, s14, 32640
  s_nop 0
  global_load_lds_dwordx4 v4, s[12:13]
  s_add_u32 s12, s12, 3840
  s_addc_u32 s13, s13, 0
  s_add_u32 m0, s14, 33600
  s_nop 0
  global_load_lds_dwordx4 v4, s[12:13]
  s_add_u32 s12, s12, 3840
  s_addc_u32 s13, s13, 0
  s_add_u32 m0, s14, 34560
  s_nop 0
  global_load_lds_dwordx4 v4, s[12:13]
  s_add_u32 s12, s12, 3840
  s_addc_u32 s13, s13, 0
  s_add_u32 m0, s14, 35520
  s_nop 0
  global_load_lds_dwordx4 v4, s[12:13]
  s_add_u32 s12, s12, 3840
  s_addc_u32 s13, s13, 0
  s_add_u32 m0, s14, 36480
  s_nop 0
  global_load_lds_dwordx4 v4, s[12:13]
  s_add_u32 s12, s12, 3840
  s_addc_u32 s13, s13, 0
  s_add_u32 m0, s14, 37440
  s_nop 0
  global_load_lds_dwordx4 v4, s[12:13]
  s_add_u32 s12, s12, 3840
  s_addc_u32 s13, s13, 0
  s_add_u32 m0, s14, 38400
  s_nop 0
  global_load_lds_dwordx4 v4, s[12:13]
  s_add_u32 s12, s12, 3840
  s_addc_u32 s13, s13, 0
  s_add_u32 m0, s14, 39360
  s_nop 0
  global_load_lds_dwordx4 v4, s[12:13]
  s_add_u32 s12, s12, 3840
  s_addc_u32 s13, s13, 0
  s_mov_b32 exec_lo, 0xffffffff
  s_mov_b32 exec_hi, 0xff
  s_add_u32 m0, s14, 40320
  s_nop 0
  global_load_lds_dwordx4 v4, s[12:13]
  s_add_u32 s12, s12, 2560
  s_addc_u32 s13, s13, 0
  s_mov_b64 exec, -1
  s_waitcnt vmcnt(33)
  ds_read_b64_tr_b16 a[0:1], v6 offset:0
  ds_read_b64_tr_b16 a[2:3], v6 offset:1280
  ds_read_b64_tr_b16 a[24:25], v6 offset:8
  ds_read_b64_tr_b16 a[26:27], v6 offset:1288
  ds_read_b64_tr_b16 a[48:49], v6 offset:64
  ds_read_b64_tr_b16 a[50:51], v6 offset:1344
  ds_read_b64_tr_b16 a[72:73], v6 offset:72
  ds_read_b64_tr_b16 a[74:75], v6 offset:1352
  ds_read_b64_tr_b16 a[96:97], v6 offset:128
  ds_read_b64_tr_b16 a[98:99], v6 offset:1408
  ds_read_b64_tr_b16 a[120:121], v6 offset:136
  ds_read_b64_tr_b16 a[122:123], v6 offset:1416
  ds_read_b64_tr_b16 a[144:145], v6 offset:192
  ds_read_b64_tr_b16 a[146:147], v6 offset:1472
  ds_read_b64_tr_b16 a[168:169], v6 offset:200
  ds_read_b64_tr_b16 a[170:171], v6 offset:1480
  ds_read_b64_tr_b16 a[192:193], v6 offset:256
  ds_read_b64_tr_b16 a[194:195], v6 offset:1536
  ds_read_b64_tr_b16 a[216:217], v6 offset:264
  ds_read_b64_tr_b16 a[218:219], v6 offset:1544
  s_waitcnt lgkmcnt(0)
  s_mov_b32 exec_lo, 0xffffffff
  s_mov_b32 exec_hi, 0xfffffff
  s_add_u32 m0, s14, 0
  s_nop 0
  global_load_lds_dwordx4 v4, s[12:13]
  s_add_u32 s12, s12, 3840
  s_addc_u32 s13, s13, 0
  s_add_u32 m0, s14, 960
  s_nop 0
  global_load_lds_dwordx4 v4, s[12:13]
  s_add_u32 s12, s12, 3840
  s_addc_u32 s13, s13, 0
  s_add_u32 m0, s14, 1920
  s_nop 0
  global_load_lds_dwordx4 v4, s[12:13]
  s_add_u32 s12, s12, 3840
  s_addc_u32 s13, s13, 0
  s_add_u32 m0, s14, 2880
  s_nop 0
  global_load_lds_dwordx4 v4, s[12:13]
  s_add_u32 s12, s12, 3840
  s_addc_u32 s13, s13, 0
  s_add_u32 m0, s14, 3840
  s_nop 0
  global_load_lds_dwordx4 v4, s[12:13]
  s_add_u32 s12, s12, 3840
  s_addc_u32 s13, s13, 0
  s_add_u32 m0, s14, 4800
  s_nop 0
  global_load_lds_dwordx4 v4, s[12:13]
  s_add_u32 s12, s12, 3840
  s_addc_u32 s13, s13, 0
  s_add_u32 m0, s14, 5760
  s_nop 0
  global_load_lds_dwordx4 v4, s[12:13]
  s_add_u32 s12, s12, 3840
  s_addc_u32 s13, s13, 0
  s_add_u32 m0, s14, 6720
  s_nop 0
  global_load_lds_dwordx4 v4, s[12:13]
  s_add_u32 s12, s12, 3840
  s_addc_u32 s13, s13, 0
  s_add_u32 m0, s14, 7680
  s_nop 0
  global_load_lds_dwordx4 v4, s[12:13]
  s_add_u32 s12, s12, 3840
  s_addc_u32 s13, s13, 0
  s_add_u32 m0, s14, 8640
  s_nop 0
  global_load_lds_dwordx4 v4, s[12:13]
  s_add_u32 s12, s12, 3840
  s_addc_u32 s13, s13, 0
  s_mov_b32 exec_lo, 0xffffffff
  s_mov_b32 exec_hi, 0xff
  s_add_u32 m0, s14, 9600
  s_nop 0
  global_load_lds_dwordx4 v4, s[12:13]
  s_add_u32 s12, s12, 2560
  s_addc_u32 s13, s13, 0
  s_mov_b64 exec, -1
  s_waitcnt vmcnt(33)
  ds_read_b64_tr_b16 a[4:5], v6 offset:10240
  ds_read_b64_tr_b16 a[6:7], v6 offset:11520
  ds_read_b64_tr_b16 a[28:29], v6 offset:10248
  ds_read_b64_tr_b16 a[30:31], v6 offset:11528
  ds_read_b64_tr_b16 a[52:53], v6 offset:10304
  ds_read_b64_tr_b16 a[54:55], v6 offset:11584
  ds_read_b64_tr_b16 a[76:77], v6 offset:10312
  ds_read_b64_tr_b16 a[78:79], v6 offset:11592
  ds_read_b64_tr_b16 a[100:101], v6 offset:10368
  ds_read_b64_tr_b16 a[102:103], v6 offset:11648
  ds_read_b64_tr_b16 a[124:125], v6 offset:10376
  ds_read_b64_tr_b16 a[126:127], v6 offset:11656
  ds_read_b64_tr_b16 a[148:149], v6 offset:10432
  ds_read_b64_tr_b16 a[150:151], v6 offset:11712
  ds_read_b64_tr_b16 a[172:173], v6 offset:10440
  ds_read_b64_tr_b16 a[174:175], v6 offset:11720
  ds_read_b64_tr_b16 a[196:197], v6 offset:10496
  ds_read_b64_tr_b16 a[198:199], v6 offset:11776
  ds_read_b64_tr_b16 a[220:221], v6 offset:10504
  ds_read_b64_tr_b16 a[222:223], v6 offset:11784
  s_waitcnt lgkmcnt(0)
  s_mov_b32 exec_lo, 0xffffffff
  s_mov_b32 exec_hi, 0xfffffff
  s_add_u32 m0, s14, 10240
  s_nop 0
  global_load_lds_dwordx4 v4, s[12:13]
  s_add_u32 s12, s12, 3840
  s_addc_u32 s13, s13, 0
  s_add_u32 m0, s14, 11200
  s_nop 0
  global_load_lds_dwordx4 v4, s[12:13]
  s_add_u32 s12, s12, 3840
  s_addc_u32 s13, s13, 0
  s_add_u32 m0, s14, 12160
  s_nop 0
  global_load_lds_dwordx4 v4, s[12:13]
  s_add_u32 s12, s12, 3840
  s_addc_u32 s13, s13, 0
  s_add_u32 m0, s14, 13120
  s_nop 0
  global_load_lds_dwordx4 v4, s[12:13]
  s_add_u32 s12, s12, 3840
  s_addc_u32 s13, s13, 0
  s_add_u32 m0, s14, 14080
  s_nop 0
  global_load_lds_dwordx4 v4, s[12:13]
  s_add_u32 s12, s12, 3840
  s_addc_u32 s13, s13, 0
  s_add_u32 m0, s14, 15040
  s_nop 0
  global_load_lds_dwordx4 v4, s[12:13]
  s_add_u32 s12, s12, 3840
  s_addc_u32 s13, s13, 0
  s_add_u32 m0, s14, 16000
  s_nop 0
  global_load_lds_dwordx4 v4, s[12:13]
  s_add_u32 s12, s12, 3840
  s_addc_u32 s13, s13, 0
  s_add_u32 m0, s14, 16960
  s_nop 0
  global_load_lds_dwordx4 v4, s[12:13]
  s_add_u32 s12, s12, 3840
  s_addc_u32 s13, s13, 0
  s_add_u32 m0, s14, 17920
  s_nop 0
  global_load_lds_dwordx4 v4, s[12:13]
  s_add_u32 s12, s12, 3840
  s_addc_u32 s13, s13, 0
  s_add_u32 m0, s14, 18880
  s_nop 0
  global_load_lds_dwordx4 v4, s[12:13]
  s_add_u32 s12, s12, 3840
  s_addc_u32 s13, s13, 0
  s_mov_b32 exec_lo, 0xffffffff
  s_mov_b32 exec_hi, 0xff
  s_add_u32 m0, s14, 19840
  s_nop 0
  global_load_lds_dwordx4 v4, s[12:13]
  s_add_u32 s12, s12, 2560
  s_addc_u32 s13, s13, 0
  s_mov_b64 exec, -1
  s_waitcnt vmcnt(33)
  ds_read_b64_tr_b16 a[8:9], v6 offset:20480
  ds_read_b64_tr_b16 a[10:11], v6 offset:21760
  ds_read_b64_tr_b16 a[32:33], v6 offset:20488
  ds_read_b64_tr_b16 a[34:35], v6 offset:21768
  ds_read_b64_tr_b16 a[56:57], v6 offset:20544
  ds_read_b64_tr_b16 a[58:59], v6 offset:21824
  ds_read_b64_tr_b16 a[80:81], v6 offset:20552
  ds_read_b64_tr_b16 a[82:83], v6 offset:21832
  ds_read_b64_tr_b16 a[104:105], v6 offset:20608
  ds_read_b64_tr_b16 a[106:107], v6 offset:21888
  ds_read_b64_tr_b16 a[128:129], v6 offset:20616
  ds_read_b64_tr_b16 a[130:131], v6 offset:21896
  ds_read_b64_tr_b16 a[152:153], v6 offset:20672
  ds_read_b64_tr_b16 a[154:155], v6 offset:21952
  ds_read_b64_tr_b16 a[176:177], v6 offset:20680
  ds_read_b64_tr_b16 a[178:179], v6 offset:21960
  ds_read_b64_tr_b16 a[200:201], v6 offset:20736
  ds_read_b64_tr_b16 a[202:203], v6 offset:22016
  ds_read_b64_tr_b16 a[224:225], v6 offset:20744
  ds_read_b64_tr_b16 a[226:227], v6 offset:22024
  s_waitcnt lgkmcnt(0)
  s_waitcnt vmcnt(22)
  ds_read_b64_tr_b16 a[12:13], v6 offset:30720
  ds_read_b64_tr_b16 a[14:15], v6 offset:32000
  ds_read_b64_tr_b16 a[36:37], v6 offset:30728
  ds_read_b64_tr_b16 a[38:39], v6 offset:32008
  ds_read_b64_tr_b16 a[60:61], v6 offset:30784
  ds_read_b64_tr_b16 a[62:63], v6 offset:32064
  ds_read_b64_tr_b16 a[84:85], v6 offset:30792
  ds_read_b64_tr_b16 a[86:87], v6 offset:32072
  ds_read_b64_tr_b16 a[108:109], v6 offset:30848
  ds_read_b64_tr_b16 a[110:111], v6 offset:32128
  ds_read_b64_tr_b16 a[132:133], v6 offset:30856
  ds_read_b64_tr_b16 a[134:135], v6 offset:32136
  ds_read_b64_tr_b16 a[156:157], v6 offset:30912
  ds_read_b64_tr_b16 a[158:159], v6 offset:32192
  ds_read_b64_tr_b16 a[180:181], v6 offset:30920
  ds_read_b64_tr_b16 a[182:183], v6 offset:32200
  ds_read_b64_tr_b16 a[204:205], v6 offset:30976
  ds_read_b64_tr_b16 a[206:207], v6 offset:32256
  ds_read_b64_tr_b16 a[228:229], v6 offset:30984
  ds_read_b64_tr_b16 a[230:231], v6 offset:32264
  s_waitcnt lgkmcnt(0)
  s_waitcnt vmcnt(11)
  ds_read_b64_tr_b16 a[16:17], v6 offset:0
  ds_read_b64_tr_b16 a[18:19], v6 offset:1280
  ds_read_b64_tr_b16 a[40:41], v6 offset:8
  ds_read_b64_tr_b16 a[42:43], v6 offset:1288
  ds_read_b64_tr_b16 a[64:65], v6 offset:64
  ds_read_b64_tr_b16 a[66:67], v6 offset:1344
  ds_read_b64_tr_b16 a[88:89], v6 offset:72
  ds_read_b64_tr_b16 a[90:91], v6 offset:1352
  ds_read_b64_tr_b16 a[112:113], v6 offset:128
  ds_read_b64_tr_b16 a[114:115], v6 offset:1408
  ds_read_b64_tr_b16 a[136:137], v6 offset:136
  ds_read_b64_tr_b16 a[138:139], v6 offset:1416
  ds_read_b64_tr_b16 a[160:161], v6 offset:192
  ds_read_b64_tr_b16 a[162:163], v6 offset:1472
  ds_read_b64_tr_b16 a[184:185], v6 offset:200
  ds_read_b64_tr_b16 a[186:187], v6 offset:1480
  ds_read_b64_tr_b16 a[208:209], v6 offset:256
  ds_read_b64_tr_b16 a[210:211], v6 offset:1536
  ds_read_b64_tr_b16 a[232:233], v6 offset:264
  ds_read_b64_tr_b16 a[234:235], v6 offset:1544
  s_waitcnt lgkmcnt(0)
  s_waitcnt vmcnt(0)
  ds_read_b64_tr_b16 a[20:21], v6 offset:10240
  ds_read_b64_tr_b16 a[22:23], v6 offset:11520
  ds_read_b64_tr_b16 a[44:45], v6 offset:10248
  ds_read_b64_tr_b16 a[46:47], v6 offset:11528
  ds_read_b64_tr_b16 a[68:69], v6 offset:10304
  ds_read_b64_tr_b16 a[70:71], v6 offset:11584
  ds_read_b64_tr_b16 a[92:93], v6 offset:10312
  ds_read_b64_tr_b16 a[94:95], v6 offset:11592
  ds_read_b64_tr_b16 a[116:117], v6 offset:10368
  ds_read_b64_tr_b16 a[118:119], v6 offset:11648
  ds_read_b64_tr_b16 a[140:141], v6 offset:10376
  ds_read_b64_tr_b16 a[142:143], v6 offset:11656
  ds_read_b64_tr_b16 a[164:165], v6 offset:10432
  ds_read_b64_tr_b16 a[166:167], v6 offset:11712
  ds_read_b64_tr_b16 a[188:189], v6 offset:10440
  ds_read_b64_tr_b16 a[190:191], v6 offset:11720
  ds_read_b64_tr_b16 a[212:213], v6 offset:10496
  ds_read_b64_tr_b16 a[214:215], v6 offset:11776
  ds_read_b64_tr_b16 a[236:237], v6 offset:10504
  ds_read_b64_tr_b16 a[238:239], v6 offset:11784
  s_waitcnt lgkmcnt(0)
  s_xor_b32 s12, s31, 8192
  s_add_u32 s30, s30, s12
  s_barrier
  s_load_dwordx2 s[26:27], s[0:1], 0
  v_and_b32 v8, 7, v0
  v_bfe_u32 v9, v0, 3, 1
  v_lshrrev_b32 v10, 4, v0
  s_and_b32 s16, s24, 1
  s_lshl_b32 s16, s16, 7
  s_lshl_b32 s17, s3, 13
  s_add_u32 s16, s16, s17
  v_lshlrev_b32 v2, 4, v8
  v_lshl_add_u32 v2, v10, 8, v2
  v_lshl_add_u32 v2, v9, 12, v2
  v_add_u32 v2, s16, v2
  v_and_b32 v13, 1023, v2
  v_lshrrev_b32 v14, 12, v2
  v_lshl_add_u32 v13, v14, 10, v13
  v_mul_u32_u24 v3, 1280, v8
  v_lshl_add_u32 v3, v10, 3, v3
  v_lshl_add_u32 v3, v9, 6, v3
  s_lshl_b32 s16, s3, 7
  v_add_u32 v3, s16, v3
  v_bfe_u32 v11, v0, 2, 1
  v_mul_u32_u24 v4, 20480, v11
  v_lshl_add_u32 v4, v10, 8, v4
  v_and_b32 v11, 3, v0
  v_lshl_add_u32 v4, v11, 4, v4
  v_lshl_add_u32 v4, v9, 10, v4
  s_and_b32 s16, s24, 3
  s_lshl_b32 s16, s16, 6
  s_lshl_b32 s17, s3, 11
  s_add_u32 s16, s16, s17
  v_add_u32 v4, s16, v4
  v_lshlrev_b32 v7, 5, v8
  s_lshl_b32 s16, s3, 3
  v_add_u32 v6, s16, v7
  s_bfe_u32 s16, s24, 0x10001
  s_lshl_b32 s16, s16, 6
  s_add_u32 s16, s16, 18432
  s_add_u32 s16, s16, s31
  v_min_u32 v5, 39, v0
  v_lshlrev_b32 v5, 7, v5
  v_add_u32 v5, s16, v5
  s_mov_b32 s18, 0x00003f80
  s_mov_b32 s19, 0x3f800000
  s_cmp_lt_u32 s3, 2
  s_cselect_b64 s[28:29], -1, 0
  s_waitcnt lgkmcnt(0)
ln2_loop:
  s_mul_i32 s15, s24, 10240
  s_add_u32 s12, s26, s15
  s_addc_u32 s13, s27, 0
  s_lshr_b32 s14, s24, 1
  s_mul_i32 s15, s14, 20480
  s_add_u32 s15, s15, 192937984
  s_mul_i32 s14, s14, 81920
  s_add_u32 s14, s14, 165675008
  s_lshr_b32 s17, s24, 2
  s_mul_i32 s16, s17, 40960
  s_add_u32 s16, s16, 196083712
  s_add_u32 s17, s17, 1
  v_mov_b32 v72, 0
  v_mov_b32 v73, 0
  v_mov_b32 v74, 0
  v_mov_b32 v75, 0
  v_mov_b32 v48, 0
  v_mov_b32 v49, 0
  v_mov_b32 v50, 0
  v_mov_b32 v51, 0
  v_mov_b32 v52, 0
  v_mov_b32 v53, 0
  v_mov_b32 v54, 0
  v_mov_b32 v55, 0
  v_mov_b32 v56, 0
  v_mov_b32 v57, 0
  v_mov_b32 v58, 0
  v_mov_b32 v59, 0
  v_mov_b32 v60, 0
  v_mov_b32 v61, 0
  v_mov_b32 v62, 0
  v_mov_b32 v63, 0
  global_load_dwordx2 v[64:65], v3, s[12:13] offset:0
  global_load_dwordx2 v[66:67], v3, s[12:13] offset:32
  global_load_dwordx2 v[68:69], v3, s[12:13] offset:512
  global_load_dwordx2 v[70:71], v3, s[12:13] offset:544
  s_cmp_ge_u32 s3, 2
  s_cbranch_scc1 l2_75
  global_load_dwordx2 v[72:73], v3, s[12:13] offset:1024
  global_load_dwordx2 v[74:75], v3, s[12:13] offset:1056
l2_75:
  s_cmp_lg_u32 s3, 0
  s_cbranch_scc1 l2_76
  s_sub_u32 s20, s17, 1
  s_branch wf_80
wf_79:
  s_sleep 24
  s_add_u32 s11, s11, 1
  s_cmp_gt_u32 s11, 131072
  s_cbranch_scc1 mega_done
wf_80:
  buffer_load_dword v8, v5, s[4:7], 0 offen sc1
  s_waitcnt vmcnt(0)
  v_cmp_gt_u32 vcc, s20, v8
  s_cbranch_vccnz wf_79
  s_branch wf_82
wf_81:
  s_sleep 4
  s_add_u32 s11, s11, 1
  s_cmp_gt_u32 s11, 131072
  s_cbranch_scc1 mega_done
wf_82:
  buffer_load_dword v8, v5, s[4:7], 0 offen sc1
  s_waitcnt vmcnt(0)
  v_cmp_gt_u32 vcc, s17, v8
  s_cbranch_vccnz wf_81
l2_76:
  s_waitcnt vmcnt(0)
  v_lshlrev_b32 v80, 16, v64
  v_and_b32 v81, 0xffff0000, v64
  v_lshlrev_b32 v82, 16, v65
  v_and_b32 v83, 0xffff0000, v65
  v_lshlrev_b32 v84, 16, v66
  v_and_b32 v85, 0xffff0000, v66
  v_lshlrev_b32 v86, 16, v67
  v_and_b32 v87, 0xffff0000, v67
  v_lshlrev_b32 v88, 16, v68
  v_and_b32 v89, 0xffff0000, v68
  v_lshlrev_b32 v90, 16, v69
  v_and_b32 v91, 0xffff0000, v69
  v_lshlrev_b32 v92, 16, v70
  v_and_b32 v93, 0xffff0000, v70
  v_lshlrev_b32 v94, 16, v71
  v_and_b32 v95, 0xffff0000, v71
  v_lshlrev_b32 v96, 16, v72
  v_and_b32 v97, 0xffff0000, v72
  v_lshlrev_b32 v98, 16, v73
  v_and_b32 v99, 0xffff0000, v73
  v_lshlrev_b32 v100, 16, v74
  v_and_b32 v101, 0xffff0000, v74
  v_lshlrev_b32 v102, 16, v75
  v_and_b32 v103, 0xffff0000, v75
  s_add_u32 s20, s14, 32768
  s_add_u32 s21, s14, 65536
  s_barrier
  s_cmp_ge_u32 s3, 2
  s_cbranch_scc1 l2_77
  buffer_load_dwordx4 v[48:51], v2, s[4:7], s21 offen offset:0
  buffer_load_dwordx4 v[52:55], v2, s[4:7], s21 offen offset:1024
  buffer_load_dwordx4 v[56:59], v2, s[4:7], s21 offen offset:2048
  buffer_load_dwordx4 v[60:63], v2, s[4:7], s21 offen offset:3072
l2_77:
  buffer_load_dwordx4 v[16:19], v2, s[4:7], s14 offen offset:0
  buffer_load_dwordx4 v[20:23], v2, s[4:7], s14 offen offset:1024
  buffer_load_dwordx4 v[24:27], v2, s[4:7], s14 offen offset:2048
  buffer_load_dwordx4 v[28:31], v2, s[4:7], s14 offen offset:3072
  buffer_load_dwordx4 v[32:35], v2, s[4:7], s20 offen offset:0
  buffer_load_dwordx4 v[36:39], v2, s[4:7], s20 offen offset:1024
  buffer_load_dwordx4 v[40:43], v2, s[4:7], s20 offen offset:2048
  buffer_load_dwordx4 v[44:47], v2, s[4:7], s20 offen offset:3072
  v_mov_b32 v8, 0
  v_mov_b32 v9, 0
  s_waitcnt vmcnt(8)
  v_dot2_f32_bf16 v96, v48, s18, v96
  v_dot2_f32_bf16 v97, v48, s19, v97
  v_dot2_f32_bf16 v98, v49, s18, v98
  v_dot2_f32_bf16 v99, v49, s19, v99
  v_dot2_f32_bf16 v100, v50, s18, v100
  v_dot2_f32_bf16 v101, v50, s19, v101
  v_dot2_f32_bf16 v102, v51, s18, v102
  v_dot2_f32_bf16 v103, v51, s19, v103
  v_dot2_f32_bf16 v96, v52, s18, v96
  v_dot2_f32_bf16 v97, v52, s19, v97
  v_dot2_f32_bf16 v98, v53, s18, v98
  v_dot2_f32_bf16 v99, v53, s19, v99
  v_dot2_f32_bf16 v100, v54, s18, v100
  v_dot2_f32_bf16 v101, v54, s19, v101
  v_dot2_f32_bf16 v102, v55, s18, v102
  v_dot2_f32_bf16 v103, v55, s19, v103
  v_dot2_f32_bf16 v96, v56, s18, v96
  v_dot2_f32_bf16 v97, v56, s19, v97
  v_dot2_f32_bf16 v98, v57, s18, v98
  v_dot2_f32_bf16 v99, v57, s19, v99
  v_dot2_f32_bf16 v100, v58, s18, v100
  v_dot2_f32_bf16 v101, v58, s19, v101
  v_dot2_f32_bf16 v102, v59, s18, v102
  v_dot2_f32_bf16 v103, v59, s19, v103
  v_dot2_f32_bf16 v96, v60, s18, v96
  v_dot2_f32_bf16 v97, v60, s19, v97
  v_dot2_f32_bf16 v98, v61, s18, v98
  v_dot2_f32_bf16 v99, v61, s19, v99
  v_dot2_f32_bf16 v100, v62, s18, v100
  v_dot2_f32_bf16 v101, v62, s19, v101
  v_dot2_f32_bf16 v102, v63, s18, v102
  v_dot2_f32_bf16 v103, v63, s19, v103
  v_cvt_pk_bf16_f32 v112, v96, v97
  v_cvt_pk_bf16_f32 v113, v98, v99
  v_cvt_pk_bf16_f32 v114, v100, v101
  v_cvt_pk_bf16_f32 v115, v102, v103
  v_lshlrev_b32 v96, 16, v112
  v_and_b32 v97, 0xffff0000, v112
  v_lshlrev_b32 v98, 16, v113
  v_and_b32 v99, 0xffff0000, v113
  v_lshlrev_b32 v100, 16, v114
  v_and_b32 v101, 0xffff0000, v114
  v_lshlrev_b32 v102, 16, v115
  v_and_b32 v103, 0xffff0000, v115
  v_add_f32 v8, v8, v96
  v_fmac_f32 v9, v96, v96
  v_add_f32 v8, v8, v97
  v_fmac_f32 v9, v97, v97
  v_add_f32 v8, v8, v98
  v_fmac_f32 v9, v98, v98
  v_add_f32 v8, v8, v99
  v_fmac_f32 v9, v99, v99
  v_add_f32 v8, v8, v100
  v_fmac_f32 v9, v100, v100
  v_add_f32 v8, v8, v101
  v_fmac_f32 v9, v101, v101
  v_add_f32 v8, v8, v102
  v_fmac_f32 v9, v102, v102
  v_add_f32 v8, v8, v103
  v_fmac_f32 v9, v103, v103
  s_waitcnt vmcnt(4)
  v_dot2_f32_bf16 v80, v16, s18, v80
  v_dot2_f32_bf16 v81, v16, s19, v81
  v_dot2_f32_bf16 v82, v17, s18, v82
  v_dot2_f32_bf16 v83, v17, s19, v83
  v_dot2_f32_bf16 v84, v18, s18, v84
  v_dot2_f32_bf16 v85, v18, s19, v85
  v_dot2_f32_bf16 v86, v19, s18, v86
  v_dot2_f32_bf16 v87, v19, s19, v87
  v_dot2_f32_bf16 v80, v20, s18, v80
  v_dot2_f32_bf16 v81, v20, s19, v81
  v_dot2_f32_bf16 v82, v21, s18, v82
  v_dot2_f32_bf16 v83, v21, s19, v83
  v_dot2_f32_bf16 v84, v22, s18, v84
  v_dot2_f32_bf16 v85, v22, s19, v85
  v_dot2_f32_bf16 v86, v23, s18, v86
  v_dot2_f32_bf16 v87, v23, s19, v87
  v_dot2_f32_bf16 v80, v24, s18, v80
  v_dot2_f32_bf16 v81, v24, s19, v81
  v_dot2_f32_bf16 v82, v25, s18, v82
  v_dot2_f32_bf16 v83, v25, s19, v83
  v_dot2_f32_bf16 v84, v26, s18, v84
  v_dot2_f32_bf16 v85, v26, s19, v85
  v_dot2_f32_bf16 v86, v27, s18, v86
  v_dot2_f32_bf16 v87, v27, s19, v87
  v_dot2_f32_bf16 v80, v28, s18, v80
  v_dot2_f32_bf16 v81, v28, s19, v81
  v_dot2_f32_bf16 v82, v29, s18, v82
  v_dot2_f32_bf16 v83, v29, s19, v83
  v_dot2_f32_bf16 v84, v30, s18, v84
  v_dot2_f32_bf16 v85, v30, s19, v85
  v_dot2_f32_bf16 v86, v31, s18, v86
  v_dot2_f32_bf16 v87, v31, s19, v87
  v_cvt_pk_bf16_f32 v104, v80, v81
  v_cvt_pk_bf16_f32 v105, v82, v83
  v_cvt_pk_bf16_f32 v106, v84, v85
  v_cvt_pk_bf16_f32 v107, v86, v87
  v_lshlrev_b32 v80, 16, v104
  v_and_b32 v81, 0xffff0000, v104
  v_lshlrev_b32 v82, 16, v105
  v_and_b32 v83, 0xffff0000, v105
  v_lshlrev_b32 v84, 16, v106
  v_and_b32 v85, 0xffff0000, v106
  v_lshlrev_b32 v86, 16, v107
  v_and_b32 v87, 0xffff0000, v107
  v_add_f32 v8, v8, v80
  v_fmac_f32 v9, v80, v80
  v_add_f32 v8, v8, v81
  v_fmac_f32 v9, v81, v81
  v_add_f32 v8, v8, v82
  v_fmac_f32 v9, v82, v82
  v_add_f32 v8, v8, v83
  v_fmac_f32 v9, v83, v83
  v_add_f32 v8, v8, v84
  v_fmac_f32 v9, v84, v84
  v_add_f32 v8, v8, v85
  v_fmac_f32 v9, v85, v85
  v_add_f32 v8, v8, v86
  v_fmac_f32 v9, v86, v86
  v_add_f32 v8, v8, v87
  v_fmac_f32 v9, v87, v87
  s_waitcnt vmcnt(0)
  v_dot2_f32_bf16 v88, v32, s18, v88
  v_dot2_f32_bf16 v89, v32, s19, v89
  v_dot2_f32_bf16 v90, v33, s18, v90
  v_dot2_f32_bf16 v91, v33, s19, v91
  v_dot2_f32_bf16 v92, v34, s18, v92
  v_dot2_f32_bf16 v93, v34, s19, v93
  v_dot2_f32_bf16 v94, v35, s18, v94
  v_dot2_f32_bf16 v95, v35, s19, v95
  v_dot2_f32_bf16 v88, v36, s18, v88
  v_dot2_f32_bf16 v89, v36, s19, v89
  v_dot2_f32_bf16 v90, v37, s18, v90
  v_dot2_f32_bf16 v91, v37, s19, v91
  v_dot2_f32_bf16 v92, v38, s18, v92
  v_dot2_f32_bf16 v93, v38, s19, v93
  v_dot2_f32_bf16 v94, v39, s18, v94
  v_dot2_f32_bf16 v95, v39, s19, v95
  v_dot2_f32_bf16 v88, v40, s18, v88
  v_dot2_f32_bf16 v89, v40, s19, v89
  v_dot2_f32_bf16 v90, v41, s18, v90
  v_dot2_f32_bf16 v91, v41, s19, v91
  v_dot2_f32_bf16 v92, v42, s18, v92
  v_dot2_f32_bf16 v93, v42, s19, v93
  v_dot2_f32_bf16 v94, v43, s18, v94
  v_dot2_f32_bf16 v95, v43, s19, v95
  v_dot2_f32_bf16 v88, v44, s18, v88
  v_dot2_f32_bf16 v89, v44, s19, v89
  v_dot2_f32_bf16 v90, v45, s18, v90
  v_dot2_f32_bf16 v91, v45, s19, v91
  v_dot2_f32_bf16 v92, v46, s18, v92
  v_dot2_f32_bf16 v93, v46, s19, v93
  v_dot2_f32_bf16 v94, v47, s18, v94
  v_dot2_f32_bf16 v95, v47, s19, v95
  v_cvt_pk_bf16_f32 v108, v88, v89
  v_cvt_pk_bf16_f32 v109, v90, v91
  v_cvt_pk_bf16_f32 v110, v92, v93
  v_cvt_pk_bf16_f32 v111, v94, v95
  v_lshlrev_b32 v88, 16, v108
  v_and_b32 v89, 0xffff0000, v108
  v_lshlrev_b32 v90, 16, v109
  v_and_b32 v91, 0xffff0000, v109
  v_lshlrev_b32 v92, 16, v110
  v_and_b32 v93, 0xffff0000, v110
  v_lshlrev_b32 v94, 16, v111
  v_and_b32 v95, 0xffff0000, v111
  v_add_f32 v8, v8, v88
  v_fmac_f32 v9, v88, v88
  v_add_f32 v8, v8, v89
  v_fmac_f32 v9, v89, v89
  v_add_f32 v8, v8, v90
  v_fmac_f32 v9, v90, v90
  v_add_f32 v8, v8, v91
  v_fmac_f32 v9, v91, v91
  v_add_f32 v8, v8, v92
  v_fmac_f32 v9, v92, v92
  v_add_f32 v8, v8, v93
  v_fmac_f32 v9, v93, v93
  v_add_f32 v8, v8, v94
  v_fmac_f32 v9, v94, v94
  v_add_f32 v8, v8, v95
  v_fmac_f32 v9, v95, v95
  s_nop 0
  v_add_f32_dpp v8, v8, v8 row_ror:8 row_mask:0xf bank_mask:0xf
  v_add_f32_dpp v9, v9, v9 row_ror:8 row_mask:0xf bank_mask:0xf
  v_mov_b32 v10, v8
  v_mov_b32 v11, v9
  s_nop 0
  v_permlane16_swap_b32 v8, v10
  v_permlane16_swap_b32 v9, v11
  v_pk_add_f32 v[8:9], v[8:9], v[10:11]
  v_mov_b32 v10, v8
  v_mov_b32 v11, v9
  s_nop 0
  v_permlane32_swap_b32 v8, v10
  v_permlane32_swap_b32 v9, v11
  v_pk_add_f32 v[8:9], v[8:9], v[10:11]
  ds_write_b64 v6, v[8:9]
  s_waitcnt lgkmcnt(0)
  s_barrier
  ds_read_b128 v[120:123], v7
  ds_read_b128 v[124:127], v7 offset:16
  s_waitcnt lgkmcnt(0)
  v_pk_add_f32 v[120:121], v[120:121], v[122:123]
  v_pk_add_f32 v[124:125], v[124:125], v[126:127]
  v_pk_add_f32 v[120:121], v[120:121], v[124:125]
  v_mul_f32 v8, 0x3acccccd, v120
  v_mul_f32 v9, 0x3acccccd, v121
  v_fma_f32 v9, -v8, v8, v9
  v_max_f32 v9, 0, v9
  v_add_f32 v9, 0x3727c5ac, v9
  v_rsq_f32 v9, v9
  s_nop 0
  v_mul_f32 v8, v8, v9
  s_add_u32 s20, s16, 8192
  s_add_u32 s21, s16, 16384
  v_fma_f32 v80, v80, v9, -v8
  v_fma_f32 v81, v81, v9, -v8
  v_fma_f32 v82, v82, v9, -v8
  v_fma_f32 v83, v83, v9, -v8
  v_fma_f32 v84, v84, v9, -v8
  v_fma_f32 v85, v85, v9, -v8
  v_fma_f32 v86, v86, v9, -v8
  v_fma_f32 v87, v87, v9, -v8
  v_cvt_pk_bf16_f32 v16, v80, v81
  v_cvt_pk_bf16_f32 v17, v82, v83
  v_cvt_pk_bf16_f32 v18, v84, v85
  v_cvt_pk_bf16_f32 v19, v86, v87
  buffer_store_dwordx4 v[16:19], v4, s[4:7], s16 offen offset:0 sc1
  v_fma_f32 v88, v88, v9, -v8
  v_fma_f32 v89, v89, v9, -v8
  v_fma_f32 v90, v90, v9, -v8
  v_fma_f32 v91, v91, v9, -v8
  v_fma_f32 v92, v92, v9, -v8
  v_fma_f32 v93, v93, v9, -v8
  v_fma_f32 v94, v94, v9, -v8
  v_fma_f32 v95, v95, v9, -v8
  v_cvt_pk_bf16_f32 v20, v88, v89
  v_cvt_pk_bf16_f32 v21, v90, v91
  v_cvt_pk_bf16_f32 v22, v92, v93
  v_cvt_pk_bf16_f32 v23, v94, v95
  buffer_store_dwordx4 v[20:23], v4, s[4:7], s20 offen offset:0 sc1
  s_cmp_ge_u32 s3, 2
  s_cbranch_scc1 l2_83
  v_fma_f32 v96, v96, v9, -v8
  v_fma_f32 v97, v97, v9, -v8
  v_fma_f32 v98, v98, v9, -v8
  v_fma_f32 v99, v99, v9, -v8
  v_fma_f32 v100, v100, v9, -v8
  v_fma_f32 v101, v101, v9, -v8
  v_fma_f32 v102, v102, v9, -v8
  v_fma_f32 v103, v103, v9, -v8
  v_cvt_pk_bf16_f32 v24, v96, v97
  v_cvt_pk_bf16_f32 v25, v98, v99
  v_cvt_pk_bf16_f32 v26, v100, v101
  v_cvt_pk_bf16_f32 v27, v102, v103
  buffer_store_dwordx4 v[24:27], v4, s[4:7], s21 offen offset:0 sc1
  s_add_u32 s21, s15, 16384
  buffer_store_dwordx4 v[112:115], v13, s[4:7], s21 offen offset:0 sc1
l2_83:
  s_add_u32 s20, s15, 8192
  buffer_store_dwordx4 v[104:107], v13, s[4:7], s15 offen offset:0 sc1
  buffer_store_dwordx4 v[108:111], v13, s[4:7], s20 offen offset:0 sc1
  s_waitcnt vmcnt(0)
  s_barrier
  s_cmp_lg_u32 s3, 0
  s_cbranch_scc1 l2_84
  v_mov_b32 v8, s17
  s_mov_b64 exec, 1
  buffer_store_dword v8, off, s[4:7], s30 sc1
  s_mov_b64 exec, -1
l2_84:
  s_add_u32 s24, s24, 24
  s_cmp_lt_u32 s24, 256
  s_cbranch_scc1 ln2_loop
  s_branch mega_out
mega_win:
  s_sub_u32 s34, s8, 4
  s_sub_u32 s35, s2, 26
  s_mul_i32 s22, s34, 6
  s_add_u32 s22, s22, s35
  s_lshl_b32 s30, s22, 7
  s_add_u32 s30, s30, 119808
  s_lshr_b32 s36, s34, 1
  s_and_b32 s34, s34, 1
  s_load_dwordx2 s[12:13], s[0:1], 32
  v_lshrrev_b32 v24, 2, v0
  v_mul_u32_u24 v24, 12288, v24
  v_and_b32 v25, 3, v0
  v_lshl_add_u32 v24, v25, 7, v24
  s_lshl_b32 s14, s22, 9
  s_mul_i32 s15, s3, 196608
  s_add_u32 s14, s14, s15
  s_add_u32 s14, s14, 786432
  s_waitcnt lgkmcnt(0)
  s_add_u32 s12, s12, s14
  s_addc_u32 s13, s13, 0
  global_load_dword v26, v24, s[12:13]
  s_add_u32 s12, s12, 1572864
  s_addc_u32 s13, s13, 0
  global_load_dword v26, v24, s[12:13]
  s_add_u32 s12, s12, 1572864
  s_addc_u32 s13, s13, 0
  global_load_dword v26, v24, s[12:13]
  s_add_u32 s12, s12, 1572864
  s_addc_u32 s13, s13, 0
  global_load_dword v26, v24, s[12:13]
  s_add_u32 s12, s12, 1572864
  s_addc_u32 s13, s13, 0
  global_load_dword v26, v24, s[12:13]
  s_load_dwordx2 s[32:33], s[0:1], 64
  s_lshr_b32 s40, s2, 3
  v_lshlrev_b32 v2, 4, v0
  v_lshrrev_b32 v16, 2, v2
  v_mov_b32 v17, 0
  s_mov_b32 exec_lo, 0x00030003
  s_mov_b32 exec_hi, 0x00030003
  v_mov_b32 v17, 32
  s_mov_b32 exec_lo, 0x00100010
  s_mov_b32 exec_hi, 0x00100010
  v_mov_b32 v17, 64
  s_mov_b64 exec, 4
  v_mov_b32 v17, 56
  s_mov_b32 exec_lo, 0
  s_mov_b32 exec_hi, 4
  v_mov_b32 v17, 268435456
  s_mov_b64 exec, -1
  s_branch isync_86
isync_85:
  s_sleep 4
  s_add_u32 s11, s11, 1
  s_cmp_gt_u32 s11, 131072
  s_cbranch_scc1 mega_done
isync_86:
  global_load_dword v18, v16, s[90:91] sc1
  s_waitcnt vmcnt(0)
  v_cmp_gt_u32 vcc, v17, v18
  s_cbranch_vccnz isync_85
  v_readlane_b32 s66, v18, 34
  s_nop 0
  s_cmp_lt_u32 s66, 268468224
  s_cselect_b32 s66, 0, 8192
  global_load_dword v18, v16, s[90:91] sc1
  s_waitcnt vmcnt(0)
  v_readlane_b32 s37, v18, 18
  s_xor_b32 s31, s66, 8192
  s_add_u32 s30, s30, s66
  s_xor_b32 s31, s31, 8192
  v_mov_b32 v4, 116736
  s_mov_b32 s12, 1
  s_branch wf_88
wf_87:
  s_sleep 8
  s_add_u32 s11, s11, 1
  s_cmp_gt_u32 s11, 131072
  s_cbranch_scc1 mega_done
wf_88:
  buffer_load_dword v5, v4, s[4:7], s66 offen sc1
  s_waitcnt vmcnt(0)
  v_cmp_gt_u32 vcc, s12, v5
  s_cbranch_vccnz wf_87
  s_load_dwordx2 s[12:13], s[0:1], 72
  s_mul_i32 s14, s8, 6
  s_add_u32 s14, s14, s2
  s_sub_u32 s14, s14, 26
  s_lshl_b32 s14, s14, 2
  s_add_u32 s14, s14, s3
  s_lshl_b32 s14, s14, 13
  v_lshlrev_b32 v4, 7, v0
  v_add_u32 v4, s14, v4
  s_waitcnt lgkmcnt(0)
  v_min_u32 v5, 8388480, v4
  global_load_dword v6, v5, s[12:13]
  v_add_u32 v4, 1572864, v4
  v_min_u32 v5, 8388480, v4
  global_load_dword v6, v5, s[12:13]
  v_add_u32 v4, 1572864, v4
  v_min_u32 v5, 8388480, v4
  global_load_dword v6, v5, s[12:13]
  v_add_u32 v4, 1572864, v4
  v_min_u32 v5, 8388480, v4
  global_load_dword v6, v5, s[12:13]
  v_add_u32 v4, 1572864, v4
  v_min_u32 v5, 8388480, v4
  global_load_dword v6, v5, s[12:13]
  v_add_u32 v4, 1572864, v4
  v_min_u32 v5, 8388480, v4
  global_load_dword v6, v5, s[12:13]
  v_add_u32 v4, 1572864, v4
  s_waitcnt vmcnt(0)
  v_mov_b32 v4, 149504
  s_mov_b32 s12, 1
  s_branch wf_90
wf_89:
  s_sleep 20
  s_add_u32 s11, s11, 1
  s_cmp_gt_u32 s11, 131072
  s_cbranch_scc1 mega_done
wf_90:
  buffer_load_dword v5, v4, s[4:7], s66 offen sc1
  s_waitcnt vmcnt(0)
  v_cmp_gt_u32 vcc, s12, v5
  s_cbranch_vccnz wf_89
  s_load_dwordx2 s[12:13], s[0:1], 88
  s_mul_i32 s14, s3, 245760
  s_mul_i32 s15, s40, 320
  s_add_u32 s14, s14, s15
  v_lshrrev_b32 v7, 4, v0
  v_lshlrev_b32 v6, 3, v7
  v_bfe_u32 v7, v0, 2, 2
  v_add_u32 v6, v6, v7
  v_mul_u32_u24 v6, 320, v6
  v_and_b32 v7, 3, v0
  v_lshl_add_u32 v6, v7, 4, v6
  s_waitcnt lgkmcnt(0)
  s_add_u32 s12, s12, s14
  s_addc_u32 s13, s13, 0
  s_mul_i32 s14, s3, 40960
  v_add_u32 v6, s14, v6
  v_mul_u32_u24 v5, 3277, v0
  v_lshrrev_b32 v5, 16, v5
  s_mov_b32 s15, 960
  v_mul_lo_u32 v4, v5, s15
  v_lshl_add_u32 v4, v0, 4, v4
  s_mov_b32 exec_lo, 0xffffffff
  s_mov_b32 exec_hi, 0xfffffff
  s_add_u32 m0, s14, 0
  s_nop 0
  global_load_lds_dwordx4 v4, s[12:13]
  s_add_u32 s12, s12, 3840
  s_addc_u32 s13, s13, 0
  s_add_u32 m0, s14, 960
  s_nop 0
  global_load_lds_dwordx4 v4, s[12:13]
  s_add_u32 s12, s12, 3840
  s_addc_u32 s13, s13, 0
  s_add_u32 m0, s14, 1920
  s_nop 0
  global_load_lds_dwordx4 v4, s[12:13]
  s_add_u32 s12, s12, 3840
  s_addc_u32 s13, s13, 0
  s_add_u32 m0, s14, 2880
  s_nop 0
  global_load_lds_dwordx4 v4, s[12:13]
  s_add_u32 s12, s12, 3840
  s_addc_u32 s13, s13, 0
  s_add_u32 m0, s14, 3840
  s_nop 0
  global_load_lds_dwordx4 v4, s[12:13]
  s_add_u32 s12, s12, 3840
  s_addc_u32 s13, s13, 0
  s_add_u32 m0, s14, 4800
  s_nop 0
  global_load_lds_dwordx4 v4, s[12:13]
  s_add_u32 s12, s12, 3840
  s_addc_u32 s13, s13, 0
  s_add_u32 m0, s14, 5760
  s_nop 0
  global_load_lds_dwordx4 v4, s[12:13]
  s_add_u32 s12, s12, 3840
  s_addc_u32 s13, s13, 0
  s_add_u32 m0, s14, 6720
  s_nop 0
  global_load_lds_dwordx4 v4, s[12:13]
  s_add_u32 s12, s12, 3840
  s_addc_u32 s13, s13, 0
  s_add_u32 m0, s14, 7680
  s_nop 0
  global_load_lds_dwordx4 v4, s[12:13]
  s_add_u32 s12, s12, 3840
  s_addc_u32 s13, s13, 0
  s_add_u32 m0, s14, 8640
  s_nop 0
  global_load_lds_dwordx4 v4, s[12:13]
  s_add_u32 s12, s12, 3840
  s_addc_u32 s13, s13, 0
  s_mov_b32 exec_lo, 0xffffffff
  s_mov_b32 exec_hi, 0xff
  s_add_u32 m0, s14, 9600
  s_nop 0
  global_load_lds_dwordx4 v4, s[12:13]
  s_add_u32 s12, s12, 2560
  s_addc_u32 s13, s13, 0
  s_mov_b64 exec, -1
  s_mov_b32 exec_lo, 0xffffffff
  s_mov_b32 exec_hi, 0xfffffff
  s_add_u32 m0, s14, 10240
  s_nop 0
  global_load_lds_dwordx4 v4, s[12:13]
  s_add_u32 s12, s12, 3840
  s_addc_u32 s13, s13, 0
  s_add_u32 m0, s14, 11200
  s_nop 0
  global_load_lds_dwordx4 v4, s[12:13]
  s_add_u32 s12, s12, 3840
  s_addc_u32 s13, s13, 0
  s_add_u32 m0, s14, 12160
  s_nop 0
  global_load_lds_dwordx4 v4, s[12:13]
  s_add_u32 s12, s12, 3840
  s_addc_u32 s13, s13, 0
  s_add_u32 m0, s14, 13120
  s_nop 0
  global_load_lds_dwordx4 v4, s[12:13]
  s_add_u32 s12, s12, 3840
  s_addc_u32 s13, s13, 0
  s_add_u32 m0, s14, 14080
  s_nop 0
  global_load_lds_dwordx4 v4, s[12:13]
  s_add_u32 s12, s12, 3840
  s_addc_u32 s13, s13, 0
  s_add_u32 m0, s14, 15040
  s_nop 0
  global_load_lds_dwordx4 v4, s[12:13]
  s_add_u32 s12, s12, 3840
  s_addc_u32 s13, s13, 0
  s_add_u32 m0, s14, 16000
  s_nop 0
  global_load_lds_dwordx4 v4, s[12:13]
  s_add_u32 s12, s12, 3840
  s_addc_u32 s13, s13, 0
  s_add_u32 m0, s14, 16960
  s_nop 0
  global_load_lds_dwordx4 v4, s[12:13]
  s_add_u32 s12, s12, 3840
  s_addc_u32 s13, s13, 0
  s_add_u32 m0, s14, 17920
  s_nop 0
  global_load_lds_dwordx4 v4, s[12:13]
  s_add_u32 s12, s12, 3840
  s_addc_u32 s13, s13, 0
  s_add_u32 m0, s14, 18880
  s_nop 0
  global_load_lds_dwordx4 v4, s[12:13]
  s_add_u32 s12, s12, 3840
  s_addc_u32 s13, s13, 0
  s_mov_b32 exec_lo, 0xffffffff
  s_mov_b32 exec_hi, 0xff
  s_add_u32 m0, s14, 19840
  s_nop 0
  global_load_lds_dwordx4 v4, s[12:13]
  s_add_u32 s12, s12, 2560
  s_addc_u32 s13, s13, 0
  s_mov_b64 exec, -1
  s_mov_b32 exec_lo, 0xffffffff
  s_mov_b32 exec_hi, 0xfffffff
  s_add_u32 m0, s14, 20480
  s_nop 0
  global_load_lds_dwordx4 v4, s[12:13]
  s_add_u32 s12, s12, 3840
  s_addc_u32 s13, s13, 0
  s_add_u32 m0, s14, 21440
  s_nop 0
  global_load_lds_dwordx4 v4, s[12:13]
  s_add_u32 s12, s12, 3840
  s_addc_u32 s13, s13, 0
  s_add_u32 m0, s14, 22400
  s_nop 0
  global_load_lds_dwordx4 v4, s[12:13]
  s_add_u32 s12, s12, 3840
  s_addc_u32 s13, s13, 0
  s_add_u32 m0, s14, 23360
  s_nop 0
  global_load_lds_dwordx4 v4, s[12:13]
  s_add_u32 s12, s12, 3840
  s_addc_u32 s13, s13, 0
  s_add_u32 m0, s14, 24320
  s_nop 0
  global_load_lds_dwordx4 v4, s[12:13]
  s_add_u32 s12, s12, 3840
  s_addc_u32 s13, s13, 0
  s_add_u32 m0, s14, 25280
  s_nop 0
  global_load_lds_dwordx4 v4, s[12:13]
  s_add_u32 s12, s12, 3840
  s_addc_u32 s13, s13, 0
  s_add_u32 m0, s14, 26240
  s_nop 0
  global_load_lds_dwordx4 v4, s[12:13]
  s_add_u32 s12, s12, 3840
  s_addc_u32 s13, s13, 0
  s_add_u32 m0, s14, 27200
  s_nop 0
  global_load_lds_dwordx4 v4, s[12:13]
  s_add_u32 s12, s12, 3840
  s_addc_u32 s13, s13, 0
  s_add_u32 m0, s14, 28160
  s_nop 0
  global_load_lds_dwordx4 v4, s[12:13]
  s_add_u32 s12, s12, 3840
  s_addc_u32 s13, s13, 0
  s_add_u32 m0, s14, 29120
  s_nop 0
  global_load_lds_dwordx4 v4, s[12:13]
  s_add_u32 s12, s12, 3840
  s_addc_u32 s13, s13, 0
  s_mov_b32 exec_lo, 0xffffffff
  s_mov_b32 exec_hi, 0xff
  s_add_u32 m0, s14, 30080
  s_nop 0
  global_load_lds_dwordx4 v4, s[12:13]
  s_add_u32 s12, s12, 2560
  s_addc_u32 s13, s13, 0
  s_mov_b64 exec, -1
  s_mov_b32 exec_lo, 0xffffffff
  s_mov_b32 exec_hi, 0xfffffff
  s_add_u32 m0, s14, 30720
  s_nop 0
  global_load_lds_dwordx4 v4, s[12:13]
  s_add_u32 s12, s12, 3840
  s_addc_u32 s13, s13, 0
  s_add_u32 m0, s14, 31680
  s_nop 0
  global_load_lds_dwordx4 v4, s[12:13]
  s_add_u32 s12, s12, 3840
  s_addc_u32 s13, s13, 0
  s_add_u32 m0, s14, 32640
  s_nop 0
  global_load_lds_dwordx4 v4, s[12:13]
  s_add_u32 s12, s12, 3840
  s_addc_u32 s13, s13, 0
  s_add_u32 m0, s14, 33600
  s_nop 0
  global_load_lds_dwordx4 v4, s[12:13]
  s_add_u32 s12, s12, 3840
  s_addc_u32 s13, s13, 0
  s_add_u32 m0, s14, 34560
  s_nop 0
  global_load_lds_dwordx4 v4, s[12:13]
  s_add_u32 s12, s12, 3840
  s_addc_u32 s13, s13, 0
  s_add_u32 m0, s14, 35520
  s_nop 0
  global_load_lds_dwordx4 v4, s[12:13]
  s_add_u32 s12, s12, 3840
  s_addc_u32 s13, s13, 0
  s_add_u32 m0, s14, 36480
  s_nop 0
  global_load_lds_dwordx4 v4, s[12:13]
  s_add_u32 s12, s12, 3840
  s_addc_u32 s13, s13, 0
  s_add_u32 m0, s14, 37440
  s_nop 0
  global_load_lds_dwordx4 v4, s[12:13]
  s_add_u32 s12, s12, 3840
  s_addc_u32 s13, s13, 0
  s_add_u32 m0, s14, 38400
  s_nop 0
  global_load_lds_dwordx4 v4, s[12:13]
  s_add_u32 s12, s12, 3840
  s_addc_u32 s13, s13, 0
  s_add_u32 m0, s14, 39360
  s_nop 0
  global_load_lds_dwordx4 v4, s[12:13]
  s_add_u32 s12, s12, 3840
  s_addc_u32 s13, s13, 0
  s_mov_b32 exec_lo, 0xffffffff
  s_mov_b32 exec_hi, 0xff
  s_add_u32 m0, s14, 40320
  s_nop 0
  global_load_lds_dwordx4 v4, s[12:13]
  s_add_u32 s12, s12, 2560
  s_addc_u32 s13, s13, 0
  s_mov_b64 exec, -1
  s_waitcnt vmcnt(33)
  ds_read_b64_tr_b16 a[0:1], v6 offset:0
  ds_read_b64_tr_b16 a[2:3], v6 offset:1280
  ds_read_b64_tr_b16 a[24:25], v6 offset:8
  ds_read_b64_tr_b16 a[26:27], v6 offset:1288
  ds_read_b64_tr_b16 a[48:49], v6 offset:64
  ds_read_b64_tr_b16 a[50:51], v6 offset:1344
  ds_read_b64_tr_b16 a[72:73], v6 offset:72
  ds_read_b64_tr_b16 a[74:75], v6 offset:1352
  ds_read_b64_tr_b16 a[96:97], v6 offset:128
  ds_read_b64_tr_b16 a[98:99], v6 offset:1408
  ds_read_b64_tr_b16 a[120:121], v6 offset:136
  ds_read_b64_tr_b16 a[122:123], v6 offset:1416
  ds_read_b64_tr_b16 a[144:145], v6 offset:192
  ds_read_b64_tr_b16 a[146:147], v6 offset:1472
  ds_read_b64_tr_b16 a[168:169], v6 offset:200
  ds_read_b64_tr_b16 a[170:171], v6 offset:1480
  ds_read_b64_tr_b16 a[192:193], v6 offset:256
  ds_read_b64_tr_b16 a[194:195], v6 offset:1536
  ds_read_b64_tr_b16 a[216:217], v6 offset:264
  ds_read_b64_tr_b16 a[218:219], v6 offset:1544
  s_waitcnt lgkmcnt(0)
  s_mov_b32 exec_lo, 0xffffffff
  s_mov_b32 exec_hi, 0xfffffff
  s_add_u32 m0, s14, 0
  s_nop 0
  global_load_lds_dwordx4 v4, s[12:13]
  s_add_u32 s12, s12, 3840
  s_addc_u32 s13, s13, 0
  s_add_u32 m0, s14, 960
  s_nop 0
  global_load_lds_dwordx4 v4, s[12:13]
  s_add_u32 s12, s12, 3840
  s_addc_u32 s13, s13, 0
  s_add_u32 m0, s14, 1920
  s_nop 0
  global_load_lds_dwordx4 v4, s[12:13]
  s_add_u32 s12, s12, 3840
  s_addc_u32 s13, s13, 0
  s_add_u32 m0, s14, 2880
  s_nop 0
  global_load_lds_dwordx4 v4, s[12:13]
  s_add_u32 s12, s12, 3840
  s_addc_u32 s13, s13, 0
  s_add_u32 m0, s14, 3840
  s_nop 0
  global_load_lds_dwordx4 v4, s[12:13]
  s_add_u32 s12, s12, 3840
  s_addc_u32 s13, s13, 0
  s_add_u32 m0, s14, 4800
  s_nop 0
  global_load_lds_dwordx4 v4, s[12:13]
  s_add_u32 s12, s12, 3840
  s_addc_u32 s13, s13, 0
  s_add_u32 m0, s14, 5760
  s_nop 0
  global_load_lds_dwordx4 v4, s[12:13]
  s_add_u32 s12, s12, 3840
  s_addc_u32 s13, s13, 0
  s_add_u32 m0, s14, 6720
  s_nop 0
  global_load_lds_dwordx4 v4, s[12:13]
  s_add_u32 s12, s12, 3840
  s_addc_u32 s13, s13, 0
  s_add_u32 m0, s14, 7680
  s_nop 0
  global_load_lds_dwordx4 v4, s[12:13]
  s_add_u32 s12, s12, 3840
  s_addc_u32 s13, s13, 0
  s_add_u32 m0, s14, 8640
  s_nop 0
  global_load_lds_dwordx4 v4, s[12:13]
  s_add_u32 s12, s12, 3840
  s_addc_u32 s13, s13, 0
  s_mov_b32 exec_lo, 0xffffffff
  s_mov_b32 exec_hi, 0xff
  s_add_u32 m0, s14, 9600
  s_nop 0
  global_load_lds_dwordx4 v4, s[12:13]
  s_add_u32 s12, s12, 2560
  s_addc_u32 s13, s13, 0
  s_mov_b64 exec, -1
  s_waitcnt vmcnt(33)
  ds_read_b64_tr_b16 a[4:5], v6 offset:10240
  ds_read_b64_tr_b16 a[6:7], v6 offset:11520
  ds_read_b64_tr_b16 a[28:29], v6 offset:10248
  ds_read_b64_tr_b16 a[30:31], v6 offset:11528
  ds_read_b64_tr_b16 a[52:53], v6 offset:10304
  ds_read_b64_tr_b16 a[54:55], v6 offset:11584
  ds_read_b64_tr_b16 a[76:77], v6 offset:10312
  ds_read_b64_tr_b16 a[78:79], v6 offset:11592
  ds_read_b64_tr_b16 a[100:101], v6 offset:10368
  ds_read_b64_tr_b16 a[102:103], v6 offset:11648
  ds_read_b64_tr_b16 a[124:125], v6 offset:10376
  ds_read_b64_tr_b16 a[126:127], v6 offset:11656
  ds_read_b64_tr_b16 a[148:149], v6 offset:10432
  ds_read_b64_tr_b16 a[150:151], v6 offset:11712
  ds_read_b64_tr_b16 a[172:173], v6 offset:10440
  ds_read_b64_tr_b16 a[174:175], v6 offset:11720
  ds_read_b64_tr_b16 a[196:197], v6 offset:10496
  ds_read_b64_tr_b16 a[198:199], v6 offset:11776
  ds_read_b64_tr_b16 a[220:221], v6 offset:10504
  ds_read_b64_tr_b16 a[222:223], v6 offset:11784
  s_waitcnt lgkmcnt(0)
  s_mov_b32 exec_lo, 0xffffffff
  s_mov_b32 exec_hi, 0xfffffff
  s_add_u32 m0, s14, 10240
  s_nop 0
  global_load_lds_dwordx4 v4, s[12:13]
  s_add_u32 s12, s12, 3840
  s_addc_u32 s13, s13, 0
  s_add_u32 m0, s14, 11200
  s_nop 0
  global_load_lds_dwordx4 v4, s[12:13]
  s_add_u32 s12, s12, 3840
  s_addc_u32 s13, s13, 0
  s_add_u32 m0, s14, 12160
  s_nop 0
  global_load_lds_dwordx4 v4, s[12:13]
  s_add_u32 s12, s12, 3840
  s_addc_u32 s13, s13, 0
  s_add_u32 m0, s14, 13120
  s_nop 0
  global_load_lds_dwordx4 v4, s[12:13]
  s_add_u32 s12, s12, 3840
  s_addc_u32 s13, s13, 0
  s_add_u32 m0, s14, 14080
  s_nop 0
  global_load_lds_dwordx4 v4, s[12:13]
  s_add_u32 s12, s12, 3840
  s_addc_u32 s13, s13, 0
  s_add_u32 m0, s14, 15040
  s_nop 0
  global_load_lds_dwordx4 v4, s[12:13]
  s_add_u32 s12, s12, 3840
  s_addc_u32 s13, s13, 0
  s_add_u32 m0, s14, 16000
  s_nop 0
  global_load_lds_dwordx4 v4, s[12:13]
  s_add_u32 s12, s12, 3840
  s_addc_u32 s13, s13, 0
  s_add_u32 m0, s14, 16960
  s_nop 0
  global_load_lds_dwordx4 v4, s[12:13]
  s_add_u32 s12, s12, 3840
  s_addc_u32 s13, s13, 0
  s_add_u32 m0, s14, 17920
  s_nop 0
  global_load_lds_dwordx4 v4, s[12:13]
  s_add_u32 s12, s12, 3840
  s_addc_u32 s13, s13, 0
  s_add_u32 m0, s14, 18880
  s_nop 0
  global_load_lds_dwordx4 v4, s[12:13]
  s_add_u32 s12, s12, 3840
  s_addc_u32 s13, s13, 0
  s_mov_b32 exec_lo, 0xffffffff
  s_mov_b32 exec_hi, 0xff
  s_add_u32 m0, s14, 19840
  s_nop 0
  global_load_lds_dwordx4 v4, s[12:13]
  s_add_u32 s12, s12, 2560
  s_addc_u32 s13, s13, 0
  s_mov_b64 exec, -1
  s_waitcnt vmcnt(33)
  ds_read_b64_tr_b16 a[8:9], v6 offset:20480
  ds_read_b64_tr_b16 a[10:11], v6 offset:21760
  ds_read_b64_tr_b16 a[32:33], v6 offset:20488
  ds_read_b64_tr_b16 a[34:35], v6 offset:21768
  ds_read_b64_tr_b16 a[56:57], v6 offset:20544
  ds_read_b64_tr_b16 a[58:59], v6 offset:21824
  ds_read_b64_tr_b16 a[80:81], v6 offset:20552
  ds_read_b64_tr_b16 a[82:83], v6 offset:21832
  ds_read_b64_tr_b16 a[104:105], v6 offset:20608
  ds_read_b64_tr_b16 a[106:107], v6 offset:21888
  ds_read_b64_tr_b16 a[128:129], v6 offset:20616
  ds_read_b64_tr_b16 a[130:131], v6 offset:21896
  ds_read_b64_tr_b16 a[152:153], v6 offset:20672
  ds_read_b64_tr_b16 a[154:155], v6 offset:21952
  ds_read_b64_tr_b16 a[176:177], v6 offset:20680
  ds_read_b64_tr_b16 a[178:179], v6 offset:21960
  ds_read_b64_tr_b16 a[200:201], v6 offset:20736
  ds_read_b64_tr_b16 a[202:203], v6 offset:22016
  ds_read_b64_tr_b16 a[224:225], v6 offset:20744
  ds_read_b64_tr_b16 a[226:227], v6 offset:22024
  s_waitcnt lgkmcnt(0)
  s_waitcnt vmcnt(22)
  ds_read_b64_tr_b16 a[12:13], v6 offset:30720
  ds_read_b64_tr_b16 a[14:15], v6 offset:32000
  ds_read_b64_tr_b16 a[36:37], v6 offset:30728
  ds_read_b64_tr_b16 a[38:39], v6 offset:32008
  ds_read_b64_tr_b16 a[60:61], v6 offset:30784
  ds_read_b64_tr_b16 a[62:63], v6 offset:32064
  ds_read_b64_tr_b16 a[84:85], v6 offset:30792
  ds_read_b64_tr_b16 a[86:87], v6 offset:32072
  ds_read_b64_tr_b16 a[108:109], v6 offset:30848
  ds_read_b64_tr_b16 a[110:111], v6 offset:32128
  ds_read_b64_tr_b16 a[132:133], v6 offset:30856
  ds_read_b64_tr_b16 a[134:135], v6 offset:32136
  ds_read_b64_tr_b16 a[156:157], v6 offset:30912
  ds_read_b64_tr_b16 a[158:159], v6 offset:32192
  ds_read_b64_tr_b16 a[180:181], v6 offset:30920
  ds_read_b64_tr_b16 a[182:183], v6 offset:32200
  ds_read_b64_tr_b16 a[204:205], v6 offset:30976
  ds_read_b64_tr_b16 a[206:207], v6 offset:32256
  ds_read_b64_tr_b16 a[228:229], v6 offset:30984
  ds_read_b64_tr_b16 a[230:231], v6 offset:32264
  s_waitcnt lgkmcnt(0)
  s_waitcnt vmcnt(11)
  ds_read_b64_tr_b16 a[16:17], v6 offset:0
  ds_read_b64_tr_b16 a[18:19], v6 offset:1280
  ds_read_b64_tr_b16 a[40:41], v6 offset:8
  ds_read_b64_tr_b16 a[42:43], v6 offset:1288
  ds_read_b64_tr_b16 a[64:65], v6 offset:64
  ds_read_b64_tr_b16 a[66:67], v6 offset:1344
  ds_read_b64_tr_b16 a[88:89], v6 offset:72
  ds_read_b64_tr_b16 a[90:91], v6 offset:1352
  ds_read_b64_tr_b16 a[112:113], v6 offset:128
  ds_read_b64_tr_b16 a[114:115], v6 offset:1408
  ds_read_b64_tr_b16 a[136:137], v6 offset:136
  ds_read_b64_tr_b16 a[138:139], v6 offset:1416
  ds_read_b64_tr_b16 a[160:161], v6 offset:192
  ds_read_b64_tr_b16 a[162:163], v6 offset:1472
  ds_read_b64_tr_b16 a[184:185], v6 offset:200
  ds_read_b64_tr_b16 a[186:187], v6 offset:1480
  ds_read_b64_tr_b16 a[208:209], v6 offset:256
  ds_read_b64_tr_b16 a[210:211], v6 offset:1536
  ds_read_b64_tr_b16 a[232:233], v6 offset:264
  ds_read_b64_tr_b16 a[234:235], v6 offset:1544
  s_waitcnt lgkmcnt(0)
  s_waitcnt vmcnt(0)
  ds_read_b64_tr_b16 a[20:21], v6 offset:10240
  ds_read_b64_tr_b16 a[22:23], v6 offset:11520
  ds_read_b64_tr_b16 a[44:45], v6 offset:10248
  ds_read_b64_tr_b16 a[46:47], v6 offset:11528
  ds_read_b64_tr_b16 a[68:69], v6 offset:10304
  ds_read_b64_tr_b16 a[70:71], v6 offset:11584
  ds_read_b64_tr_b16 a[92:93], v6 offset:10312
  ds_read_b64_tr_b16 a[94:95], v6 offset:11592
  ds_read_b64_tr_b16 a[116:117], v6 offset:10368
  ds_read_b64_tr_b16 a[118:119], v6 offset:11648
  ds_read_b64_tr_b16 a[140:141], v6 offset:10376
  ds_read_b64_tr_b16 a[142:143], v6 offset:11656
  ds_read_b64_tr_b16 a[164:165], v6 offset:10432
  ds_read_b64_tr_b16 a[166:167], v6 offset:11712
  ds_read_b64_tr_b16 a[188:189], v6 offset:10440
  ds_read_b64_tr_b16 a[190:191], v6 offset:11720
  ds_read_b64_tr_b16 a[212:213], v6 offset:10496
  ds_read_b64_tr_b16 a[214:215], v6 offset:11776
  ds_read_b64_tr_b16 a[236:237], v6 offset:10504
  ds_read_b64_tr_b16 a[238:239], v6 offset:11784
  s_waitcnt lgkmcnt(0)
  s_mul_i32 s25, s34, 6
  s_add_u32 s25, s25, s35
  s_lshl_b32 s25, s25, 2
  s_add_u32 s25, s25, s3
  s_lshl_b32 s25, s25, 6
  s_add_u32 s32, s32, s25
  s_addc_u32 s33, s33, 0
  v_lshrrev_b32 v7, 4, v0
  v_lshlrev_b32 v6, 2, v7
  v_bfe_u32 v7, v0, 2, 2
  v_add_u32 v6, v6, v7
  v_lshlrev_b32 v6, 6, v6
  v_and_b32 v7, 3, v0
  v_lshl_add_u32 v6, v7, 4, v6
  s_mul_i32 s12, s3, 40960
  v_add_u32 v6, s12, v6
  v_mul_u32_u24 v5, 16384, v0
  v_lshrrev_b32 v5, 16, v5
  s_mov_b32 s13, 3008
  v_mul_lo_u32 v4, v5, s13
  v_lshl_add_u32 v4, v0, 4, v4
  s_mov_b32 exec_lo, 0xffffffff
  s_mov_b32 exec_hi, 0xffffffff
  s_add_u32 m0, s12, 0
  s_nop 0
  global_load_lds_dwordx4 v4, s[32:33]
  s_add_u32 s32, s32, 49152
  s_addc_u32 s33, s33, 0
  s_add_u32 m0, s12, 1024
  s_nop 0
  global_load_lds_dwordx4 v4, s[32:33]
  s_add_u32 s32, s32, 49152
  s_addc_u32 s33, s33, 0
  s_add_u32 m0, s12, 2048
  s_nop 0
  global_load_lds_dwordx4 v4, s[32:33]
  s_add_u32 s32, s32, 49152
  s_addc_u32 s33, s33, 0
  s_add_u32 m0, s12, 3072
  s_nop 0
  global_load_lds_dwordx4 v4, s[32:33]
  s_add_u32 s32, s32, 49152
  s_addc_u32 s33, s33, 0
  s_add_u32 m0, s12, 4096
  s_nop 0
  global_load_lds_dwordx4 v4, s[32:33]
  s_add_u32 s32, s32, 49152
  s_addc_u32 s33, s33, 0
  s_add_u32 m0, s12, 5120
  s_nop 0
  global_load_lds_dwordx4 v4, s[32:33]
  s_add_u32 s32, s32, 49152
  s_addc_u32 s33, s33, 0
  s_add_u32 m0, s12, 6144
  s_nop 0
  global_load_lds_dwordx4 v4, s[32:33]
  s_add_u32 s32, s32, 49152
  s_addc_u32 s33, s33, 0
  s_add_u32 m0, s12, 7168
  s_nop 0
  global_load_lds_dwordx4 v4, s[32:33]
  s_add_u32 s32, s32, 49152
  s_addc_u32 s33, s33, 0
  s_add_u32 m0, s12, 8192
  s_nop 0
  global_load_lds_dwordx4 v4, s[32:33]
  s_add_u32 s32, s32, 49152
  s_addc_u32 s33, s33, 0
  s_add_u32 m0, s12, 9216
  s_nop 0
  global_load_lds_dwordx4 v4, s[32:33]
  s_add_u32 s32, s32, 49152
  s_addc_u32 s33, s33, 0
  s_mov_b64 exec, -1
  s_mov_b32 exec_lo, 0xffffffff
  s_mov_b32 exec_hi, 0xffffffff
  s_add_u32 m0, s12, 10240
  s_nop 0
  global_load_lds_dwordx4 v4, s[32:33]
  s_add_u32 s32, s32, 49152
  s_addc_u32 s33, s33, 0
  s_add_u32 m0, s12, 11264
  s_nop 0
  global_load_lds_dwordx4 v4, s[32:33]
  s_add_u32 s32, s32, 49152
  s_addc_u32 s33, s33, 0
  s_add_u32 m0, s12, 12288
  s_nop 0
  global_load_lds_dwordx4 v4, s[32:33]
  s_add_u32 s32, s32, 49152
  s_addc_u32 s33, s33, 0
  s_add_u32 m0, s12, 13312
  s_nop 0
  global_load_lds_dwordx4 v4, s[32:33]
  s_add_u32 s32, s32, 49152
  s_addc_u32 s33, s33, 0
  s_add_u32 m0, s12, 14336
  s_nop 0
  global_load_lds_dwordx4 v4, s[32:33]
  s_add_u32 s32, s32, 49152
  s_addc_u32 s33, s33, 0
  s_add_u32 m0, s12, 15360
  s_nop 0
  global_load_lds_dwordx4 v4, s[32:33]
  s_add_u32 s32, s32, 49152
  s_addc_u32 s33, s33, 0
  s_add_u32 m0, s12, 16384
  s_nop 0
  global_load_lds_dwordx4 v4, s[32:33]
  s_add_u32 s32, s32, 49152
  s_addc_u32 s33, s33, 0
  s_add_u32 m0, s12, 17408
  s_nop 0
  global_load_lds_dwordx4 v4, s[32:33]
  s_add_u32 s32, s32, 49152
  s_addc_u32 s33, s33, 0
  s_add_u32 m0, s12, 18432
  s_nop 0
  global_load_lds_dwordx4 v4, s[32:33]
  s_add_u32 s32, s32, 49152
  s_addc_u32 s33, s33, 0
  s_add_u32 m0, s12, 19456
  s_nop 0
  global_load_lds_dwordx4 v4, s[32:33]
  s_add_u32 s32, s32, 49152
  s_addc_u32 s33, s33, 0
  s_mov_b64 exec, -1
  s_mov_b32 exec_lo, 0xffffffff
  s_mov_b32 exec_hi, 0xffffffff
  s_add_u32 m0, s12, 20480
  s_nop 0
  global_load_lds_dwordx4 v4, s[32:33]
  s_add_u32 s32, s32, 49152
  s_addc_u32 s33, s33, 0
  s_add_u32 m0, s12, 21504
  s_nop 0
  global_load_lds_dwordx4 v4, s[32:33]
  s_add_u32 s32, s32, 49152
  s_addc_u32 s33, s33, 0
  s_add_u32 m0, s12, 22528
  s_nop 0
  global_load_lds_dwordx4 v4, s[32:33]
  s_add_u32 s32, s32, 49152
  s_addc_u32 s33, s33, 0
  s_add_u32 m0, s12, 23552
  s_nop 0
  global_load_lds_dwordx4 v4, s[32:33]
  s_add_u32 s32, s32, 49152
  s_addc_u32 s33, s33, 0
  s_add_u32 m0, s12, 24576
  s_nop 0
  global_load_lds_dwordx4 v4, s[32:33]
  s_add_u32 s32, s32, 49152
  s_addc_u32 s33, s33, 0
  s_add_u32 m0, s12, 25600
  s_nop 0
  global_load_lds_dwordx4 v4, s[32:33]
  s_add_u32 s32, s32, 49152
  s_addc_u32 s33, s33, 0
  s_add_u32 m0, s12, 26624
  s_nop 0
  global_load_lds_dwordx4 v4, s[32:33]
  s_add_u32 s32, s32, 49152
  s_addc_u32 s33, s33, 0
  s_add_u32 m0, s12, 27648
  s_nop 0
  global_load_lds_dwordx4 v4, s[32:33]
  s_add_u32 s32, s32, 49152
  s_addc_u32 s33, s33, 0
  s_add_u32 m0, s12, 28672
  s_nop 0
  global_load_lds_dwordx4 v4, s[32:33]
  s_add_u32 s32, s32, 49152
  s_addc_u32 s33, s33, 0
  s_add_u32 m0, s12, 29696
  s_nop 0
  global_load_lds_dwordx4 v4, s[32:33]
  s_add_u32 s32, s32, 49152
  s_addc_u32 s33, s33, 0
  s_mov_b64 exec, -1
  s_mov_b32 exec_lo, 0xffffffff
  s_mov_b32 exec_hi, 0xffffffff
  s_add_u32 m0, s12, 30720
  s_nop 0
  global_load_lds_dwordx4 v4, s[32:33]
  s_add_u32 s32, s32, 49152
  s_addc_u32 s33, s33, 0
  s_add_u32 m0, s12, 31744
  s_nop 0
  global_load_lds_dwordx4 v4, s[32:33]
  s_add_u32 s32, s32, 49152
  s_addc_u32 s33, s33, 0
  s_add_u32 m0, s12, 32768
  s_nop 0
  global_load_lds_dwordx4 v4, s[32:33]
  s_add_u32 s32, s32, 49152
  s_addc_u32 s33, s33, 0
  s_add_u32 m0, s12, 33792
  s_nop 0
  global_load_lds_dwordx4 v4, s[32:33]
  s_add_u32 s32, s32, 49152
  s_addc_u32 s33, s33, 0
  s_add_u32 m0, s12, 34816
  s_nop 0
  global_load_lds_dwordx4 v4, s[32:33]
  s_add_u32 s32, s32, 49152
  s_addc_u32 s33, s33, 0
  s_add_u32 m0, s12, 35840
  s_nop 0
  global_load_lds_dwordx4 v4, s[32:33]
  s_add_u32 s32, s32, 49152
  s_addc_u32 s33, s33, 0
  s_add_u32 m0, s12, 36864
  s_nop 0
  global_load_lds_dwordx4 v4, s[32:33]
  s_add_u32 s32, s32, 49152
  s_addc_u32 s33, s33, 0
  s_add_u32 m0, s12, 37888
  s_nop 0
  global_load_lds_dwordx4 v4, s[32:33]
  s_add_u32 s32, s32, 49152
  s_addc_u32 s33, s33, 0
  s_add_u32 m0, s12, 38912
  s_nop 0
  global_load_lds_dwordx4 v4, s[32:33]
  s_add_u32 s32, s32, 49152
  s_addc_u32 s33, s33, 0
  s_add_u32 m0, s12, 39936
  s_nop 0
  global_load_lds_dwordx4 v4, s[32:33]
  s_add_u32 s32, s32, 49152
  s_addc_u32 s33, s33, 0
  s_mov_b64 exec, -1
  s_waitcnt vmcnt(30)
  ds_read_b64_tr_b16 v[96:97], v6 offset:0
  ds_read_b64_tr_b16 v[98:99], v6 offset:1024
  ds_read_b64_tr_b16 v[100:101], v6 offset:8
  ds_read_b64_tr_b16 v[102:103], v6 offset:1032
  ds_read_b64_tr_b16 v[104:105], v6 offset:2048
  ds_read_b64_tr_b16 v[106:107], v6 offset:3072
  ds_read_b64_tr_b16 v[108:109], v6 offset:2056
  ds_read_b64_tr_b16 v[110:111], v6 offset:3080
  ds_read_b64_tr_b16 v[112:113], v6 offset:4096
  ds_read_b64_tr_b16 v[114:115], v6 offset:5120
  ds_read_b64_tr_b16 v[116:117], v6 offset:4104
  ds_read_b64_tr_b16 v[118:119], v6 offset:5128
  ds_read_b64_tr_b16 v[120:121], v6 offset:6144
  ds_read_b64_tr_b16 v[122:123], v6 offset:7168
  ds_read_b64_tr_b16 v[124:125], v6 offset:6152
  ds_read_b64_tr_b16 v[126:127], v6 offset:7176
  ds_read_b64_tr_b16 v[128:129], v6 offset:8192
  ds_read_b64_tr_b16 v[130:131], v6 offset:9216
  ds_read_b64_tr_b16 v[132:133], v6 offset:8200
  ds_read_b64_tr_b16 v[134:135], v6 offset:9224
  s_waitcnt lgkmcnt(0)
  s_waitcnt vmcnt(20)
  ds_read_b64_tr_b16 v[136:137], v6 offset:10240
  ds_read_b64_tr_b16 v[138:139], v6 offset:11264
  ds_read_b64_tr_b16 v[140:141], v6 offset:10248
  ds_read_b64_tr_b16 v[142:143], v6 offset:11272
  ds_read_b64_tr_b16 v[144:145], v6 offset:12288
  ds_read_b64_tr_b16 v[146:147], v6 offset:13312
  ds_read_b64_tr_b16 v[148:149], v6 offset:12296
  ds_read_b64_tr_b16 v[150:151], v6 offset:13320
  ds_read_b64_tr_b16 v[152:153], v6 offset:14336
  ds_read_b64_tr_b16 v[154:155], v6 offset:15360
  ds_read_b64_tr_b16 v[156:157], v6 offset:14344
  ds_read_b64_tr_b16 v[158:159], v6 offset:15368
  ds_read_b64_tr_b16 v[160:161], v6 offset:16384
  ds_read_b64_tr_b16 v[162:163], v6 offset:17408
  ds_read_b64_tr_b16 v[164:165], v6 offset:16392
  ds_read_b64_tr_b16 v[166:167], v6 offset:17416
  ds_read_b64_tr_b16 v[168:169], v6 offset:18432
  ds_read_b64_tr_b16 v[170:171], v6 offset:19456
  ds_read_b64_tr_b16 v[172:173], v6 offset:18440
  ds_read_b64_tr_b16 v[174:175], v6 offset:19464
  s_waitcnt lgkmcnt(0)
  s_waitcnt vmcnt(10)
  ds_read_b64_tr_b16 v[176:177], v6 offset:20480
  ds_read_b64_tr_b16 v[178:179], v6 offset:21504
  ds_read_b64_tr_b16 v[180:181], v6 offset:20488
  ds_read_b64_tr_b16 v[182:183], v6 offset:21512
  ds_read_b64_tr_b16 v[184:185], v6 offset:22528
  ds_read_b64_tr_b16 v[186:187], v6 offset:23552
  ds_read_b64_tr_b16 v[188:189], v6 offset:22536
  ds_read_b64_tr_b16 v[190:191], v6 offset:23560
  ds_read_b64_tr_b16 v[192:193], v6 offset:24576
  ds_read_b64_tr_b16 v[194:195], v6 offset:25600
  ds_read_b64_tr_b16 v[196:197], v6 offset:24584
  ds_read_b64_tr_b16 v[198:199], v6 offset:25608
  ds_read_b64_tr_b16 v[200:201], v6 offset:26624
  ds_read_b64_tr_b16 v[202:203], v6 offset:27648
  ds_read_b64_tr_b16 v[204:205], v6 offset:26632
  ds_read_b64_tr_b16 v[206:207], v6 offset:27656
  ds_read_b64_tr_b16 v[208:209], v6 offset:28672
  ds_read_b64_tr_b16 v[210:211], v6 offset:29696
  ds_read_b64_tr_b16 v[212:213], v6 offset:28680
  ds_read_b64_tr_b16 v[214:215], v6 offset:29704
  s_waitcnt lgkmcnt(0)
  s_waitcnt vmcnt(0)
  ds_read_b64_tr_b16 v[216:217], v6 offset:30720
  ds_read_b64_tr_b16 v[218:219], v6 offset:31744
  ds_read_b64_tr_b16 v[220:221], v6 offset:30728
  ds_read_b64_tr_b16 v[222:223], v6 offset:31752
  ds_read_b64_tr_b16 v[224:225], v6 offset:32768
  ds_read_b64_tr_b16 v[226:227], v6 offset:33792
  ds_read_b64_tr_b16 v[228:229], v6 offset:32776
  ds_read_b64_tr_b16 v[230:231], v6 offset:33800
  ds_read_b64_tr_b16 v[232:233], v6 offset:34816
  ds_read_b64_tr_b16 v[234:235], v6 offset:35840
  ds_read_b64_tr_b16 v[236:237], v6 offset:34824
  ds_read_b64_tr_b16 v[238:239], v6 offset:35848
  ds_read_b64_tr_b16 v[240:241], v6 offset:36864
  ds_read_b64_tr_b16 v[242:243], v6 offset:37888
  ds_read_b64_tr_b16 v[244:245], v6 offset:36872
  ds_read_b64_tr_b16 v[246:247], v6 offset:37896
  ds_read_b64_tr_b16 v[248:249], v6 offset:38912
  ds_read_b64_tr_b16 v[250:251], v6 offset:39936
  ds_read_b64_tr_b16 v[252:253], v6 offset:38920
  ds_read_b64_tr_b16 v[254:255], v6 offset:39944
  s_waitcnt lgkmcnt(0)
  s_cmp_lg_u32 s34, 0
  s_cbranch_scc1 mega_win2
  v_lshlrev_b32 v2, 4, v0
  s_mul_i32 s14, s3, 5120
  v_add_u32 v3, s14, v2
  v_mov_b32 v4, 0xc0135761
  s_mov_b32 s16, 0xbdd2d3e8
  v_and_b32 v5, 3, v0
  v_lshlrev_b32 v5, 7, v5
  v_add_u32 v5, 51200, v5
  v_add_u32 v5, s31, v5
  s_lshl_b32 s18, s35, 2
  s_add_u32 s18, s18, s3
  s_lshl_b32 s18, s18, 10
  s_add_u32 s18, s18, 199229440
  s_barrier
win1_loop:
  s_mul_hi_u32 s19, s36, 715827883
  s_mul_i32 s19, s19, 6
  s_sub_u32 s19, s36, s19
  s_lshl_b32 s19, s19, 9
  v_add_u32 v6, s19, v5
  s_add_u32 s15, s36, 1
  s_mul_i32 s12, s36, 40960
  s_add_u32 s12, s12, 196083712
  s_mul_i32 s13, s36, 49152
  s_add_u32 s13, s13, s18
  s_branch wf_92
wf_91:
  s_sleep 1
  s_add_u32 s11, s11, 1
  s_cmp_gt_u32 s11, 131072
  s_cbranch_scc1 mega_done
wf_92:
  buffer_load_dword v7, v6, s[4:7], 0 offen sc1
  s_waitcnt vmcnt(0)
  v_cmp_gt_u32 vcc, s15, v7
  s_cbranch_vccnz wf_91
  s_add_u32 m0, s14, 0
  s_add_u32 s17, s12, 0
  buffer_load_dwordx4 v3, s[4:7], s17 offen offset:0 lds
  buffer_load_dwordx4 v3, s[4:7], s17 offen offset:1024 lds
  buffer_load_dwordx4 v3, s[4:7], s17 offen offset:2048 lds
  buffer_load_dwordx4 v3, s[4:7], s17 offen offset:3072 lds
  s_add_u32 m0, s14, 4096
  s_add_u32 s17, s12, 4096
  buffer_load_dwordx4 v3, s[4:7], s17 offen offset:0 lds
  s_add_u32 m0, s14, 20480
  s_add_u32 s17, s12, 20480
  buffer_load_dwordx4 v3, s[4:7], s17 offen offset:0 lds
  buffer_load_dwordx4 v3, s[4:7], s17 offen offset:1024 lds
  buffer_load_dwordx4 v3, s[4:7], s17 offen offset:2048 lds
  buffer_load_dwordx4 v3, s[4:7], s17 offen offset:3072 lds
  s_add_u32 m0, s14, 24576
  s_add_u32 s17, s12, 24576
  buffer_load_dwordx4 v3, s[4:7], s17 offen offset:0 lds
  s_waitcnt vmcnt(5)
  s_barrier
  ds_read_b128 v[32:35], v2 offset:0
  ds_read_b128 v[36:39], v2 offset:1024
  ds_read_b128 v[40:43], v2 offset:2048
  ds_read_b128 v[44:47], v2 offset:3072
  s_waitcnt lgkmcnt(3)
  v_mfma_f32_16x16x32_bf16 v[16:19], v[96:99], v[32:35], 0
  v_mfma_f32_16x16x32_bf16 v[20:23], v[100:103], v[32:35], 0
  ds_read_b128 v[32:35], v2 offset:4096
  s_waitcnt lgkmcnt(3)
  v_mfma_f32_16x16x32_bf16 v[16:19], v[104:107], v[36:39], v[16:19]
  v_mfma_f32_16x16x32_bf16 v[20:23], v[108:111], v[36:39], v[20:23]
  ds_read_b128 v[36:39], v2 offset:5120
  s_waitcnt lgkmcnt(3)
  v_mfma_f32_16x16x32_bf16 v[16:19], v[112:115], v[40:43], v[16:19]
  v_mfma_f32_16x16x32_bf16 v[20:23], v[116:119], v[40:43], v[20:23]
  ds_read_b128 v[40:43], v2 offset:6144
  s_waitcnt lgkmcnt(3)
  v_mfma_f32_16x16x32_bf16 v[16:19], v[120:123], v[44:47], v[16:19]
  v_mfma_f32_16x16x32_bf16 v[20:23], v[124:127], v[44:47], v[20:23]
  ds_read_b128 v[44:47], v2 offset:7168
  s_waitcnt lgkmcnt(3)
  v_mfma_f32_16x16x32_bf16 v[16:19], v[128:131], v[32:35], v[16:19]
  v_mfma_f32_16x16x32_bf16 v[20:23], v[132:135], v[32:35], v[20:23]
  ds_read_b128 v[32:35], v2 offset:8192
  s_waitcnt lgkmcnt(3)
  v_mfma_f32_16x16x32_bf16 v[16:19], v[136:139], v[36:39], v[16:19]
  v_mfma_f32_16x16x32_bf16 v[20:23], v[140:143], v[36:39], v[20:23]
  ds_read_b128 v[36:39], v2 offset:9216
  s_waitcnt lgkmcnt(3)
  v_mfma_f32_16x16x32_bf16 v[16:19], v[144:147], v[40:43], v[16:19]
  v_mfma_f32_16x16x32_bf16 v[20:23], v[148:151], v[40:43], v[20:23]
  ds_read_b128 v[40:43], v2 offset:10240
  s_waitcnt lgkmcnt(3)
  v_mfma_f32_16x16x32_bf16 v[16:19], v[152:155], v[44:47], v[16:19]
  v_mfma_f32_16x16x32_bf16 v[20:23], v[156:159], v[44:47], v[20:23]
  ds_read_b128 v[44:47], v2 offset:11264
  s_waitcnt lgkmcnt(3)
  v_mfma_f32_16x16x32_bf16 v[16:19], v[160:163], v[32:35], v[16:19]
  v_mfma_f32_16x16x32_bf16 v[20:23], v[164:167], v[32:35], v[20:23]
  ds_read_b128 v[32:35], v2 offset:12288
  s_waitcnt lgkmcnt(3)
  v_mfma_f32_16x16x32_bf16 v[16:19], v[168:171], v[36:39], v[16:19]
  v_mfma_f32_16x16x32_bf16 v[20:23], v[172:175], v[36:39], v[20:23]
  ds_read_b128 v[36:39], v2 offset:13312
  s_waitcnt lgkmcnt(3)
  v_mfma_f32_16x16x32_bf16 v[16:19], v[176:179], v[40:43], v[16:19]
  v_mfma_f32_16x16x32_bf16 v[20:23], v[180:183], v[40:43], v[20:23]
  ds_read_b128 v[40:43], v2 offset:14336
  s_waitcnt lgkmcnt(3)
  v_mfma_f32_16x16x32_bf16 v[16:19], v[184:187], v[44:47], v[16:19]
  v_mfma_f32_16x16x32_bf16 v[20:23], v[188:191], v[44:47], v[20:23]
  ds_read_b128 v[44:47], v2 offset:15360
  s_waitcnt lgkmcnt(3)
  v_mfma_f32_16x16x32_bf16 v[16:19], v[192:195], v[32:35], v[16:19]
  v_mfma_f32_16x16x32_bf16 v[20:23], v[196:199], v[32:35], v[20:23]
  ds_read_b128 v[32:35], v2 offset:16384
  s_waitcnt lgkmcnt(3)
  v_mfma_f32_16x16x32_bf16 v[16:19], v[200:203], v[36:39], v[16:19]
  v_mfma_f32_16x16x32_bf16 v[20:23], v[204:207], v[36:39], v[20:23]
  ds_read_b128 v[36:39], v2 offset:17408
  s_waitcnt lgkmcnt(3)
  v_mfma_f32_16x16x32_bf16 v[16:19], v[208:211], v[40:43], v[16:19]
  v_mfma_f32_16x16x32_bf16 v[20:23], v[212:215], v[40:43], v[20:23]
  ds_read_b128 v[40:43], v2 offset:18432
  s_waitcnt lgkmcnt(3)
  v_mfma_f32_16x16x32_bf16 v[16:19], v[216:219], v[44:47], v[16:19]
  v_mfma_f32_16x16x32_bf16 v[20:23], v[220:223], v[44:47], v[20:23]
  ds_read_b128 v[44:47], v2 offset:19456
  s_waitcnt lgkmcnt(3)
  v_mfma_f32_16x16x32_bf16 v[16:19], v[224:227], v[32:35], v[16:19]
  v_mfma_f32_16x16x32_bf16 v[20:23], v[228:231], v[32:35], v[20:23]
  s_waitcnt vmcnt(0)
  s_barrier
  ds_read_b128 v[32:35], v2 offset:20480
  s_waitcnt lgkmcnt(3)
  v_mfma_f32_16x16x32_bf16 v[16:19], v[232:235], v[36:39], v[16:19]
  v_mfma_f32_16x16x32_bf16 v[20:23], v[236:239], v[36:39], v[20:23]
  ds_read_b128 v[36:39], v2 offset:21504
  s_waitcnt lgkmcnt(3)
  v_mfma_f32_16x16x32_bf16 v[16:19], v[240:243], v[40:43], v[16:19]
  v_mfma_f32_16x16x32_bf16 v[20:23], v[244:247], v[40:43], v[20:23]
  ds_read_b128 v[40:43], v2 offset:22528
  s_waitcnt lgkmcnt(3)
  v_mfma_f32_16x16x32_bf16 v[16:19], v[248:251], v[44:47], v[16:19]
  v_mfma_f32_16x16x32_bf16 v[20:23], v[252:255], v[44:47], v[20:23]
  ds_read_b128 v[44:47], v2 offset:23552
  s_waitcnt lgkmcnt(3)
  v_mfma_f32_16x16x32_bf16 v[24:27], v[96:99], v[32:35], 0
  v_mfma_f32_16x16x32_bf16 v[28:31], v[100:103], v[32:35], 0
  ds_read_b128 v[32:35], v2 offset:24576
  s_waitcnt lgkmcnt(3)
  v_mfma_f32_16x16x32_bf16 v[24:27], v[104:107], v[36:39], v[24:27]
  v_mfma_f32_16x16x32_bf16 v[28:31], v[108:111], v[36:39], v[28:31]
  ds_read_b128 v[36:39], v2 offset:25600
  s_waitcnt lgkmcnt(3)
  v_mfma_f32_16x16x32_bf16 v[24:27], v[112:115], v[40:43], v[24:27]
  v_mul_f32 v48, v16, v16
  v_mul_f32 v49, v17, v17
  v_mfma_f32_16x16x32_bf16 v[28:31], v[116:119], v[40:43], v[28:31]
  v_mul_f32 v50, v18, v18
  v_mul_f32 v51, v19, v19
  ds_read_b128 v[40:43], v2 offset:26624
  s_waitcnt lgkmcnt(3)
  v_mfma_f32_16x16x32_bf16 v[24:27], v[120:123], v[44:47], v[24:27]
  v_mul_f32 v52, v20, v20
  v_mul_f32 v53, v21, v21
  v_mfma_f32_16x16x32_bf16 v[28:31], v[124:127], v[44:47], v[28:31]
  v_mul_f32 v54, v22, v22
  v_mul_f32 v55, v23, v23
  ds_read_b128 v[44:47], v2 offset:27648
  s_waitcnt lgkmcnt(3)
  v_mfma_f32_16x16x32_bf16 v[24:27], v[128:131], v[32:35], v[24:27]
  v_fma_f32 v48, v48, s16, v4
  v_fma_f32 v49, v49, s16, v4
  v_mfma_f32_16x16x32_bf16 v[28:31], v[132:135], v[32:35], v[28:31]
  v_fma_f32 v50, v50, s16, v4
  v_fma_f32 v51, v51, s16, v4
  ds_read_b128 v[32:35], v2 offset:28672
  s_waitcnt lgkmcnt(3)
  v_mfma_f32_16x16x32_bf16 v[24:27], v[136:139], v[36:39], v[24:27]
  v_fma_f32 v52, v52, s16, v4
  v_fma_f32 v53, v53, s16, v4
  v_mfma_f32_16x16x32_bf16 v[28:31], v[140:143], v[36:39], v[28:31]
  v_fma_f32 v54, v54, s16, v4
  v_fma_f32 v55, v55, s16, v4
  ds_read_b128 v[36:39], v2 offset:29696
  s_waitcnt lgkmcnt(3)
  v_mfma_f32_16x16x32_bf16 v[24:27], v[144:147], v[40:43], v[24:27]
  v_mul_f32 v48, v48, v16
  v_mul_f32 v49, v49, v17
  v_mfma_f32_16x16x32_bf16 v[28:31], v[148:151], v[40:43], v[28:31]
  v_mul_f32 v50, v50, v18
  v_mul_f32 v51, v51, v19
  ds_read_b128 v[40:43], v2 offset:30720
  s_waitcnt lgkmcnt(3)
  v_mfma_f32_16x16x32_bf16 v[24:27], v[152:155], v[44:47], v[24:27]
  v_mul_f32 v52, v52, v20
  v_mul_f32 v53, v53, v21
  v_mfma_f32_16x16x32_bf16 v[28:31], v[156:159], v[44:47], v[28:31]
  v_mul_f32 v54, v54, v22
  v_mul_f32 v55, v55, v23
  ds_read_b128 v[44:47], v2 offset:31744
  s_waitcnt lgkmcnt(3)
  v_mfma_f32_16x16x32_bf16 v[24:27], v[160:163], v[32:35], v[24:27]
  v_exp_f32 v48, v48
  v_exp_f32 v49, v49
  v_mfma_f32_16x16x32_bf16 v[28:31], v[164:167], v[32:35], v[28:31]
  v_exp_f32 v50, v50
  v_exp_f32 v51, v51
  ds_read_b128 v[32:35], v2 offset:32768
  s_waitcnt lgkmcnt(3)
  v_mfma_f32_16x16x32_bf16 v[24:27], v[168:171], v[36:39], v[24:27]
  v_exp_f32 v52, v52
  v_exp_f32 v53, v53
  v_mfma_f32_16x16x32_bf16 v[28:31], v[172:175], v[36:39], v[28:31]
  v_exp_f32 v54, v54
  v_exp_f32 v55, v55
  ds_read_b128 v[36:39], v2 offset:33792
  s_waitcnt lgkmcnt(3)
  v_mfma_f32_16x16x32_bf16 v[24:27], v[176:179], v[40:43], v[24:27]
  v_add_f32 v48, 1.0, v48
  v_add_f32 v49, 1.0, v49
  v_mfma_f32_16x16x32_bf16 v[28:31], v[180:183], v[40:43], v[28:31]
  v_add_f32 v50, 1.0, v50
  v_add_f32 v51, 1.0, v51
  ds_read_b128 v[40:43], v2 offset:34816
  s_waitcnt lgkmcnt(3)
  v_mfma_f32_16x16x32_bf16 v[24:27], v[184:187], v[44:47], v[24:27]
  v_add_f32 v52, 1.0, v52
  v_add_f32 v53, 1.0, v53
  v_mfma_f32_16x16x32_bf16 v[28:31], v[188:191], v[44:47], v[28:31]
  v_add_f32 v54, 1.0, v54
  v_add_f32 v55, 1.0, v55
  ds_read_b128 v[44:47], v2 offset:35840
  s_waitcnt lgkmcnt(3)
  v_mfma_f32_16x16x32_bf16 v[24:27], v[192:195], v[32:35], v[24:27]
  v_rcp_f32 v48, v48
  v_rcp_f32 v49, v49
  v_mfma_f32_16x16x32_bf16 v[28:31], v[196:199], v[32:35], v[28:31]
  v_rcp_f32 v50, v50
  v_rcp_f32 v51, v51
  ds_read_b128 v[32:35], v2 offset:36864
  s_waitcnt lgkmcnt(3)
  v_mfma_f32_16x16x32_bf16 v[24:27], v[200:203], v[36:39], v[24:27]
  v_rcp_f32 v52, v52
  v_rcp_f32 v53, v53
  v_mfma_f32_16x16x32_bf16 v[28:31], v[204:207], v[36:39], v[28:31]
  v_rcp_f32 v54, v54
  v_rcp_f32 v55, v55
  ds_read_b128 v[36:39], v2 offset:37888
  s_waitcnt lgkmcnt(3)
  v_mfma_f32_16x16x32_bf16 v[24:27], v[208:211], v[40:43], v[24:27]
  v_mul_f32 v48, v48, v16
  v_mul_f32 v49, v49, v17
  v_mfma_f32_16x16x32_bf16 v[28:31], v[212:215], v[40:43], v[28:31]
  v_mul_f32 v50, v50, v18
  v_mul_f32 v51, v51, v19
  ds_read_b128 v[40:43], v2 offset:38912
  s_waitcnt lgkmcnt(3)
  v_mfma_f32_16x16x32_bf16 v[24:27], v[216:219], v[44:47], v[24:27]
  v_mul_f32 v52, v52, v20
  v_mul_f32 v53, v53, v21
  v_mfma_f32_16x16x32_bf16 v[28:31], v[220:223], v[44:47], v[28:31]
  v_mul_f32 v54, v54, v22
  v_mul_f32 v55, v55, v23
  ds_read_b128 v[44:47], v2 offset:39936
  s_waitcnt lgkmcnt(3)
  v_mfma_f32_16x16x32_bf16 v[24:27], v[224:227], v[32:35], v[24:27]
  v_cvt_pk_bf16_f32 v80, v48, v49
  v_cvt_pk_bf16_f32 v81, v50, v51
  v_mfma_f32_16x16x32_bf16 v[28:31], v[228:231], v[32:35], v[28:31]
  v_cvt_pk_bf16_f32 v82, v52, v53
  v_cvt_pk_bf16_f32 v83, v54, v55
  s_waitcnt lgkmcnt(2)
  v_mfma_f32_16x16x32_bf16 v[24:27], v[232:235], v[36:39], v[24:27]
  buffer_store_dwordx4 v[80:83], v2, s[4:7], s13 offen offset:0 sc1
  v_mfma_f32_16x16x32_bf16 v[28:31], v[236:239], v[36:39], v[28:31]
  s_waitcnt lgkmcnt(1)
  v_mfma_f32_16x16x32_bf16 v[24:27], v[240:243], v[40:43], v[24:27]
  v_mfma_f32_16x16x32_bf16 v[28:31], v[244:247], v[40:43], v[28:31]
  s_waitcnt lgkmcnt(0)
  v_mfma_f32_16x16x32_bf16 v[24:27], v[248:251], v[44:47], v[24:27]
  v_mfma_f32_16x16x32_bf16 v[28:31], v[252:255], v[44:47], v[28:31]
  s_nop 4
  v_mul_f32 v56, v24, v24
  v_mul_f32 v57, v25, v25
  v_mul_f32 v58, v26, v26
  v_mul_f32 v59, v27, v27
  v_mul_f32 v60, v28, v28
  v_mul_f32 v61, v29, v29
  v_mul_f32 v62, v30, v30
  v_mul_f32 v63, v31, v31
  v_fma_f32 v56, v56, s16, v4
  v_fma_f32 v57, v57, s16, v4
  v_fma_f32 v58, v58, s16, v4
  v_fma_f32 v59, v59, s16, v4
  v_fma_f32 v60, v60, s16, v4
  v_fma_f32 v61, v61, s16, v4
  v_fma_f32 v62, v62, s16, v4
  v_fma_f32 v63, v63, s16, v4
  v_mul_f32 v56, v56, v24
  v_mul_f32 v57, v57, v25
  v_mul_f32 v58, v58, v26
  v_mul_f32 v59, v59, v27
  v_mul_f32 v60, v60, v28
  v_mul_f32 v61, v61, v29
  v_mul_f32 v62, v62, v30
  v_mul_f32 v63, v63, v31
  v_exp_f32 v56, v56
  v_exp_f32 v57, v57
  v_exp_f32 v58, v58
  v_exp_f32 v59, v59
  v_exp_f32 v60, v60
  v_exp_f32 v61, v61
  v_exp_f32 v62, v62
  v_exp_f32 v63, v63
  v_add_f32 v56, 1.0, v56
  v_add_f32 v57, 1.0, v57
  v_add_f32 v58, 1.0, v58
  v_add_f32 v59, 1.0, v59
  v_add_f32 v60, 1.0, v60
  v_add_f32 v61, 1.0, v61
  v_add_f32 v62, 1.0, v62
  v_add_f32 v63, 1.0, v63
  v_rcp_f32 v56, v56
  v_rcp_f32 v57, v57
  v_rcp_f32 v58, v58
  v_rcp_f32 v59, v59
  v_rcp_f32 v60, v60
  v_rcp_f32 v61, v61
  v_rcp_f32 v62, v62
  v_rcp_f32 v63, v63
  v_mul_f32 v56, v56, v24
  v_mul_f32 v57, v57, v25
  v_mul_f32 v58, v58, v26
  v_mul_f32 v59, v59, v27
  v_mul_f32 v60, v60, v28
  v_mul_f32 v61, v61, v29
  v_mul_f32 v62, v62, v30
  v_mul_f32 v63, v63, v31
  v_cvt_pk_bf16_f32 v84, v56, v57
  v_cvt_pk_bf16_f32 v85, v58, v59
  v_cvt_pk_bf16_f32 v86, v60, v61
  v_cvt_pk_bf16_f32 v87, v62, v63
  s_add_u32 s13, s13, 24576
  buffer_store_dwordx4 v[84:87], v2, s[4:7], s13 offen offset:0 sc1
  s_waitcnt vmcnt(0)
  s_barrier
  s_cmp_lg_u32 s3, 0
  s_cbranch_scc1 wz_93
  v_mov_b32 v7, s15
  s_mov_b64 exec, 1
  buffer_store_dword v7, off, s[4:7], s30 sc1
  s_mov_b64 exec, -1
wz_93:
  s_add_u32 s36, s36, 2
  s_cmp_lt_u32 s36, 64
  s_cbranch_scc1 win1_loop
  s_mov_b32 s41, 3
  s_branch mega_out2
mega_win2:
  v_lshlrev_b32 v2, 4, v0
  s_mul_i32 s14, s3, 5120
  v_add_u32 v3, s14, v2
  v_mov_b32 v4, 0xc0135761
  s_mov_b32 s16, 0xbdd2d3e8
  v_and_b32 v5, 3, v0
  v_lshlrev_b32 v5, 7, v5
  v_add_u32 v5, 51200, v5
  v_add_u32 v5, s31, v5
  s_lshl_b32 s18, s35, 2
  s_add_u32 s18, s18, s3
  s_lshl_b32 s18, s18, 11
  s_add_u32 s18, s18, 203423744
  s_barrier
win2_loop:
  s_mul_hi_u32 s19, s36, 715827883
  s_mul_i32 s19, s19, 6
  s_sub_u32 s19, s36, s19
  s_lshl_b32 s19, s19, 9
  v_add_u32 v6, s19, v5
  s_add_u32 s15, s36, 1
  s_mul_i32 s12, s36, 40960
  s_add_u32 s12, s12, 196083712
  s_mul_i32 s13, s36, 49152
  s_add_u32 s13, s13, s18
  v_lshlrev_b32 v9, 5, v0
  s_mul_i32 s19, s36, 1536
  s_add_u32 s19, s19, 212860928
  buffer_load_dword v8, v9, s[4:7], s19 offen offset:0 sc1
  s_branch wf_95
wf_94:
  s_sleep 1
  s_add_u32 s11, s11, 1
  s_cmp_gt_u32 s11, 131072
  s_cbranch_scc1 mega_done
wf_95:
  buffer_load_dword v7, v6, s[4:7], 0 offen sc1
  s_waitcnt vmcnt(0)
  v_cmp_gt_u32 vcc, s15, v7
  s_cbranch_vccnz wf_94
  s_add_u32 m0, s14, 0
  s_add_u32 s17, s12, 0
  buffer_load_dwordx4 v3, s[4:7], s17 offen offset:0 lds
  buffer_load_dwordx4 v3, s[4:7], s17 offen offset:1024 lds
  buffer_load_dwordx4 v3, s[4:7], s17 offen offset:2048 lds
  buffer_load_dwordx4 v3, s[4:7], s17 offen offset:3072 lds
  s_add_u32 m0, s14, 4096
  s_add_u32 s17, s12, 4096
  buffer_load_dwordx4 v3, s[4:7], s17 offen offset:0 lds
  s_add_u32 m0, s14, 20480
  s_add_u32 s17, s12, 20480
  buffer_load_dwordx4 v3, s[4:7], s17 offen offset:0 lds
  buffer_load_dwordx4 v3, s[4:7], s17 offen offset:1024 lds
  buffer_load_dwordx4 v3, s[4:7], s17 offen offset:2048 lds
  buffer_load_dwordx4 v3, s[4:7], s17 offen offset:3072 lds
  s_add_u32 m0, s14, 24576
  s_add_u32 s17, s12, 24576
  buffer_load_dwordx4 v3, s[4:7], s17 offen offset:0 lds
  s_waitcnt vmcnt(5)
  s_barrier
  ds_read_b128 v[32:35], v2 offset:0
  ds_read_b128 v[36:39], v2 offset:1024
  ds_read_b128 v[40:43], v2 offset:2048
  ds_read_b128 v[44:47], v2 offset:3072
  s_waitcnt lgkmcnt(3)
  v_mfma_f32_16x16x32_bf16 v[16:19], v[32:35], v[96:99], 0
  v_mfma_f32_16x16x32_bf16 v[20:23], v[32:35], v[100:103], 0
  ds_read_b128 v[32:35], v2 offset:4096
  s_waitcnt lgkmcnt(3)
  v_mfma_f32_16x16x32_bf16 v[16:19], v[36:39], v[104:107], v[16:19]
  v_mfma_f32_16x16x32_bf16 v[20:23], v[36:39], v[108:111], v[20:23]
  ds_read_b128 v[36:39], v2 offset:5120
  s_waitcnt lgkmcnt(3)
  v_mfma_f32_16x16x32_bf16 v[16:19], v[40:43], v[112:115], v[16:19]
  v_mfma_f32_16x16x32_bf16 v[20:23], v[40:43], v[116:119], v[20:23]
  ds_read_b128 v[40:43], v2 offset:6144
  s_waitcnt lgkmcnt(3)
  v_mfma_f32_16x16x32_bf16 v[16:19], v[44:47], v[120:123], v[16:19]
  v_mfma_f32_16x16x32_bf16 v[20:23], v[44:47], v[124:127], v[20:23]
  ds_read_b128 v[44:47], v2 offset:7168
  s_waitcnt lgkmcnt(3)
  v_mfma_f32_16x16x32_bf16 v[16:19], v[32:35], v[128:131], v[16:19]
  v_mfma_f32_16x16x32_bf16 v[20:23], v[32:35], v[132:135], v[20:23]
  ds_read_b128 v[32:35], v2 offset:8192
  s_waitcnt lgkmcnt(3)
  v_mfma_f32_16x16x32_bf16 v[16:19], v[36:39], v[136:139], v[16:19]
  v_mfma_f32_16x16x32_bf16 v[20:23], v[36:39], v[140:143], v[20:23]
  ds_read_b128 v[36:39], v2 offset:9216
  s_waitcnt lgkmcnt(3)
  v_mfma_f32_16x16x32_bf16 v[16:19], v[40:43], v[144:147], v[16:19]
  v_mfma_f32_16x16x32_bf16 v[20:23], v[40:43], v[148:151], v[20:23]
  ds_read_b128 v[40:43], v2 offset:10240
  s_waitcnt lgkmcnt(3)
  v_mfma_f32_16x16x32_bf16 v[16:19], v[44:47], v[152:155], v[16:19]
  v_mfma_f32_16x16x32_bf16 v[20:23], v[44:47], v[156:159], v[20:23]
  ds_read_b128 v[44:47], v2 offset:11264
  s_waitcnt lgkmcnt(3)
  v_mfma_f32_16x16x32_bf16 v[16:19], v[32:35], v[160:163], v[16:19]
  v_mfma_f32_16x16x32_bf16 v[20:23], v[32:35], v[164:167], v[20:23]
  ds_read_b128 v[32:35], v2 offset:12288
  s_waitcnt lgkmcnt(3)
  v_mfma_f32_16x16x32_bf16 v[16:19], v[36:39], v[168:171], v[16:19]
  v_mfma_f32_16x16x32_bf16 v[20:23], v[36:39], v[172:175], v[20:23]
  ds_read_b128 v[36:39], v2 offset:13312
  s_waitcnt lgkmcnt(3)
  v_mfma_f32_16x16x32_bf16 v[16:19], v[40:43], v[176:179], v[16:19]
  v_mfma_f32_16x16x32_bf16 v[20:23], v[40:43], v[180:183], v[20:23]
  ds_read_b128 v[40:43], v2 offset:14336
  s_waitcnt lgkmcnt(3)
  v_mfma_f32_16x16x32_bf16 v[16:19], v[44:47], v[184:187], v[16:19]
  v_mfma_f32_16x16x32_bf16 v[20:23], v[44:47], v[188:191], v[20:23]
  ds_read_b128 v[44:47], v2 offset:15360
  s_waitcnt lgkmcnt(3)
  v_mfma_f32_16x16x32_bf16 v[16:19], v[32:35], v[192:195], v[16:19]
  v_mfma_f32_16x16x32_bf16 v[20:23], v[32:35], v[196:199], v[20:23]
  ds_read_b128 v[32:35], v2 offset:16384
  s_waitcnt lgkmcnt(3)
  v_mfma_f32_16x16x32_bf16 v[16:19], v[36:39], v[200:203], v[16:19]
  v_mfma_f32_16x16x32_bf16 v[20:23], v[36:39], v[204:207], v[20:23]
  ds_read_b128 v[36:39], v2 offset:17408
  s_waitcnt lgkmcnt(3)
  v_mfma_f32_16x16x32_bf16 v[16:19], v[40:43], v[208:211], v[16:19]
  v_mfma_f32_16x16x32_bf16 v[20:23], v[40:43], v[212:215], v[20:23]
  ds_read_b128 v[40:43], v2 offset:18432
  s_waitcnt lgkmcnt(3)
  v_mfma_f32_16x16x32_bf16 v[16:19], v[44:47], v[216:219], v[16:19]
  v_mfma_f32_16x16x32_bf16 v[20:23], v[44:47], v[220:223], v[20:23]
  ds_read_b128 v[44:47], v2 offset:19456
  s_waitcnt lgkmcnt(3)
  v_mfma_f32_16x16x32_bf16 v[16:19], v[32:35], v[224:227], v[16:19]
  v_mfma_f32_16x16x32_bf16 v[20:23], v[32:35], v[228:231], v[20:23]
  s_waitcnt vmcnt(0)
  s_barrier
  ds_read_b128 v[32:35], v2 offset:20480
  s_waitcnt lgkmcnt(3)
  v_mfma_f32_16x16x32_bf16 v[16:19], v[36:39], v[232:235], v[16:19]
  v_mfma_f32_16x16x32_bf16 v[20:23], v[36:39], v[236:239], v[20:23]
  ds_read_b128 v[36:39], v2 offset:21504
  s_waitcnt lgkmcnt(3)
  v_mfma_f32_16x16x32_bf16 v[16:19], v[40:43], v[240:243], v[16:19]
  v_mfma_f32_16x16x32_bf16 v[20:23], v[40:43], v[244:247], v[20:23]
  ds_read_b128 v[40:43], v2 offset:22528
  s_waitcnt lgkmcnt(3)
  v_mfma_f32_16x16x32_bf16 v[16:19], v[44:47], v[248:251], v[16:19]
  v_mfma_f32_16x16x32_bf16 v[20:23], v[44:47], v[252:255], v[20:23]
  ds_read_b128 v[44:47], v2 offset:23552
  s_waitcnt lgkmcnt(3)
  v_mfma_f32_16x16x32_bf16 v[24:27], v[32:35], v[96:99], 0
  v_mfma_f32_16x16x32_bf16 v[28:31], v[32:35], v[100:103], 0
  ds_read_b128 v[32:35], v2 offset:24576
  s_waitcnt lgkmcnt(3)
  v_mfma_f32_16x16x32_bf16 v[24:27], v[36:39], v[104:107], v[24:27]
  v_mfma_f32_16x16x32_bf16 v[28:31], v[36:39], v[108:111], v[28:31]
  ds_read_b128 v[36:39], v2 offset:25600
  s_waitcnt lgkmcnt(3)
  v_mfma_f32_16x16x32_bf16 v[24:27], v[40:43], v[112:115], v[24:27]
  v_mul_f32 v48, v16, v16
  v_mul_f32 v49, v17, v17
  v_mfma_f32_16x16x32_bf16 v[28:31], v[40:43], v[116:119], v[28:31]
  v_mul_f32 v50, v18, v18
  v_mul_f32 v51, v19, v19
  ds_read_b128 v[40:43], v2 offset:26624
  s_waitcnt lgkmcnt(3)
  v_mfma_f32_16x16x32_bf16 v[24:27], v[44:47], v[120:123], v[24:27]
  v_mul_f32 v52, v20, v20
  v_mul_f32 v53, v21, v21
  v_mfma_f32_16x16x32_bf16 v[28:31], v[44:47], v[124:127], v[28:31]
  v_mul_f32 v54, v22, v22
  v_mul_f32 v55, v23, v23
  ds_read_b128 v[44:47], v2 offset:27648
  s_waitcnt lgkmcnt(3)
  v_mfma_f32_16x16x32_bf16 v[24:27], v[32:35], v[128:131], v[24:27]
  v_fma_f32 v48, v48, s16, v4
  v_fma_f32 v49, v49, s16, v4
  v_mfma_f32_16x16x32_bf16 v[28:31], v[32:35], v[132:135], v[28:31]
  v_fma_f32 v50, v50, s16, v4
  v_fma_f32 v51, v51, s16, v4
  ds_read_b128 v[32:35], v2 offset:28672
  s_waitcnt lgkmcnt(3)
  v_mfma_f32_16x16x32_bf16 v[24:27], v[36:39], v[136:139], v[24:27]
  v_fma_f32 v52, v52, s16, v4
  v_fma_f32 v53, v53, s16, v4
  v_mfma_f32_16x16x32_bf16 v[28:31], v[36:39], v[140:143], v[28:31]
  v_fma_f32 v54, v54, s16, v4
  v_fma_f32 v55, v55, s16, v4
  ds_read_b128 v[36:39], v2 offset:29696
  s_waitcnt lgkmcnt(3)
  v_mfma_f32_16x16x32_bf16 v[24:27], v[40:43], v[144:147], v[24:27]
  v_mul_f32 v48, v48, v16
  v_mul_f32 v49, v49, v17
  v_mfma_f32_16x16x32_bf16 v[28:31], v[40:43], v[148:151], v[28:31]
  v_mul_f32 v50, v50, v18
  v_mul_f32 v51, v51, v19
  ds_read_b128 v[40:43], v2 offset:30720
  s_waitcnt lgkmcnt(3)
  v_mfma_f32_16x16x32_bf16 v[24:27], v[44:47], v[152:155], v[24:27]
  v_mul_f32 v52, v52, v20
  v_mul_f32 v53, v53, v21
  v_mfma_f32_16x16x32_bf16 v[28:31], v[44:47], v[156:159], v[28:31]
  v_mul_f32 v54, v54, v22
  v_mul_f32 v55, v55, v23
  ds_read_b128 v[44:47], v2 offset:31744
  s_waitcnt lgkmcnt(3)
  v_mfma_f32_16x16x32_bf16 v[24:27], v[32:35], v[160:163], v[24:27]
  v_exp_f32 v48, v48
  v_exp_f32 v49, v49
  v_mfma_f32_16x16x32_bf16 v[28:31], v[32:35], v[164:167], v[28:31]
  v_exp_f32 v50, v50
  v_exp_f32 v51, v51
  ds_read_b128 v[32:35], v2 offset:32768
  s_waitcnt lgkmcnt(3)
  v_mfma_f32_16x16x32_bf16 v[24:27], v[36:39], v[168:171], v[24:27]
  v_exp_f32 v52, v52
  v_exp_f32 v53, v53
  v_mfma_f32_16x16x32_bf16 v[28:31], v[36:39], v[172:175], v[28:31]
  v_exp_f32 v54, v54
  v_exp_f32 v55, v55
  ds_read_b128 v[36:39], v2 offset:33792
  s_waitcnt lgkmcnt(3)
  v_mfma_f32_16x16x32_bf16 v[24:27], v[40:43], v[176:179], v[24:27]
  v_add_f32 v48, 1.0, v48
  v_add_f32 v49, 1.0, v49
  v_mfma_f32_16x16x32_bf16 v[28:31], v[40:43], v[180:183], v[28:31]
  v_add_f32 v50, 1.0, v50
  v_add_f32 v51, 1.0, v51
  ds_read_b128 v[40:43], v2 offset:34816
  s_waitcnt lgkmcnt(3)
  v_mfma_f32_16x16x32_bf16 v[24:27], v[44:47], v[184:187], v[24:27]
  v_add_f32 v52, 1.0, v52
  v_add_f32 v53, 1.0, v53
  v_mfma_f32_16x16x32_bf16 v[28:31], v[44:47], v[188:191], v[28:31]
  v_add_f32 v54, 1.0, v54
  v_add_f32 v55, 1.0, v55
  ds_read_b128 v[44:47], v2 offset:35840
  s_waitcnt lgkmcnt(3)
  v_mfma_f32_16x16x32_bf16 v[24:27], v[32:35], v[192:195], v[24:27]
  v_rcp_f32 v48, v48
  v_rcp_f32 v49, v49
  v_mfma_f32_16x16x32_bf16 v[28:31], v[32:35], v[196:199], v[28:31]
  v_rcp_f32 v50, v50
  v_rcp_f32 v51, v51
  ds_read_b128 v[32:35], v2 offset:36864
  s_waitcnt lgkmcnt(3)
  v_mfma_f32_16x16x32_bf16 v[24:27], v[36:39], v[200:203], v[24:27]
  v_rcp_f32 v52, v52
  v_rcp_f32 v53, v53
  v_mfma_f32_16x16x32_bf16 v[28:31], v[36:39], v[204:207], v[28:31]
  v_rcp_f32 v54, v54
  v_rcp_f32 v55, v55
  ds_read_b128 v[36:39], v2 offset:37888
  s_waitcnt lgkmcnt(3)
  v_mfma_f32_16x16x32_bf16 v[24:27], v[40:43], v[208:211], v[24:27]
  v_mul_f32 v48, v48, v16
  v_mul_f32 v49, v49, v17
  v_mfma_f32_16x16x32_bf16 v[28:31], v[40:43], v[212:215], v[28:31]
  v_mul_f32 v50, v50, v18
  v_mul_f32 v51, v51, v19
  ds_read_b128 v[40:43], v2 offset:38912
  s_waitcnt lgkmcnt(3)
  v_mfma_f32_16x16x32_bf16 v[24:27], v[44:47], v[216:219], v[24:27]
  v_mul_f32 v52, v52, v20
  v_mul_f32 v53, v53, v21
  v_mfma_f32_16x16x32_bf16 v[28:31], v[44:47], v[220:223], v[28:31]
  v_mul_f32 v54, v54, v22
  v_mul_f32 v55, v55, v23
  ds_read_b128 v[44:47], v2 offset:39936
  s_waitcnt lgkmcnt(3)
  v_mfma_f32_16x16x32_bf16 v[24:27], v[32:35], v[224:227], v[24:27]
  v_add_f32 v64, v48, v52
  v_add_f32 v65, v49, v53
  v_mfma_f32_16x16x32_bf16 v[28:31], v[32:35], v[228:231], v[28:31]
  v_add_f32 v66, v50, v54
  v_add_f32 v67, v51, v55
  s_waitcnt lgkmcnt(2)
  v_mfma_f32_16x16x32_bf16 v[24:27], v[36:39], v[232:235], v[24:27]
  v_mul_f32 v68, v48, v48
  v_mul_f32 v69, v49, v49
  v_mfma_f32_16x16x32_bf16 v[28:31], v[36:39], v[236:239], v[28:31]
  v_mul_f32 v70, v50, v50
  v_mul_f32 v71, v51, v51
  s_waitcnt lgkmcnt(1)
  v_mfma_f32_16x16x32_bf16 v[24:27], v[40:43], v[240:243], v[24:27]
  v_fmac_f32 v68, v52, v52
  v_fmac_f32 v69, v53, v53
  v_mfma_f32_16x16x32_bf16 v[28:31], v[40:43], v[244:247], v[28:31]
  v_fmac_f32 v70, v54, v54
  v_fmac_f32 v71, v55, v55
  s_waitcnt lgkmcnt(0)
  v_mfma_f32_16x16x32_bf16 v[24:27], v[44:47], v[248:251], v[24:27]
  v_add_f32_dpp v64, v64, v64 row_ror:8 row_mask:0xf bank_mask:0xf
  v_add_f32_dpp v65, v65, v65 row_ror:8 row_mask:0xf bank_mask:0xf
  v_mfma_f32_16x16x32_bf16 v[28:31], v[44:47], v[252:255], v[28:31]
  v_add_f32_dpp v66, v66, v66 row_ror:8 row_mask:0xf bank_mask:0xf
  v_add_f32_dpp v67, v67, v67 row_ror:8 row_mask:0xf bank_mask:0xf
  v_add_f32_dpp v68, v68, v68 row_ror:8 row_mask:0xf bank_mask:0xf
  v_add_f32_dpp v69, v69, v69 row_ror:8 row_mask:0xf bank_mask:0xf
  v_add_f32_dpp v70, v70, v70 row_ror:8 row_mask:0xf bank_mask:0xf
  v_add_f32_dpp v71, v71, v71 row_ror:8 row_mask:0xf bank_mask:0xf
  v_add_f32_dpp v64, v64, v64 row_ror:4 row_mask:0xf bank_mask:0xf
  v_add_f32_dpp v65, v65, v65 row_ror:4 row_mask:0xf bank_mask:0xf
  v_add_f32_dpp v66, v66, v66 row_ror:4 row_mask:0xf bank_mask:0xf
  v_add_f32_dpp v67, v67, v67 row_ror:4 row_mask:0xf bank_mask:0xf
  v_add_f32_dpp v68, v68, v68 row_ror:4 row_mask:0xf bank_mask:0xf
  v_add_f32_dpp v69, v69, v69 row_ror:4 row_mask:0xf bank_mask:0xf
  v_add_f32_dpp v70, v70, v70 row_ror:4 row_mask:0xf bank_mask:0xf
  v_add_f32_dpp v71, v71, v71 row_ror:4 row_mask:0xf bank_mask:0xf
  v_add_f32_dpp v64, v64, v64 row_ror:2 row_mask:0xf bank_mask:0xf
  v_add_f32_dpp v65, v65, v65 row_ror:2 row_mask:0xf bank_mask:0xf
  v_add_f32_dpp v66, v66, v66 row_ror:2 row_mask:0xf bank_mask:0xf
  v_add_f32_dpp v67, v67, v67 row_ror:2 row_mask:0xf bank_mask:0xf
  v_add_f32_dpp v68, v68, v68 row_ror:2 row_mask:0xf bank_mask:0xf
  v_add_f32_dpp v69, v69, v69 row_ror:2 row_mask:0xf bank_mask:0xf
  v_add_f32_dpp v70, v70, v70 row_ror:2 row_mask:0xf bank_mask:0xf
  v_add_f32_dpp v71, v71, v71 row_ror:2 row_mask:0xf bank_mask:0xf
  v_add_f32_dpp v64, v64, v64 row_ror:1 row_mask:0xf bank_mask:0xf
  v_add_f32_dpp v65, v65, v65 row_ror:1 row_mask:0xf bank_mask:0xf
  v_add_f32_dpp v66, v66, v66 row_ror:1 row_mask:0xf bank_mask:0xf
  v_add_f32_dpp v67, v67, v67 row_ror:1 row_mask:0xf bank_mask:0xf
  v_add_f32_dpp v68, v68, v68 row_ror:1 row_mask:0xf bank_mask:0xf
  v_add_f32_dpp v69, v69, v69 row_ror:1 row_mask:0xf bank_mask:0xf
  v_add_f32_dpp v70, v70, v70 row_ror:1 row_mask:0xf bank_mask:0xf
  v_add_f32_dpp v71, v71, v71 row_ror:1 row_mask:0xf bank_mask:0xf
  v_mul_f32 v56, v24, v24
  v_mul_f32 v57, v25, v25
  v_mul_f32 v58, v26, v26
  v_mul_f32 v59, v27, v27
  v_mul_f32 v60, v28, v28
  v_mul_f32 v61, v29, v29
  v_mul_f32 v62, v30, v30
  v_mul_f32 v63, v31, v31
  v_fma_f32 v56, v56, s16, v4
  v_fma_f32 v57, v57, s16, v4
  v_fma_f32 v58, v58, s16, v4
  v_fma_f32 v59, v59, s16, v4
  v_fma_f32 v60, v60, s16, v4
  v_fma_f32 v61, v61, s16, v4
  v_fma_f32 v62, v62, s16, v4
  v_fma_f32 v63, v63, s16, v4
  v_mul_f32 v56, v56, v24
  v_mul_f32 v57, v57, v25
  v_mul_f32 v58, v58, v26
  v_mul_f32 v59, v59, v27
  v_mul_f32 v60, v60, v28
  v_mul_f32 v61, v61, v29
  v_mul_f32 v62, v62, v30
  v_mul_f32 v63, v63, v31
  v_exp_f32 v56, v56
  v_exp_f32 v57, v57
  v_exp_f32 v58, v58
  v_exp_f32 v59, v59
  v_exp_f32 v60, v60
  v_exp_f32 v61, v61
  v_exp_f32 v62, v62
  v_exp_f32 v63, v63
  v_add_f32 v56, 1.0, v56
  v_add_f32 v57, 1.0, v57
  v_add_f32 v58, 1.0, v58
  v_add_f32 v59, 1.0, v59
  v_add_f32 v60, 1.0, v60
  v_add_f32 v61, 1.0, v61
  v_add_f32 v62, 1.0, v62
  v_add_f32 v63, 1.0, v63
  v_rcp_f32 v56, v56
  v_rcp_f32 v57, v57
  v_rcp_f32 v58, v58
  v_rcp_f32 v59, v59
  v_rcp_f32 v60, v60
  v_rcp_f32 v61, v61
  v_rcp_f32 v62, v62
  v_rcp_f32 v63, v63
  v_mul_f32 v56, v56, v24
  v_mul_f32 v57, v57, v25
  v_mul_f32 v58, v58, v26
  v_mul_f32 v59, v59, v27
  v_mul_f32 v60, v60, v28
  v_mul_f32 v61, v61, v29
  v_mul_f32 v62, v62, v30
  v_mul_f32 v63, v63, v31
  v_add_f32 v72, v56, v60
  v_add_f32 v73, v57, v61
  v_add_f32 v74, v58, v62
  v_add_f32 v75, v59, v63
  v_mul_f32 v76, v56, v56
  v_mul_f32 v77, v57, v57
  v_mul_f32 v78, v58, v58
  v_mul_f32 v79, v59, v59
  v_fmac_f32 v76, v60, v60
  v_fmac_f32 v77, v61, v61
  v_fmac_f32 v78, v62, v62
  v_fmac_f32 v79, v63, v63
  v_add_f32_dpp v72, v72, v72 row_ror:8 row_mask:0xf bank_mask:0xf
  v_add_f32_dpp v73, v73, v73 row_ror:8 row_mask:0xf bank_mask:0xf
  v_add_f32_dpp v74, v74, v74 row_ror:8 row_mask:0xf bank_mask:0xf
  v_add_f32_dpp v75, v75, v75 row_ror:8 row_mask:0xf bank_mask:0xf
  v_add_f32_dpp v76, v76, v76 row_ror:8 row_mask:0xf bank_mask:0xf
  v_add_f32_dpp v77, v77, v77 row_ror:8 row_mask:0xf bank_mask:0xf
  v_add_f32_dpp v78, v78, v78 row_ror:8 row_mask:0xf bank_mask:0xf
  v_add_f32_dpp v79, v79, v79 row_ror:8 row_mask:0xf bank_mask:0xf
  v_add_f32_dpp v72, v72, v72 row_ror:4 row_mask:0xf bank_mask:0xf
  v_add_f32_dpp v73, v73, v73 row_ror:4 row_mask:0xf bank_mask:0xf
  v_add_f32_dpp v74, v74, v74 row_ror:4 row_mask:0xf bank_mask:0xf
  v_add_f32_dpp v75, v75, v75 row_ror:4 row_mask:0xf bank_mask:0xf
  v_add_f32_dpp v76, v76, v76 row_ror:4 row_mask:0xf bank_mask:0xf
  v_add_f32_dpp v77, v77, v77 row_ror:4 row_mask:0xf bank_mask:0xf
  v_add_f32_dpp v78, v78, v78 row_ror:4 row_mask:0xf bank_mask:0xf
  v_add_f32_dpp v79, v79, v79 row_ror:4 row_mask:0xf bank_mask:0xf
  v_add_f32_dpp v72, v72, v72 row_ror:2 row_mask:0xf bank_mask:0xf
  v_add_f32_dpp v73, v73, v73 row_ror:2 row_mask:0xf bank_mask:0xf
  v_add_f32_dpp v74, v74, v74 row_ror:2 row_mask:0xf bank_mask:0xf
  v_add_f32_dpp v75, v75, v75 row_ror:2 row_mask:0xf bank_mask:0xf
  v_add_f32_dpp v76, v76, v76 row_ror:2 row_mask:0xf bank_mask:0xf
  v_add_f32_dpp v77, v77, v77 row_ror:2 row_mask:0xf bank_mask:0xf
  v_add_f32_dpp v78, v78, v78 row_ror:2 row_mask:0xf bank_mask:0xf
  v_add_f32_dpp v79, v79, v79 row_ror:2 row_mask:0xf bank_mask:0xf
  v_add_f32_dpp v72, v72, v72 row_ror:1 row_mask:0xf bank_mask:0xf
  v_add_f32_dpp v73, v73, v73 row_ror:1 row_mask:0xf bank_mask:0xf
  v_add_f32_dpp v74, v74, v74 row_ror:1 row_mask:0xf bank_mask:0xf
  v_add_f32_dpp v75, v75, v75 row_ror:1 row_mask:0xf bank_mask:0xf
  v_add_f32_dpp v76, v76, v76 row_ror:1 row_mask:0xf bank_mask:0xf
  v_add_f32_dpp v77, v77, v77 row_ror:1 row_mask:0xf bank_mask:0xf
  v_add_f32_dpp v78, v78, v78 row_ror:1 row_mask:0xf bank_mask:0xf
  v_add_f32_dpp v79, v79, v79 row_ror:1 row_mask:0xf bank_mask:0xf
  s_lshl_b32 s19, s3, 8
  s_add_u32 s19, s19, 40960
  v_lshlrev_b32 v7, 2, v0
  v_add_u32 v7, s19, v7
  s_mov_b32 exec_lo, 0x00010001
  s_mov_b32 exec_hi, 0x00010001
  ds_write_b128 v7, v[64:67] offset:0
  ds_write_b128 v7, v[68:71] offset:16
  ds_write_b128 v7, v[72:75] offset:32
  ds_write_b128 v7, v[76:79] offset:48
  s_mov_b64 exec, -1
  v_lshlrev_b32 v9, 2, v0
  s_mul_i32 s19, s36, 1536
  s_add_u32 s19, s19, 212860928
  s_lshl_b32 s20, s35, 8
  s_add_u32 s20, s20, s19
  s_waitcnt lgkmcnt(0)
  s_barrier
  s_cmp_lg_u32 s3, 0
  s_cbranch_scc1 wz_96
  ds_read_b32 v64, v9 offset:40960
  ds_read_b32 v65, v9 offset:41216
  ds_read_b32 v66, v9 offset:41472
  ds_read_b32 v67, v9 offset:41728
  s_waitcnt lgkmcnt(0)
  v_add_f32 v64, v64, v65
  v_add_f32 v66, v66, v67
  v_add_f32 v64, v64, v66
  v_min_u32 v64, -2, v64
  s_cmp_lg_u32 s37, 0
  s_cbranch_scc1 wz_98
  buffer_store_dword v64, v9, s[4:7], s20 offen offset:0
  s_branch wz_97
wz_98:
  buffer_store_dword v64, v9, s[4:7], s20 offen offset:0 sc1
wz_97:
  buffer_load_dword v64, v9, s[4:7], s19 offen offset:0 sc1
  buffer_load_dword v65, v9, s[4:7], s19 offen offset:256 sc1
  buffer_load_dword v66, v9, s[4:7], s19 offen offset:512 sc1
  buffer_load_dword v67, v9, s[4:7], s19 offen offset:768 sc1
  buffer_load_dword v68, v9, s[4:7], s19 offen offset:1024 sc1
  buffer_load_dword v69, v9, s[4:7], s19 offen offset:1280 sc1
  s_add_u32 s11, s11, 1
  s_cmp_gt_u32 s11, 131072
  s_cbranch_scc1 mega_done
  s_waitcnt vmcnt(0)
  v_max3_u32 v7, v64, v65, v66
  v_max3_u32 v8, v67, v68, v69
  v_max_u32 v7, v7, v8
  v_cmp_eq_u32 vcc, -1, v7
  s_cbranch_vccnz wz_97
  v_add_f32 v64, v64, v65
  v_add_f32 v66, v66, v67
  v_add_f32 v68, v68, v69
  v_add_f32 v64, v64, v66
  v_add_f32 v64, v64, v68
  v_mul_f32 v64, 0x3aaaaaab, v64
  s_nop 1
  v_mov_b32_dpp v65, v64 row_shl:4 row_mask:0xf bank_mask:0x5
  s_nop 1
  v_mov_b32_dpp v65, v64 row_shr:4 row_mask:0xf bank_mask:0xa
  s_mov_b32 vcc_lo, 0xf0f0f0f0
  s_mov_b32 vcc_hi, 0xf0f0f0f0
  v_cndmask_b32 v66, v64, v65, vcc
  v_cndmask_b32 v67, v65, v64, vcc
  v_fma_f32 v67, -v66, v66, v67
  v_max_f32 v67, 0, v67
  v_add_f32 v67, 0x3727c5ac, v67
  v_rsq_f32 v67, v67
  s_nop 0
  v_mul_f32 v66, v66, v67
  v_cndmask_b32 v66, v66, v67, vcc
  ds_write_b32 v9, v66 offset:41984
  s_waitcnt lgkmcnt(0)
wz_96:
  v_and_b32 v7, 0xc0, v9
  s_barrier
  ds_read_b128 v[64:67], v7 offset:41984
  ds_read_b128 v[68:71], v7 offset:42000
  ds_read_b128 v[72:75], v7 offset:42016
  ds_read_b128 v[76:79], v7 offset:42032
  s_waitcnt lgkmcnt(0)
  v_fma_f32 v48, v48, v68, -v64
  v_fma_f32 v49, v49, v69, -v65
  v_fma_f32 v50, v50, v70, -v66
  v_fma_f32 v51, v51, v71, -v67
  v_cvt_pk_bf16_f32 v80, v48, v49
  v_cvt_pk_bf16_f32 v81, v50, v51
  v_fma_f32 v56, v56, v76, -v72
  v_fma_f32 v57, v57, v77, -v73
  v_fma_f32 v58, v58, v78, -v74
  v_fma_f32 v59, v59, v79, -v75
  v_cvt_pk_bf16_f32 v82, v56, v57
  v_cvt_pk_bf16_f32 v83, v58, v59
  buffer_store_dwordx4 v[80:83], v2, s[4:7], s13 offen offset:0 sc1
  v_fma_f32 v52, v52, v68, -v64
  v_fma_f32 v53, v53, v69, -v65
  v_fma_f32 v54, v54, v70, -v66
  v_fma_f32 v55, v55, v71, -v67
  v_cvt_pk_bf16_f32 v84, v52, v53
  v_cvt_pk_bf16_f32 v85, v54, v55
  v_fma_f32 v60, v60, v76, -v72
  v_fma_f32 v61, v61, v77, -v73
  v_fma_f32 v62, v62, v78, -v74
  v_fma_f32 v63, v63, v79, -v75
  v_cvt_pk_bf16_f32 v86, v60, v61
  v_cvt_pk_bf16_f32 v87, v62, v63
  buffer_store_dwordx4 v[84:87], v2, s[4:7], s13 offen offset:1024 sc1
  s_waitcnt vmcnt(0)
  s_barrier
  s_cmp_lg_u32 s3, 0
  s_cbranch_scc1 wz_99
  v_mov_b32 v7, s15
  s_mov_b64 exec, 1
  buffer_store_dword v7, off, s[4:7], s30 sc1
  s_mov_b64 exec, -1
wz_99:
  s_add_u32 s36, s36, 2
  s_cmp_lt_u32 s36, 64
  s_cbranch_scc1 win2_loop
  s_mov_b32 s41, 3
  s_branch mega_out2
mega_A:
  v_lshlrev_b32 v1, 4, v0
  s_lshl_b32 s12, s3, 10
  v_add_u32 v2, s12, v1
  s_and_b32 s32, s12, 1024
  s_xor_b32 s13, s12, 1024
  v_add_u32 v4, s13, v1
  s_xor_b32 s13, s12, 2048
  v_add_u32 v5, s13, v1
  s_xor_b32 s13, s12, 3072
  v_add_u32 v6, s13, v1
  s_mov_b32 s52, 0xff00ff00
  s_mov_b32 s53, 0xff00ff00
  v_mov_b32 v8, 0x4444
  v_mov_b32 v9, 0xeeee
  v_cndmask_b32 v8, v8, v9, s[52:53]
  s_mul_i32 s13, s3, 20480
  s_add_u32 s13, s13, 81920
  v_add_u32 v11, s13, v1
  s_lshl_b32 s26, s8, 3
  s_add_u32 s26, s26, s9
  s_mov_b32 s68, 0x00003f80
  s_mov_b32 s69, 0x3f800000
  s_lshl_b32 s27, s8, 18
  s_add_u32 s27, s27, 213909504
  s_mov_b32 s28, 0
  s_mov_b32 s29, 0
  s_add_u32 s30, s27, 0
  s_add_u32 s31, s30, 4096
  s_add_u32 s32, s32, s30
  s_add_u32 s32, s32, 8192
  s_mov_b32 s10, 0
  s_and_b32 s12, s3, 1
  s_mul_i32 s13, s3, 3
  s_add_u32 s14, s13, s12
  s_lshl_b32 s63, s14, 9
  s_lshl_b32 s14, s14, 7
  s_lshl_b32 s15, s12, 1
  s_sub_u32 s15, s13, s15
  s_add_u32 s15, s15, 2
  s_lshl_b32 s15, s15, 7
  s_lshl_b32 s65, s12, 11
  s_sub_u32 s65, 1024, s65
  v_lshrrev_b32 v16, 4, v0
  v_and_b32 v17, 1, v16
  v_mul_u32_u24 v9, 1568, v17
  v_and_b32 v17, 15, v0
  v_lshl_add_u32 v9, v17, 3, v9
  v_lshrrev_b32 v17, 5, v0
  v_lshl_add_u32 v3, v17, 2, v9
  v_add_u32 v3, s15, v3
  v_lshl_add_u32 v9, v17, 7, v9
  v_add_u32 v9, s14, v9
  v_and_b32 v18, 3, v0
  v_mul_u32_u24 v10, 1536, v18
  v_and_b32 v17, 1, v18
  v_lshl_add_u32 v10, v17, 5, v10
  v_lshrrev_b32 v17, 1, v18
  v_lshl_add_u32 v10, v17, 7, v10
  v_bfe_u32 v17, v0, 2, 2
  v_lshl_add_u32 v17, v16, 3, v17
  v_lshl_add_u32 v10, v17, 3, v10
  v_add_u32 v12, 24576, v1
  v_add_u32 v12, s63, v12
  v_and_b32 v18, 1, v0
  v_mul_u32_u24 v15, 1536, v18
  v_and_b32 v17, 1, v18
  v_lshl_add_u32 v15, v17, 5, v15
  v_lshrrev_b32 v17, 1, v18
  v_lshl_add_u32 v15, v17, 7, v15
  v_bfe_u32 v17, v0, 2, 2
  v_lshl_add_u32 v17, v16, 3, v17
  v_lshl_add_u32 v15, v17, 3, v15
  s_and_b32 s15, s15, 0xffffff00
  v_add_u32 v7, s15, v15
  v_add_u32 v15, s14, v15
  v_lshrrev_b32 v17, 5, v0
  v_cmp_eq_u32 vcc, s12, v17
  v_mov_b32 v17, 6400
  s_nop 0
  v_cndmask_b32 v7, v17, v7, vcc
  v_and_b32 v17, 15, v0
  v_lshlrev_b32 v13, 4, v17
  v_and_b32 v17, 1, v16
  v_lshl_add_u32 v13, v17, 3, v13
  v_and_b32 v17, 15, v0
  s_sub_u32 s12, s3, 1
  s_lshl_b32 s12, s12, 4
  v_add_u32 v17, s12, v17
  v_lshlrev_b32 v18, 2, v16
  v_add_u32 v18, 0, v18
  v_cmp_le_i32 s[34:35], v18, v17
  v_lshlrev_b32 v18, 2, v16
  v_add_u32 v18, 1, v18
  v_cmp_le_i32 s[36:37], v18, v17
  v_lshlrev_b32 v18, 2, v16
  v_add_u32 v18, 2, v18
  v_cmp_le_i32 s[38:39], v18, v17
  v_lshlrev_b32 v18, 2, v16
  v_add_u32 v18, 3, v18
  v_cmp_le_i32 s[40:41], v18, v17
  v_lshlrev_b32 v18, 2, v16
  v_add_u32 v18, 16, v18
  v_cmp_le_i32 s[42:43], v18, v17
  v_lshlrev_b32 v18, 2, v16
  v_add_u32 v18, 17, v18
  v_cmp_le_i32 s[44:45], v18, v17
  v_lshlrev_b32 v18, 2, v16
  v_add_u32 v18, 18, v18
  v_cmp_le_i32 s[46:47], v18, v17
  v_lshlrev_b32 v18, 2, v16
  v_add_u32 v18, 19, v18
  v_cmp_le_i32 s[48:49], v18, v17
  s_mov_b32 s50, 0
  s_mov_b32 s51, -1
  s_mov_b32 s70, 0x3dd53b95
  v_bfe_u32 v17, v0, 4, 1
  v_lshlrev_b32 v17, 2, v17
  v_sub_u32 v14, v13, v17
  s_cmp_lg_u32 s3, 0
  s_cbranch_scc1 a_i_100
  v_lshrrev_b32 v18, 5, v0
  v_lshl_add_u32 v13, v18, 8, v13
a_i_100:
  s_mul_i32 s12, s26, 12288
  s_add_u32 s56, s12, 31457280
  s_add_u32 s57, s12, 6291456
  s_lshl_b32 s58, s9, 9
  s_add_u32 s58, s58, 16384
  s_lshr_b32 s13, s9, 1
  s_lshl_b32 s13, s13, 8
  s_and_b32 s14, s9, 1
  s_lshl_b32 s14, s14, 3
  s_add_u32 s59, s13, s14
  s_add_u32 s59, s59, 20480
  s_sub_u32 s12, s3, 1
  s_and_b32 s12, s12, 1
  s_mul_i32 s12, s12, 10240
  s_add_u32 s12, s12, 32768
  s_add_u32 s12, s12, s27
  s_lshl_b32 s60, s9, 10
  s_add_u32 s60, s60, s12
  s_lshl_b32 s61, s9, 8
  s_add_u32 s61, s61, s12
  s_add_u32 s61, s61, 8192
  s_add_u32 s58, s58, s27
  s_add_u32 s59, s59, s27
  s_mul_i32 s12, s3, 3072
  s_add_u32 s56, s56, s12
  s_add_u32 s57, s57, s12
  s_add_u32 s62, s12, 24576
  s_load_dwordx4 s[20:23], s[0:1], 16
  s_mul_i32 s12, s26, 384
  s_waitcnt lgkmcnt(0)
  s_add_u32 s20, s20, s12
  s_addc_u32 s21, s21, 0
  s_add_u32 s22, s22, s12
  s_addc_u32 s23, s23, 0
  v_add_u32 v26, 0, v0
  v_mul_u32_u24 v27, 2731, v26
  v_lshrrev_b32 v27, 16, v27
  v_mul_u32_u24 v16, 24, v27
  v_sub_u32 v26, v26, v16
  v_lshrrev_b32 v16, 1, v27
  v_and_b32 v16, 6, v16
  v_xor_b32 v26, v26, v16
  v_mul_u32_u24 v16, 12288, v27
  v_lshl_add_u32 v16, v26, 4, v16
  v_add_u32 v26, 64, v0
  v_mul_u32_u24 v27, 2731, v26
  v_lshrrev_b32 v27, 16, v27
  v_mul_u32_u24 v17, 24, v27
  v_sub_u32 v26, v26, v17
  v_lshrrev_b32 v17, 1, v27
  v_and_b32 v17, 6, v17
  v_xor_b32 v26, v26, v17
  v_mul_u32_u24 v17, 12288, v27
  v_lshl_add_u32 v17, v26, 4, v17
  v_add_u32 v26, 128, v0
  v_mul_u32_u24 v27, 2731, v26
  v_lshrrev_b32 v27, 16, v27
  v_mul_u32_u24 v18, 24, v27
  v_sub_u32 v26, v26, v18
  v_lshrrev_b32 v18, 1, v27
  v_and_b32 v18, 6, v18
  v_xor_b32 v26, v26, v18
  v_mul_u32_u24 v18, 12288, v27
  v_lshl_add_u32 v18, v26, 4, v18
  v_add_u32 v26, 192, v0
  v_mul_u32_u24 v27, 2731, v26
  v_lshrrev_b32 v27, 16, v27
  v_mul_u32_u24 v19, 24, v27
  v_sub_u32 v26, v26, v19
  v_lshrrev_b32 v19, 1, v27
  v_and_b32 v19, 6, v19
  v_xor_b32 v26, v26, v19
  v_mul_u32_u24 v19, 12288, v27
  v_lshl_add_u32 v19, v26, 4, v19
  v_add_u32 v26, 256, v0
  v_mul_u32_u24 v27, 2731, v26
  v_lshrrev_b32 v27, 16, v27
  v_mul_u32_u24 v20, 24, v27
  v_sub_u32 v26, v26, v20
  v_lshrrev_b32 v20, 1, v27
  v_and_b32 v20, 6, v20
  v_xor_b32 v26, v26, v20
  v_mul_u32_u24 v20, 12288, v27
  v_lshl_add_u32 v20, v26, 4, v20
  v_add_u32 v26, 320, v0
  v_mul_u32_u24 v27, 2731, v26
  v_lshrrev_b32 v27, 16, v27
  v_mul_u32_u24 v21, 24, v27
  v_sub_u32 v26, v26, v21
  v_lshrrev_b32 v21, 1, v27
  v_and_b32 v21, 6, v21
  v_xor_b32 v26, v26, v21
  v_mul_u32_u24 v21, 12288, v27
  v_lshl_add_u32 v21, v26, 4, v21
  v_bfe_u32 v27, v0, 4, 1
  v_bfe_u32 v26, v0, 3, 1
  v_lshl_add_u32 v27, v26, 1, v27
  v_lshlrev_b32 v22, 1, v27
  v_bfe_u32 v26, v0, 1, 1
  v_add_u32 v26, 0, v26
  v_xor_b32 v22, v22, v26
  v_lshlrev_b32 v22, 4, v22
  v_and_b32 v26, 1, v0
  v_lshl_add_u32 v22, v26, 3, v22
  v_lshlrev_b32 v27, 2, v27
  v_bfe_u32 v26, v0, 2, 1
  v_add_u32 v27, v27, v26
  v_bfe_u32 v26, v0, 5, 1
  v_lshl_add_u32 v27, v26, 4, v27
  v_mul_u32_u24 v27, 384, v27
  v_add_u32 v22, v22, v27
  v_bfe_u32 v27, v0, 4, 1
  v_bfe_u32 v26, v0, 3, 1
  v_lshl_add_u32 v27, v26, 1, v27
  v_lshlrev_b32 v23, 1, v27
  v_bfe_u32 v26, v0, 1, 1
  v_add_u32 v26, 2, v26
  v_xor_b32 v23, v23, v26
  v_lshlrev_b32 v23, 4, v23
  v_and_b32 v26, 1, v0
  v_lshl_add_u32 v23, v26, 3, v23
  v_lshlrev_b32 v27, 2, v27
  v_bfe_u32 v26, v0, 2, 1
  v_add_u32 v27, v27, v26
  v_bfe_u32 v26, v0, 5, 1
  v_lshl_add_u32 v27, v26, 4, v27
  v_mul_u32_u24 v27, 384, v27
  v_add_u32 v23, v23, v27
  v_bfe_u32 v27, v0, 4, 1
  v_bfe_u32 v26, v0, 3, 1
  v_lshl_add_u32 v27, v26, 1, v27
  v_lshlrev_b32 v24, 1, v27
  v_bfe_u32 v26, v0, 1, 1
  v_add_u32 v26, 4, v26
  v_xor_b32 v24, v24, v26
  v_lshlrev_b32 v24, 4, v24
  v_and_b32 v26, 1, v0
  v_lshl_add_u32 v24, v26, 3, v24
  v_lshlrev_b32 v27, 2, v27
  v_bfe_u32 v26, v0, 2, 1
  v_add_u32 v27, v27, v26
  v_bfe_u32 v26, v0, 5, 1
  v_lshl_add_u32 v27, v26, 4, v27
  v_mul_u32_u24 v27, 384, v27
  v_add_u32 v24, v24, v27
  v_bfe_u32 v27, v0, 4, 1
  v_bfe_u32 v26, v0, 3, 1
  v_lshl_add_u32 v27, v26, 1, v27
  v_lshlrev_b32 v25, 1, v27
  v_bfe_u32 v26, v0, 1, 1
  v_add_u32 v26, 6, v26
  v_xor_b32 v25, v25, v26
  v_lshlrev_b32 v25, 4, v25
  v_and_b32 v26, 1, v0
  v_lshl_add_u32 v25, v26, 3, v25
  v_lshlrev_b32 v27, 2, v27
  v_bfe_u32 v26, v0, 2, 1
  v_add_u32 v27, v27, v26
  v_bfe_u32 v26, v0, 5, 1
  v_lshl_add_u32 v27, v26, 4, v27
  v_mul_u32_u24 v27, 384, v27
  v_add_u32 v25, v25, v27
  s_mul_i32 s16, s3, 6144
  s_mul_i32 s12, s3, 196608
  s_add_u32 s20, s20, s12
  s_addc_u32 s21, s21, 0
  s_add_u32 s22, s22, s12
  s_addc_u32 s23, s23, 0
  s_add_u32 m0, s16, 0
  s_nop 0
  global_load_lds_dwordx4 v16, s[20:21]
  s_add_u32 m0, s16, 1024
  s_nop 0
  global_load_lds_dwordx4 v17, s[20:21]
  s_add_u32 m0, s16, 2048
  s_nop 0
  global_load_lds_dwordx4 v18, s[20:21]
  s_add_u32 m0, s16, 3072
  s_nop 0
  global_load_lds_dwordx4 v19, s[20:21]
  s_add_u32 m0, s16, 4096
  s_nop 0
  global_load_lds_dwordx4 v20, s[20:21]
  s_add_u32 m0, s16, 5120
  s_nop 0
  global_load_lds_dwordx4 v21, s[20:21]
  s_add_u32 s20, s20, 786432
  s_addc_u32 s21, s21, 0
  s_add_u32 m0, s16, 24576
  s_nop 0
  global_load_lds_dwordx4 v16, s[20:21]
  s_add_u32 m0, s16, 25600
  s_nop 0
  global_load_lds_dwordx4 v17, s[20:21]
  s_add_u32 m0, s16, 26624
  s_nop 0
  global_load_lds_dwordx4 v18, s[20:21]
  s_add_u32 m0, s16, 27648
  s_nop 0
  global_load_lds_dwordx4 v19, s[20:21]
  s_add_u32 m0, s16, 28672
  s_nop 0
  global_load_lds_dwordx4 v20, s[20:21]
  s_add_u32 m0, s16, 29696
  s_nop 0
  global_load_lds_dwordx4 v21, s[20:21]
  s_add_u32 s20, s20, 786432
  s_addc_u32 s21, s21, 0
  s_add_u32 m0, s16, 49152
  s_nop 0
  global_load_lds_dwordx4 v16, s[20:21]
  s_add_u32 m0, s16, 50176
  s_nop 0
  global_load_lds_dwordx4 v17, s[20:21]
  s_add_u32 m0, s16, 51200
  s_nop 0
  global_load_lds_dwordx4 v18, s[20:21]
  s_add_u32 m0, s16, 52224
  s_nop 0
  global_load_lds_dwordx4 v19, s[20:21]
  s_add_u32 m0, s16, 53248
  s_nop 0
  global_load_lds_dwordx4 v20, s[20:21]
  s_add_u32 m0, s16, 54272
  s_nop 0
  global_load_lds_dwordx4 v21, s[20:21]
  s_add_u32 s20, s20, 786432
  s_addc_u32 s21, s21, 0
  s_cmp_eq_u32 s3, 1
  s_cbranch_scc1 lw_102
  s_cmp_eq_u32 s3, 2
  s_cbranch_scc1 lw_103
  s_cmp_eq_u32 s3, 3
  s_cbranch_scc1 lw_104
lw_101:
  s_waitcnt vmcnt(12)
  s_barrier
  ds_read_b64_tr_b16 v[80:81], v22 offset:0
  ds_read_b64_tr_b16 v[82:83], v22 offset:768
  ds_read_b64_tr_b16 v[84:85], v22 offset:12288
  ds_read_b64_tr_b16 v[86:87], v22 offset:13056
  s_waitcnt lgkmcnt(0)
  ds_write_b128 v11, v[80:83] offset:0
  ds_write_b128 v11, v[84:87] offset:1024
  s_waitcnt lgkmcnt(0)
  ds_read_b64_tr_b16 v[80:81], v23 offset:0
  ds_read_b64_tr_b16 v[82:83], v23 offset:768
  ds_read_b64_tr_b16 v[84:85], v23 offset:12288
  ds_read_b64_tr_b16 v[86:87], v23 offset:13056
  s_waitcnt lgkmcnt(0)
  ds_write_b128 v11, v[80:83] offset:2048
  ds_write_b128 v11, v[84:87] offset:3072
  s_waitcnt lgkmcnt(0)
  ds_read_b64_tr_b16 v[80:81], v24 offset:0
  ds_read_b64_tr_b16 v[82:83], v24 offset:768
  ds_read_b64_tr_b16 v[84:85], v24 offset:12288
  ds_read_b64_tr_b16 v[86:87], v24 offset:13056
  s_waitcnt lgkmcnt(0)
  ds_write_b128 v11, v[80:83] offset:4096
  ds_write_b128 v11, v[84:87] offset:5120
  s_waitcnt lgkmcnt(0)
  s_waitcnt lgkmcnt(0)
  s_barrier
  s_add_u32 m0, s16, 0
  s_nop 0
  global_load_lds_dwordx4 v16, s[20:21]
  s_add_u32 m0, s16, 1024
  s_nop 0
  global_load_lds_dwordx4 v17, s[20:21]
  s_add_u32 m0, s16, 2048
  s_nop 0
  global_load_lds_dwordx4 v18, s[20:21]
  s_add_u32 m0, s16, 3072
  s_nop 0
  global_load_lds_dwordx4 v19, s[20:21]
  s_add_u32 m0, s16, 4096
  s_nop 0
  global_load_lds_dwordx4 v20, s[20:21]
  s_add_u32 m0, s16, 5120
  s_nop 0
  global_load_lds_dwordx4 v21, s[20:21]
  s_add_u32 s20, s20, 786432
  s_addc_u32 s21, s21, 0
  s_waitcnt vmcnt(12)
  s_barrier
  ds_read_b64_tr_b16 a[64:65], v22 offset:24576
  ds_read_b64_tr_b16 a[66:67], v22 offset:25344
  ds_read_b64_tr_b16 a[68:69], v22 offset:36864
  ds_read_b64_tr_b16 a[70:71], v22 offset:37632
  ds_read_b64_tr_b16 a[72:73], v23 offset:24576
  ds_read_b64_tr_b16 a[74:75], v23 offset:25344
  ds_read_b64_tr_b16 a[76:77], v23 offset:36864
  ds_read_b64_tr_b16 a[78:79], v23 offset:37632
  ds_read_b64_tr_b16 v[80:81], v24 offset:24576
  ds_read_b64_tr_b16 v[82:83], v24 offset:25344
  ds_read_b64_tr_b16 v[84:85], v24 offset:36864
  ds_read_b64_tr_b16 v[86:87], v24 offset:37632
  s_waitcnt lgkmcnt(0)
  ds_write_b128 v11, v[80:83] offset:18432
  ds_write_b128 v11, v[84:87] offset:19456
  s_waitcnt lgkmcnt(0)
  s_waitcnt lgkmcnt(0)
  s_barrier
  s_add_u32 m0, s16, 24576
  s_nop 0
  global_load_lds_dwordx4 v16, s[20:21]
  s_add_u32 m0, s16, 25600
  s_nop 0
  global_load_lds_dwordx4 v17, s[20:21]
  s_add_u32 m0, s16, 26624
  s_nop 0
  global_load_lds_dwordx4 v18, s[20:21]
  s_add_u32 m0, s16, 27648
  s_nop 0
  global_load_lds_dwordx4 v19, s[20:21]
  s_add_u32 m0, s16, 28672
  s_nop 0
  global_load_lds_dwordx4 v20, s[20:21]
  s_add_u32 m0, s16, 29696
  s_nop 0
  global_load_lds_dwordx4 v21, s[20:21]
  s_add_u32 s20, s20, 786432
  s_addc_u32 s21, s21, 0
  s_waitcnt vmcnt(12)
  s_barrier
  v_add_u32 v22, 49152, v22
  v_add_u32 v23, 49152, v23
  v_add_u32 v24, 49152, v24
  v_add_u32 v25, 49152, v25
  ds_read_b64_tr_b16 a[80:81], v22 offset:0
  ds_read_b64_tr_b16 a[82:83], v22 offset:768
  ds_read_b64_tr_b16 a[84:85], v22 offset:12288
  ds_read_b64_tr_b16 a[86:87], v22 offset:13056
  ds_read_b64_tr_b16 a[88:89], v23 offset:0
  ds_read_b64_tr_b16 a[90:91], v23 offset:768
  ds_read_b64_tr_b16 a[92:93], v23 offset:12288
  ds_read_b64_tr_b16 a[94:95], v23 offset:13056
  ds_read_b64_tr_b16 a[152:153], v24 offset:0
  ds_read_b64_tr_b16 a[154:155], v24 offset:768
  ds_read_b64_tr_b16 a[156:157], v24 offset:12288
  ds_read_b64_tr_b16 a[158:159], v24 offset:13056
  v_subrev_u32 v22, 49152, v22
  v_subrev_u32 v23, 49152, v23
  v_subrev_u32 v24, 49152, v24
  v_subrev_u32 v25, 49152, v25
  s_waitcnt lgkmcnt(0)
  s_barrier
  s_add_u32 m0, s16, 49152
  s_nop 0
  global_load_lds_dwordx4 v16, s[20:21]
  s_add_u32 m0, s16, 50176
  s_nop 0
  global_load_lds_dwordx4 v17, s[20:21]
  s_add_u32 m0, s16, 51200
  s_nop 0
  global_load_lds_dwordx4 v18, s[20:21]
  s_add_u32 m0, s16, 52224
  s_nop 0
  global_load_lds_dwordx4 v19, s[20:21]
  s_add_u32 m0, s16, 53248
  s_nop 0
  global_load_lds_dwordx4 v20, s[20:21]
  s_add_u32 m0, s16, 54272
  s_nop 0
  global_load_lds_dwordx4 v21, s[20:21]
  s_add_u32 s20, s20, 786432
  s_addc_u32 s21, s21, 0
  s_waitcnt vmcnt(12)
  s_barrier
  ds_read_b64_tr_b16 a[96:97], v22 offset:0
  ds_read_b64_tr_b16 a[98:99], v22 offset:768
  ds_read_b64_tr_b16 a[100:101], v22 offset:12288
  ds_read_b64_tr_b16 a[102:103], v22 offset:13056
  ds_read_b64_tr_b16 a[104:105], v23 offset:0
  ds_read_b64_tr_b16 a[106:107], v23 offset:768
  ds_read_b64_tr_b16 a[108:109], v23 offset:12288
  ds_read_b64_tr_b16 a[110:111], v23 offset:13056
  ds_read_b64_tr_b16 a[160:161], v24 offset:0
  ds_read_b64_tr_b16 a[162:163], v24 offset:768
  ds_read_b64_tr_b16 a[164:165], v24 offset:12288
  ds_read_b64_tr_b16 a[166:167], v24 offset:13056
  s_waitcnt lgkmcnt(0)
  s_barrier
  s_add_u32 m0, s16, 0
  s_nop 0
  global_load_lds_dwordx4 v16, s[20:21]
  s_add_u32 m0, s16, 1024
  s_nop 0
  global_load_lds_dwordx4 v17, s[20:21]
  s_add_u32 m0, s16, 2048
  s_nop 0
  global_load_lds_dwordx4 v18, s[20:21]
  s_add_u32 m0, s16, 3072
  s_nop 0
  global_load_lds_dwordx4 v19, s[20:21]
  s_add_u32 m0, s16, 4096
  s_nop 0
  global_load_lds_dwordx4 v20, s[20:21]
  s_add_u32 m0, s16, 5120
  s_nop 0
  global_load_lds_dwordx4 v21, s[20:21]
  s_add_u32 s20, s20, 786432
  s_addc_u32 s21, s21, 0
  s_waitcnt vmcnt(12)
  s_barrier
  ds_read_b64_tr_b16 v[80:81], v22 offset:24576
  ds_read_b64_tr_b16 v[82:83], v22 offset:25344
  ds_read_b64_tr_b16 v[84:85], v22 offset:36864
  ds_read_b64_tr_b16 v[86:87], v22 offset:37632
  s_waitcnt lgkmcnt(0)
  ds_write_b128 v11, v[80:83] offset:6144
  ds_write_b128 v11, v[84:87] offset:7168
  s_waitcnt lgkmcnt(0)
  ds_read_b64_tr_b16 a[0:1], v23 offset:24576
  ds_read_b64_tr_b16 a[2:3], v23 offset:25344
  ds_read_b64_tr_b16 a[4:5], v23 offset:36864
  ds_read_b64_tr_b16 a[6:7], v23 offset:37632
  ds_read_b64_tr_b16 a[8:9], v24 offset:24576
  ds_read_b64_tr_b16 a[10:11], v24 offset:25344
  ds_read_b64_tr_b16 a[12:13], v24 offset:36864
  ds_read_b64_tr_b16 a[14:15], v24 offset:37632
  s_waitcnt lgkmcnt(0)
  s_barrier
  s_add_u32 m0, s16, 24576
  s_nop 0
  global_load_lds_dwordx4 v16, s[20:21]
  s_add_u32 m0, s16, 25600
  s_nop 0
  global_load_lds_dwordx4 v17, s[20:21]
  s_add_u32 m0, s16, 26624
  s_nop 0
  global_load_lds_dwordx4 v18, s[20:21]
  s_add_u32 m0, s16, 27648
  s_nop 0
  global_load_lds_dwordx4 v19, s[20:21]
  s_add_u32 m0, s16, 28672
  s_nop 0
  global_load_lds_dwordx4 v20, s[20:21]
  s_add_u32 m0, s16, 29696
  s_nop 0
  global_load_lds_dwordx4 v21, s[20:21]
  s_add_u32 s20, s20, 786432
  s_addc_u32 s21, s21, 0
  s_waitcnt vmcnt(12)
  s_barrier
  v_add_u32 v22, 49152, v22
  v_add_u32 v23, 49152, v23
  v_add_u32 v24, 49152, v24
  v_add_u32 v25, 49152, v25
  ds_read_b64_tr_b16 a[112:113], v22 offset:0
  ds_read_b64_tr_b16 a[114:115], v22 offset:768
  ds_read_b64_tr_b16 a[116:117], v22 offset:12288
  ds_read_b64_tr_b16 a[118:119], v22 offset:13056
  ds_read_b64_tr_b16 a[120:121], v23 offset:0
  ds_read_b64_tr_b16 a[122:123], v23 offset:768
  ds_read_b64_tr_b16 a[124:125], v23 offset:12288
  ds_read_b64_tr_b16 a[126:127], v23 offset:13056
  ds_read_b64_tr_b16 a[168:169], v24 offset:0
  ds_read_b64_tr_b16 a[170:171], v24 offset:768
  ds_read_b64_tr_b16 a[172:173], v24 offset:12288
  ds_read_b64_tr_b16 a[174:175], v24 offset:13056
  v_subrev_u32 v22, 49152, v22
  v_subrev_u32 v23, 49152, v23
  v_subrev_u32 v24, 49152, v24
  v_subrev_u32 v25, 49152, v25
  s_waitcnt lgkmcnt(0)
  s_barrier
  s_add_u32 m0, s16, 49152
  s_nop 0
  global_load_lds_dwordx4 v16, s[20:21]
  s_add_u32 m0, s16, 50176
  s_nop 0
  global_load_lds_dwordx4 v17, s[20:21]
  s_add_u32 m0, s16, 51200
  s_nop 0
  global_load_lds_dwordx4 v18, s[20:21]
  s_add_u32 m0, s16, 52224
  s_nop 0
  global_load_lds_dwordx4 v19, s[20:21]
  s_add_u32 m0, s16, 53248
  s_nop 0
  global_load_lds_dwordx4 v20, s[20:21]
  s_add_u32 m0, s16, 54272
  s_nop 0
  global_load_lds_dwordx4 v21, s[20:21]
  s_add_u32 s20, s20, 786432
  s_addc_u32 s21, s21, 0
  s_waitcnt vmcnt(12)
  s_barrier
  ds_read_b64_tr_b16 v[80:81], v22 offset:0
  ds_read_b64_tr_b16 v[82:83], v22 offset:768
  ds_read_b64_tr_b16 v[84:85], v22 offset:12288
  ds_read_b64_tr_b16 v[86:87], v22 offset:13056
  s_waitcnt lgkmcnt(0)
  ds_write_b128 v11, v[80:83] offset:12288
  ds_write_b128 v11, v[84:87] offset:13312
  s_waitcnt lgkmcnt(0)
  ds_read_b64_tr_b16 a[128:129], v23 offset:0
  ds_read_b64_tr_b16 a[130:131], v23 offset:768
  ds_read_b64_tr_b16 a[132:133], v23 offset:12288
  ds_read_b64_tr_b16 a[134:135], v23 offset:13056
  ds_read_b64_tr_b16 a[176:177], v24 offset:0
  ds_read_b64_tr_b16 a[178:179], v24 offset:768
  ds_read_b64_tr_b16 a[180:181], v24 offset:12288
  ds_read_b64_tr_b16 a[182:183], v24 offset:13056
  s_waitcnt lgkmcnt(0)
  s_barrier
  s_add_u32 m0, s16, 0
  s_nop 0
  global_load_lds_dwordx4 v16, s[20:21]
  s_add_u32 m0, s16, 1024
  s_nop 0
  global_load_lds_dwordx4 v17, s[20:21]
  s_add_u32 m0, s16, 2048
  s_nop 0
  global_load_lds_dwordx4 v18, s[20:21]
  s_add_u32 m0, s16, 3072
  s_nop 0
  global_load_lds_dwordx4 v19, s[20:21]
  s_add_u32 m0, s16, 4096
  s_nop 0
  global_load_lds_dwordx4 v20, s[20:21]
  s_add_u32 m0, s16, 5120
  s_nop 0
  global_load_lds_dwordx4 v21, s[20:21]
  s_add_u32 s20, s20, 786432
  s_addc_u32 s21, s21, 0
  s_waitcnt vmcnt(12)
  s_barrier
  ds_read_b64_tr_b16 v[80:81], v22 offset:24576
  ds_read_b64_tr_b16 v[82:83], v22 offset:25344
  ds_read_b64_tr_b16 v[84:85], v22 offset:36864
  ds_read_b64_tr_b16 v[86:87], v22 offset:37632
  s_waitcnt lgkmcnt(0)
  ds_write_b128 v11, v[80:83] offset:14336
  ds_write_b128 v11, v[84:87] offset:15360
  s_waitcnt lgkmcnt(0)
  ds_read_b64_tr_b16 a[136:137], v23 offset:24576
  ds_read_b64_tr_b16 a[138:139], v23 offset:25344
  ds_read_b64_tr_b16 a[140:141], v23 offset:36864
  ds_read_b64_tr_b16 a[142:143], v23 offset:37632
  ds_read_b64_tr_b16 a[184:185], v24 offset:24576
  ds_read_b64_tr_b16 a[186:187], v24 offset:25344
  ds_read_b64_tr_b16 a[188:189], v24 offset:36864
  ds_read_b64_tr_b16 a[190:191], v24 offset:37632
  s_waitcnt lgkmcnt(0)
  s_barrier
  s_add_u32 m0, s16, 24576
  s_nop 0
  global_load_lds_dwordx4 v16, s[22:23]
  s_add_u32 m0, s16, 25600
  s_nop 0
  global_load_lds_dwordx4 v17, s[22:23]
  s_add_u32 m0, s16, 26624
  s_nop 0
  global_load_lds_dwordx4 v18, s[22:23]
  s_add_u32 m0, s16, 27648
  s_nop 0
  global_load_lds_dwordx4 v19, s[22:23]
  s_add_u32 m0, s16, 28672
  s_nop 0
  global_load_lds_dwordx4 v20, s[22:23]
  s_add_u32 m0, s16, 29696
  s_nop 0
  global_load_lds_dwordx4 v21, s[22:23]
  s_add_u32 s22, s22, 786432
  s_addc_u32 s23, s23, 0
  s_waitcnt vmcnt(12)
  s_barrier
  v_add_u32 v22, 49152, v22
  v_add_u32 v23, 49152, v23
  v_add_u32 v24, 49152, v24
  v_add_u32 v25, 49152, v25
  ds_read_b64_tr_b16 a[16:17], v22 offset:0
  ds_read_b64_tr_b16 a[18:19], v22 offset:768
  ds_read_b64_tr_b16 a[20:21], v22 offset:12288
  ds_read_b64_tr_b16 a[22:23], v22 offset:13056
  ds_read_b64_tr_b16 a[24:25], v23 offset:0
  ds_read_b64_tr_b16 a[26:27], v23 offset:768
  ds_read_b64_tr_b16 a[28:29], v23 offset:12288
  ds_read_b64_tr_b16 a[30:31], v23 offset:13056
  ds_read_b64_tr_b16 a[32:33], v24 offset:0
  ds_read_b64_tr_b16 a[34:35], v24 offset:768
  ds_read_b64_tr_b16 a[36:37], v24 offset:12288
  ds_read_b64_tr_b16 a[38:39], v24 offset:13056
  v_subrev_u32 v22, 49152, v22
  v_subrev_u32 v23, 49152, v23
  v_subrev_u32 v24, 49152, v24
  v_subrev_u32 v25, 49152, v25
  s_waitcnt lgkmcnt(0)
  s_barrier
  s_add_u32 m0, s16, 49152
  s_nop 0
  global_load_lds_dwordx4 v16, s[22:23]
  s_add_u32 m0, s16, 50176
  s_nop 0
  global_load_lds_dwordx4 v17, s[22:23]
  s_add_u32 m0, s16, 51200
  s_nop 0
  global_load_lds_dwordx4 v18, s[22:23]
  s_add_u32 m0, s16, 52224
  s_nop 0
  global_load_lds_dwordx4 v19, s[22:23]
  s_add_u32 m0, s16, 53248
  s_nop 0
  global_load_lds_dwordx4 v20, s[22:23]
  s_add_u32 m0, s16, 54272
  s_nop 0
  global_load_lds_dwordx4 v21, s[22:23]
  s_add_u32 s22, s22, 786432
  s_addc_u32 s23, s23, 0
  s_waitcnt vmcnt(12)
  s_barrier
  ds_read_b64_tr_b16 v[80:81], v22 offset:0
  ds_read_b64_tr_b16 v[82:83], v22 offset:768
  ds_read_b64_tr_b16 v[84:85], v22 offset:12288
  ds_read_b64_tr_b16 v[86:87], v22 offset:13056
  s_waitcnt lgkmcnt(0)
  ds_write_b128 v11, v[80:83] offset:16384
  ds_write_b128 v11, v[84:87] offset:17408
  s_waitcnt lgkmcnt(0)
  ds_read_b64_tr_b16 a[144:145], v23 offset:0
  ds_read_b64_tr_b16 a[146:147], v23 offset:768
  ds_read_b64_tr_b16 a[148:149], v23 offset:12288
  ds_read_b64_tr_b16 a[150:151], v23 offset:13056
  ds_read_b64_tr_b16 a[192:193], v24 offset:0
  ds_read_b64_tr_b16 a[194:195], v24 offset:768
  ds_read_b64_tr_b16 a[196:197], v24 offset:12288
  ds_read_b64_tr_b16 a[198:199], v24 offset:13056
  s_waitcnt lgkmcnt(0)
  s_barrier
  s_add_u32 m0, s16, 0
  s_nop 0
  global_load_lds_dwordx4 v16, s[22:23]
  s_add_u32 m0, s16, 1024
  s_nop 0
  global_load_lds_dwordx4 v17, s[22:23]
  s_add_u32 m0, s16, 2048
  s_nop 0
  global_load_lds_dwordx4 v18, s[22:23]
  s_add_u32 m0, s16, 3072
  s_nop 0
  global_load_lds_dwordx4 v19, s[22:23]
  s_add_u32 m0, s16, 4096
  s_nop 0
  global_load_lds_dwordx4 v20, s[22:23]
  s_add_u32 m0, s16, 5120
  s_nop 0
  global_load_lds_dwordx4 v21, s[22:23]
  s_add_u32 s22, s22, 786432
  s_addc_u32 s23, s23, 0
  s_waitcnt vmcnt(12)
  s_barrier
  ds_read_b64_tr_b16 a[40:41], v24 offset:24576
  ds_read_b64_tr_b16 a[42:43], v24 offset:25344
  ds_read_b64_tr_b16 a[44:45], v24 offset:36864
  ds_read_b64_tr_b16 a[46:47], v24 offset:37632
  ds_read_b64_tr_b16 a[56:57], v22 offset:24576
  ds_read_b64_tr_b16 a[58:59], v22 offset:25344
  ds_read_b64_tr_b16 a[60:61], v22 offset:36864
  ds_read_b64_tr_b16 a[62:63], v22 offset:37632
  ds_read_b64_tr_b16 v[120:121], v23 offset:24576
  ds_read_b64_tr_b16 v[122:123], v23 offset:25344
  ds_read_b64_tr_b16 v[124:125], v23 offset:36864
  ds_read_b64_tr_b16 v[126:127], v23 offset:37632
  s_waitcnt lgkmcnt(0)
  s_barrier
  s_add_u32 m0, s16, 24576
  s_nop 0
  global_load_lds_dwordx4 v16, s[22:23]
  s_add_u32 m0, s16, 25600
  s_nop 0
  global_load_lds_dwordx4 v17, s[22:23]
  s_add_u32 m0, s16, 26624
  s_nop 0
  global_load_lds_dwordx4 v18, s[22:23]
  s_add_u32 m0, s16, 27648
  s_nop 0
  global_load_lds_dwordx4 v19, s[22:23]
  s_add_u32 m0, s16, 28672
  s_nop 0
  global_load_lds_dwordx4 v20, s[22:23]
  s_add_u32 m0, s16, 29696
  s_nop 0
  global_load_lds_dwordx4 v21, s[22:23]
  s_add_u32 s22, s22, 786432
  s_addc_u32 s23, s23, 0
  s_waitcnt vmcnt(12)
  s_barrier
  v_add_u32 v22, 49152, v22
  v_add_u32 v23, 49152, v23
  v_add_u32 v24, 49152, v24
  v_add_u32 v25, 49152, v25
  ds_read_b64_tr_b16 a[200:201], v24 offset:0
  ds_read_b64_tr_b16 a[202:203], v24 offset:768
  ds_read_b64_tr_b16 a[204:205], v24 offset:12288
  ds_read_b64_tr_b16 a[206:207], v24 offset:13056
  ds_read_b64_tr_b16 v[144:145], v22 offset:0
  ds_read_b64_tr_b16 v[146:147], v22 offset:768
  ds_read_b64_tr_b16 v[148:149], v22 offset:12288
  ds_read_b64_tr_b16 v[150:151], v22 offset:13056
  ds_read_b64_tr_b16 v[152:153], v23 offset:0
  ds_read_b64_tr_b16 v[154:155], v23 offset:768
  ds_read_b64_tr_b16 v[156:157], v23 offset:12288
  ds_read_b64_tr_b16 v[158:159], v23 offset:13056
  v_subrev_u32 v22, 49152, v22
  v_subrev_u32 v23, 49152, v23
  v_subrev_u32 v24, 49152, v24
  v_subrev_u32 v25, 49152, v25
  s_waitcnt lgkmcnt(0)
  s_barrier
  s_add_u32 m0, s16, 49152
  s_nop 0
  global_load_lds_dwordx4 v16, s[22:23]
  s_add_u32 m0, s16, 50176
  s_nop 0
  global_load_lds_dwordx4 v17, s[22:23]
  s_add_u32 m0, s16, 51200
  s_nop 0
  global_load_lds_dwordx4 v18, s[22:23]
  s_add_u32 m0, s16, 52224
  s_nop 0
  global_load_lds_dwordx4 v19, s[22:23]
  s_add_u32 m0, s16, 53248
  s_nop 0
  global_load_lds_dwordx4 v20, s[22:23]
  s_add_u32 m0, s16, 54272
  s_nop 0
  global_load_lds_dwordx4 v21, s[22:23]
  s_add_u32 s22, s22, 786432
  s_addc_u32 s23, s23, 0
  s_waitcnt vmcnt(12)
  s_barrier
  ds_read_b64_tr_b16 a[208:209], v24 offset:0
  ds_read_b64_tr_b16 a[210:211], v24 offset:768
  ds_read_b64_tr_b16 a[212:213], v24 offset:12288
  ds_read_b64_tr_b16 a[214:215], v24 offset:13056
  ds_read_b64_tr_b16 v[160:161], v22 offset:0
  ds_read_b64_tr_b16 v[162:163], v22 offset:768
  ds_read_b64_tr_b16 v[164:165], v22 offset:12288
  ds_read_b64_tr_b16 v[166:167], v22 offset:13056
  ds_read_b64_tr_b16 v[168:169], v23 offset:0
  ds_read_b64_tr_b16 v[170:171], v23 offset:768
  ds_read_b64_tr_b16 v[172:173], v23 offset:12288
  ds_read_b64_tr_b16 v[174:175], v23 offset:13056
  s_waitcnt lgkmcnt(0)
  s_barrier
  s_add_u32 m0, s16, 0
  s_nop 0
  global_load_lds_dwordx4 v16, s[22:23]
  s_add_u32 m0, s16, 1024
  s_nop 0
  global_load_lds_dwordx4 v17, s[22:23]
  s_add_u32 m0, s16, 2048
  s_nop 0
  global_load_lds_dwordx4 v18, s[22:23]
  s_add_u32 m0, s16, 3072
  s_nop 0
  global_load_lds_dwordx4 v19, s[22:23]
  s_add_u32 m0, s16, 4096
  s_nop 0
  global_load_lds_dwordx4 v20, s[22:23]
  s_add_u32 m0, s16, 5120
  s_nop 0
  global_load_lds_dwordx4 v21, s[22:23]
  s_add_u32 s22, s22, 786432
  s_addc_u32 s23, s23, 0
  s_waitcnt vmcnt(12)
  s_barrier
  ds_read_b64_tr_b16 a[216:217], v24 offset:24576
  ds_read_b64_tr_b16 a[218:219], v24 offset:25344
  ds_read_b64_tr_b16 a[220:221], v24 offset:36864
  ds_read_b64_tr_b16 a[222:223], v24 offset:37632
  ds_read_b64_tr_b16 v[176:177], v22 offset:24576
  ds_read_b64_tr_b16 v[178:179], v22 offset:25344
  ds_read_b64_tr_b16 v[180:181], v22 offset:36864
  ds_read_b64_tr_b16 v[182:183], v22 offset:37632
  ds_read_b64_tr_b16 v[184:185], v23 offset:24576
  ds_read_b64_tr_b16 v[186:187], v23 offset:25344
  ds_read_b64_tr_b16 v[188:189], v23 offset:36864
  ds_read_b64_tr_b16 v[190:191], v23 offset:37632
  s_waitcnt lgkmcnt(0)
  s_barrier
  s_add_u32 m0, s16, 24576
  s_nop 0
  global_load_lds_dwordx4 v16, s[22:23]
  s_add_u32 m0, s16, 25600
  s_nop 0
  global_load_lds_dwordx4 v17, s[22:23]
  s_add_u32 m0, s16, 26624
  s_nop 0
  global_load_lds_dwordx4 v18, s[22:23]
  s_add_u32 m0, s16, 27648
  s_nop 0
  global_load_lds_dwordx4 v19, s[22:23]
  s_add_u32 m0, s16, 28672
  s_nop 0
  global_load_lds_dwordx4 v20, s[22:23]
  s_add_u32 m0, s16, 29696
  s_nop 0
  global_load_lds_dwordx4 v21, s[22:23]
  s_add_u32 s22, s22, 786432
  s_addc_u32 s23, s23, 0
  s_waitcnt vmcnt(12)
  s_barrier
  v_add_u32 v22, 49152, v22
  v_add_u32 v23, 49152, v23
  v_add_u32 v24, 49152, v24
  v_add_u32 v25, 49152, v25
  ds_read_b64_tr_b16 a[48:49], v24 offset:0
  ds_read_b64_tr_b16 a[50:51], v24 offset:768
  ds_read_b64_tr_b16 a[52:53], v24 offset:12288
  ds_read_b64_tr_b16 a[54:55], v24 offset:13056
  ds_read_b64_tr_b16 v[80:81], v22 offset:0
  ds_read_b64_tr_b16 v[82:83], v22 offset:768
  ds_read_b64_tr_b16 v[84:85], v22 offset:12288
  ds_read_b64_tr_b16 v[86:87], v22 offset:13056
  s_waitcnt lgkmcnt(0)
  ds_write_b128 v11, v[80:83] offset:10240
  ds_write_b128 v11, v[84:87] offset:11264
  s_waitcnt lgkmcnt(0)
  ds_read_b64_tr_b16 v[128:129], v23 offset:0
  ds_read_b64_tr_b16 v[130:131], v23 offset:768
  ds_read_b64_tr_b16 v[132:133], v23 offset:12288
  ds_read_b64_tr_b16 v[134:135], v23 offset:13056
  v_subrev_u32 v22, 49152, v22
  v_subrev_u32 v23, 49152, v23
  v_subrev_u32 v24, 49152, v24
  v_subrev_u32 v25, 49152, v25
  s_waitcnt lgkmcnt(0)
  s_barrier
  s_add_u32 m0, s16, 49152
  s_nop 0
  global_load_lds_dwordx4 v16, s[22:23]
  s_add_u32 m0, s16, 50176
  s_nop 0
  global_load_lds_dwordx4 v17, s[22:23]
  s_add_u32 m0, s16, 51200
  s_nop 0
  global_load_lds_dwordx4 v18, s[22:23]
  s_add_u32 m0, s16, 52224
  s_nop 0
  global_load_lds_dwordx4 v19, s[22:23]
  s_add_u32 m0, s16, 53248
  s_nop 0
  global_load_lds_dwordx4 v20, s[22:23]
  s_add_u32 m0, s16, 54272
  s_nop 0
  global_load_lds_dwordx4 v21, s[22:23]
  s_add_u32 s22, s22, 786432
  s_addc_u32 s23, s23, 0
  s_waitcnt vmcnt(12)
  s_barrier
  ds_read_b64_tr_b16 a[224:225], v24 offset:0
  ds_read_b64_tr_b16 a[226:227], v24 offset:768
  ds_read_b64_tr_b16 a[228:229], v24 offset:12288
  ds_read_b64_tr_b16 a[230:231], v24 offset:13056
  ds_read_b64_tr_b16 v[192:193], v22 offset:0
  ds_read_b64_tr_b16 v[194:195], v22 offset:768
  ds_read_b64_tr_b16 v[196:197], v22 offset:12288
  ds_read_b64_tr_b16 v[198:199], v22 offset:13056
  ds_read_b64_tr_b16 v[200:201], v23 offset:0
  ds_read_b64_tr_b16 v[202:203], v23 offset:768
  ds_read_b64_tr_b16 v[204:205], v23 offset:12288
  ds_read_b64_tr_b16 v[206:207], v23 offset:13056
  s_waitcnt lgkmcnt(0)
  s_barrier
  s_add_u32 m0, s16, 0
  s_nop 0
  global_load_lds_dwordx4 v16, s[22:23]
  s_add_u32 m0, s16, 1024
  s_nop 0
  global_load_lds_dwordx4 v17, s[22:23]
  s_add_u32 m0, s16, 2048
  s_nop 0
  global_load_lds_dwordx4 v18, s[22:23]
  s_add_u32 m0, s16, 3072
  s_nop 0
  global_load_lds_dwordx4 v19, s[22:23]
  s_add_u32 m0, s16, 4096
  s_nop 0
  global_load_lds_dwordx4 v20, s[22:23]
  s_add_u32 m0, s16, 5120
  s_nop 0
  global_load_lds_dwordx4 v21, s[22:23]
  s_add_u32 s22, s22, 786432
  s_addc_u32 s23, s23, 0
  s_waitcnt vmcnt(12)
  s_barrier
  ds_read_b64_tr_b16 a[232:233], v24 offset:24576
  ds_read_b64_tr_b16 a[234:235], v24 offset:25344
  ds_read_b64_tr_b16 a[236:237], v24 offset:36864
  ds_read_b64_tr_b16 a[238:239], v24 offset:37632
  ds_read_b64_tr_b16 v[208:209], v22 offset:24576
  ds_read_b64_tr_b16 v[210:211], v22 offset:25344
  ds_read_b64_tr_b16 v[212:213], v22 offset:36864
  ds_read_b64_tr_b16 v[214:215], v22 offset:37632
  ds_read_b64_tr_b16 v[216:217], v23 offset:24576
  ds_read_b64_tr_b16 v[218:219], v23 offset:25344
  ds_read_b64_tr_b16 v[220:221], v23 offset:36864
  ds_read_b64_tr_b16 v[222:223], v23 offset:37632
  s_waitcnt lgkmcnt(0)
  s_barrier
  s_add_u32 m0, s16, 24576
  s_nop 0
  global_load_lds_dwordx4 v16, s[22:23]
  s_add_u32 m0, s16, 25600
  s_nop 0
  global_load_lds_dwordx4 v17, s[22:23]
  s_add_u32 m0, s16, 26624
  s_nop 0
  global_load_lds_dwordx4 v18, s[22:23]
  s_add_u32 m0, s16, 27648
  s_nop 0
  global_load_lds_dwordx4 v19, s[22:23]
  s_add_u32 m0, s16, 28672
  s_nop 0
  global_load_lds_dwordx4 v20, s[22:23]
  s_add_u32 m0, s16, 29696
  s_nop 0
  global_load_lds_dwordx4 v21, s[22:23]
  s_add_u32 s22, s22, 786432
  s_addc_u32 s23, s23, 0
  s_waitcnt vmcnt(12)
  s_barrier
  v_add_u32 v22, 49152, v22
  v_add_u32 v23, 49152, v23
  v_add_u32 v24, 49152, v24
  v_add_u32 v25, 49152, v25
  ds_read_b64_tr_b16 a[240:241], v24 offset:0
  ds_read_b64_tr_b16 a[242:243], v24 offset:768
  ds_read_b64_tr_b16 a[244:245], v24 offset:12288
  ds_read_b64_tr_b16 a[246:247], v24 offset:13056
  ds_read_b64_tr_b16 v[224:225], v22 offset:0
  ds_read_b64_tr_b16 v[226:227], v22 offset:768
  ds_read_b64_tr_b16 v[228:229], v22 offset:12288
  ds_read_b64_tr_b16 v[230:231], v22 offset:13056
  ds_read_b64_tr_b16 v[232:233], v23 offset:0
  ds_read_b64_tr_b16 v[234:235], v23 offset:768
  ds_read_b64_tr_b16 v[236:237], v23 offset:12288
  ds_read_b64_tr_b16 v[238:239], v23 offset:13056
  v_subrev_u32 v22, 49152, v22
  v_subrev_u32 v23, 49152, v23
  v_subrev_u32 v24, 49152, v24
  v_subrev_u32 v25, 49152, v25
  s_waitcnt lgkmcnt(0)
  s_barrier
  s_waitcnt vmcnt(6)
  s_barrier
  ds_read_b64_tr_b16 v[80:81], v24 offset:0
  ds_read_b64_tr_b16 v[82:83], v24 offset:768
  ds_read_b64_tr_b16 v[84:85], v24 offset:12288
  ds_read_b64_tr_b16 v[86:87], v24 offset:13056
  s_waitcnt lgkmcnt(0)
  ds_write_b128 v11, v[80:83] offset:8192
  ds_write_b128 v11, v[84:87] offset:9216
  s_waitcnt lgkmcnt(0)
  ds_read_b64_tr_b16 v[112:113], v22 offset:0
  ds_read_b64_tr_b16 v[114:115], v22 offset:768
  ds_read_b64_tr_b16 v[116:117], v22 offset:12288
  ds_read_b64_tr_b16 v[118:119], v22 offset:13056
  ds_read_b64_tr_b16 v[136:137], v23 offset:0
  ds_read_b64_tr_b16 v[138:139], v23 offset:768
  ds_read_b64_tr_b16 v[140:141], v23 offset:12288
  ds_read_b64_tr_b16 v[142:143], v23 offset:13056
  s_waitcnt lgkmcnt(0)
  s_barrier
  s_waitcnt vmcnt(0)
  s_barrier
  ds_read_b64_tr_b16 a[248:249], v24 offset:24576
  ds_read_b64_tr_b16 a[250:251], v24 offset:25344
  ds_read_b64_tr_b16 a[252:253], v24 offset:36864
  ds_read_b64_tr_b16 a[254:255], v24 offset:37632
  ds_read_b64_tr_b16 v[240:241], v22 offset:24576
  ds_read_b64_tr_b16 v[242:243], v22 offset:25344
  ds_read_b64_tr_b16 v[244:245], v22 offset:36864
  ds_read_b64_tr_b16 v[246:247], v22 offset:37632
  ds_read_b64_tr_b16 v[248:249], v23 offset:24576
  ds_read_b64_tr_b16 v[250:251], v23 offset:25344
  ds_read_b64_tr_b16 v[252:253], v23 offset:36864
  ds_read_b64_tr_b16 v[254:255], v23 offset:37632
  s_waitcnt lgkmcnt(0)
  s_barrier
  s_branch lw_105
lw_102:
  s_waitcnt vmcnt(12)
  s_barrier
  ds_read_b64_tr_b16 a[64:65], v22 offset:128
  ds_read_b64_tr_b16 a[66:67], v22 offset:896
  ds_read_b64_tr_b16 a[68:69], v22 offset:12416
  ds_read_b64_tr_b16 a[70:71], v22 offset:13184
  ds_read_b64_tr_b16 a[72:73], v23 offset:128
  ds_read_b64_tr_b16 a[74:75], v23 offset:896
  ds_read_b64_tr_b16 a[76:77], v23 offset:12416
  ds_read_b64_tr_b16 a[78:79], v23 offset:13184
  ds_read_b64_tr_b16 v[80:81], v25 offset:0
  ds_read_b64_tr_b16 v[82:83], v25 offset:768
  ds_read_b64_tr_b16 v[84:85], v25 offset:12288
  ds_read_b64_tr_b16 v[86:87], v25 offset:13056
  s_waitcnt lgkmcnt(0)
  ds_write_b128 v11, v[80:83] offset:18432
  ds_write_b128 v11, v[84:87] offset:19456
  s_waitcnt lgkmcnt(0)
  s_waitcnt lgkmcnt(0)
  s_barrier
  s_add_u32 m0, s16, 0
  s_nop 0
  global_load_lds_dwordx4 v16, s[20:21]
  s_add_u32 m0, s16, 1024
  s_nop 0
  global_load_lds_dwordx4 v17, s[20:21]
  s_add_u32 m0, s16, 2048
  s_nop 0
  global_load_lds_dwordx4 v18, s[20:21]
  s_add_u32 m0, s16, 3072
  s_nop 0
  global_load_lds_dwordx4 v19, s[20:21]
  s_add_u32 m0, s16, 4096
  s_nop 0
  global_load_lds_dwordx4 v20, s[20:21]
  s_add_u32 m0, s16, 5120
  s_nop 0
  global_load_lds_dwordx4 v21, s[20:21]
  s_add_u32 s20, s20, 786432
  s_addc_u32 s21, s21, 0
  s_waitcnt vmcnt(12)
  s_barrier
  ds_read_b64_tr_b16 v[80:81], v22 offset:24704
  ds_read_b64_tr_b16 v[82:83], v22 offset:25472
  ds_read_b64_tr_b16 v[84:85], v22 offset:36992
  ds_read_b64_tr_b16 v[86:87], v22 offset:37760
  s_waitcnt lgkmcnt(0)
  ds_write_b128 v11, v[80:83] offset:0
  ds_write_b128 v11, v[84:87] offset:1024
  s_waitcnt lgkmcnt(0)
  ds_read_b64_tr_b16 v[80:81], v23 offset:24704
  ds_read_b64_tr_b16 v[82:83], v23 offset:25472
  ds_read_b64_tr_b16 v[84:85], v23 offset:36992
  ds_read_b64_tr_b16 v[86:87], v23 offset:37760
  s_waitcnt lgkmcnt(0)
  ds_write_b128 v11, v[80:83] offset:2048
  ds_write_b128 v11, v[84:87] offset:3072
  s_waitcnt lgkmcnt(0)
  ds_read_b64_tr_b16 v[80:81], v25 offset:24576
  ds_read_b64_tr_b16 v[82:83], v25 offset:25344
  ds_read_b64_tr_b16 v[84:85], v25 offset:36864
  ds_read_b64_tr_b16 v[86:87], v25 offset:37632
  s_waitcnt lgkmcnt(0)
  ds_write_b128 v11, v[80:83] offset:4096
  ds_write_b128 v11, v[84:87] offset:5120
  s_waitcnt lgkmcnt(0)
  s_waitcnt lgkmcnt(0)
  s_barrier
  s_add_u32 m0, s16, 24576
  s_nop 0
  global_load_lds_dwordx4 v16, s[20:21]
  s_add_u32 m0, s16, 25600
  s_nop 0
  global_load_lds_dwordx4 v17, s[20:21]
  s_add_u32 m0, s16, 26624
  s_nop 0
  global_load_lds_dwordx4 v18, s[20:21]
  s_add_u32 m0, s16, 27648
  s_nop 0
  global_load_lds_dwordx4 v19, s[20:21]
  s_add_u32 m0, s16, 28672
  s_nop 0
  global_load_lds_dwordx4 v20, s[20:21]
  s_add_u32 m0, s16, 29696
  s_nop 0
  global_load_lds_dwordx4 v21, s[20:21]
  s_add_u32 s20, s20, 786432
  s_addc_u32 s21, s21, 0
  s_waitcnt vmcnt(12)
  s_barrier
  v_add_u32 v22, 49152, v22
  v_add_u32 v23, 49152, v23
  v_add_u32 v24, 49152, v24
  v_add_u32 v25, 49152, v25
  ds_read_b64_tr_b16 a[96:97], v22 offset:128
  ds_read_b64_tr_b16 a[98:99], v22 offset:896
  ds_read_b64_tr_b16 a[100:101], v22 offset:12416
  ds_read_b64_tr_b16 a[102:103], v22 offset:13184
  ds_read_b64_tr_b16 a[104:105], v23 offset:128
  ds_read_b64_tr_b16 a[106:107], v23 offset:896
  ds_read_b64_tr_b16 a[108:109], v23 offset:12416
  ds_read_b64_tr_b16 a[110:111], v23 offset:13184
  ds_read_b64_tr_b16 a[160:161], v25 offset:0
  ds_read_b64_tr_b16 a[162:163], v25 offset:768
  ds_read_b64_tr_b16 a[164:165], v25 offset:12288
  ds_read_b64_tr_b16 a[166:167], v25 offset:13056
  v_subrev_u32 v22, 49152, v22
  v_subrev_u32 v23, 49152, v23
  v_subrev_u32 v24, 49152, v24
  v_subrev_u32 v25, 49152, v25
  s_waitcnt lgkmcnt(0)
  s_barrier
  s_add_u32 m0, s16, 49152
  s_nop 0
  global_load_lds_dwordx4 v16, s[20:21]
  s_add_u32 m0, s16, 50176
  s_nop 0
  global_load_lds_dwordx4 v17, s[20:21]
  s_add_u32 m0, s16, 51200
  s_nop 0
  global_load_lds_dwordx4 v18, s[20:21]
  s_add_u32 m0, s16, 52224
  s_nop 0
  global_load_lds_dwordx4 v19, s[20:21]
  s_add_u32 m0, s16, 53248
  s_nop 0
  global_load_lds_dwordx4 v20, s[20:21]
  s_add_u32 m0, s16, 54272
  s_nop 0
  global_load_lds_dwordx4 v21, s[20:21]
  s_add_u32 s20, s20, 786432
  s_addc_u32 s21, s21, 0
  s_waitcnt vmcnt(12)
  s_barrier
  ds_read_b64_tr_b16 a[80:81], v22 offset:128
  ds_read_b64_tr_b16 a[82:83], v22 offset:896
  ds_read_b64_tr_b16 a[84:85], v22 offset:12416
  ds_read_b64_tr_b16 a[86:87], v22 offset:13184
  ds_read_b64_tr_b16 a[88:89], v23 offset:128
  ds_read_b64_tr_b16 a[90:91], v23 offset:896
  ds_read_b64_tr_b16 a[92:93], v23 offset:12416
  ds_read_b64_tr_b16 a[94:95], v23 offset:13184
  ds_read_b64_tr_b16 a[152:153], v25 offset:0
  ds_read_b64_tr_b16 a[154:155], v25 offset:768
  ds_read_b64_tr_b16 a[156:157], v25 offset:12288
  ds_read_b64_tr_b16 a[158:159], v25 offset:13056
  s_waitcnt lgkmcnt(0)
  s_barrier
  s_add_u32 m0, s16, 0
  s_nop 0
  global_load_lds_dwordx4 v16, s[20:21]
  s_add_u32 m0, s16, 1024
  s_nop 0
  global_load_lds_dwordx4 v17, s[20:21]
  s_add_u32 m0, s16, 2048
  s_nop 0
  global_load_lds_dwordx4 v18, s[20:21]
  s_add_u32 m0, s16, 3072
  s_nop 0
  global_load_lds_dwordx4 v19, s[20:21]
  s_add_u32 m0, s16, 4096
  s_nop 0
  global_load_lds_dwordx4 v20, s[20:21]
  s_add_u32 m0, s16, 5120
  s_nop 0
  global_load_lds_dwordx4 v21, s[20:21]
  s_add_u32 s20, s20, 786432
  s_addc_u32 s21, s21, 0
  s_waitcnt vmcnt(12)
  s_barrier
  ds_read_b64_tr_b16 a[112:113], v22 offset:24704
  ds_read_b64_tr_b16 a[114:115], v22 offset:25472
  ds_read_b64_tr_b16 a[116:117], v22 offset:36992
  ds_read_b64_tr_b16 a[118:119], v22 offset:37760
  ds_read_b64_tr_b16 a[120:121], v23 offset:24704
  ds_read_b64_tr_b16 a[122:123], v23 offset:25472
  ds_read_b64_tr_b16 a[124:125], v23 offset:36992
  ds_read_b64_tr_b16 a[126:127], v23 offset:37760
  ds_read_b64_tr_b16 a[168:169], v25 offset:24576
  ds_read_b64_tr_b16 a[170:171], v25 offset:25344
  ds_read_b64_tr_b16 a[172:173], v25 offset:36864
  ds_read_b64_tr_b16 a[174:175], v25 offset:37632
  s_waitcnt lgkmcnt(0)
  s_barrier
  s_add_u32 m0, s16, 24576
  s_nop 0
  global_load_lds_dwordx4 v16, s[20:21]
  s_add_u32 m0, s16, 25600
  s_nop 0
  global_load_lds_dwordx4 v17, s[20:21]
  s_add_u32 m0, s16, 26624
  s_nop 0
  global_load_lds_dwordx4 v18, s[20:21]
  s_add_u32 m0, s16, 27648
  s_nop 0
  global_load_lds_dwordx4 v19, s[20:21]
  s_add_u32 m0, s16, 28672
  s_nop 0
  global_load_lds_dwordx4 v20, s[20:21]
  s_add_u32 m0, s16, 29696
  s_nop 0
  global_load_lds_dwordx4 v21, s[20:21]
  s_add_u32 s20, s20, 786432
  s_addc_u32 s21, s21, 0
  s_waitcnt vmcnt(12)
  s_barrier
  v_add_u32 v22, 49152, v22
  v_add_u32 v23, 49152, v23
  v_add_u32 v24, 49152, v24
  v_add_u32 v25, 49152, v25
  ds_read_b64_tr_b16 v[80:81], v22 offset:128
  ds_read_b64_tr_b16 v[82:83], v22 offset:896
  ds_read_b64_tr_b16 v[84:85], v22 offset:12416
  ds_read_b64_tr_b16 v[86:87], v22 offset:13184
  s_waitcnt lgkmcnt(0)
  ds_write_b128 v11, v[80:83] offset:6144
  ds_write_b128 v11, v[84:87] offset:7168
  s_waitcnt lgkmcnt(0)
  ds_read_b64_tr_b16 a[0:1], v23 offset:128
  ds_read_b64_tr_b16 a[2:3], v23 offset:896
  ds_read_b64_tr_b16 a[4:5], v23 offset:12416
  ds_read_b64_tr_b16 a[6:7], v23 offset:13184
  ds_read_b64_tr_b16 a[8:9], v25 offset:0
  ds_read_b64_tr_b16 a[10:11], v25 offset:768
  ds_read_b64_tr_b16 a[12:13], v25 offset:12288
  ds_read_b64_tr_b16 a[14:15], v25 offset:13056
  v_subrev_u32 v22, 49152, v22
  v_subrev_u32 v23, 49152, v23
  v_subrev_u32 v24, 49152, v24
  v_subrev_u32 v25, 49152, v25
  s_waitcnt lgkmcnt(0)
  s_barrier
  s_add_u32 m0, s16, 49152
  s_nop 0
  global_load_lds_dwordx4 v16, s[20:21]
  s_add_u32 m0, s16, 50176
  s_nop 0
  global_load_lds_dwordx4 v17, s[20:21]
  s_add_u32 m0, s16, 51200
  s_nop 0
  global_load_lds_dwordx4 v18, s[20:21]
  s_add_u32 m0, s16, 52224
  s_nop 0
  global_load_lds_dwordx4 v19, s[20:21]
  s_add_u32 m0, s16, 53248
  s_nop 0
  global_load_lds_dwordx4 v20, s[20:21]
  s_add_u32 m0, s16, 54272
  s_nop 0
  global_load_lds_dwordx4 v21, s[20:21]
  s_add_u32 s20, s20, 786432
  s_addc_u32 s21, s21, 0
  s_waitcnt vmcnt(12)
  s_barrier
  ds_read_b64_tr_b16 v[80:81], v22 offset:128
  ds_read_b64_tr_b16 v[82:83], v22 offset:896
  ds_read_b64_tr_b16 v[84:85], v22 offset:12416
  ds_read_b64_tr_b16 v[86:87], v22 offset:13184
  s_waitcnt lgkmcnt(0)
  ds_write_b128 v11, v[80:83] offset:14336
  ds_write_b128 v11, v[84:87] offset:15360
  s_waitcnt lgkmcnt(0)
  ds_read_b64_tr_b16 a[136:137], v23 offset:128
  ds_read_b64_tr_b16 a[138:139], v23 offset:896
  ds_read_b64_tr_b16 a[140:141], v23 offset:12416
  ds_read_b64_tr_b16 a[142:143], v23 offset:13184
  ds_read_b64_tr_b16 a[184:185], v25 offset:0
  ds_read_b64_tr_b16 a[186:187], v25 offset:768
  ds_read_b64_tr_b16 a[188:189], v25 offset:12288
  ds_read_b64_tr_b16 a[190:191], v25 offset:13056
  s_waitcnt lgkmcnt(0)
  s_barrier
  s_add_u32 m0, s16, 0
  s_nop 0
  global_load_lds_dwordx4 v16, s[20:21]
  s_add_u32 m0, s16, 1024
  s_nop 0
  global_load_lds_dwordx4 v17, s[20:21]
  s_add_u32 m0, s16, 2048
  s_nop 0
  global_load_lds_dwordx4 v18, s[20:21]
  s_add_u32 m0, s16, 3072
  s_nop 0
  global_load_lds_dwordx4 v19, s[20:21]
  s_add_u32 m0, s16, 4096
  s_nop 0
  global_load_lds_dwordx4 v20, s[20:21]
  s_add_u32 m0, s16, 5120
  s_nop 0
  global_load_lds_dwordx4 v21, s[20:21]
  s_add_u32 s20, s20, 786432
  s_addc_u32 s21, s21, 0
  s_waitcnt vmcnt(12)
  s_barrier
  ds_read_b64_tr_b16 v[80:81], v22 offset:24704
  ds_read_b64_tr_b16 v[82:83], v22 offset:25472
  ds_read_b64_tr_b16 v[84:85], v22 offset:36992
  ds_read_b64_tr_b16 v[86:87], v22 offset:37760
  s_waitcnt lgkmcnt(0)
  ds_write_b128 v11, v[80:83] offset:12288
  ds_write_b128 v11, v[84:87] offset:13312
  s_waitcnt lgkmcnt(0)
  ds_read_b64_tr_b16 a[128:129], v23 offset:24704
  ds_read_b64_tr_b16 a[130:131], v23 offset:25472
  ds_read_b64_tr_b16 a[132:133], v23 offset:36992
  ds_read_b64_tr_b16 a[134:135], v23 offset:37760
  ds_read_b64_tr_b16 a[176:177], v25 offset:24576
  ds_read_b64_tr_b16 a[178:179], v25 offset:25344
  ds_read_b64_tr_b16 a[180:181], v25 offset:36864
  ds_read_b64_tr_b16 a[182:183], v25 offset:37632
  s_waitcnt lgkmcnt(0)
  s_barrier
  s_add_u32 m0, s16, 24576
  s_nop 0
  global_load_lds_dwordx4 v16, s[22:23]
  s_add_u32 m0, s16, 25600
  s_nop 0
  global_load_lds_dwordx4 v17, s[22:23]
  s_add_u32 m0, s16, 26624
  s_nop 0
  global_load_lds_dwordx4 v18, s[22:23]
  s_add_u32 m0, s16, 27648
  s_nop 0
  global_load_lds_dwordx4 v19, s[22:23]
  s_add_u32 m0, s16, 28672
  s_nop 0
  global_load_lds_dwordx4 v20, s[22:23]
  s_add_u32 m0, s16, 29696
  s_nop 0
  global_load_lds_dwordx4 v21, s[22:23]
  s_add_u32 s22, s22, 786432
  s_addc_u32 s23, s23, 0
  s_waitcnt vmcnt(12)
  s_barrier
  v_add_u32 v22, 49152, v22
  v_add_u32 v23, 49152, v23
  v_add_u32 v24, 49152, v24
  v_add_u32 v25, 49152, v25
  ds_read_b64_tr_b16 v[80:81], v22 offset:128
  ds_read_b64_tr_b16 v[82:83], v22 offset:896
  ds_read_b64_tr_b16 v[84:85], v22 offset:12416
  ds_read_b64_tr_b16 v[86:87], v22 offset:13184
  s_waitcnt lgkmcnt(0)
  ds_write_b128 v11, v[80:83] offset:16384
  ds_write_b128 v11, v[84:87] offset:17408
  s_waitcnt lgkmcnt(0)
  ds_read_b64_tr_b16 a[144:145], v23 offset:128
  ds_read_b64_tr_b16 a[146:147], v23 offset:896
  ds_read_b64_tr_b16 a[148:149], v23 offset:12416
  ds_read_b64_tr_b16 a[150:151], v23 offset:13184
  ds_read_b64_tr_b16 a[192:193], v25 offset:0
  ds_read_b64_tr_b16 a[194:195], v25 offset:768
  ds_read_b64_tr_b16 a[196:197], v25 offset:12288
  ds_read_b64_tr_b16 a[198:199], v25 offset:13056
  v_subrev_u32 v22, 49152, v22
  v_subrev_u32 v23, 49152, v23
  v_subrev_u32 v24, 49152, v24
  v_subrev_u32 v25, 49152, v25
  s_waitcnt lgkmcnt(0)
  s_barrier
  s_add_u32 m0, s16, 49152
  s_nop 0
  global_load_lds_dwordx4 v16, s[22:23]
  s_add_u32 m0, s16, 50176
  s_nop 0
  global_load_lds_dwordx4 v17, s[22:23]
  s_add_u32 m0, s16, 51200
  s_nop 0
  global_load_lds_dwordx4 v18, s[22:23]
  s_add_u32 m0, s16, 52224
  s_nop 0
  global_load_lds_dwordx4 v19, s[22:23]
  s_add_u32 m0, s16, 53248
  s_nop 0
  global_load_lds_dwordx4 v20, s[22:23]
  s_add_u32 m0, s16, 54272
  s_nop 0
  global_load_lds_dwordx4 v21, s[22:23]
  s_add_u32 s22, s22, 786432
  s_addc_u32 s23, s23, 0
  s_waitcnt vmcnt(12)
  s_barrier
  ds_read_b64_tr_b16 a[16:17], v22 offset:128
  ds_read_b64_tr_b16 a[18:19], v22 offset:896
  ds_read_b64_tr_b16 a[20:21], v22 offset:12416
  ds_read_b64_tr_b16 a[22:23], v22 offset:13184
  ds_read_b64_tr_b16 a[24:25], v23 offset:128
  ds_read_b64_tr_b16 a[26:27], v23 offset:896
  ds_read_b64_tr_b16 a[28:29], v23 offset:12416
  ds_read_b64_tr_b16 a[30:31], v23 offset:13184
  ds_read_b64_tr_b16 a[32:33], v25 offset:0
  ds_read_b64_tr_b16 a[34:35], v25 offset:768
  ds_read_b64_tr_b16 a[36:37], v25 offset:12288
  ds_read_b64_tr_b16 a[38:39], v25 offset:13056
  s_waitcnt lgkmcnt(0)
  s_barrier
  s_add_u32 m0, s16, 0
  s_nop 0
  global_load_lds_dwordx4 v16, s[22:23]
  s_add_u32 m0, s16, 1024
  s_nop 0
  global_load_lds_dwordx4 v17, s[22:23]
  s_add_u32 m0, s16, 2048
  s_nop 0
  global_load_lds_dwordx4 v18, s[22:23]
  s_add_u32 m0, s16, 3072
  s_nop 0
  global_load_lds_dwordx4 v19, s[22:23]
  s_add_u32 m0, s16, 4096
  s_nop 0
  global_load_lds_dwordx4 v20, s[22:23]
  s_add_u32 m0, s16, 5120
  s_nop 0
  global_load_lds_dwordx4 v21, s[22:23]
  s_add_u32 s22, s22, 786432
  s_addc_u32 s23, s23, 0
  s_waitcnt vmcnt(12)
  s_barrier
  ds_read_b64_tr_b16 a[200:201], v25 offset:24576
  ds_read_b64_tr_b16 a[202:203], v25 offset:25344
  ds_read_b64_tr_b16 a[204:205], v25 offset:36864
  ds_read_b64_tr_b16 a[206:207], v25 offset:37632
  ds_read_b64_tr_b16 v[144:145], v22 offset:24704
  ds_read_b64_tr_b16 v[146:147], v22 offset:25472
  ds_read_b64_tr_b16 v[148:149], v22 offset:36992
  ds_read_b64_tr_b16 v[150:151], v22 offset:37760
  ds_read_b64_tr_b16 v[152:153], v23 offset:24704
  ds_read_b64_tr_b16 v[154:155], v23 offset:25472
  ds_read_b64_tr_b16 v[156:157], v23 offset:36992
  ds_read_b64_tr_b16 v[158:159], v23 offset:37760
  s_waitcnt lgkmcnt(0)
  s_barrier
  s_add_u32 m0, s16, 24576
  s_nop 0
  global_load_lds_dwordx4 v16, s[22:23]
  s_add_u32 m0, s16, 25600
  s_nop 0
  global_load_lds_dwordx4 v17, s[22:23]
  s_add_u32 m0, s16, 26624
  s_nop 0
  global_load_lds_dwordx4 v18, s[22:23]
  s_add_u32 m0, s16, 27648
  s_nop 0
  global_load_lds_dwordx4 v19, s[22:23]
  s_add_u32 m0, s16, 28672
  s_nop 0
  global_load_lds_dwordx4 v20, s[22:23]
  s_add_u32 m0, s16, 29696
  s_nop 0
  global_load_lds_dwordx4 v21, s[22:23]
  s_add_u32 s22, s22, 786432
  s_addc_u32 s23, s23, 0
  s_waitcnt vmcnt(12)
  s_barrier
  v_add_u32 v22, 49152, v22
  v_add_u32 v23, 49152, v23
  v_add_u32 v24, 49152, v24
  v_add_u32 v25, 49152, v25
  ds_read_b64_tr_b16 a[40:41], v25 offset:0
  ds_read_b64_tr_b16 a[42:43], v25 offset:768
  ds_read_b64_tr_b16 a[44:45], v25 offset:12288
  ds_read_b64_tr_b16 a[46:47], v25 offset:13056
  ds_read_b64_tr_b16 a[56:57], v22 offset:128
  ds_read_b64_tr_b16 a[58:59], v22 offset:896
  ds_read_b64_tr_b16 a[60:61], v22 offset:12416
  ds_read_b64_tr_b16 a[62:63], v22 offset:13184
  ds_read_b64_tr_b16 v[120:121], v23 offset:128
  ds_read_b64_tr_b16 v[122:123], v23 offset:896
  ds_read_b64_tr_b16 v[124:125], v23 offset:12416
  ds_read_b64_tr_b16 v[126:127], v23 offset:13184
  v_subrev_u32 v22, 49152, v22
  v_subrev_u32 v23, 49152, v23
  v_subrev_u32 v24, 49152, v24
  v_subrev_u32 v25, 49152, v25
  s_waitcnt lgkmcnt(0)
  s_barrier
  s_add_u32 m0, s16, 49152
  s_nop 0
  global_load_lds_dwordx4 v16, s[22:23]
  s_add_u32 m0, s16, 50176
  s_nop 0
  global_load_lds_dwordx4 v17, s[22:23]
  s_add_u32 m0, s16, 51200
  s_nop 0
  global_load_lds_dwordx4 v18, s[22:23]
  s_add_u32 m0, s16, 52224
  s_nop 0
  global_load_lds_dwordx4 v19, s[22:23]
  s_add_u32 m0, s16, 53248
  s_nop 0
  global_load_lds_dwordx4 v20, s[22:23]
  s_add_u32 m0, s16, 54272
  s_nop 0
  global_load_lds_dwordx4 v21, s[22:23]
  s_add_u32 s22, s22, 786432
  s_addc_u32 s23, s23, 0
  s_waitcnt vmcnt(12)
  s_barrier
  ds_read_b64_tr_b16 a[216:217], v25 offset:0
  ds_read_b64_tr_b16 a[218:219], v25 offset:768
  ds_read_b64_tr_b16 a[220:221], v25 offset:12288
  ds_read_b64_tr_b16 a[222:223], v25 offset:13056
  ds_read_b64_tr_b16 v[176:177], v22 offset:128
  ds_read_b64_tr_b16 v[178:179], v22 offset:896
  ds_read_b64_tr_b16 v[180:181], v22 offset:12416
  ds_read_b64_tr_b16 v[182:183], v22 offset:13184
  ds_read_b64_tr_b16 v[184:185], v23 offset:128
  ds_read_b64_tr_b16 v[186:187], v23 offset:896
  ds_read_b64_tr_b16 v[188:189], v23 offset:12416
  ds_read_b64_tr_b16 v[190:191], v23 offset:13184
  s_waitcnt lgkmcnt(0)
  s_barrier
  s_add_u32 m0, s16, 0
  s_nop 0
  global_load_lds_dwordx4 v16, s[22:23]
  s_add_u32 m0, s16, 1024
  s_nop 0
  global_load_lds_dwordx4 v17, s[22:23]
  s_add_u32 m0, s16, 2048
  s_nop 0
  global_load_lds_dwordx4 v18, s[22:23]
  s_add_u32 m0, s16, 3072
  s_nop 0
  global_load_lds_dwordx4 v19, s[22:23]
  s_add_u32 m0, s16, 4096
  s_nop 0
  global_load_lds_dwordx4 v20, s[22:23]
  s_add_u32 m0, s16, 5120
  s_nop 0
  global_load_lds_dwordx4 v21, s[22:23]
  s_add_u32 s22, s22, 786432
  s_addc_u32 s23, s23, 0
  s_waitcnt vmcnt(12)
  s_barrier
  ds_read_b64_tr_b16 a[208:209], v25 offset:24576
  ds_read_b64_tr_b16 a[210:211], v25 offset:25344
  ds_read_b64_tr_b16 a[212:213], v25 offset:36864
  ds_read_b64_tr_b16 a[214:215], v25 offset:37632
  ds_read_b64_tr_b16 v[160:161], v22 offset:24704
  ds_read_b64_tr_b16 v[162:163], v22 offset:25472
  ds_read_b64_tr_b16 v[164:165], v22 offset:36992
  ds_read_b64_tr_b16 v[166:167], v22 offset:37760
  ds_read_b64_tr_b16 v[168:169], v23 offset:24704
  ds_read_b64_tr_b16 v[170:171], v23 offset:25472
  ds_read_b64_tr_b16 v[172:173], v23 offset:36992
  ds_read_b64_tr_b16 v[174:175], v23 offset:37760
  s_waitcnt lgkmcnt(0)
  s_barrier
  s_add_u32 m0, s16, 24576
  s_nop 0
  global_load_lds_dwordx4 v16, s[22:23]
  s_add_u32 m0, s16, 25600
  s_nop 0
  global_load_lds_dwordx4 v17, s[22:23]
  s_add_u32 m0, s16, 26624
  s_nop 0
  global_load_lds_dwordx4 v18, s[22:23]
  s_add_u32 m0, s16, 27648
  s_nop 0
  global_load_lds_dwordx4 v19, s[22:23]
  s_add_u32 m0, s16, 28672
  s_nop 0
  global_load_lds_dwordx4 v20, s[22:23]
  s_add_u32 m0, s16, 29696
  s_nop 0
  global_load_lds_dwordx4 v21, s[22:23]
  s_add_u32 s22, s22, 786432
  s_addc_u32 s23, s23, 0
  s_waitcnt vmcnt(12)
  s_barrier
  v_add_u32 v22, 49152, v22
  v_add_u32 v23, 49152, v23
  v_add_u32 v24, 49152, v24
  v_add_u32 v25, 49152, v25
  ds_read_b64_tr_b16 a[224:225], v25 offset:0
  ds_read_b64_tr_b16 a[226:227], v25 offset:768
  ds_read_b64_tr_b16 a[228:229], v25 offset:12288
  ds_read_b64_tr_b16 a[230:231], v25 offset:13056
  ds_read_b64_tr_b16 v[192:193], v22 offset:128
  ds_read_b64_tr_b16 v[194:195], v22 offset:896
  ds_read_b64_tr_b16 v[196:197], v22 offset:12416
  ds_read_b64_tr_b16 v[198:199], v22 offset:13184
  ds_read_b64_tr_b16 v[200:201], v23 offset:128
  ds_read_b64_tr_b16 v[202:203], v23 offset:896
  ds_read_b64_tr_b16 v[204:205], v23 offset:12416
  ds_read_b64_tr_b16 v[206:207], v23 offset:13184
  v_subrev_u32 v22, 49152, v22
  v_subrev_u32 v23, 49152, v23
  v_subrev_u32 v24, 49152, v24
  v_subrev_u32 v25, 49152, v25
  s_waitcnt lgkmcnt(0)
  s_barrier
  s_add_u32 m0, s16, 49152
  s_nop 0
  global_load_lds_dwordx4 v16, s[22:23]
  s_add_u32 m0, s16, 50176
  s_nop 0
  global_load_lds_dwordx4 v17, s[22:23]
  s_add_u32 m0, s16, 51200
  s_nop 0
  global_load_lds_dwordx4 v18, s[22:23]
  s_add_u32 m0, s16, 52224
  s_nop 0
  global_load_lds_dwordx4 v19, s[22:23]
  s_add_u32 m0, s16, 53248
  s_nop 0
  global_load_lds_dwordx4 v20, s[22:23]
  s_add_u32 m0, s16, 54272
  s_nop 0
  global_load_lds_dwordx4 v21, s[22:23]
  s_add_u32 s22, s22, 786432
  s_addc_u32 s23, s23, 0
  s_waitcnt vmcnt(12)
  s_barrier
  ds_read_b64_tr_b16 a[48:49], v25 offset:0
  ds_read_b64_tr_b16 a[50:51], v25 offset:768
  ds_read_b64_tr_b16 a[52:53], v25 offset:12288
  ds_read_b64_tr_b16 a[54:55], v25 offset:13056
  ds_read_b64_tr_b16 v[80:81], v22 offset:128
  ds_read_b64_tr_b16 v[82:83], v22 offset:896
  ds_read_b64_tr_b16 v[84:85], v22 offset:12416
  ds_read_b64_tr_b16 v[86:87], v22 offset:13184
  s_waitcnt lgkmcnt(0)
  ds_write_b128 v11, v[80:83] offset:10240
  ds_write_b128 v11, v[84:87] offset:11264
  s_waitcnt lgkmcnt(0)
  ds_read_b64_tr_b16 v[128:129], v23 offset:128
  ds_read_b64_tr_b16 v[130:131], v23 offset:896
  ds_read_b64_tr_b16 v[132:133], v23 offset:12416
  ds_read_b64_tr_b16 v[134:135], v23 offset:13184
  s_waitcnt lgkmcnt(0)
  s_barrier
  s_add_u32 m0, s16, 0
  s_nop 0
  global_load_lds_dwordx4 v16, s[22:23]
  s_add_u32 m0, s16, 1024
  s_nop 0
  global_load_lds_dwordx4 v17, s[22:23]
  s_add_u32 m0, s16, 2048
  s_nop 0
  global_load_lds_dwordx4 v18, s[22:23]
  s_add_u32 m0, s16, 3072
  s_nop 0
  global_load_lds_dwordx4 v19, s[22:23]
  s_add_u32 m0, s16, 4096
  s_nop 0
  global_load_lds_dwordx4 v20, s[22:23]
  s_add_u32 m0, s16, 5120
  s_nop 0
  global_load_lds_dwordx4 v21, s[22:23]
  s_add_u32 s22, s22, 786432
  s_addc_u32 s23, s23, 0
  s_waitcnt vmcnt(12)
  s_barrier
  ds_read_b64_tr_b16 a[240:241], v25 offset:24576
  ds_read_b64_tr_b16 a[242:243], v25 offset:25344
  ds_read_b64_tr_b16 a[244:245], v25 offset:36864
  ds_read_b64_tr_b16 a[246:247], v25 offset:37632
  ds_read_b64_tr_b16 v[224:225], v22 offset:24704
  ds_read_b64_tr_b16 v[226:227], v22 offset:25472
  ds_read_b64_tr_b16 v[228:229], v22 offset:36992
  ds_read_b64_tr_b16 v[230:231], v22 offset:37760
  ds_read_b64_tr_b16 v[232:233], v23 offset:24704
  ds_read_b64_tr_b16 v[234:235], v23 offset:25472
  ds_read_b64_tr_b16 v[236:237], v23 offset:36992
  ds_read_b64_tr_b16 v[238:239], v23 offset:37760
  s_waitcnt lgkmcnt(0)
  s_barrier
  s_add_u32 m0, s16, 24576
  s_nop 0
  global_load_lds_dwordx4 v16, s[22:23]
  s_add_u32 m0, s16, 25600
  s_nop 0
  global_load_lds_dwordx4 v17, s[22:23]
  s_add_u32 m0, s16, 26624
  s_nop 0
  global_load_lds_dwordx4 v18, s[22:23]
  s_add_u32 m0, s16, 27648
  s_nop 0
  global_load_lds_dwordx4 v19, s[22:23]
  s_add_u32 m0, s16, 28672
  s_nop 0
  global_load_lds_dwordx4 v20, s[22:23]
  s_add_u32 m0, s16, 29696
  s_nop 0
  global_load_lds_dwordx4 v21, s[22:23]
  s_add_u32 s22, s22, 786432
  s_addc_u32 s23, s23, 0
  s_waitcnt vmcnt(12)
  s_barrier
  v_add_u32 v22, 49152, v22
  v_add_u32 v23, 49152, v23
  v_add_u32 v24, 49152, v24
  v_add_u32 v25, 49152, v25
  ds_read_b64_tr_b16 a[232:233], v25 offset:0
  ds_read_b64_tr_b16 a[234:235], v25 offset:768
  ds_read_b64_tr_b16 a[236:237], v25 offset:12288
  ds_read_b64_tr_b16 a[238:239], v25 offset:13056
  ds_read_b64_tr_b16 v[208:209], v22 offset:128
  ds_read_b64_tr_b16 v[210:211], v22 offset:896
  ds_read_b64_tr_b16 v[212:213], v22 offset:12416
  ds_read_b64_tr_b16 v[214:215], v22 offset:13184
  ds_read_b64_tr_b16 v[216:217], v23 offset:128
  ds_read_b64_tr_b16 v[218:219], v23 offset:896
  ds_read_b64_tr_b16 v[220:221], v23 offset:12416
  ds_read_b64_tr_b16 v[222:223], v23 offset:13184
  v_subrev_u32 v22, 49152, v22
  v_subrev_u32 v23, 49152, v23
  v_subrev_u32 v24, 49152, v24
  v_subrev_u32 v25, 49152, v25
  s_waitcnt lgkmcnt(0)
  s_barrier
  s_waitcnt vmcnt(6)
  s_barrier
  ds_read_b64_tr_b16 a[248:249], v25 offset:0
  ds_read_b64_tr_b16 a[250:251], v25 offset:768
  ds_read_b64_tr_b16 a[252:253], v25 offset:12288
  ds_read_b64_tr_b16 a[254:255], v25 offset:13056
  ds_read_b64_tr_b16 v[240:241], v22 offset:128
  ds_read_b64_tr_b16 v[242:243], v22 offset:896
  ds_read_b64_tr_b16 v[244:245], v22 offset:12416
  ds_read_b64_tr_b16 v[246:247], v22 offset:13184
  ds_read_b64_tr_b16 v[248:249], v23 offset:128
  ds_read_b64_tr_b16 v[250:251], v23 offset:896
  ds_read_b64_tr_b16 v[252:253], v23 offset:12416
  ds_read_b64_tr_b16 v[254:255], v23 offset:13184
  s_waitcnt lgkmcnt(0)
  s_barrier
  s_waitcnt vmcnt(0)
  s_barrier
  ds_read_b64_tr_b16 v[80:81], v25 offset:24576
  ds_read_b64_tr_b16 v[82:83], v25 offset:25344
  ds_read_b64_tr_b16 v[84:85], v25 offset:36864
  ds_read_b64_tr_b16 v[86:87], v25 offset:37632
  s_waitcnt lgkmcnt(0)
  ds_write_b128 v11, v[80:83] offset:8192
  ds_write_b128 v11, v[84:87] offset:9216
  s_waitcnt lgkmcnt(0)
  ds_read_b64_tr_b16 v[112:113], v22 offset:24704
  ds_read_b64_tr_b16 v[114:115], v22 offset:25472
  ds_read_b64_tr_b16 v[116:117], v22 offset:36992
  ds_read_b64_tr_b16 v[118:119], v22 offset:37760
  ds_read_b64_tr_b16 v[136:137], v23 offset:24704
  ds_read_b64_tr_b16 v[138:139], v23 offset:25472
  ds_read_b64_tr_b16 v[140:141], v23 offset:36992
  ds_read_b64_tr_b16 v[142:143], v23 offset:37760
  s_waitcnt lgkmcnt(0)
  s_barrier
  s_branch lw_105
lw_103:
  s_waitcnt vmcnt(12)
  s_barrier
  ds_read_b64_tr_b16 a[80:81], v24 offset:128
  ds_read_b64_tr_b16 a[82:83], v24 offset:896
  ds_read_b64_tr_b16 a[84:85], v24 offset:12416
  ds_read_b64_tr_b16 a[86:87], v24 offset:13184
  ds_read_b64_tr_b16 a[88:89], v25 offset:128
  ds_read_b64_tr_b16 a[90:91], v25 offset:896
  ds_read_b64_tr_b16 a[92:93], v25 offset:12416
  ds_read_b64_tr_b16 a[94:95], v25 offset:13184
  ds_read_b64_tr_b16 a[152:153], v22 offset:256
  ds_read_b64_tr_b16 a[154:155], v22 offset:1024
  ds_read_b64_tr_b16 a[156:157], v22 offset:12544
  ds_read_b64_tr_b16 a[158:159], v22 offset:13312
  s_waitcnt lgkmcnt(0)
  s_barrier
  s_add_u32 m0, s16, 0
  s_nop 0
  global_load_lds_dwordx4 v16, s[20:21]
  s_add_u32 m0, s16, 1024
  s_nop 0
  global_load_lds_dwordx4 v17, s[20:21]
  s_add_u32 m0, s16, 2048
  s_nop 0
  global_load_lds_dwordx4 v18, s[20:21]
  s_add_u32 m0, s16, 3072
  s_nop 0
  global_load_lds_dwordx4 v19, s[20:21]
  s_add_u32 m0, s16, 4096
  s_nop 0
  global_load_lds_dwordx4 v20, s[20:21]
  s_add_u32 m0, s16, 5120
  s_nop 0
  global_load_lds_dwordx4 v21, s[20:21]
  s_add_u32 s20, s20, 786432
  s_addc_u32 s21, s21, 0
  s_waitcnt vmcnt(12)
  s_barrier
  ds_read_b64_tr_b16 a[96:97], v24 offset:24704
  ds_read_b64_tr_b16 a[98:99], v24 offset:25472
  ds_read_b64_tr_b16 a[100:101], v24 offset:36992
  ds_read_b64_tr_b16 a[102:103], v24 offset:37760
  ds_read_b64_tr_b16 a[104:105], v25 offset:24704
  ds_read_b64_tr_b16 a[106:107], v25 offset:25472
  ds_read_b64_tr_b16 a[108:109], v25 offset:36992
  ds_read_b64_tr_b16 a[110:111], v25 offset:37760
  ds_read_b64_tr_b16 a[160:161], v22 offset:24832
  ds_read_b64_tr_b16 a[162:163], v22 offset:25600
  ds_read_b64_tr_b16 a[164:165], v22 offset:37120
  ds_read_b64_tr_b16 a[166:167], v22 offset:37888
  s_waitcnt lgkmcnt(0)
  s_barrier
  s_add_u32 m0, s16, 24576
  s_nop 0
  global_load_lds_dwordx4 v16, s[20:21]
  s_add_u32 m0, s16, 25600
  s_nop 0
  global_load_lds_dwordx4 v17, s[20:21]
  s_add_u32 m0, s16, 26624
  s_nop 0
  global_load_lds_dwordx4 v18, s[20:21]
  s_add_u32 m0, s16, 27648
  s_nop 0
  global_load_lds_dwordx4 v19, s[20:21]
  s_add_u32 m0, s16, 28672
  s_nop 0
  global_load_lds_dwordx4 v20, s[20:21]
  s_add_u32 m0, s16, 29696
  s_nop 0
  global_load_lds_dwordx4 v21, s[20:21]
  s_add_u32 s20, s20, 786432
  s_addc_u32 s21, s21, 0
  s_waitcnt vmcnt(12)
  s_barrier
  v_add_u32 v22, 49152, v22
  v_add_u32 v23, 49152, v23
  v_add_u32 v24, 49152, v24
  v_add_u32 v25, 49152, v25
  ds_read_b64_tr_b16 v[80:81], v24 offset:128
  ds_read_b64_tr_b16 v[82:83], v24 offset:896
  ds_read_b64_tr_b16 v[84:85], v24 offset:12416
  ds_read_b64_tr_b16 v[86:87], v24 offset:13184
  s_waitcnt lgkmcnt(0)
  ds_write_b128 v11, v[80:83] offset:0
  ds_write_b128 v11, v[84:87] offset:1024
  s_waitcnt lgkmcnt(0)
  ds_read_b64_tr_b16 v[80:81], v25 offset:128
  ds_read_b64_tr_b16 v[82:83], v25 offset:896
  ds_read_b64_tr_b16 v[84:85], v25 offset:12416
  ds_read_b64_tr_b16 v[86:87], v25 offset:13184
  s_waitcnt lgkmcnt(0)
  ds_write_b128 v11, v[80:83] offset:2048
  ds_write_b128 v11, v[84:87] offset:3072
  s_waitcnt lgkmcnt(0)
  ds_read_b64_tr_b16 v[80:81], v22 offset:256
  ds_read_b64_tr_b16 v[82:83], v22 offset:1024
  ds_read_b64_tr_b16 v[84:85], v22 offset:12544
  ds_read_b64_tr_b16 v[86:87], v22 offset:13312
  s_waitcnt lgkmcnt(0)
  ds_write_b128 v11, v[80:83] offset:4096
  ds_write_b128 v11, v[84:87] offset:5120
  s_waitcnt lgkmcnt(0)
  v_subrev_u32 v22, 49152, v22
  v_subrev_u32 v23, 49152, v23
  v_subrev_u32 v24, 49152, v24
  v_subrev_u32 v25, 49152, v25
  s_waitcnt lgkmcnt(0)
  s_barrier
  s_add_u32 m0, s16, 49152
  s_nop 0
  global_load_lds_dwordx4 v16, s[20:21]
  s_add_u32 m0, s16, 50176
  s_nop 0
  global_load_lds_dwordx4 v17, s[20:21]
  s_add_u32 m0, s16, 51200
  s_nop 0
  global_load_lds_dwordx4 v18, s[20:21]
  s_add_u32 m0, s16, 52224
  s_nop 0
  global_load_lds_dwordx4 v19, s[20:21]
  s_add_u32 m0, s16, 53248
  s_nop 0
  global_load_lds_dwordx4 v20, s[20:21]
  s_add_u32 m0, s16, 54272
  s_nop 0
  global_load_lds_dwordx4 v21, s[20:21]
  s_add_u32 s20, s20, 786432
  s_addc_u32 s21, s21, 0
  s_waitcnt vmcnt(12)
  s_barrier
  ds_read_b64_tr_b16 a[64:65], v24 offset:128
  ds_read_b64_tr_b16 a[66:67], v24 offset:896
  ds_read_b64_tr_b16 a[68:69], v24 offset:12416
  ds_read_b64_tr_b16 a[70:71], v24 offset:13184
  ds_read_b64_tr_b16 a[72:73], v25 offset:128
  ds_read_b64_tr_b16 a[74:75], v25 offset:896
  ds_read_b64_tr_b16 a[76:77], v25 offset:12416
  ds_read_b64_tr_b16 a[78:79], v25 offset:13184
  ds_read_b64_tr_b16 v[80:81], v22 offset:256
  ds_read_b64_tr_b16 v[82:83], v22 offset:1024
  ds_read_b64_tr_b16 v[84:85], v22 offset:12544
  ds_read_b64_tr_b16 v[86:87], v22 offset:13312
  s_waitcnt lgkmcnt(0)
  ds_write_b128 v11, v[80:83] offset:18432
  ds_write_b128 v11, v[84:87] offset:19456
  s_waitcnt lgkmcnt(0)
  s_waitcnt lgkmcnt(0)
  s_barrier
  s_add_u32 m0, s16, 0
  s_nop 0
  global_load_lds_dwordx4 v16, s[20:21]
  s_add_u32 m0, s16, 1024
  s_nop 0
  global_load_lds_dwordx4 v17, s[20:21]
  s_add_u32 m0, s16, 2048
  s_nop 0
  global_load_lds_dwordx4 v18, s[20:21]
  s_add_u32 m0, s16, 3072
  s_nop 0
  global_load_lds_dwordx4 v19, s[20:21]
  s_add_u32 m0, s16, 4096
  s_nop 0
  global_load_lds_dwordx4 v20, s[20:21]
  s_add_u32 m0, s16, 5120
  s_nop 0
  global_load_lds_dwordx4 v21, s[20:21]
  s_add_u32 s20, s20, 786432
  s_addc_u32 s21, s21, 0
  s_waitcnt vmcnt(12)
  s_barrier
  ds_read_b64_tr_b16 v[80:81], v24 offset:24704
  ds_read_b64_tr_b16 v[82:83], v24 offset:25472
  ds_read_b64_tr_b16 v[84:85], v24 offset:36992
  ds_read_b64_tr_b16 v[86:87], v24 offset:37760
  s_waitcnt lgkmcnt(0)
  ds_write_b128 v11, v[80:83] offset:12288
  ds_write_b128 v11, v[84:87] offset:13312
  s_waitcnt lgkmcnt(0)
  ds_read_b64_tr_b16 a[128:129], v25 offset:24704
  ds_read_b64_tr_b16 a[130:131], v25 offset:25472
  ds_read_b64_tr_b16 a[132:133], v25 offset:36992
  ds_read_b64_tr_b16 a[134:135], v25 offset:37760
  ds_read_b64_tr_b16 a[176:177], v22 offset:24832
  ds_read_b64_tr_b16 a[178:179], v22 offset:25600
  ds_read_b64_tr_b16 a[180:181], v22 offset:37120
  ds_read_b64_tr_b16 a[182:183], v22 offset:37888
  s_waitcnt lgkmcnt(0)
  s_barrier
  s_add_u32 m0, s16, 24576
  s_nop 0
  global_load_lds_dwordx4 v16, s[20:21]
  s_add_u32 m0, s16, 25600
  s_nop 0
  global_load_lds_dwordx4 v17, s[20:21]
  s_add_u32 m0, s16, 26624
  s_nop 0
  global_load_lds_dwordx4 v18, s[20:21]
  s_add_u32 m0, s16, 27648
  s_nop 0
  global_load_lds_dwordx4 v19, s[20:21]
  s_add_u32 m0, s16, 28672
  s_nop 0
  global_load_lds_dwordx4 v20, s[20:21]
  s_add_u32 m0, s16, 29696
  s_nop 0
  global_load_lds_dwordx4 v21, s[20:21]
  s_add_u32 s20, s20, 786432
  s_addc_u32 s21, s21, 0
  s_waitcnt vmcnt(12)
  s_barrier
  v_add_u32 v22, 49152, v22
  v_add_u32 v23, 49152, v23
  v_add_u32 v24, 49152, v24
  v_add_u32 v25, 49152, v25
  ds_read_b64_tr_b16 v[80:81], v24 offset:128
  ds_read_b64_tr_b16 v[82:83], v24 offset:896
  ds_read_b64_tr_b16 v[84:85], v24 offset:12416
  ds_read_b64_tr_b16 v[86:87], v24 offset:13184
  s_waitcnt lgkmcnt(0)
  ds_write_b128 v11, v[80:83] offset:14336
  ds_write_b128 v11, v[84:87] offset:15360
  s_waitcnt lgkmcnt(0)
  ds_read_b64_tr_b16 a[136:137], v25 offset:128
  ds_read_b64_tr_b16 a[138:139], v25 offset:896
  ds_read_b64_tr_b16 a[140:141], v25 offset:12416
  ds_read_b64_tr_b16 a[142:143], v25 offset:13184
  ds_read_b64_tr_b16 a[184:185], v22 offset:256
  ds_read_b64_tr_b16 a[186:187], v22 offset:1024
  ds_read_b64_tr_b16 a[188:189], v22 offset:12544
  ds_read_b64_tr_b16 a[190:191], v22 offset:13312
  v_subrev_u32 v22, 49152, v22
  v_subrev_u32 v23, 49152, v23
  v_subrev_u32 v24, 49152, v24
  v_subrev_u32 v25, 49152, v25
  s_waitcnt lgkmcnt(0)
  s_barrier
  s_add_u32 m0, s16, 49152
  s_nop 0
  global_load_lds_dwordx4 v16, s[20:21]
  s_add_u32 m0, s16, 50176
  s_nop 0
  global_load_lds_dwordx4 v17, s[20:21]
  s_add_u32 m0, s16, 51200
  s_nop 0
  global_load_lds_dwordx4 v18, s[20:21]
  s_add_u32 m0, s16, 52224
  s_nop 0
  global_load_lds_dwordx4 v19, s[20:21]
  s_add_u32 m0, s16, 53248
  s_nop 0
  global_load_lds_dwordx4 v20, s[20:21]
  s_add_u32 m0, s16, 54272
  s_nop 0
  global_load_lds_dwordx4 v21, s[20:21]
  s_add_u32 s20, s20, 786432
  s_addc_u32 s21, s21, 0
  s_waitcnt vmcnt(12)
  s_barrier
  ds_read_b64_tr_b16 v[80:81], v24 offset:128
  ds_read_b64_tr_b16 v[82:83], v24 offset:896
  ds_read_b64_tr_b16 v[84:85], v24 offset:12416
  ds_read_b64_tr_b16 v[86:87], v24 offset:13184
  s_waitcnt lgkmcnt(0)
  ds_write_b128 v11, v[80:83] offset:6144
  ds_write_b128 v11, v[84:87] offset:7168
  s_waitcnt lgkmcnt(0)
  ds_read_b64_tr_b16 a[0:1], v25 offset:128
  ds_read_b64_tr_b16 a[2:3], v25 offset:896
  ds_read_b64_tr_b16 a[4:5], v25 offset:12416
  ds_read_b64_tr_b16 a[6:7], v25 offset:13184
  ds_read_b64_tr_b16 a[8:9], v22 offset:256
  ds_read_b64_tr_b16 a[10:11], v22 offset:1024
  ds_read_b64_tr_b16 a[12:13], v22 offset:12544
  ds_read_b64_tr_b16 a[14:15], v22 offset:13312
  s_waitcnt lgkmcnt(0)
  s_barrier
  s_add_u32 m0, s16, 0
  s_nop 0
  global_load_lds_dwordx4 v16, s[20:21]
  s_add_u32 m0, s16, 1024
  s_nop 0
  global_load_lds_dwordx4 v17, s[20:21]
  s_add_u32 m0, s16, 2048
  s_nop 0
  global_load_lds_dwordx4 v18, s[20:21]
  s_add_u32 m0, s16, 3072
  s_nop 0
  global_load_lds_dwordx4 v19, s[20:21]
  s_add_u32 m0, s16, 4096
  s_nop 0
  global_load_lds_dwordx4 v20, s[20:21]
  s_add_u32 m0, s16, 5120
  s_nop 0
  global_load_lds_dwordx4 v21, s[20:21]
  s_add_u32 s20, s20, 786432
  s_addc_u32 s21, s21, 0
  s_waitcnt vmcnt(12)
  s_barrier
  ds_read_b64_tr_b16 a[112:113], v24 offset:24704
  ds_read_b64_tr_b16 a[114:115], v24 offset:25472
  ds_read_b64_tr_b16 a[116:117], v24 offset:36992
  ds_read_b64_tr_b16 a[118:119], v24 offset:37760
  ds_read_b64_tr_b16 a[120:121], v25 offset:24704
  ds_read_b64_tr_b16 a[122:123], v25 offset:25472
  ds_read_b64_tr_b16 a[124:125], v25 offset:36992
  ds_read_b64_tr_b16 a[126:127], v25 offset:37760
  ds_read_b64_tr_b16 a[168:169], v22 offset:24832
  ds_read_b64_tr_b16 a[170:171], v22 offset:25600
  ds_read_b64_tr_b16 a[172:173], v22 offset:37120
  ds_read_b64_tr_b16 a[174:175], v22 offset:37888
  s_waitcnt lgkmcnt(0)
  s_barrier
  s_add_u32 m0, s16, 24576
  s_nop 0
  global_load_lds_dwordx4 v16, s[22:23]
  s_add_u32 m0, s16, 25600
  s_nop 0
  global_load_lds_dwordx4 v17, s[22:23]
  s_add_u32 m0, s16, 26624
  s_nop 0
  global_load_lds_dwordx4 v18, s[22:23]
  s_add_u32 m0, s16, 27648
  s_nop 0
  global_load_lds_dwordx4 v19, s[22:23]
  s_add_u32 m0, s16, 28672
  s_nop 0
  global_load_lds_dwordx4 v20, s[22:23]
  s_add_u32 m0, s16, 29696
  s_nop 0
  global_load_lds_dwordx4 v21, s[22:23]
  s_add_u32 s22, s22, 786432
  s_addc_u32 s23, s23, 0
  s_waitcnt vmcnt(12)
  s_barrier
  v_add_u32 v22, 49152, v22
  v_add_u32 v23, 49152, v23
  v_add_u32 v24, 49152, v24
  v_add_u32 v25, 49152, v25
  ds_read_b64_tr_b16 a[16:17], v24 offset:128
  ds_read_b64_tr_b16 a[18:19], v24 offset:896
  ds_read_b64_tr_b16 a[20:21], v24 offset:12416
  ds_read_b64_tr_b16 a[22:23], v24 offset:13184
  ds_read_b64_tr_b16 a[24:25], v25 offset:128
  ds_read_b64_tr_b16 a[26:27], v25 offset:896
  ds_read_b64_tr_b16 a[28:29], v25 offset:12416
  ds_read_b64_tr_b16 a[30:31], v25 offset:13184
  ds_read_b64_tr_b16 a[32:33], v22 offset:256
  ds_read_b64_tr_b16 a[34:35], v22 offset:1024
  ds_read_b64_tr_b16 a[36:37], v22 offset:12544
  ds_read_b64_tr_b16 a[38:39], v22 offset:13312
  v_subrev_u32 v22, 49152, v22
  v_subrev_u32 v23, 49152, v23
  v_subrev_u32 v24, 49152, v24
  v_subrev_u32 v25, 49152, v25
  s_waitcnt lgkmcnt(0)
  s_barrier
  s_add_u32 m0, s16, 49152
  s_nop 0
  global_load_lds_dwordx4 v16, s[22:23]
  s_add_u32 m0, s16, 50176
  s_nop 0
  global_load_lds_dwordx4 v17, s[22:23]
  s_add_u32 m0, s16, 51200
  s_nop 0
  global_load_lds_dwordx4 v18, s[22:23]
  s_add_u32 m0, s16, 52224
  s_nop 0
  global_load_lds_dwordx4 v19, s[22:23]
  s_add_u32 m0, s16, 53248
  s_nop 0
  global_load_lds_dwordx4 v20, s[22:23]
  s_add_u32 m0, s16, 54272
  s_nop 0
  global_load_lds_dwordx4 v21, s[22:23]
  s_add_u32 s22, s22, 786432
  s_addc_u32 s23, s23, 0
  s_waitcnt vmcnt(12)
  s_barrier
  ds_read_b64_tr_b16 v[80:81], v24 offset:128
  ds_read_b64_tr_b16 v[82:83], v24 offset:896
  ds_read_b64_tr_b16 v[84:85], v24 offset:12416
  ds_read_b64_tr_b16 v[86:87], v24 offset:13184
  s_waitcnt lgkmcnt(0)
  ds_write_b128 v11, v[80:83] offset:16384
  ds_write_b128 v11, v[84:87] offset:17408
  s_waitcnt lgkmcnt(0)
  ds_read_b64_tr_b16 a[144:145], v25 offset:128
  ds_read_b64_tr_b16 a[146:147], v25 offset:896
  ds_read_b64_tr_b16 a[148:149], v25 offset:12416
  ds_read_b64_tr_b16 a[150:151], v25 offset:13184
  ds_read_b64_tr_b16 a[192:193], v22 offset:256
  ds_read_b64_tr_b16 a[194:195], v22 offset:1024
  ds_read_b64_tr_b16 a[196:197], v22 offset:12544
  ds_read_b64_tr_b16 a[198:199], v22 offset:13312
  s_waitcnt lgkmcnt(0)
  s_barrier
  s_add_u32 m0, s16, 0
  s_nop 0
  global_load_lds_dwordx4 v16, s[22:23]
  s_add_u32 m0, s16, 1024
  s_nop 0
  global_load_lds_dwordx4 v17, s[22:23]
  s_add_u32 m0, s16, 2048
  s_nop 0
  global_load_lds_dwordx4 v18, s[22:23]
  s_add_u32 m0, s16, 3072
  s_nop 0
  global_load_lds_dwordx4 v19, s[22:23]
  s_add_u32 m0, s16, 4096
  s_nop 0
  global_load_lds_dwordx4 v20, s[22:23]
  s_add_u32 m0, s16, 5120
  s_nop 0
  global_load_lds_dwordx4 v21, s[22:23]
  s_add_u32 s22, s22, 786432
  s_addc_u32 s23, s23, 0
  s_waitcnt vmcnt(12)
  s_barrier
  ds_read_b64_tr_b16 a[208:209], v22 offset:24832
  ds_read_b64_tr_b16 a[210:211], v22 offset:25600
  ds_read_b64_tr_b16 a[212:213], v22 offset:37120
  ds_read_b64_tr_b16 a[214:215], v22 offset:37888
  ds_read_b64_tr_b16 v[160:161], v24 offset:24704
  ds_read_b64_tr_b16 v[162:163], v24 offset:25472
  ds_read_b64_tr_b16 v[164:165], v24 offset:36992
  ds_read_b64_tr_b16 v[166:167], v24 offset:37760
  ds_read_b64_tr_b16 v[168:169], v25 offset:24704
  ds_read_b64_tr_b16 v[170:171], v25 offset:25472
  ds_read_b64_tr_b16 v[172:173], v25 offset:36992
  ds_read_b64_tr_b16 v[174:175], v25 offset:37760
  s_waitcnt lgkmcnt(0)
  s_barrier
  s_add_u32 m0, s16, 24576
  s_nop 0
  global_load_lds_dwordx4 v16, s[22:23]
  s_add_u32 m0, s16, 25600
  s_nop 0
  global_load_lds_dwordx4 v17, s[22:23]
  s_add_u32 m0, s16, 26624
  s_nop 0
  global_load_lds_dwordx4 v18, s[22:23]
  s_add_u32 m0, s16, 27648
  s_nop 0
  global_load_lds_dwordx4 v19, s[22:23]
  s_add_u32 m0, s16, 28672
  s_nop 0
  global_load_lds_dwordx4 v20, s[22:23]
  s_add_u32 m0, s16, 29696
  s_nop 0
  global_load_lds_dwordx4 v21, s[22:23]
  s_add_u32 s22, s22, 786432
  s_addc_u32 s23, s23, 0
  s_waitcnt vmcnt(12)
  s_barrier
  v_add_u32 v22, 49152, v22
  v_add_u32 v23, 49152, v23
  v_add_u32 v24, 49152, v24
  v_add_u32 v25, 49152, v25
  ds_read_b64_tr_b16 a[216:217], v22 offset:256
  ds_read_b64_tr_b16 a[218:219], v22 offset:1024
  ds_read_b64_tr_b16 a[220:221], v22 offset:12544
  ds_read_b64_tr_b16 a[222:223], v22 offset:13312
  ds_read_b64_tr_b16 v[176:177], v24 offset:128
  ds_read_b64_tr_b16 v[178:179], v24 offset:896
  ds_read_b64_tr_b16 v[180:181], v24 offset:12416
  ds_read_b64_tr_b16 v[182:183], v24 offset:13184
  ds_read_b64_tr_b16 v[184:185], v25 offset:128
  ds_read_b64_tr_b16 v[186:187], v25 offset:896
  ds_read_b64_tr_b16 v[188:189], v25 offset:12416
  ds_read_b64_tr_b16 v[190:191], v25 offset:13184
  v_subrev_u32 v22, 49152, v22
  v_subrev_u32 v23, 49152, v23
  v_subrev_u32 v24, 49152, v24
  v_subrev_u32 v25, 49152, v25
  s_waitcnt lgkmcnt(0)
  s_barrier
  s_add_u32 m0, s16, 49152
  s_nop 0
  global_load_lds_dwordx4 v16, s[22:23]
  s_add_u32 m0, s16, 50176
  s_nop 0
  global_load_lds_dwordx4 v17, s[22:23]
  s_add_u32 m0, s16, 51200
  s_nop 0
  global_load_lds_dwordx4 v18, s[22:23]
  s_add_u32 m0, s16, 52224
  s_nop 0
  global_load_lds_dwordx4 v19, s[22:23]
  s_add_u32 m0, s16, 53248
  s_nop 0
  global_load_lds_dwordx4 v20, s[22:23]
  s_add_u32 m0, s16, 54272
  s_nop 0
  global_load_lds_dwordx4 v21, s[22:23]
  s_add_u32 s22, s22, 786432
  s_addc_u32 s23, s23, 0
  s_waitcnt vmcnt(12)
  s_barrier
  ds_read_b64_tr_b16 a[40:41], v22 offset:256
  ds_read_b64_tr_b16 a[42:43], v22 offset:1024
  ds_read_b64_tr_b16 a[44:45], v22 offset:12544
  ds_read_b64_tr_b16 a[46:47], v22 offset:13312
  ds_read_b64_tr_b16 a[56:57], v24 offset:128
  ds_read_b64_tr_b16 a[58:59], v24 offset:896
  ds_read_b64_tr_b16 a[60:61], v24 offset:12416
  ds_read_b64_tr_b16 a[62:63], v24 offset:13184
  ds_read_b64_tr_b16 v[120:121], v25 offset:128
  ds_read_b64_tr_b16 v[122:123], v25 offset:896
  ds_read_b64_tr_b16 v[124:125], v25 offset:12416
  ds_read_b64_tr_b16 v[126:127], v25 offset:13184
  s_waitcnt lgkmcnt(0)
  s_barrier
  s_add_u32 m0, s16, 0
  s_nop 0
  global_load_lds_dwordx4 v16, s[22:23]
  s_add_u32 m0, s16, 1024
  s_nop 0
  global_load_lds_dwordx4 v17, s[22:23]
  s_add_u32 m0, s16, 2048
  s_nop 0
  global_load_lds_dwordx4 v18, s[22:23]
  s_add_u32 m0, s16, 3072
  s_nop 0
  global_load_lds_dwordx4 v19, s[22:23]
  s_add_u32 m0, s16, 4096
  s_nop 0
  global_load_lds_dwordx4 v20, s[22:23]
  s_add_u32 m0, s16, 5120
  s_nop 0
  global_load_lds_dwordx4 v21, s[22:23]
  s_add_u32 s22, s22, 786432
  s_addc_u32 s23, s23, 0
  s_waitcnt vmcnt(12)
  s_barrier
  ds_read_b64_tr_b16 a[200:201], v22 offset:24832
  ds_read_b64_tr_b16 a[202:203], v22 offset:25600
  ds_read_b64_tr_b16 a[204:205], v22 offset:37120
  ds_read_b64_tr_b16 a[206:207], v22 offset:37888
  ds_read_b64_tr_b16 v[144:145], v24 offset:24704
  ds_read_b64_tr_b16 v[146:147], v24 offset:25472
  ds_read_b64_tr_b16 v[148:149], v24 offset:36992
  ds_read_b64_tr_b16 v[150:151], v24 offset:37760
  ds_read_b64_tr_b16 v[152:153], v25 offset:24704
  ds_read_b64_tr_b16 v[154:155], v25 offset:25472
  ds_read_b64_tr_b16 v[156:157], v25 offset:36992
  ds_read_b64_tr_b16 v[158:159], v25 offset:37760
  s_waitcnt lgkmcnt(0)
  s_barrier
  s_add_u32 m0, s16, 24576
  s_nop 0
  global_load_lds_dwordx4 v16, s[22:23]
  s_add_u32 m0, s16, 25600
  s_nop 0
  global_load_lds_dwordx4 v17, s[22:23]
  s_add_u32 m0, s16, 26624
  s_nop 0
  global_load_lds_dwordx4 v18, s[22:23]
  s_add_u32 m0, s16, 27648
  s_nop 0
  global_load_lds_dwordx4 v19, s[22:23]
  s_add_u32 m0, s16, 28672
  s_nop 0
  global_load_lds_dwordx4 v20, s[22:23]
  s_add_u32 m0, s16, 29696
  s_nop 0
  global_load_lds_dwordx4 v21, s[22:23]
  s_add_u32 s22, s22, 786432
  s_addc_u32 s23, s23, 0
  s_waitcnt vmcnt(12)
  s_barrier
  v_add_u32 v22, 49152, v22
  v_add_u32 v23, 49152, v23
  v_add_u32 v24, 49152, v24
  v_add_u32 v25, 49152, v25
  ds_read_b64_tr_b16 a[232:233], v22 offset:256
  ds_read_b64_tr_b16 a[234:235], v22 offset:1024
  ds_read_b64_tr_b16 a[236:237], v22 offset:12544
  ds_read_b64_tr_b16 a[238:239], v22 offset:13312
  ds_read_b64_tr_b16 v[208:209], v24 offset:128
  ds_read_b64_tr_b16 v[210:211], v24 offset:896
  ds_read_b64_tr_b16 v[212:213], v24 offset:12416
  ds_read_b64_tr_b16 v[214:215], v24 offset:13184
  ds_read_b64_tr_b16 v[216:217], v25 offset:128
  ds_read_b64_tr_b16 v[218:219], v25 offset:896
  ds_read_b64_tr_b16 v[220:221], v25 offset:12416
  ds_read_b64_tr_b16 v[222:223], v25 offset:13184
  v_subrev_u32 v22, 49152, v22
  v_subrev_u32 v23, 49152, v23
  v_subrev_u32 v24, 49152, v24
  v_subrev_u32 v25, 49152, v25
  s_waitcnt lgkmcnt(0)
  s_barrier
  s_add_u32 m0, s16, 49152
  s_nop 0
  global_load_lds_dwordx4 v16, s[22:23]
  s_add_u32 m0, s16, 50176
  s_nop 0
  global_load_lds_dwordx4 v17, s[22:23]
  s_add_u32 m0, s16, 51200
  s_nop 0
  global_load_lds_dwordx4 v18, s[22:23]
  s_add_u32 m0, s16, 52224
  s_nop 0
  global_load_lds_dwordx4 v19, s[22:23]
  s_add_u32 m0, s16, 53248
  s_nop 0
  global_load_lds_dwordx4 v20, s[22:23]
  s_add_u32 m0, s16, 54272
  s_nop 0
  global_load_lds_dwordx4 v21, s[22:23]
  s_add_u32 s22, s22, 786432
  s_addc_u32 s23, s23, 0
  s_waitcnt vmcnt(12)
  s_barrier
  ds_read_b64_tr_b16 a[240:241], v22 offset:256
  ds_read_b64_tr_b16 a[242:243], v22 offset:1024
  ds_read_b64_tr_b16 a[244:245], v22 offset:12544
  ds_read_b64_tr_b16 a[246:247], v22 offset:13312
  ds_read_b64_tr_b16 v[224:225], v24 offset:128
  ds_read_b64_tr_b16 v[226:227], v24 offset:896
  ds_read_b64_tr_b16 v[228:229], v24 offset:12416
  ds_read_b64_tr_b16 v[230:231], v24 offset:13184
  ds_read_b64_tr_b16 v[232:233], v25 offset:128
  ds_read_b64_tr_b16 v[234:235], v25 offset:896
  ds_read_b64_tr_b16 v[236:237], v25 offset:12416
  ds_read_b64_tr_b16 v[238:239], v25 offset:13184
  s_waitcnt lgkmcnt(0)
  s_barrier
  s_add_u32 m0, s16, 0
  s_nop 0
  global_load_lds_dwordx4 v16, s[22:23]
  s_add_u32 m0, s16, 1024
  s_nop 0
  global_load_lds_dwordx4 v17, s[22:23]
  s_add_u32 m0, s16, 2048
  s_nop 0
  global_load_lds_dwordx4 v18, s[22:23]
  s_add_u32 m0, s16, 3072
  s_nop 0
  global_load_lds_dwordx4 v19, s[22:23]
  s_add_u32 m0, s16, 4096
  s_nop 0
  global_load_lds_dwordx4 v20, s[22:23]
  s_add_u32 m0, s16, 5120
  s_nop 0
  global_load_lds_dwordx4 v21, s[22:23]
  s_add_u32 s22, s22, 786432
  s_addc_u32 s23, s23, 0
  s_waitcnt vmcnt(12)
  s_barrier
  ds_read_b64_tr_b16 a[48:49], v22 offset:24832
  ds_read_b64_tr_b16 a[50:51], v22 offset:25600
  ds_read_b64_tr_b16 a[52:53], v22 offset:37120
  ds_read_b64_tr_b16 a[54:55], v22 offset:37888
  ds_read_b64_tr_b16 v[80:81], v24 offset:24704
  ds_read_b64_tr_b16 v[82:83], v24 offset:25472
  ds_read_b64_tr_b16 v[84:85], v24 offset:36992
  ds_read_b64_tr_b16 v[86:87], v24 offset:37760
  s_waitcnt lgkmcnt(0)
  ds_write_b128 v11, v[80:83] offset:10240
  ds_write_b128 v11, v[84:87] offset:11264
  s_waitcnt lgkmcnt(0)
  ds_read_b64_tr_b16 v[128:129], v25 offset:24704
  ds_read_b64_tr_b16 v[130:131], v25 offset:25472
  ds_read_b64_tr_b16 v[132:133], v25 offset:36992
  ds_read_b64_tr_b16 v[134:135], v25 offset:37760
  s_waitcnt lgkmcnt(0)
  s_barrier
  s_add_u32 m0, s16, 24576
  s_nop 0
  global_load_lds_dwordx4 v16, s[22:23]
  s_add_u32 m0, s16, 25600
  s_nop 0
  global_load_lds_dwordx4 v17, s[22:23]
  s_add_u32 m0, s16, 26624
  s_nop 0
  global_load_lds_dwordx4 v18, s[22:23]
  s_add_u32 m0, s16, 27648
  s_nop 0
  global_load_lds_dwordx4 v19, s[22:23]
  s_add_u32 m0, s16, 28672
  s_nop 0
  global_load_lds_dwordx4 v20, s[22:23]
  s_add_u32 m0, s16, 29696
  s_nop 0
  global_load_lds_dwordx4 v21, s[22:23]
  s_add_u32 s22, s22, 786432
  s_addc_u32 s23, s23, 0
  s_waitcnt vmcnt(12)
  s_barrier
  v_add_u32 v22, 49152, v22
  v_add_u32 v23, 49152, v23
  v_add_u32 v24, 49152, v24
  v_add_u32 v25, 49152, v25
  ds_read_b64_tr_b16 a[224:225], v22 offset:256
  ds_read_b64_tr_b16 a[226:227], v22 offset:1024
  ds_read_b64_tr_b16 a[228:229], v22 offset:12544
  ds_read_b64_tr_b16 a[230:231], v22 offset:13312
  ds_read_b64_tr_b16 v[192:193], v24 offset:128
  ds_read_b64_tr_b16 v[194:195], v24 offset:896
  ds_read_b64_tr_b16 v[196:197], v24 offset:12416
  ds_read_b64_tr_b16 v[198:199], v24 offset:13184
  ds_read_b64_tr_b16 v[200:201], v25 offset:128
  ds_read_b64_tr_b16 v[202:203], v25 offset:896
  ds_read_b64_tr_b16 v[204:205], v25 offset:12416
  ds_read_b64_tr_b16 v[206:207], v25 offset:13184
  v_subrev_u32 v22, 49152, v22
  v_subrev_u32 v23, 49152, v23
  v_subrev_u32 v24, 49152, v24
  v_subrev_u32 v25, 49152, v25
  s_waitcnt lgkmcnt(0)
  s_barrier
  s_waitcnt vmcnt(6)
  s_barrier
  ds_read_b64_tr_b16 v[80:81], v22 offset:256
  ds_read_b64_tr_b16 v[82:83], v22 offset:1024
  ds_read_b64_tr_b16 v[84:85], v22 offset:12544
  ds_read_b64_tr_b16 v[86:87], v22 offset:13312
  s_waitcnt lgkmcnt(0)
  ds_write_b128 v11, v[80:83] offset:8192
  ds_write_b128 v11, v[84:87] offset:9216
  s_waitcnt lgkmcnt(0)
  ds_read_b64_tr_b16 v[112:113], v24 offset:128
  ds_read_b64_tr_b16 v[114:115], v24 offset:896
  ds_read_b64_tr_b16 v[116:117], v24 offset:12416
  ds_read_b64_tr_b16 v[118:119], v24 offset:13184
  ds_read_b64_tr_b16 v[136:137], v25 offset:128
  ds_read_b64_tr_b16 v[138:139], v25 offset:896
  ds_read_b64_tr_b16 v[140:141], v25 offset:12416
  ds_read_b64_tr_b16 v[142:143], v25 offset:13184
  s_waitcnt lgkmcnt(0)
  s_barrier
  s_waitcnt vmcnt(0)
  s_barrier
  ds_read_b64_tr_b16 a[248:249], v22 offset:24832
  ds_read_b64_tr_b16 a[250:251], v22 offset:25600
  ds_read_b64_tr_b16 a[252:253], v22 offset:37120
  ds_read_b64_tr_b16 a[254:255], v22 offset:37888
  ds_read_b64_tr_b16 v[240:241], v24 offset:24704
  ds_read_b64_tr_b16 v[242:243], v24 offset:25472
  ds_read_b64_tr_b16 v[244:245], v24 offset:36992
  ds_read_b64_tr_b16 v[246:247], v24 offset:37760
  ds_read_b64_tr_b16 v[248:249], v25 offset:24704
  ds_read_b64_tr_b16 v[250:251], v25 offset:25472
  ds_read_b64_tr_b16 v[252:253], v25 offset:36992
  ds_read_b64_tr_b16 v[254:255], v25 offset:37760
  s_waitcnt lgkmcnt(0)
  s_barrier
  s_branch lw_105
lw_104:
  s_waitcnt vmcnt(12)
  s_barrier
  ds_read_b64_tr_b16 a[96:97], v24 offset:256
  ds_read_b64_tr_b16 a[98:99], v24 offset:1024
  ds_read_b64_tr_b16 a[100:101], v24 offset:12544
  ds_read_b64_tr_b16 a[102:103], v24 offset:13312
  ds_read_b64_tr_b16 a[104:105], v25 offset:256
  ds_read_b64_tr_b16 a[106:107], v25 offset:1024
  ds_read_b64_tr_b16 a[108:109], v25 offset:12544
  ds_read_b64_tr_b16 a[110:111], v25 offset:13312
  ds_read_b64_tr_b16 a[160:161], v23 offset:256
  ds_read_b64_tr_b16 a[162:163], v23 offset:1024
  ds_read_b64_tr_b16 a[164:165], v23 offset:12544
  ds_read_b64_tr_b16 a[166:167], v23 offset:13312
  s_waitcnt lgkmcnt(0)
  s_barrier
  s_add_u32 m0, s16, 0
  s_nop 0
  global_load_lds_dwordx4 v16, s[20:21]
  s_add_u32 m0, s16, 1024
  s_nop 0
  global_load_lds_dwordx4 v17, s[20:21]
  s_add_u32 m0, s16, 2048
  s_nop 0
  global_load_lds_dwordx4 v18, s[20:21]
  s_add_u32 m0, s16, 3072
  s_nop 0
  global_load_lds_dwordx4 v19, s[20:21]
  s_add_u32 m0, s16, 4096
  s_nop 0
  global_load_lds_dwordx4 v20, s[20:21]
  s_add_u32 m0, s16, 5120
  s_nop 0
  global_load_lds_dwordx4 v21, s[20:21]
  s_add_u32 s20, s20, 786432
  s_addc_u32 s21, s21, 0
  s_waitcnt vmcnt(12)
  s_barrier
  ds_read_b64_tr_b16 a[80:81], v24 offset:24832
  ds_read_b64_tr_b16 a[82:83], v24 offset:25600
  ds_read_b64_tr_b16 a[84:85], v24 offset:37120
  ds_read_b64_tr_b16 a[86:87], v24 offset:37888
  ds_read_b64_tr_b16 a[88:89], v25 offset:24832
  ds_read_b64_tr_b16 a[90:91], v25 offset:25600
  ds_read_b64_tr_b16 a[92:93], v25 offset:37120
  ds_read_b64_tr_b16 a[94:95], v25 offset:37888
  ds_read_b64_tr_b16 a[152:153], v23 offset:24832
  ds_read_b64_tr_b16 a[154:155], v23 offset:25600
  ds_read_b64_tr_b16 a[156:157], v23 offset:37120
  ds_read_b64_tr_b16 a[158:159], v23 offset:37888
  s_waitcnt lgkmcnt(0)
  s_barrier
  s_add_u32 m0, s16, 24576
  s_nop 0
  global_load_lds_dwordx4 v16, s[20:21]
  s_add_u32 m0, s16, 25600
  s_nop 0
  global_load_lds_dwordx4 v17, s[20:21]
  s_add_u32 m0, s16, 26624
  s_nop 0
  global_load_lds_dwordx4 v18, s[20:21]
  s_add_u32 m0, s16, 27648
  s_nop 0
  global_load_lds_dwordx4 v19, s[20:21]
  s_add_u32 m0, s16, 28672
  s_nop 0
  global_load_lds_dwordx4 v20, s[20:21]
  s_add_u32 m0, s16, 29696
  s_nop 0
  global_load_lds_dwordx4 v21, s[20:21]
  s_add_u32 s20, s20, 786432
  s_addc_u32 s21, s21, 0
  s_waitcnt vmcnt(12)
  s_barrier
  v_add_u32 v22, 49152, v22
  v_add_u32 v23, 49152, v23
  v_add_u32 v24, 49152, v24
  v_add_u32 v25, 49152, v25
  ds_read_b64_tr_b16 a[64:65], v24 offset:256
  ds_read_b64_tr_b16 a[66:67], v24 offset:1024
  ds_read_b64_tr_b16 a[68:69], v24 offset:12544
  ds_read_b64_tr_b16 a[70:71], v24 offset:13312
  ds_read_b64_tr_b16 a[72:73], v25 offset:256
  ds_read_b64_tr_b16 a[74:75], v25 offset:1024
  ds_read_b64_tr_b16 a[76:77], v25 offset:12544
  ds_read_b64_tr_b16 a[78:79], v25 offset:13312
  ds_read_b64_tr_b16 v[80:81], v23 offset:256
  ds_read_b64_tr_b16 v[82:83], v23 offset:1024
  ds_read_b64_tr_b16 v[84:85], v23 offset:12544
  ds_read_b64_tr_b16 v[86:87], v23 offset:13312
  s_waitcnt lgkmcnt(0)
  ds_write_b128 v11, v[80:83] offset:18432
  ds_write_b128 v11, v[84:87] offset:19456
  s_waitcnt lgkmcnt(0)
  v_subrev_u32 v22, 49152, v22
  v_subrev_u32 v23, 49152, v23
  v_subrev_u32 v24, 49152, v24
  v_subrev_u32 v25, 49152, v25
  s_waitcnt lgkmcnt(0)
  s_barrier
  s_add_u32 m0, s16, 49152
  s_nop 0
  global_load_lds_dwordx4 v16, s[20:21]
  s_add_u32 m0, s16, 50176
  s_nop 0
  global_load_lds_dwordx4 v17, s[20:21]
  s_add_u32 m0, s16, 51200
  s_nop 0
  global_load_lds_dwordx4 v18, s[20:21]
  s_add_u32 m0, s16, 52224
  s_nop 0
  global_load_lds_dwordx4 v19, s[20:21]
  s_add_u32 m0, s16, 53248
  s_nop 0
  global_load_lds_dwordx4 v20, s[20:21]
  s_add_u32 m0, s16, 54272
  s_nop 0
  global_load_lds_dwordx4 v21, s[20:21]
  s_add_u32 s20, s20, 786432
  s_addc_u32 s21, s21, 0
  s_waitcnt vmcnt(12)
  s_barrier
  ds_read_b64_tr_b16 v[80:81], v24 offset:256
  ds_read_b64_tr_b16 v[82:83], v24 offset:1024
  ds_read_b64_tr_b16 v[84:85], v24 offset:12544
  ds_read_b64_tr_b16 v[86:87], v24 offset:13312
  s_waitcnt lgkmcnt(0)
  ds_write_b128 v11, v[80:83] offset:0
  ds_write_b128 v11, v[84:87] offset:1024
  s_waitcnt lgkmcnt(0)
  ds_read_b64_tr_b16 v[80:81], v25 offset:256
  ds_read_b64_tr_b16 v[82:83], v25 offset:1024
  ds_read_b64_tr_b16 v[84:85], v25 offset:12544
  ds_read_b64_tr_b16 v[86:87], v25 offset:13312
  s_waitcnt lgkmcnt(0)
  ds_write_b128 v11, v[80:83] offset:2048
  ds_write_b128 v11, v[84:87] offset:3072
  s_waitcnt lgkmcnt(0)
  ds_read_b64_tr_b16 v[80:81], v23 offset:256
  ds_read_b64_tr_b16 v[82:83], v23 offset:1024
  ds_read_b64_tr_b16 v[84:85], v23 offset:12544
  ds_read_b64_tr_b16 v[86:87], v23 offset:13312
  s_waitcnt lgkmcnt(0)
  ds_write_b128 v11, v[80:83] offset:4096
  ds_write_b128 v11, v[84:87] offset:5120
  s_waitcnt lgkmcnt(0)
  s_waitcnt lgkmcnt(0)
  s_barrier
  s_add_u32 m0, s16, 0
  s_nop 0
  global_load_lds_dwordx4 v16, s[20:21]
  s_add_u32 m0, s16, 1024
  s_nop 0
  global_load_lds_dwordx4 v17, s[20:21]
  s_add_u32 m0, s16, 2048
  s_nop 0
  global_load_lds_dwordx4 v18, s[20:21]
  s_add_u32 m0, s16, 3072
  s_nop 0
  global_load_lds_dwordx4 v19, s[20:21]
  s_add_u32 m0, s16, 4096
  s_nop 0
  global_load_lds_dwordx4 v20, s[20:21]
  s_add_u32 m0, s16, 5120
  s_nop 0
  global_load_lds_dwordx4 v21, s[20:21]
  s_add_u32 s20, s20, 786432
  s_addc_u32 s21, s21, 0
  s_waitcnt vmcnt(12)
  s_barrier
  ds_read_b64_tr_b16 v[80:81], v24 offset:24832
  ds_read_b64_tr_b16 v[82:83], v24 offset:25600
  ds_read_b64_tr_b16 v[84:85], v24 offset:37120
  ds_read_b64_tr_b16 v[86:87], v24 offset:37888
  s_waitcnt lgkmcnt(0)
  ds_write_b128 v11, v[80:83] offset:14336
  ds_write_b128 v11, v[84:87] offset:15360
  s_waitcnt lgkmcnt(0)
  ds_read_b64_tr_b16 a[136:137], v25 offset:24832
  ds_read_b64_tr_b16 a[138:139], v25 offset:25600
  ds_read_b64_tr_b16 a[140:141], v25 offset:37120
  ds_read_b64_tr_b16 a[142:143], v25 offset:37888
  ds_read_b64_tr_b16 a[184:185], v23 offset:24832
  ds_read_b64_tr_b16 a[186:187], v23 offset:25600
  ds_read_b64_tr_b16 a[188:189], v23 offset:37120
  ds_read_b64_tr_b16 a[190:191], v23 offset:37888
  s_waitcnt lgkmcnt(0)
  s_barrier
  s_add_u32 m0, s16, 24576
  s_nop 0
  global_load_lds_dwordx4 v16, s[20:21]
  s_add_u32 m0, s16, 25600
  s_nop 0
  global_load_lds_dwordx4 v17, s[20:21]
  s_add_u32 m0, s16, 26624
  s_nop 0
  global_load_lds_dwordx4 v18, s[20:21]
  s_add_u32 m0, s16, 27648
  s_nop 0
  global_load_lds_dwordx4 v19, s[20:21]
  s_add_u32 m0, s16, 28672
  s_nop 0
  global_load_lds_dwordx4 v20, s[20:21]
  s_add_u32 m0, s16, 29696
  s_nop 0
  global_load_lds_dwordx4 v21, s[20:21]
  s_add_u32 s20, s20, 786432
  s_addc_u32 s21, s21, 0
  s_waitcnt vmcnt(12)
  s_barrier
  v_add_u32 v22, 49152, v22
  v_add_u32 v23, 49152, v23
  v_add_u32 v24, 49152, v24
  v_add_u32 v25, 49152, v25
  ds_read_b64_tr_b16 v[80:81], v24 offset:256
  ds_read_b64_tr_b16 v[82:83], v24 offset:1024
  ds_read_b64_tr_b16 v[84:85], v24 offset:12544
  ds_read_b64_tr_b16 v[86:87], v24 offset:13312
  s_waitcnt lgkmcnt(0)
  ds_write_b128 v11, v[80:83] offset:12288
  ds_write_b128 v11, v[84:87] offset:13312
  s_waitcnt lgkmcnt(0)
  ds_read_b64_tr_b16 a[128:129], v25 offset:256
  ds_read_b64_tr_b16 a[130:131], v25 offset:1024
  ds_read_b64_tr_b16 a[132:133], v25 offset:12544
  ds_read_b64_tr_b16 a[134:135], v25 offset:13312
  ds_read_b64_tr_b16 a[176:177], v23 offset:256
  ds_read_b64_tr_b16 a[178:179], v23 offset:1024
  ds_read_b64_tr_b16 a[180:181], v23 offset:12544
  ds_read_b64_tr_b16 a[182:183], v23 offset:13312
  v_subrev_u32 v22, 49152, v22
  v_subrev_u32 v23, 49152, v23
  v_subrev_u32 v24, 49152, v24
  v_subrev_u32 v25, 49152, v25
  s_waitcnt lgkmcnt(0)
  s_barrier
  s_add_u32 m0, s16, 49152
  s_nop 0
  global_load_lds_dwordx4 v16, s[20:21]
  s_add_u32 m0, s16, 50176
  s_nop 0
  global_load_lds_dwordx4 v17, s[20:21]
  s_add_u32 m0, s16, 51200
  s_nop 0
  global_load_lds_dwordx4 v18, s[20:21]
  s_add_u32 m0, s16, 52224
  s_nop 0
  global_load_lds_dwordx4 v19, s[20:21]
  s_add_u32 m0, s16, 53248
  s_nop 0
  global_load_lds_dwordx4 v20, s[20:21]
  s_add_u32 m0, s16, 54272
  s_nop 0
  global_load_lds_dwordx4 v21, s[20:21]
  s_add_u32 s20, s20, 786432
  s_addc_u32 s21, s21, 0
  s_waitcnt vmcnt(12)
  s_barrier
  ds_read_b64_tr_b16 a[112:113], v24 offset:256
  ds_read_b64_tr_b16 a[114:115], v24 offset:1024
  ds_read_b64_tr_b16 a[116:117], v24 offset:12544
  ds_read_b64_tr_b16 a[118:119], v24 offset:13312
  ds_read_b64_tr_b16 a[120:121], v25 offset:256
  ds_read_b64_tr_b16 a[122:123], v25 offset:1024
  ds_read_b64_tr_b16 a[124:125], v25 offset:12544
  ds_read_b64_tr_b16 a[126:127], v25 offset:13312
  ds_read_b64_tr_b16 a[168:169], v23 offset:256
  ds_read_b64_tr_b16 a[170:171], v23 offset:1024
  ds_read_b64_tr_b16 a[172:173], v23 offset:12544
  ds_read_b64_tr_b16 a[174:175], v23 offset:13312
  s_waitcnt lgkmcnt(0)
  s_barrier
  s_add_u32 m0, s16, 0
  s_nop 0
  global_load_lds_dwordx4 v16, s[20:21]
  s_add_u32 m0, s16, 1024
  s_nop 0
  global_load_lds_dwordx4 v17, s[20:21]
  s_add_u32 m0, s16, 2048
  s_nop 0
  global_load_lds_dwordx4 v18, s[20:21]
  s_add_u32 m0, s16, 3072
  s_nop 0
  global_load_lds_dwordx4 v19, s[20:21]
  s_add_u32 m0, s16, 4096
  s_nop 0
  global_load_lds_dwordx4 v20, s[20:21]
  s_add_u32 m0, s16, 5120
  s_nop 0
  global_load_lds_dwordx4 v21, s[20:21]
  s_add_u32 s20, s20, 786432
  s_addc_u32 s21, s21, 0
  s_waitcnt vmcnt(12)
  s_barrier
  ds_read_b64_tr_b16 v[80:81], v24 offset:24832
  ds_read_b64_tr_b16 v[82:83], v24 offset:25600
  ds_read_b64_tr_b16 v[84:85], v24 offset:37120
  ds_read_b64_tr_b16 v[86:87], v24 offset:37888
  s_waitcnt lgkmcnt(0)
  ds_write_b128 v11, v[80:83] offset:6144
  ds_write_b128 v11, v[84:87] offset:7168
  s_waitcnt lgkmcnt(0)
  ds_read_b64_tr_b16 a[0:1], v25 offset:24832
  ds_read_b64_tr_b16 a[2:3], v25 offset:25600
  ds_read_b64_tr_b16 a[4:5], v25 offset:37120
  ds_read_b64_tr_b16 a[6:7], v25 offset:37888
  ds_read_b64_tr_b16 a[8:9], v23 offset:24832
  ds_read_b64_tr_b16 a[10:11], v23 offset:25600
  ds_read_b64_tr_b16 a[12:13], v23 offset:37120
  ds_read_b64_tr_b16 a[14:15], v23 offset:37888
  s_waitcnt lgkmcnt(0)
  s_barrier
  s_add_u32 m0, s16, 24576
  s_nop 0
  global_load_lds_dwordx4 v16, s[22:23]
  s_add_u32 m0, s16, 25600
  s_nop 0
  global_load_lds_dwordx4 v17, s[22:23]
  s_add_u32 m0, s16, 26624
  s_nop 0
  global_load_lds_dwordx4 v18, s[22:23]
  s_add_u32 m0, s16, 27648
  s_nop 0
  global_load_lds_dwordx4 v19, s[22:23]
  s_add_u32 m0, s16, 28672
  s_nop 0
  global_load_lds_dwordx4 v20, s[22:23]
  s_add_u32 m0, s16, 29696
  s_nop 0
  global_load_lds_dwordx4 v21, s[22:23]
  s_add_u32 s22, s22, 786432
  s_addc_u32 s23, s23, 0
  s_waitcnt vmcnt(12)
  s_barrier
  v_add_u32 v22, 49152, v22
  v_add_u32 v23, 49152, v23
  v_add_u32 v24, 49152, v24
  v_add_u32 v25, 49152, v25
  ds_read_b64_tr_b16 v[80:81], v24 offset:256
  ds_read_b64_tr_b16 v[82:83], v24 offset:1024
  ds_read_b64_tr_b16 v[84:85], v24 offset:12544
  ds_read_b64_tr_b16 v[86:87], v24 offset:13312
  s_waitcnt lgkmcnt(0)
  ds_write_b128 v11, v[80:83] offset:16384
  ds_write_b128 v11, v[84:87] offset:17408
  s_waitcnt lgkmcnt(0)
  ds_read_b64_tr_b16 a[144:145], v25 offset:256
  ds_read_b64_tr_b16 a[146:147], v25 offset:1024
  ds_read_b64_tr_b16 a[148:149], v25 offset:12544
  ds_read_b64_tr_b16 a[150:151], v25 offset:13312
  ds_read_b64_tr_b16 a[192:193], v23 offset:256
  ds_read_b64_tr_b16 a[194:195], v23 offset:1024
  ds_read_b64_tr_b16 a[196:197], v23 offset:12544
  ds_read_b64_tr_b16 a[198:199], v23 offset:13312
  v_subrev_u32 v22, 49152, v22
  v_subrev_u32 v23, 49152, v23
  v_subrev_u32 v24, 49152, v24
  v_subrev_u32 v25, 49152, v25
  s_waitcnt lgkmcnt(0)
  s_barrier
  s_add_u32 m0, s16, 49152
  s_nop 0
  global_load_lds_dwordx4 v16, s[22:23]
  s_add_u32 m0, s16, 50176
  s_nop 0
  global_load_lds_dwordx4 v17, s[22:23]
  s_add_u32 m0, s16, 51200
  s_nop 0
  global_load_lds_dwordx4 v18, s[22:23]
  s_add_u32 m0, s16, 52224
  s_nop 0
  global_load_lds_dwordx4 v19, s[22:23]
  s_add_u32 m0, s16, 53248
  s_nop 0
  global_load_lds_dwordx4 v20, s[22:23]
  s_add_u32 m0, s16, 54272
  s_nop 0
  global_load_lds_dwordx4 v21, s[22:23]
  s_add_u32 s22, s22, 786432
  s_addc_u32 s23, s23, 0
  s_waitcnt vmcnt(12)
  s_barrier
  ds_read_b64_tr_b16 a[16:17], v24 offset:256
  ds_read_b64_tr_b16 a[18:19], v24 offset:1024
  ds_read_b64_tr_b16 a[20:21], v24 offset:12544
  ds_read_b64_tr_b16 a[22:23], v24 offset:13312
  ds_read_b64_tr_b16 a[24:25], v25 offset:256
  ds_read_b64_tr_b16 a[26:27], v25 offset:1024
  ds_read_b64_tr_b16 a[28:29], v25 offset:12544
  ds_read_b64_tr_b16 a[30:31], v25 offset:13312
  ds_read_b64_tr_b16 a[32:33], v23 offset:256
  ds_read_b64_tr_b16 a[34:35], v23 offset:1024
  ds_read_b64_tr_b16 a[36:37], v23 offset:12544
  ds_read_b64_tr_b16 a[38:39], v23 offset:13312
  s_waitcnt lgkmcnt(0)
  s_barrier
  s_add_u32 m0, s16, 0
  s_nop 0
  global_load_lds_dwordx4 v16, s[22:23]
  s_add_u32 m0, s16, 1024
  s_nop 0
  global_load_lds_dwordx4 v17, s[22:23]
  s_add_u32 m0, s16, 2048
  s_nop 0
  global_load_lds_dwordx4 v18, s[22:23]
  s_add_u32 m0, s16, 3072
  s_nop 0
  global_load_lds_dwordx4 v19, s[22:23]
  s_add_u32 m0, s16, 4096
  s_nop 0
  global_load_lds_dwordx4 v20, s[22:23]
  s_add_u32 m0, s16, 5120
  s_nop 0
  global_load_lds_dwordx4 v21, s[22:23]
  s_add_u32 s22, s22, 786432
  s_addc_u32 s23, s23, 0
  s_waitcnt vmcnt(12)
  s_barrier
  ds_read_b64_tr_b16 a[216:217], v23 offset:24832
  ds_read_b64_tr_b16 a[218:219], v23 offset:25600
  ds_read_b64_tr_b16 a[220:221], v23 offset:37120
  ds_read_b64_tr_b16 a[222:223], v23 offset:37888
  ds_read_b64_tr_b16 v[176:177], v24 offset:24832
  ds_read_b64_tr_b16 v[178:179], v24 offset:25600
  ds_read_b64_tr_b16 v[180:181], v24 offset:37120
  ds_read_b64_tr_b16 v[182:183], v24 offset:37888
  ds_read_b64_tr_b16 v[184:185], v25 offset:24832
  ds_read_b64_tr_b16 v[186:187], v25 offset:25600
  ds_read_b64_tr_b16 v[188:189], v25 offset:37120
  ds_read_b64_tr_b16 v[190:191], v25 offset:37888
  s_waitcnt lgkmcnt(0)
  s_barrier
  s_add_u32 m0, s16, 24576
  s_nop 0
  global_load_lds_dwordx4 v16, s[22:23]
  s_add_u32 m0, s16, 25600
  s_nop 0
  global_load_lds_dwordx4 v17, s[22:23]
  s_add_u32 m0, s16, 26624
  s_nop 0
  global_load_lds_dwordx4 v18, s[22:23]
  s_add_u32 m0, s16, 27648
  s_nop 0
  global_load_lds_dwordx4 v19, s[22:23]
  s_add_u32 m0, s16, 28672
  s_nop 0
  global_load_lds_dwordx4 v20, s[22:23]
  s_add_u32 m0, s16, 29696
  s_nop 0
  global_load_lds_dwordx4 v21, s[22:23]
  s_add_u32 s22, s22, 786432
  s_addc_u32 s23, s23, 0
  s_waitcnt vmcnt(12)
  s_barrier
  v_add_u32 v22, 49152, v22
  v_add_u32 v23, 49152, v23
  v_add_u32 v24, 49152, v24
  v_add_u32 v25, 49152, v25
  ds_read_b64_tr_b16 a[208:209], v23 offset:256
  ds_read_b64_tr_b16 a[210:211], v23 offset:1024
  ds_read_b64_tr_b16 a[212:213], v23 offset:12544
  ds_read_b64_tr_b16 a[214:215], v23 offset:13312
  ds_read_b64_tr_b16 v[160:161], v24 offset:256
  ds_read_b64_tr_b16 v[162:163], v24 offset:1024
  ds_read_b64_tr_b16 v[164:165], v24 offset:12544
  ds_read_b64_tr_b16 v[166:167], v24 offset:13312
  ds_read_b64_tr_b16 v[168:169], v25 offset:256
  ds_read_b64_tr_b16 v[170:171], v25 offset:1024
  ds_read_b64_tr_b16 v[172:173], v25 offset:12544
  ds_read_b64_tr_b16 v[174:175], v25 offset:13312
  v_subrev_u32 v22, 49152, v22
  v_subrev_u32 v23, 49152, v23
  v_subrev_u32 v24, 49152, v24
  v_subrev_u32 v25, 49152, v25
  s_waitcnt lgkmcnt(0)
  s_barrier
  s_add_u32 m0, s16, 49152
  s_nop 0
  global_load_lds_dwordx4 v16, s[22:23]
  s_add_u32 m0, s16, 50176
  s_nop 0
  global_load_lds_dwordx4 v17, s[22:23]
  s_add_u32 m0, s16, 51200
  s_nop 0
  global_load_lds_dwordx4 v18, s[22:23]
  s_add_u32 m0, s16, 52224
  s_nop 0
  global_load_lds_dwordx4 v19, s[22:23]
  s_add_u32 m0, s16, 53248
  s_nop 0
  global_load_lds_dwordx4 v20, s[22:23]
  s_add_u32 m0, s16, 54272
  s_nop 0
  global_load_lds_dwordx4 v21, s[22:23]
  s_add_u32 s22, s22, 786432
  s_addc_u32 s23, s23, 0
  s_waitcnt vmcnt(12)
  s_barrier
  ds_read_b64_tr_b16 a[200:201], v23 offset:256
  ds_read_b64_tr_b16 a[202:203], v23 offset:1024
  ds_read_b64_tr_b16 a[204:205], v23 offset:12544
  ds_read_b64_tr_b16 a[206:207], v23 offset:13312
  ds_read_b64_tr_b16 v[144:145], v24 offset:256
  ds_read_b64_tr_b16 v[146:147], v24 offset:1024
  ds_read_b64_tr_b16 v[148:149], v24 offset:12544
  ds_read_b64_tr_b16 v[150:151], v24 offset:13312
  ds_read_b64_tr_b16 v[152:153], v25 offset:256
  ds_read_b64_tr_b16 v[154:155], v25 offset:1024
  ds_read_b64_tr_b16 v[156:157], v25 offset:12544
  ds_read_b64_tr_b16 v[158:159], v25 offset:13312
  s_waitcnt lgkmcnt(0)
  s_barrier
  s_add_u32 m0, s16, 0
  s_nop 0
  global_load_lds_dwordx4 v16, s[22:23]
  s_add_u32 m0, s16, 1024
  s_nop 0
  global_load_lds_dwordx4 v17, s[22:23]
  s_add_u32 m0, s16, 2048
  s_nop 0
  global_load_lds_dwordx4 v18, s[22:23]
  s_add_u32 m0, s16, 3072
  s_nop 0
  global_load_lds_dwordx4 v19, s[22:23]
  s_add_u32 m0, s16, 4096
  s_nop 0
  global_load_lds_dwordx4 v20, s[22:23]
  s_add_u32 m0, s16, 5120
  s_nop 0
  global_load_lds_dwordx4 v21, s[22:23]
  s_add_u32 s22, s22, 786432
  s_addc_u32 s23, s23, 0
  s_waitcnt vmcnt(12)
  s_barrier
  ds_read_b64_tr_b16 a[40:41], v23 offset:24832
  ds_read_b64_tr_b16 a[42:43], v23 offset:25600
  ds_read_b64_tr_b16 a[44:45], v23 offset:37120
  ds_read_b64_tr_b16 a[46:47], v23 offset:37888
  ds_read_b64_tr_b16 a[56:57], v24 offset:24832
  ds_read_b64_tr_b16 a[58:59], v24 offset:25600
  ds_read_b64_tr_b16 a[60:61], v24 offset:37120
  ds_read_b64_tr_b16 a[62:63], v24 offset:37888
  ds_read_b64_tr_b16 v[120:121], v25 offset:24832
  ds_read_b64_tr_b16 v[122:123], v25 offset:25600
  ds_read_b64_tr_b16 v[124:125], v25 offset:37120
  ds_read_b64_tr_b16 v[126:127], v25 offset:37888
  s_waitcnt lgkmcnt(0)
  s_barrier
  s_add_u32 m0, s16, 24576
  s_nop 0
  global_load_lds_dwordx4 v16, s[22:23]
  s_add_u32 m0, s16, 25600
  s_nop 0
  global_load_lds_dwordx4 v17, s[22:23]
  s_add_u32 m0, s16, 26624
  s_nop 0
  global_load_lds_dwordx4 v18, s[22:23]
  s_add_u32 m0, s16, 27648
  s_nop 0
  global_load_lds_dwordx4 v19, s[22:23]
  s_add_u32 m0, s16, 28672
  s_nop 0
  global_load_lds_dwordx4 v20, s[22:23]
  s_add_u32 m0, s16, 29696
  s_nop 0
  global_load_lds_dwordx4 v21, s[22:23]
  s_add_u32 s22, s22, 786432
  s_addc_u32 s23, s23, 0
  s_waitcnt vmcnt(12)
  s_barrier
  v_add_u32 v22, 49152, v22
  v_add_u32 v23, 49152, v23
  v_add_u32 v24, 49152, v24
  v_add_u32 v25, 49152, v25
  ds_read_b64_tr_b16 a[240:241], v23 offset:256
  ds_read_b64_tr_b16 a[242:243], v23 offset:1024
  ds_read_b64_tr_b16 a[244:245], v23 offset:12544
  ds_read_b64_tr_b16 a[246:247], v23 offset:13312
  ds_read_b64_tr_b16 v[224:225], v24 offset:256
  ds_read_b64_tr_b16 v[226:227], v24 offset:1024
  ds_read_b64_tr_b16 v[228:229], v24 offset:12544
  ds_read_b64_tr_b16 v[230:231], v24 offset:13312
  ds_read_b64_tr_b16 v[232:233], v25 offset:256
  ds_read_b64_tr_b16 v[234:235], v25 offset:1024
  ds_read_b64_tr_b16 v[236:237], v25 offset:12544
  ds_read_b64_tr_b16 v[238:239], v25 offset:13312
  v_subrev_u32 v22, 49152, v22
  v_subrev_u32 v23, 49152, v23
  v_subrev_u32 v24, 49152, v24
  v_subrev_u32 v25, 49152, v25
  s_waitcnt lgkmcnt(0)
  s_barrier
  s_add_u32 m0, s16, 49152
  s_nop 0
  global_load_lds_dwordx4 v16, s[22:23]
  s_add_u32 m0, s16, 50176
  s_nop 0
  global_load_lds_dwordx4 v17, s[22:23]
  s_add_u32 m0, s16, 51200
  s_nop 0
  global_load_lds_dwordx4 v18, s[22:23]
  s_add_u32 m0, s16, 52224
  s_nop 0
  global_load_lds_dwordx4 v19, s[22:23]
  s_add_u32 m0, s16, 53248
  s_nop 0
  global_load_lds_dwordx4 v20, s[22:23]
  s_add_u32 m0, s16, 54272
  s_nop 0
  global_load_lds_dwordx4 v21, s[22:23]
  s_add_u32 s22, s22, 786432
  s_addc_u32 s23, s23, 0
  s_waitcnt vmcnt(12)
  s_barrier
  ds_read_b64_tr_b16 a[232:233], v23 offset:256
  ds_read_b64_tr_b16 a[234:235], v23 offset:1024
  ds_read_b64_tr_b16 a[236:237], v23 offset:12544
  ds_read_b64_tr_b16 a[238:239], v23 offset:13312
  ds_read_b64_tr_b16 v[208:209], v24 offset:256
  ds_read_b64_tr_b16 v[210:211], v24 offset:1024
  ds_read_b64_tr_b16 v[212:213], v24 offset:12544
  ds_read_b64_tr_b16 v[214:215], v24 offset:13312
  ds_read_b64_tr_b16 v[216:217], v25 offset:256
  ds_read_b64_tr_b16 v[218:219], v25 offset:1024
  ds_read_b64_tr_b16 v[220:221], v25 offset:12544
  ds_read_b64_tr_b16 v[222:223], v25 offset:13312
  s_waitcnt lgkmcnt(0)
  s_barrier
  s_add_u32 m0, s16, 0
  s_nop 0
  global_load_lds_dwordx4 v16, s[22:23]
  s_add_u32 m0, s16, 1024
  s_nop 0
  global_load_lds_dwordx4 v17, s[22:23]
  s_add_u32 m0, s16, 2048
  s_nop 0
  global_load_lds_dwordx4 v18, s[22:23]
  s_add_u32 m0, s16, 3072
  s_nop 0
  global_load_lds_dwordx4 v19, s[22:23]
  s_add_u32 m0, s16, 4096
  s_nop 0
  global_load_lds_dwordx4 v20, s[22:23]
  s_add_u32 m0, s16, 5120
  s_nop 0
  global_load_lds_dwordx4 v21, s[22:23]
  s_add_u32 s22, s22, 786432
  s_addc_u32 s23, s23, 0
  s_waitcnt vmcnt(12)
  s_barrier
  ds_read_b64_tr_b16 a[224:225], v23 offset:24832
  ds_read_b64_tr_b16 a[226:227], v23 offset:25600
  ds_read_b64_tr_b16 a[228:229], v23 offset:37120
  ds_read_b64_tr_b16 a[230:231], v23 offset:37888
  ds_read_b64_tr_b16 v[192:193], v24 offset:24832
  ds_read_b64_tr_b16 v[194:195], v24 offset:25600
  ds_read_b64_tr_b16 v[196:197], v24 offset:37120
  ds_read_b64_tr_b16 v[198:199], v24 offset:37888
  ds_read_b64_tr_b16 v[200:201], v25 offset:24832
  ds_read_b64_tr_b16 v[202:203], v25 offset:25600
  ds_read_b64_tr_b16 v[204:205], v25 offset:37120
  ds_read_b64_tr_b16 v[206:207], v25 offset:37888
  s_waitcnt lgkmcnt(0)
  s_barrier
  s_add_u32 m0, s16, 24576
  s_nop 0
  global_load_lds_dwordx4 v16, s[22:23]
  s_add_u32 m0, s16, 25600
  s_nop 0
  global_load_lds_dwordx4 v17, s[22:23]
  s_add_u32 m0, s16, 26624
  s_nop 0
  global_load_lds_dwordx4 v18, s[22:23]
  s_add_u32 m0, s16, 27648
  s_nop 0
  global_load_lds_dwordx4 v19, s[22:23]
  s_add_u32 m0, s16, 28672
  s_nop 0
  global_load_lds_dwordx4 v20, s[22:23]
  s_add_u32 m0, s16, 29696
  s_nop 0
  global_load_lds_dwordx4 v21, s[22:23]
  s_add_u32 s22, s22, 786432
  s_addc_u32 s23, s23, 0
  s_waitcnt vmcnt(12)
  s_barrier
  v_add_u32 v22, 49152, v22
  v_add_u32 v23, 49152, v23
  v_add_u32 v24, 49152, v24
  v_add_u32 v25, 49152, v25
  ds_read_b64_tr_b16 a[48:49], v23 offset:256
  ds_read_b64_tr_b16 a[50:51], v23 offset:1024
  ds_read_b64_tr_b16 a[52:53], v23 offset:12544
  ds_read_b64_tr_b16 a[54:55], v23 offset:13312
  ds_read_b64_tr_b16 v[80:81], v24 offset:256
  ds_read_b64_tr_b16 v[82:83], v24 offset:1024
  ds_read_b64_tr_b16 v[84:85], v24 offset:12544
  ds_read_b64_tr_b16 v[86:87], v24 offset:13312
  s_waitcnt lgkmcnt(0)
  ds_write_b128 v11, v[80:83] offset:10240
  ds_write_b128 v11, v[84:87] offset:11264
  s_waitcnt lgkmcnt(0)
  ds_read_b64_tr_b16 v[128:129], v25 offset:256
  ds_read_b64_tr_b16 v[130:131], v25 offset:1024
  ds_read_b64_tr_b16 v[132:133], v25 offset:12544
  ds_read_b64_tr_b16 v[134:135], v25 offset:13312
  v_subrev_u32 v22, 49152, v22
  v_subrev_u32 v23, 49152, v23
  v_subrev_u32 v24, 49152, v24
  v_subrev_u32 v25, 49152, v25
  s_waitcnt lgkmcnt(0)
  s_barrier
  s_waitcnt vmcnt(6)
  s_barrier
  ds_read_b64_tr_b16 a[248:249], v23 offset:256
  ds_read_b64_tr_b16 a[250:251], v23 offset:1024
  ds_read_b64_tr_b16 a[252:253], v23 offset:12544
  ds_read_b64_tr_b16 a[254:255], v23 offset:13312
  ds_read_b64_tr_b16 v[240:241], v24 offset:256
  ds_read_b64_tr_b16 v[242:243], v24 offset:1024
  ds_read_b64_tr_b16 v[244:245], v24 offset:12544
  ds_read_b64_tr_b16 v[246:247], v24 offset:13312
  ds_read_b64_tr_b16 v[248:249], v25 offset:256
  ds_read_b64_tr_b16 v[250:251], v25 offset:1024
  ds_read_b64_tr_b16 v[252:253], v25 offset:12544
  ds_read_b64_tr_b16 v[254:255], v25 offset:13312
  s_waitcnt lgkmcnt(0)
  s_barrier
  s_waitcnt vmcnt(0)
  s_barrier
  ds_read_b64_tr_b16 v[80:81], v23 offset:24832
  ds_read_b64_tr_b16 v[82:83], v23 offset:25600
  ds_read_b64_tr_b16 v[84:85], v23 offset:37120
  ds_read_b64_tr_b16 v[86:87], v23 offset:37888
  s_waitcnt lgkmcnt(0)
  ds_write_b128 v11, v[80:83] offset:8192
  ds_write_b128 v11, v[84:87] offset:9216
  s_waitcnt lgkmcnt(0)
  ds_read_b64_tr_b16 v[112:113], v24 offset:24832
  ds_read_b64_tr_b16 v[114:115], v24 offset:25600
  ds_read_b64_tr_b16 v[116:117], v24 offset:37120
  ds_read_b64_tr_b16 v[118:119], v24 offset:37888
  ds_read_b64_tr_b16 v[136:137], v25 offset:24832
  ds_read_b64_tr_b16 v[138:139], v25 offset:25600
  ds_read_b64_tr_b16 v[140:141], v25 offset:37120
  ds_read_b64_tr_b16 v[142:143], v25 offset:37888
  s_waitcnt lgkmcnt(0)
  s_barrier
lw_105:
  v_mov_b32 v16, 0
  v_lshrrev_b32 v17, 2, v1
  ds_write_b32 v17, v16 offset:6400
  s_cmp_lg_u32 s3, 0
  s_cbranch_scc1 a_i_106
  v_mov_b32 v0, 0x40000000
  v_cndmask_b32 v0, v0, v14, s[50:51]
a_i_106:
  v_lshrrev_b32 v16, 2, v1
  v_mov_b32 v17, 0
  s_mov_b32 exec_lo, 0x00030003
  s_mov_b32 exec_hi, 0x00030003
  v_mov_b32 v17, 32
  s_mov_b32 exec_lo, 0x00100010
  s_mov_b32 exec_hi, 0x00100010
  v_mov_b32 v17, 64
  s_mov_b64 exec, 4
  v_mov_b32 v17, 56
  s_mov_b32 exec_lo, 0
  s_mov_b32 exec_hi, 4
  v_mov_b32 v17, 268435456
  s_mov_b64 exec, -1
  s_branch isync_108
isync_107:
  s_sleep 4
  s_add_u32 s11, s11, 1
  s_cmp_gt_u32 s11, 131072
  s_cbranch_scc1 mega_done
isync_108:
  global_load_dword v18, v16, s[90:91] sc1
  s_waitcnt vmcnt(0)
  v_cmp_gt_u32 vcc, v17, v18
  s_cbranch_vccnz isync_107
  v_readlane_b32 s66, v18, 34
  s_nop 0
  s_cmp_lt_u32 s66, 268468224
  s_cselect_b32 s66, 0, 8192
  global_load_dword v18, v16, s[90:91] sc1
  s_waitcnt vmcnt(0)
  v_readlane_b32 s25, v18, 18
  s_mov_b32 s12, 1
  s_mov_b32 s67, 0
  s_mul_i32 s13, s26, 192
  v_bfe_u32 v40, v1, 4, 1
  v_mul_u32_u24 v40, 191, v40
  v_add_u32 v40, s13, v40
  v_lshrrev_b32 v40, 8, v40
  v_bfe_u32 v41, v1, 5, 1
  v_mad_u32_u24 v40, v41, 24, v40
  v_lshlrev_b32 v40, 7, v40
  v_add_u32 v40, 83968, v40
  s_branch wf_111
wf_110:
  s_sleep 2
  s_add_u32 s11, s11, 1
  s_cmp_gt_u32 s11, 131072
  s_cbranch_scc1 mega_done
wf_111:
  buffer_load_dword v41, v40, s[4:7], s66 offen sc1
  s_waitcnt vmcnt(0)
  v_cmp_gt_u32 vcc, s12, v41
  s_cbranch_vccnz wf_110
  s_add_u32 m0, s62, 0
  s_nop 0
  buffer_load_dwordx4 v1, s[4:7], s56 offen offset:0 lds
  buffer_load_dwordx4 v1, s[4:7], s56 offen offset:1024 lds
  buffer_load_dwordx4 v1, s[4:7], s56 offen offset:2048 lds
  s_add_u32 s56, s56, 393216
  s_add_u32 m0, s62, 12288
  s_nop 0
  buffer_load_dwordx4 v1, s[4:7], s57 offen offset:0 lds
  buffer_load_dwordx4 v1, s[4:7], s57 offen offset:1024 lds
  buffer_load_dwordx4 v1, s[4:7], s57 offen offset:2048 lds
  s_add_u32 s57, s57, 393216
  s_add_u32 s62, s62, 24576
  s_mov_b32 s64, -24576
  s_cmp_lg_u32 s25, 0
  s_cbranch_scc1 a_loop_slow
a_loop:
  ds_read_b128 v[80:83], v11 offset:0
  ds_read_b128 v[84:87], v11 offset:1024
  ds_read_b128 v[88:91], v11 offset:2048
  ds_read_b128 v[92:95], v11 offset:3072
  ds_read_b128 v[96:99], v11 offset:4096
  ds_read_b128 v[100:103], v11 offset:5120
  ds_read_b128 v[104:107], v11 offset:6144
  ds_read_b128 v[108:111], v11 offset:7168
  v_mov_b32 v56, 0
  v_mov_b32 v57, 0
  v_mov_b32 v58, 0
  v_mov_b32 v59, 0
  v_mov_b32 v60, 0
  v_mov_b32 v61, 0
  v_mov_b32 v62, 0
  v_mov_b32 v63, 0
  v_mov_b32 v64, 0
  v_mov_b32 v65, 0
  v_mov_b32 v66, 0
  v_mov_b32 v67, 0
  v_mov_b32 v68, 0
  v_mov_b32 v69, 0
  v_mov_b32 v70, 0
  v_mov_b32 v71, 0
  v_mov_b32 v72, 0
  v_mov_b32 v73, 0
  v_mov_b32 v74, 0
  v_mov_b32 v75, 0
  v_mov_b32 v76, 0
  v_mov_b32 v77, 0
  v_mov_b32 v78, 0
  v_mov_b32 v79, 0
  s_add_u32 s12, s10, 2
  s_min_u32 s12, s12, 64
  s_cmp_le_u32 s12, s67
  s_cbranch_scc1 ak_112
  s_mul_i32 s13, s26, 192
  v_bfe_u32 v40, v1, 4, 1
  v_mul_u32_u24 v40, 191, v40
  v_add_u32 v40, s13, v40
  v_lshrrev_b32 v40, 8, v40
  v_bfe_u32 v41, v1, 5, 1
  v_mad_u32_u24 v40, v41, 24, v40
  v_lshlrev_b32 v40, 7, v40
  v_add_u32 v40, 83968, v40
  buffer_load_dword v41, v40, s[4:7], s66 offen sc1
  s_waitcnt vmcnt(0)
  v_cmp_gt_u32 s[54:55], s12, v41
  v_readlane_b32 s67, v41, 0
  v_readlane_b32 s12, v41, 1
  v_readlane_b32 s13, v41, 2
  v_readlane_b32 s14, v41, 3
  s_min_u32 s67, s67, s12
  s_min_u32 s13, s13, s14
  s_min_u32 s67, s67, s13
ak_112:
  s_waitcnt vmcnt(0)
  s_sleep 5
  s_waitcnt lgkmcnt(0)
pm_113:
  buffer_load_dwordx4 v[16:19], v2, s[4:7], s30 offen offset:0 sc1
  buffer_load_dwordx4 v[20:23], v2, s[4:7], s31 offen offset:0 sc1
  buffer_load_dwordx4 v[24:27], v1, s[4:7], s32 offen offset:0 sc1
  s_add_u32 s11, s11, 1
  s_cmp_gt_u32 s11, 131072
  s_cbranch_scc1 mega_done
  s_waitcnt vmcnt(0)
  v_bitop3_b32 v14, v16, v20, s28 bitop3:0x7e
  v_bitop3_b32 v14, v24, v14, s28 bitop3:0xde
  v_and_b32 v14, 1, v14
  v_cmp_ne_u32 vcc, 0, v14
  s_cbranch_vccnz pm_113
  v_smfmac_f32_16x16x64_bf16 v[56:59], v[16:19], v[80:87], v8
  ds_write_b128 v2, v[16:19] offset:12288
  v_smfmac_f32_16x16x64_bf16 v[60:63], v[16:19], v[88:95], v8
  v_add_u32 v14, s65, v12
  v_smfmac_f32_16x16x64_bf16 v[64:67], v[16:19], v[96:103], v8
  ds_write_b128 v2, v[20:23] offset:16384
  v_smfmac_f32_16x16x64_bf16 v[56:59], v[20:23], v[104:111], v8
  v_smfmac_f32_16x16x64_bf16 v[60:63], v[20:23], a[0:7], v8
  ds_write_b128 v2, v[24:27] offset:20480
  v_smfmac_f32_16x16x64_bf16 v[64:67], v[20:23], a[8:15], v8
  ds_read_b128 v[80:83], v11 offset:8192
  v_smfmac_f32_16x16x64_bf16 v[56:59], v[24:27], a[16:23], v8
  ds_read_b128 v[84:87], v11 offset:9216
  v_smfmac_f32_16x16x64_bf16 v[60:63], v[24:27], a[24:31], v8
  ds_read_b128 v[88:91], v11 offset:10240
  v_smfmac_f32_16x16x64_bf16 v[64:67], v[24:27], a[32:39], v8
  ds_read_b128 v[92:95], v11 offset:11264
  s_waitcnt lgkmcnt(4)
  s_barrier
  ds_read_b128 v[28:31], v4 offset:12288
  v_smfmac_f32_16x16x64_bf16 v[68:71], v[16:19], a[40:47], v8
  ds_read_b128 v[32:35], v5 offset:12288
  v_smfmac_f32_16x16x64_bf16 v[68:71], v[20:23], a[48:55], v8
  ds_read_b128 v[36:39], v6 offset:12288
  s_waitcnt lgkmcnt(5)
  v_smfmac_f32_16x16x64_bf16 v[68:71], v[24:27], v[80:87], v8
  ds_read_b128 v[40:43], v4 offset:16384
  v_smfmac_f32_16x16x64_bf16 v[72:75], v[16:19], a[56:63], v8
  ds_read_b128 v[44:47], v5 offset:16384
  s_waitcnt lgkmcnt(5)
  v_smfmac_f32_16x16x64_bf16 v[72:75], v[20:23], v[88:95], v8
  ds_read_b128 v[48:51], v6 offset:16384
  s_waitcnt lgkmcnt(5)
  v_smfmac_f32_16x16x64_bf16 v[56:59], v[28:31], a[64:71], v8
  ds_read_b128 v[52:55], v4 offset:20480
  v_smfmac_f32_16x16x64_bf16 v[60:63], v[28:31], a[72:79], v8
  ds_read_b128 v[96:99], v11 offset:12288
  s_waitcnt lgkmcnt(6)
  v_smfmac_f32_16x16x64_bf16 v[56:59], v[32:35], a[80:87], v8
  ds_read_b128 v[100:103], v11 offset:13312
  v_smfmac_f32_16x16x64_bf16 v[60:63], v[32:35], a[88:95], v8
  ds_read_b128 v[104:107], v11 offset:14336
  s_waitcnt lgkmcnt(7)
  v_smfmac_f32_16x16x64_bf16 v[56:59], v[36:39], a[96:103], v8
  ds_read_b128 v[108:111], v11 offset:15360
  v_smfmac_f32_16x16x64_bf16 v[60:63], v[36:39], a[104:111], v8
  ds_read_b128 v[80:83], v11 offset:16384
  s_waitcnt lgkmcnt(8)
  v_smfmac_f32_16x16x64_bf16 v[56:59], v[40:43], a[112:119], v8
  ds_read_b128 v[84:87], v11 offset:17408
  v_smfmac_f32_16x16x64_bf16 v[60:63], v[40:43], a[120:127], v8
  ds_read_b128 v[88:91], v11 offset:18432
  s_waitcnt lgkmcnt(5)
  v_smfmac_f32_16x16x64_bf16 v[56:59], v[44:47], v[96:103], v8
  ds_read_b128 v[92:95], v11 offset:19456
  v_smfmac_f32_16x16x64_bf16 v[60:63], v[44:47], a[128:135], v8
  s_waitcnt lgkmcnt(4)
  v_smfmac_f32_16x16x64_bf16 v[56:59], v[48:51], v[104:111], v8
  v_smfmac_f32_16x16x64_bf16 v[60:63], v[48:51], a[136:143], v8
  ds_read_b128 v[96:99], v12 offset:0
  s_waitcnt lgkmcnt(3)
  v_smfmac_f32_16x16x64_bf16 v[56:59], v[52:55], v[80:87], v8
  ds_read_b128 v[100:103], v12 offset:6144
  v_smfmac_f32_16x16x64_bf16 v[60:63], v[52:55], a[144:151], v8
  ds_read_b128 v[104:107], v14 offset:0
  s_waitcnt lgkmcnt(3)
  v_smfmac_f32_16x16x64_bf16 v[64:67], v[28:31], v[88:95], v8
  ds_read_b128 v[108:111], v14 offset:6144
  v_smfmac_f32_16x16x64_bf16 v[64:67], v[32:35], a[152:159], v8
  v_smfmac_f32_16x16x64_bf16 v[64:67], v[36:39], a[160:167], v8
  v_permlane32_swap_b32 v56, v60
  v_smfmac_f32_16x16x64_bf16 v[64:67], v[40:43], a[168:175], v8
  v_permlane32_swap_b32 v57, v61
  v_smfmac_f32_16x16x64_bf16 v[64:67], v[44:47], a[176:183], v8
  v_permlane32_swap_b32 v58, v62
  v_smfmac_f32_16x16x64_bf16 v[64:67], v[48:51], a[184:191], v8
  v_permlane32_swap_b32 v59, v63
  v_smfmac_f32_16x16x64_bf16 v[64:67], v[52:55], a[192:199], v8
  v_add_f32 v56, v56, v60
  v_smfmac_f32_16x16x64_bf16 v[68:71], v[28:31], a[200:207], v8
  v_add_f32 v57, v57, v61
  v_smfmac_f32_16x16x64_bf16 v[68:71], v[32:35], a[208:215], v8
  v_add_f32 v58, v58, v62
  v_smfmac_f32_16x16x64_bf16 v[68:71], v[36:39], a[216:223], v8
  v_add_f32 v59, v59, v63
  v_smfmac_f32_16x16x64_bf16 v[68:71], v[40:43], a[224:231], v8
  v_cvt_pk_bf16_f32 v60, v56, v57
  v_smfmac_f32_16x16x64_bf16 v[68:71], v[44:47], a[232:239], v8
  v_cvt_pk_bf16_f32 v61, v58, v59
  v_smfmac_f32_16x16x64_bf16 v[68:71], v[48:51], a[240:247], v8
  ds_write_b64 v9, v[60:61] offset:0
  v_permlane32_swap_b32 v64, v66
  v_smfmac_f32_16x16x64_bf16 v[68:71], v[52:55], a[248:255], v8
  ds_read_b64_tr_b16 v[80:81], v15 offset:0
  v_permlane32_swap_b32 v65, v67
  v_smfmac_f32_16x16x64_bf16 v[72:75], v[24:27], v[112:119], v8
  ds_read_b64_tr_b16 v[82:83], v15 offset:32
  v_add_f32 v64, v64, v66
  v_smfmac_f32_16x16x64_bf16 v[76:79], v[16:19], v[120:127], v8
  v_add_f32 v65, v65, v67
  v_smfmac_f32_16x16x64_bf16 v[76:79], v[20:23], v[128:135], v8
  v_cvt_pk_bf16_f32 v64, v64, v65
  v_smfmac_f32_16x16x64_bf16 v[76:79], v[24:27], v[136:143], v8
  ds_write_b32 v3, v64 offset:0
  v_smfmac_f32_16x16x64_bf16 v[72:75], v[28:31], v[144:151], v8
  ds_read_b64_tr_b16 v[84:85], v7 offset:0
  v_smfmac_f32_16x16x64_bf16 v[76:79], v[28:31], v[152:159], v8
  ds_read_b64_tr_b16 v[86:87], v7 offset:32
  v_permlane32_swap_b32 v68, v70
  s_waitcnt lgkmcnt(8)
  s_waitcnt lgkmcnt(3)
  v_mfma_f32_16x16x32_bf16 v[56:59], v[96:99], v[80:83], 0
  v_mfma_f32_16x16x32_bf16 v[60:63], v[100:103], v[80:83], 0
  v_smfmac_f32_16x16x64_bf16 v[72:75], v[32:35], v[160:167], v8
  v_permlane32_swap_b32 v69, v71
  v_smfmac_f32_16x16x64_bf16 v[76:79], v[32:35], v[168:175], v8
  v_add_f32 v68, v68, v70
  v_smfmac_f32_16x16x64_bf16 v[72:75], v[36:39], v[176:183], v8
  v_add_f32 v69, v69, v71
  v_smfmac_f32_16x16x64_bf16 v[76:79], v[36:39], v[184:191], v8
  v_cvt_pk_bf16_f32 v68, v68, v69
  s_waitcnt lgkmcnt(0)
  v_mfma_f32_16x16x32_bf16 v[56:59], v[104:107], v[84:87], v[56:59]
  v_mfma_f32_16x16x32_bf16 v[60:63], v[108:111], v[84:87], v[60:63]
  v_smfmac_f32_16x16x64_bf16 v[72:75], v[40:43], v[192:199], v8
  ds_write_b32 v3, v68 offset:3200
  v_smfmac_f32_16x16x64_bf16 v[76:79], v[40:43], v[200:207], v8
  v_smfmac_f32_16x16x64_bf16 v[72:75], v[44:47], v[208:215], v8
  v_cndmask_b32 v88, v56, v58, s[52:53]
  v_smfmac_f32_16x16x64_bf16 v[76:79], v[44:47], v[216:223], v8
  v_cndmask_b32 v89, v57, v59, s[52:53]
  v_smfmac_f32_16x16x64_bf16 v[72:75], v[48:51], v[224:231], v8
  ds_write_b64 v2, v[88:89] offset:8192
  v_cndmask_b32 v90, v60, v62, s[52:53]
  v_smfmac_f32_16x16x64_bf16 v[76:79], v[48:51], v[232:239], v8
  v_cndmask_b32 v91, v61, v63, s[52:53]
  v_smfmac_f32_16x16x64_bf16 v[72:75], v[52:55], v[240:247], v8
  ds_write_b64 v2, v[90:91] offset:8200
  v_smfmac_f32_16x16x64_bf16 v[76:79], v[52:55], v[248:255], v8
  s_cmp_lg_u32 s3, 0
  s_nop 6
  v_permlane32_swap_b32 v72, v76
  v_permlane32_swap_b32 v73, v77
  v_permlane32_swap_b32 v74, v78
  v_permlane32_swap_b32 v75, v79
  v_pk_add_f32 v[72:73], v[72:73], v[76:77]
  v_pk_add_f32 v[74:75], v[74:75], v[78:79]
  v_cvt_pk_bf16_f32 v76, v72, v73
  v_cvt_pk_bf16_f32 v77, v74, v75
  ds_write_b64 v9, v[76:77] offset:3200
  v_mov_b32 v14, 0xf149f2ca
  v_cndmask_b32 v64, v14, 0, s[50:51]
  v_cndmask_b32 v65, v14, 0, s[50:51]
  v_cndmask_b32 v66, v14, 0, s[50:51]
  v_cndmask_b32 v67, v14, 0, s[50:51]
  s_waitcnt lgkmcnt(0)
  s_barrier
  s_cbranch_scc1 a_xrows
  ds_read_b64_tr_b16 v[28:29], v10 offset:0
  ds_read_b64_tr_b16 v[30:31], v10 offset:32
  ds_read_b64_tr_b16 v[32:33], v10 offset:256
  ds_read_b64_tr_b16 v[34:35], v10 offset:288
  ds_read_b64_tr_b16 v[36:37], v10 offset:512
  ds_read_b64_tr_b16 v[38:39], v10 offset:544
  ds_read_b64_tr_b16 v[40:41], v10 offset:768
  ds_read_b64_tr_b16 v[42:43], v10 offset:800
  ds_read_b64_tr_b16 v[44:45], v10 offset:1024
  ds_read_b64_tr_b16 v[46:47], v10 offset:1056
  ds_read_b64_tr_b16 v[48:49], v10 offset:1280
  ds_read_b64_tr_b16 v[50:51], v10 offset:1312
  ds_read_b128 v[16:19], v1 offset:9216
  ds_read_b128 v[80:83], v1 offset:10240
  ds_read_b128 v[84:87], v1 offset:11264
  s_waitcnt lgkmcnt(13)
  v_mfma_f32_16x16x32_bf16 v[64:67], v[28:31], v[28:31], v[64:67]
  s_waitcnt lgkmcnt(11)
  v_mfma_f32_16x16x32_bf16 v[64:67], v[32:35], v[32:35], v[64:67]
  s_waitcnt lgkmcnt(9)
  v_mfma_f32_16x16x32_bf16 v[64:67], v[36:39], v[36:39], v[64:67]
  s_waitcnt lgkmcnt(7)
  v_mfma_f32_16x16x32_bf16 v[64:67], v[40:43], v[40:43], v[64:67]
  s_waitcnt lgkmcnt(5)
  v_mfma_f32_16x16x32_bf16 v[64:67], v[44:47], v[44:47], v[64:67]
  s_waitcnt lgkmcnt(3)
  v_mfma_f32_16x16x32_bf16 v[64:67], v[48:51], v[48:51], v[64:67]
  s_waitcnt lgkmcnt(2)
  v_pk_add_f32 v[16:17], v[16:17], v[88:89]
  v_pk_add_f32 v[18:19], v[18:19], v[90:91]
  s_waitcnt lgkmcnt(1)
  v_pk_add_f32 v[16:17], v[16:17], v[80:81]
  v_pk_add_f32 v[18:19], v[18:19], v[82:83]
  s_waitcnt lgkmcnt(0)
  v_pk_add_f32 v[16:17], v[16:17], v[84:85]
  v_pk_add_f32 v[18:19], v[18:19], v[86:87]
  v_max3_f32 v24, v16, v17, v18
  v_max_f32 v24, v24, v19
  v_mov_b32_dpp v64, v66 row_shr:8 row_mask:0xf bank_mask:0xc
  v_mov_b32_dpp v65, v67 row_shr:8 row_mask:0xf bank_mask:0xc
  v_max3_f32 v24, v24, v64, v65
  v_mul_f32 v24, s70, v24
  v_fma_f32 v16, v16, s70, -v24
  v_fma_f32 v17, v17, s70, -v24
  v_max_f32_dpp v27, v24, v24 row_ror:8 row_mask:0xf bank_mask:0xf
  v_mov_b32 v25, v27
  v_fma_f32 v18, v18, s70, -v24
  v_fma_f32 v19, v19, s70, -v24
  v_permlane16_swap_b32 v27, v25
  v_max_f32 v27, v27, v25
  v_mov_b32 v25, v27
  v_fma_f32 v20, v64, s70, -v24
  v_fma_f32 v21, v65, s70, -v24
  v_permlane32_swap_b32 v27, v25
  v_max_f32 v27, v27, v25
  v_sub_f32 v27, v24, v27
  v_exp_f32 v16, v16
  v_exp_f32 v17, v17
  v_exp_f32 v18, v18
  v_exp_f32 v19, v19
  v_exp_f32 v20, v20
  v_exp_f32 v21, v21
  v_exp_f32 v27, v27
  v_pk_add_f32 v[24:25], v[16:17], v[18:19]
  v_pk_add_f32 v[24:25], v[24:25], v[20:21]
  v_add_f32 v26, v24, v25
  v_mul_f32 v26, v26, v27
  v_mul_f32 v16, v16, v27
  v_mul_f32 v17, v17, v27
  v_add_f32_dpp v26, v26, v26 row_ror:8 row_mask:0xf bank_mask:0xf
  v_mov_b32 v25, v26
  v_mul_f32 v18, v18, v27
  v_mul_f32 v19, v19, v27
  v_permlane16_swap_b32 v26, v25
  v_add_f32 v26, v26, v25
  v_mov_b32 v25, v26
  v_mul_f32 v20, v20, v27
  v_mul_f32 v21, v21, v27
  v_permlane32_swap_b32 v26, v25
  v_add_f32 v26, v26, v25
  v_rcp_f32 v26, v26
  s_nop 0
  v_pk_mul_f32 v[16:17], v[16:17], v[26:27] op_sel_hi:[1,0]
  v_pk_mul_f32 v[18:19], v[18:19], v[26:27] op_sel_hi:[1,0]
  v_cvt_pk_bf16_f32 v32, v16, v17
  v_cvt_pk_bf16_f32 v33, v18, v19
  v_and_or_b32 v32, v32, -2, s28
  buffer_store_dwordx2 v[32:33], v13, s[4:7], s58 offen offset:0
  v_pk_mul_f32 v[20:21], v[20:21], v[26:27] op_sel_hi:[1,0]
  v_cvt_pk_bf16_f32 v34, v20, v21
  v_and_or_b32 v34, v34, -2, s28
  buffer_store_dword v34, v0, s[4:7], s59 offen offset:0
  s_branch a_end
a_w3:
  s_sleep 12
  s_branch a_end
a_xrows:
  s_cmp_eq_u32 s3, 3
  s_cbranch_scc1 a_w3
  v_cndmask_b32 v56, v14, 0, s[34:35]
  v_cndmask_b32 v57, v14, 0, s[36:37]
  v_cndmask_b32 v58, v14, 0, s[38:39]
  v_cndmask_b32 v59, v14, 0, s[40:41]
  v_cndmask_b32 v60, v14, 0, s[42:43]
  v_cndmask_b32 v61, v14, 0, s[44:45]
  v_cndmask_b32 v62, v14, 0, s[46:47]
  v_cndmask_b32 v63, v14, 0, s[48:49]
  v_subrev_u32 v68, s63, v12
  s_mul_i32 s12, s3, 6144
  v_add_u32 v69, s12, v68
  ds_read_b128 v[16:19], v69 offset:6144
  ds_read_b128 v[80:83], v68 offset:0
  ds_read_b128 v[84:87], v68 offset:6144
  ds_read_b64_tr_b16 v[28:29], v10 offset:0
  ds_read_b64_tr_b16 v[30:31], v10 offset:32
  ds_read_b128 v[20:23], v69 offset:7168
  ds_read_b128 v[88:91], v68 offset:1024
  ds_read_b128 v[92:95], v68 offset:7168
  ds_read_b64_tr_b16 v[32:33], v10 offset:256
  ds_read_b64_tr_b16 v[34:35], v10 offset:288
  ds_read_b128 v[24:27], v69 offset:8192
  ds_read_b128 v[96:99], v68 offset:2048
  ds_read_b128 v[100:103], v68 offset:8192
  ds_read_b64_tr_b16 v[36:37], v10 offset:512
  ds_read_b64_tr_b16 v[38:39], v10 offset:544
  s_waitcnt lgkmcnt(10)
  v_mfma_f32_16x16x32_bf16 v[56:59], v[80:83], v[16:19], v[56:59]
  v_mfma_f32_16x16x32_bf16 v[60:63], v[84:87], v[16:19], v[60:63]
  v_mfma_f32_16x16x32_bf16 v[64:67], v[28:31], v[16:19], v[64:67]
  ds_read_b128 v[16:19], v69 offset:9216
  ds_read_b128 v[80:83], v68 offset:3072
  ds_read_b128 v[84:87], v68 offset:9216
  ds_read_b64_tr_b16 v[40:41], v10 offset:768
  ds_read_b64_tr_b16 v[42:43], v10 offset:800
  s_waitcnt lgkmcnt(10)
  v_mfma_f32_16x16x32_bf16 v[56:59], v[88:91], v[20:23], v[56:59]
  v_mfma_f32_16x16x32_bf16 v[60:63], v[92:95], v[20:23], v[60:63]
  v_mfma_f32_16x16x32_bf16 v[64:67], v[32:35], v[20:23], v[64:67]
  ds_read_b128 v[20:23], v69 offset:10240
  ds_read_b128 v[88:91], v68 offset:4096
  ds_read_b128 v[92:95], v68 offset:10240
  ds_read_b64_tr_b16 v[44:45], v10 offset:1024
  ds_read_b64_tr_b16 v[46:47], v10 offset:1056
  s_waitcnt lgkmcnt(10)
  v_mfma_f32_16x16x32_bf16 v[56:59], v[96:99], v[24:27], v[56:59]
  v_mfma_f32_16x16x32_bf16 v[60:63], v[100:103], v[24:27], v[60:63]
  v_mfma_f32_16x16x32_bf16 v[64:67], v[36:39], v[24:27], v[64:67]
  ds_read_b128 v[24:27], v69 offset:11264
  ds_read_b128 v[96:99], v68 offset:5120
  ds_read_b128 v[100:103], v68 offset:11264
  ds_read_b64_tr_b16 v[48:49], v10 offset:1280
  ds_read_b64_tr_b16 v[50:51], v10 offset:1312
  s_waitcnt lgkmcnt(10)
  v_mfma_f32_16x16x32_bf16 v[56:59], v[80:83], v[16:19], v[56:59]
  v_mfma_f32_16x16x32_bf16 v[60:63], v[84:87], v[16:19], v[60:63]
  v_mfma_f32_16x16x32_bf16 v[64:67], v[40:43], v[16:19], v[64:67]
  s_waitcnt lgkmcnt(5)
  v_mfma_f32_16x16x32_bf16 v[56:59], v[88:91], v[20:23], v[56:59]
  v_mfma_f32_16x16x32_bf16 v[60:63], v[92:95], v[20:23], v[60:63]
  v_mfma_f32_16x16x32_bf16 v[64:67], v[44:47], v[20:23], v[64:67]
  s_waitcnt lgkmcnt(0)
  v_mfma_f32_16x16x32_bf16 v[56:59], v[96:99], v[24:27], v[56:59]
  v_mfma_f32_16x16x32_bf16 v[60:63], v[100:103], v[24:27], v[60:63]
  v_mfma_f32_16x16x32_bf16 v[64:67], v[48:51], v[24:27], v[64:67]
  s_nop 0
  v_max3_f32 v24, v56, v57, v58
  s_nop 2
  v_max3_f32 v24, v24, v59, v60
  v_max3_f32 v24, v24, v61, v62
  s_nop 0
  v_max3_f32 v24, v24, v63, v64
  v_max3_f32 v24, v24, v65, v66
  v_max_f32 v24, v24, v67
  v_mov_b32 v25, v24
  s_nop 1
  v_permlane16_swap_b32 v24, v25
  v_max_f32 v24, v24, v25
  v_mov_b32 v25, v24
  s_nop 1
  v_permlane32_swap_b32 v24, v25
  v_max_f32 v24, v24, v25
  v_mul_f32 v24, s70, v24
  v_fma_f32 v56, v56, s70, -v24
  v_fma_f32 v57, v57, s70, -v24
  v_fma_f32 v58, v58, s70, -v24
  v_fma_f32 v59, v59, s70, -v24
  v_fma_f32 v60, v60, s70, -v24
  v_fma_f32 v61, v61, s70, -v24
  v_fma_f32 v62, v62, s70, -v24
  v_fma_f32 v63, v63, s70, -v24
  v_fma_f32 v64, v64, s70, -v24
  v_fma_f32 v65, v65, s70, -v24
  v_fma_f32 v66, v66, s70, -v24
  v_fma_f32 v67, v67, s70, -v24
  v_exp_f32 v56, v56
  v_exp_f32 v57, v57
  v_exp_f32 v58, v58
  v_exp_f32 v59, v59
  v_exp_f32 v60, v60
  v_exp_f32 v61, v61
  v_exp_f32 v62, v62
  v_exp_f32 v63, v63
  v_exp_f32 v64, v64
  v_exp_f32 v65, v65
  v_exp_f32 v66, v66
  v_exp_f32 v67, v67
  v_add_f32 v26, v56, v57
  v_add_f32 v26, v26, v58
  v_add_f32 v26, v26, v59
  v_add_f32 v26, v26, v60
  v_add_f32 v26, v26, v61
  v_add_f32 v26, v26, v62
  v_add_f32 v26, v26, v63
  v_add_f32 v26, v26, v64
  v_add_f32 v26, v26, v65
  v_add_f32 v26, v26, v66
  v_add_f32 v26, v26, v67
  v_mov_b32 v25, v26
  s_nop 1
  v_permlane16_swap_b32 v26, v25
  v_add_f32 v26, v26, v25
  v_mov_b32 v25, v26
  s_nop 1
  v_permlane32_swap_b32 v26, v25
  v_add_f32 v26, v26, v25
  v_rcp_f32 v26, v26
  s_nop 0
  v_mul_f32 v56, v56, v26
  v_mul_f32 v57, v57, v26
  v_mul_f32 v58, v58, v26
  v_mul_f32 v59, v59, v26
  v_mul_f32 v60, v60, v26
  v_mul_f32 v61, v61, v26
  v_mul_f32 v62, v62, v26
  v_mul_f32 v63, v63, v26
  v_mul_f32 v64, v64, v26
  v_mul_f32 v65, v65, v26
  v_mul_f32 v66, v66, v26
  v_mul_f32 v67, v67, v26
  v_cvt_pk_bf16_f32 v16, v56, v57
  v_cvt_pk_bf16_f32 v17, v58, v59
  v_cvt_pk_bf16_f32 v18, v60, v61
  v_cvt_pk_bf16_f32 v19, v62, v63
  v_cvt_pk_bf16_f32 v20, v64, v65
  v_cvt_pk_bf16_f32 v21, v66, v67
  s_bfe_u32 s12, s10, 0x10002
  s_and_b32 s13, s10, 3
  s_lshl_b32 s13, s13, 15
  s_add_u32 s14, s13, s61
  s_add_u32 s13, s13, s60
  v_and_or_b32 v16, v16, -2, s12
  v_and_or_b32 v20, v20, -2, s12
  buffer_store_dwordx4 v[16:19], v1, s[4:7], s13 offen offset:0
  s_mov_b32 exec_lo, 0
  buffer_store_dwordx2 v[20:21], v13, s[4:7], s14 offen offset:0
  s_mov_b32 exec_lo, -1
a_end:
  s_cmp_eq_u64 s[54:55], 0
  s_cbranch_scc1 kq_114
  s_add_u32 s12, s10, 2
  s_min_u32 s12, s12, 64
  s_mul_i32 s13, s26, 192
  v_bfe_u32 v40, v1, 4, 1
  v_mul_u32_u24 v40, 191, v40
  v_add_u32 v40, s13, v40
  v_lshrrev_b32 v40, 8, v40
  v_bfe_u32 v41, v1, 5, 1
  v_mad_u32_u24 v40, v41, 24, v40
  v_lshlrev_b32 v40, 7, v40
  v_add_u32 v40, 83968, v40
  s_branch wf_117
wf_116:
  s_sleep 2
  s_add_u32 s11, s11, 1
  s_cmp_gt_u32 s11, 131072
  s_cbranch_scc1 mega_done
wf_117:
  buffer_load_dword v41, v40, s[4:7], s66 offen sc1
  s_waitcnt vmcnt(0)
  v_cmp_gt_u32 vcc, s12, v41
  s_cbranch_vccnz wf_116
kq_114:
  s_add_u32 m0, s62, 0
  s_nop 0
  buffer_load_dwordx4 v1, s[4:7], s56 offen offset:0 lds
  buffer_load_dwordx4 v1, s[4:7], s56 offen offset:1024 lds
  buffer_load_dwordx4 v1, s[4:7], s56 offen offset:2048 lds
  s_add_u32 s56, s56, 393216
  s_add_u32 m0, s62, 12288
  s_nop 0
  buffer_load_dwordx4 v1, s[4:7], s57 offen offset:0 lds
  buffer_load_dwordx4 v1, s[4:7], s57 offen offset:1024 lds
  buffer_load_dwordx4 v1, s[4:7], s57 offen offset:2048 lds
  s_add_u32 s57, s57, 393216
  s_add_u32 s10, s10, 1
  s_xor_b32 s28, s28, 1
  s_add_u32 s62, s62, s64
  s_sub_u32 s64, 0, s64
  v_add_u32 v12, s64, v12
  s_cmp_lt_u32 s10, 64
  s_cbranch_scc1 a_loop
  s_branch a_fin
a_loop_slow:
  ds_read_b128 v[80:83], v11 offset:0
  ds_read_b128 v[84:87], v11 offset:1024
  ds_read_b128 v[88:91], v11 offset:2048
  ds_read_b128 v[92:95], v11 offset:3072
  ds_read_b128 v[96:99], v11 offset:4096
  ds_read_b128 v[100:103], v11 offset:5120
  ds_read_b128 v[104:107], v11 offset:6144
  ds_read_b128 v[108:111], v11 offset:7168
  v_mov_b32 v56, 0
  v_mov_b32 v57, 0
  v_mov_b32 v58, 0
  v_mov_b32 v59, 0
  v_mov_b32 v60, 0
  v_mov_b32 v61, 0
  v_mov_b32 v62, 0
  v_mov_b32 v63, 0
  v_mov_b32 v64, 0
  v_mov_b32 v65, 0
  v_mov_b32 v66, 0
  v_mov_b32 v67, 0
  v_mov_b32 v68, 0
  v_mov_b32 v69, 0
  v_mov_b32 v70, 0
  v_mov_b32 v71, 0
  v_mov_b32 v72, 0
  v_mov_b32 v73, 0
  v_mov_b32 v74, 0
  v_mov_b32 v75, 0
  v_mov_b32 v76, 0
  v_mov_b32 v77, 0
  v_mov_b32 v78, 0
  v_mov_b32 v79, 0
  s_add_u32 s12, s10, 2
  s_min_u32 s12, s12, 64
  s_cmp_le_u32 s12, s67
  s_cbranch_scc1 ak_118
  s_mul_i32 s13, s26, 192
  v_bfe_u32 v40, v1, 4, 1
  v_mul_u32_u24 v40, 191, v40
  v_add_u32 v40, s13, v40
  v_lshrrev_b32 v40, 8, v40
  v_bfe_u32 v41, v1, 5, 1
  v_mad_u32_u24 v40, v41, 24, v40
  v_lshlrev_b32 v40, 7, v40
  v_add_u32 v40, 83968, v40
  buffer_load_dword v41, v40, s[4:7], s66 offen sc1
  s_waitcnt vmcnt(0)
  v_cmp_gt_u32 s[54:55], s12, v41
  v_readlane_b32 s67, v41, 0
  v_readlane_b32 s12, v41, 1
  v_readlane_b32 s13, v41, 2
  v_readlane_b32 s14, v41, 3
  s_min_u32 s67, s67, s12
  s_min_u32 s13, s13, s14
  s_min_u32 s67, s67, s13
ak_118:
  s_waitcnt vmcnt(0)
  s_sleep 5
  s_waitcnt lgkmcnt(0)
pm_119:
  buffer_load_dwordx4 v[16:19], v2, s[4:7], s30 offen offset:0 sc1
  buffer_load_dwordx4 v[20:23], v2, s[4:7], s31 offen offset:0 sc1
  buffer_load_dwordx4 v[24:27], v1, s[4:7], s32 offen offset:0 sc1
  s_add_u32 s11, s11, 1
  s_cmp_gt_u32 s11, 131072
  s_cbranch_scc1 mega_done
  s_waitcnt vmcnt(0)
  v_bitop3_b32 v14, v16, v20, s28 bitop3:0x7e
  v_bitop3_b32 v14, v24, v14, s28 bitop3:0xde
  v_and_b32 v14, 1, v14
  v_cmp_ne_u32 vcc, 0, v14
  s_cbranch_vccnz pm_119
  v_smfmac_f32_16x16x64_bf16 v[56:59], v[16:19], v[80:87], v8
  ds_write_b128 v2, v[16:19] offset:12288
  v_smfmac_f32_16x16x64_bf16 v[60:63], v[16:19], v[88:95], v8
  v_add_u32 v14, s65, v12
  v_smfmac_f32_16x16x64_bf16 v[64:67], v[16:19], v[96:103], v8
  ds_write_b128 v2, v[20:23] offset:16384
  v_smfmac_f32_16x16x64_bf16 v[56:59], v[20:23], v[104:111], v8
  v_smfmac_f32_16x16x64_bf16 v[60:63], v[20:23], a[0:7], v8
  ds_write_b128 v2, v[24:27] offset:20480
  v_smfmac_f32_16x16x64_bf16 v[64:67], v[20:23], a[8:15], v8
  ds_read_b128 v[80:83], v11 offset:8192
  v_smfmac_f32_16x16x64_bf16 v[56:59], v[24:27], a[16:23], v8
  ds_read_b128 v[84:87], v11 offset:9216
  v_smfmac_f32_16x16x64_bf16 v[60:63], v[24:27], a[24:31], v8
  ds_read_b128 v[88:91], v11 offset:10240
  v_smfmac_f32_16x16x64_bf16 v[64:67], v[24:27], a[32:39], v8
  ds_read_b128 v[92:95], v11 offset:11264
  s_waitcnt lgkmcnt(4)
  s_barrier
  ds_read_b128 v[28:31], v4 offset:12288
  v_smfmac_f32_16x16x64_bf16 v[68:71], v[16:19], a[40:47], v8
  ds_read_b128 v[32:35], v5 offset:12288
  v_smfmac_f32_16x16x64_bf16 v[68:71], v[20:23], a[48:55], v8
  ds_read_b128 v[36:39], v6 offset:12288
  s_waitcnt lgkmcnt(5)
  v_smfmac_f32_16x16x64_bf16 v[68:71], v[24:27], v[80:87], v8
  ds_read_b128 v[40:43], v4 offset:16384
  v_smfmac_f32_16x16x64_bf16 v[72:75], v[16:19], a[56:63], v8
  ds_read_b128 v[44:47], v5 offset:16384
  s_waitcnt lgkmcnt(5)
  v_smfmac_f32_16x16x64_bf16 v[72:75], v[20:23], v[88:95], v8
  ds_read_b128 v[48:51], v6 offset:16384
  s_waitcnt lgkmcnt(5)
  v_smfmac_f32_16x16x64_bf16 v[56:59], v[28:31], a[64:71], v8
  ds_read_b128 v[52:55], v4 offset:20480
  v_smfmac_f32_16x16x64_bf16 v[60:63], v[28:31], a[72:79], v8
  ds_read_b128 v[96:99], v11 offset:12288
  s_waitcnt lgkmcnt(6)
  v_smfmac_f32_16x16x64_bf16 v[56:59], v[32:35], a[80:87], v8
  ds_read_b128 v[100:103], v11 offset:13312
  v_smfmac_f32_16x16x64_bf16 v[60:63], v[32:35], a[88:95], v8
  ds_read_b128 v[104:107], v11 offset:14336
  s_waitcnt lgkmcnt(7)
  v_smfmac_f32_16x16x64_bf16 v[56:59], v[36:39], a[96:103], v8
  ds_read_b128 v[108:111], v11 offset:15360
  v_smfmac_f32_16x16x64_bf16 v[60:63], v[36:39], a[104:111], v8
  ds_read_b128 v[80:83], v11 offset:16384
  s_waitcnt lgkmcnt(8)
  v_smfmac_f32_16x16x64_bf16 v[56:59], v[40:43], a[112:119], v8
  ds_read_b128 v[84:87], v11 offset:17408
  v_smfmac_f32_16x16x64_bf16 v[60:63], v[40:43], a[120:127], v8
  ds_read_b128 v[88:91], v11 offset:18432
  s_waitcnt lgkmcnt(5)
  v_smfmac_f32_16x16x64_bf16 v[56:59], v[44:47], v[96:103], v8
  ds_read_b128 v[92:95], v11 offset:19456
  v_smfmac_f32_16x16x64_bf16 v[60:63], v[44:47], a[128:135], v8
  s_waitcnt lgkmcnt(4)
  v_smfmac_f32_16x16x64_bf16 v[56:59], v[48:51], v[104:111], v8
  v_smfmac_f32_16x16x64_bf16 v[60:63], v[48:51], a[136:143], v8
  ds_read_b128 v[96:99], v12 offset:0
  s_waitcnt lgkmcnt(3)
  v_smfmac_f32_16x16x64_bf16 v[56:59], v[52:55], v[80:87], v8
  ds_read_b128 v[100:103], v12 offset:6144
  v_smfmac_f32_16x16x64_bf16 v[60:63], v[52:55], a[144:151], v8
  ds_read_b128 v[104:107], v14 offset:0
  s_waitcnt lgkmcnt(3)
  v_smfmac_f32_16x16x64_bf16 v[64:67], v[28:31], v[88:95], v8
  ds_read_b128 v[108:111], v14 offset:6144
  v_smfmac_f32_16x16x64_bf16 v[64:67], v[32:35], a[152:159], v8
  v_smfmac_f32_16x16x64_bf16 v[64:67], v[36:39], a[160:167], v8
  v_permlane32_swap_b32 v56, v60
  v_smfmac_f32_16x16x64_bf16 v[64:67], v[40:43], a[168:175], v8
  v_permlane32_swap_b32 v57, v61
  v_smfmac_f32_16x16x64_bf16 v[64:67], v[44:47], a[176:183], v8
  v_permlane32_swap_b32 v58, v62
  v_smfmac_f32_16x16x64_bf16 v[64:67], v[48:51], a[184:191], v8
  v_permlane32_swap_b32 v59, v63
  v_smfmac_f32_16x16x64_bf16 v[64:67], v[52:55], a[192:199], v8
  v_add_f32 v56, v56, v60
  v_smfmac_f32_16x16x64_bf16 v[68:71], v[28:31], a[200:207], v8
  v_add_f32 v57, v57, v61
  v_smfmac_f32_16x16x64_bf16 v[68:71], v[32:35], a[208:215], v8
  v_add_f32 v58, v58, v62
  v_smfmac_f32_16x16x64_bf16 v[68:71], v[36:39], a[216:223], v8
  v_add_f32 v59, v59, v63
  v_smfmac_f32_16x16x64_bf16 v[68:71], v[40:43], a[224:231], v8
  v_cvt_pk_bf16_f32 v60, v56, v57
  v_smfmac_f32_16x16x64_bf16 v[68:71], v[44:47], a[232:239], v8
  v_cvt_pk_bf16_f32 v61, v58, v59
  v_smfmac_f32_16x16x64_bf16 v[68:71], v[48:51], a[240:247], v8
  ds_write_b64 v9, v[60:61] offset:0
  v_permlane32_swap_b32 v64, v66
  v_smfmac_f32_16x16x64_bf16 v[68:71], v[52:55], a[248:255], v8
  ds_read_b64_tr_b16 v[80:81], v15 offset:0
  v_permlane32_swap_b32 v65, v67
  v_smfmac_f32_16x16x64_bf16 v[72:75], v[24:27], v[112:119], v8
  ds_read_b64_tr_b16 v[82:83], v15 offset:32
  v_add_f32 v64, v64, v66
  v_smfmac_f32_16x16x64_bf16 v[76:79], v[16:19], v[120:127], v8
  v_add_f32 v65, v65, v67
  v_smfmac_f32_16x16x64_bf16 v[76:79], v[20:23], v[128:135], v8
  v_cvt_pk_bf16_f32 v64, v64, v65
  v_smfmac_f32_16x16x64_bf16 v[76:79], v[24:27], v[136:143], v8
  ds_write_b32 v3, v64 offset:0
  v_smfmac_f32_16x16x64_bf16 v[72:75], v[28:31], v[144:151], v8
  ds_read_b64_tr_b16 v[84:85], v7 offset:0
  v_smfmac_f32_16x16x64_bf16 v[76:79], v[28:31], v[152:159], v8
  ds_read_b64_tr_b16 v[86:87], v7 offset:32
  v_permlane32_swap_b32 v68, v70
  s_waitcnt lgkmcnt(8)
  s_waitcnt lgkmcnt(3)
  v_mfma_f32_16x16x32_bf16 v[56:59], v[96:99], v[80:83], 0
  v_mfma_f32_16x16x32_bf16 v[60:63], v[100:103], v[80:83], 0
  v_smfmac_f32_16x16x64_bf16 v[72:75], v[32:35], v[160:167], v8
  v_permlane32_swap_b32 v69, v71
  v_smfmac_f32_16x16x64_bf16 v[76:79], v[32:35], v[168:175], v8
  v_add_f32 v68, v68, v70
  v_smfmac_f32_16x16x64_bf16 v[72:75], v[36:39], v[176:183], v8
  v_add_f32 v69, v69, v71
  v_smfmac_f32_16x16x64_bf16 v[76:79], v[36:39], v[184:191], v8
  v_cvt_pk_bf16_f32 v68, v68, v69
  s_waitcnt lgkmcnt(0)
  v_mfma_f32_16x16x32_bf16 v[56:59], v[104:107], v[84:87], v[56:59]
  v_mfma_f32_16x16x32_bf16 v[60:63], v[108:111], v[84:87], v[60:63]
  v_smfmac_f32_16x16x64_bf16 v[72:75], v[40:43], v[192:199], v8
  ds_write_b32 v3, v68 offset:3200
  v_smfmac_f32_16x16x64_bf16 v[76:79], v[40:43], v[200:207], v8
  v_smfmac_f32_16x16x64_bf16 v[72:75], v[44:47], v[208:215], v8
  v_cndmask_b32 v88, v56, v58, s[52:53]
  v_smfmac_f32_16x16x64_bf16 v[76:79], v[44:47], v[216:223], v8
  v_cndmask_b32 v89, v57, v59, s[52:53]
  v_smfmac_f32_16x16x64_bf16 v[72:75], v[48:51], v[224:231], v8
  ds_write_b64 v2, v[88:89] offset:8192
  v_cndmask_b32 v90, v60, v62, s[52:53]
  v_smfmac_f32_16x16x64_bf16 v[76:79], v[48:51], v[232:239], v8
  v_cndmask_b32 v91, v61, v63, s[52:53]
  v_smfmac_f32_16x16x64_bf16 v[72:75], v[52:55], v[240:247], v8
  ds_write_b64 v2, v[90:91] offset:8200
  v_smfmac_f32_16x16x64_bf16 v[76:79], v[52:55], v[248:255], v8
  s_cmp_lg_u32 s3, 0
  s_nop 6
  v_permlane32_swap_b32 v72, v76
  v_permlane32_swap_b32 v73, v77
  v_permlane32_swap_b32 v74, v78
  v_permlane32_swap_b32 v75, v79
  v_pk_add_f32 v[72:73], v[72:73], v[76:77]
  v_pk_add_f32 v[74:75], v[74:75], v[78:79]
  v_cvt_pk_bf16_f32 v76, v72, v73
  v_cvt_pk_bf16_f32 v77, v74, v75
  ds_write_b64 v9, v[76:77] offset:3200
  v_mov_b32 v14, 0xf149f2ca
  v_cndmask_b32 v64, v14, 0, s[50:51]
  v_cndmask_b32 v65, v14, 0, s[50:51]
  v_cndmask_b32 v66, v14, 0, s[50:51]
  v_cndmask_b32 v67, v14, 0, s[50:51]
  s_waitcnt lgkmcnt(0)
  s_barrier
  s_cbranch_scc1 a_xrows_slow
  ds_read_b64_tr_b16 v[28:29], v10 offset:0
  ds_read_b64_tr_b16 v[30:31], v10 offset:32
  ds_read_b64_tr_b16 v[32:33], v10 offset:256
  ds_read_b64_tr_b16 v[34:35], v10 offset:288
  ds_read_b64_tr_b16 v[36:37], v10 offset:512
  ds_read_b64_tr_b16 v[38:39], v10 offset:544
  ds_read_b64_tr_b16 v[40:41], v10 offset:768
  ds_read_b64_tr_b16 v[42:43], v10 offset:800
  ds_read_b64_tr_b16 v[44:45], v10 offset:1024
  ds_read_b64_tr_b16 v[46:47], v10 offset:1056
  ds_read_b64_tr_b16 v[48:49], v10 offset:1280
  ds_read_b64_tr_b16 v[50:51], v10 offset:1312
  ds_read_b128 v[16:19], v1 offset:9216
  ds_read_b128 v[80:83], v1 offset:10240
  ds_read_b128 v[84:87], v1 offset:11264
  s_waitcnt lgkmcnt(13)
  v_mfma_f32_16x16x32_bf16 v[64:67], v[28:31], v[28:31], v[64:67]
  s_waitcnt lgkmcnt(11)
  v_mfma_f32_16x16x32_bf16 v[64:67], v[32:35], v[32:35], v[64:67]
  s_waitcnt lgkmcnt(9)
  v_mfma_f32_16x16x32_bf16 v[64:67], v[36:39], v[36:39], v[64:67]
  s_waitcnt lgkmcnt(7)
  v_mfma_f32_16x16x32_bf16 v[64:67], v[40:43], v[40:43], v[64:67]
  s_waitcnt lgkmcnt(5)
  v_mfma_f32_16x16x32_bf16 v[64:67], v[44:47], v[44:47], v[64:67]
  s_waitcnt lgkmcnt(3)
  v_mfma_f32_16x16x32_bf16 v[64:67], v[48:51], v[48:51], v[64:67]
  s_waitcnt lgkmcnt(2)
  v_pk_add_f32 v[16:17], v[16:17], v[88:89]
  v_pk_add_f32 v[18:19], v[18:19], v[90:91]
  s_waitcnt lgkmcnt(1)
  v_pk_add_f32 v[16:17], v[16:17], v[80:81]
  v_pk_add_f32 v[18:19], v[18:19], v[82:83]
  s_waitcnt lgkmcnt(0)
  v_pk_add_f32 v[16:17], v[16:17], v[84:85]
  v_pk_add_f32 v[18:19], v[18:19], v[86:87]
  v_max3_f32 v24, v16, v17, v18
  v_max_f32 v24, v24, v19
  v_mov_b32_dpp v64, v66 row_shr:8 row_mask:0xf bank_mask:0xc
  v_mov_b32_dpp v65, v67 row_shr:8 row_mask:0xf bank_mask:0xc
  v_max3_f32 v24, v24, v64, v65
  v_mul_f32 v24, s70, v24
  v_fma_f32 v16, v16, s70, -v24
  v_fma_f32 v17, v17, s70, -v24
  v_max_f32_dpp v27, v24, v24 row_ror:8 row_mask:0xf bank_mask:0xf
  v_mov_b32 v25, v27
  v_fma_f32 v18, v18, s70, -v24
  v_fma_f32 v19, v19, s70, -v24
  v_permlane16_swap_b32 v27, v25
  v_max_f32 v27, v27, v25
  v_mov_b32 v25, v27
  v_fma_f32 v20, v64, s70, -v24
  v_fma_f32 v21, v65, s70, -v24
  v_permlane32_swap_b32 v27, v25
  v_max_f32 v27, v27, v25
  v_sub_f32 v27, v24, v27
  v_exp_f32 v16, v16
  v_exp_f32 v17, v17
  v_exp_f32 v18, v18
  v_exp_f32 v19, v19
  v_exp_f32 v20, v20
  v_exp_f32 v21, v21
  v_exp_f32 v27, v27
  v_pk_add_f32 v[24:25], v[16:17], v[18:19]
  v_pk_add_f32 v[24:25], v[24:25], v[20:21]
  v_add_f32 v26, v24, v25
  v_mul_f32 v26, v26, v27
  v_mul_f32 v16, v16, v27
  v_mul_f32 v17, v17, v27
  v_add_f32_dpp v26, v26, v26 row_ror:8 row_mask:0xf bank_mask:0xf
  v_mov_b32 v25, v26
  v_mul_f32 v18, v18, v27
  v_mul_f32 v19, v19, v27
  v_permlane16_swap_b32 v26, v25
  v_add_f32 v26, v26, v25
  v_mov_b32 v25, v26
  v_mul_f32 v20, v20, v27
  v_mul_f32 v21, v21, v27
  v_permlane32_swap_b32 v26, v25
  v_add_f32 v26, v26, v25
  v_rcp_f32 v26, v26
  s_nop 0
  v_pk_mul_f32 v[16:17], v[16:17], v[26:27] op_sel_hi:[1,0]
  v_pk_mul_f32 v[18:19], v[18:19], v[26:27] op_sel_hi:[1,0]
  v_cvt_pk_bf16_f32 v32, v16, v17
  v_cvt_pk_bf16_f32 v33, v18, v19
  v_and_or_b32 v32, v32, -2, s28
  buffer_store_dwordx2 v[32:33], v13, s[4:7], s58 offen offset:0 sc1
  v_pk_mul_f32 v[20:21], v[20:21], v[26:27] op_sel_hi:[1,0]
  v_cvt_pk_bf16_f32 v34, v20, v21
  v_and_or_b32 v34, v34, -2, s28
  buffer_store_dword v34, v0, s[4:7], s59 offen offset:0 sc1
  s_branch a_end_slow
a_w3_slow:
  s_sleep 12
  s_branch a_end_slow
a_xrows_slow:
  s_cmp_eq_u32 s3, 3
  s_cbranch_scc1 a_w3_slow
  v_cndmask_b32 v56, v14, 0, s[34:35]
  v_cndmask_b32 v57, v14, 0, s[36:37]
  v_cndmask_b32 v58, v14, 0, s[38:39]
  v_cndmask_b32 v59, v14, 0, s[40:41]
  v_cndmask_b32 v60, v14, 0, s[42:43]
  v_cndmask_b32 v61, v14, 0, s[44:45]
  v_cndmask_b32 v62, v14, 0, s[46:47]
  v_cndmask_b32 v63, v14, 0, s[48:49]
  v_subrev_u32 v68, s63, v12
  s_mul_i32 s12, s3, 6144
  v_add_u32 v69, s12, v68
  ds_read_b128 v[16:19], v69 offset:6144
  ds_read_b128 v[80:83], v68 offset:0
  ds_read_b128 v[84:87], v68 offset:6144
  ds_read_b64_tr_b16 v[28:29], v10 offset:0
  ds_read_b64_tr_b16 v[30:31], v10 offset:32
  ds_read_b128 v[20:23], v69 offset:7168
  ds_read_b128 v[88:91], v68 offset:1024
  ds_read_b128 v[92:95], v68 offset:7168
  ds_read_b64_tr_b16 v[32:33], v10 offset:256
  ds_read_b64_tr_b16 v[34:35], v10 offset:288
  ds_read_b128 v[24:27], v69 offset:8192
  ds_read_b128 v[96:99], v68 offset:2048
  ds_read_b128 v[100:103], v68 offset:8192
  ds_read_b64_tr_b16 v[36:37], v10 offset:512
  ds_read_b64_tr_b16 v[38:39], v10 offset:544
  s_waitcnt lgkmcnt(10)
  v_mfma_f32_16x16x32_bf16 v[56:59], v[80:83], v[16:19], v[56:59]
  v_mfma_f32_16x16x32_bf16 v[60:63], v[84:87], v[16:19], v[60:63]
  v_mfma_f32_16x16x32_bf16 v[64:67], v[28:31], v[16:19], v[64:67]
  ds_read_b128 v[16:19], v69 offset:9216
  ds_read_b128 v[80:83], v68 offset:3072
  ds_read_b128 v[84:87], v68 offset:9216
  ds_read_b64_tr_b16 v[40:41], v10 offset:768
  ds_read_b64_tr_b16 v[42:43], v10 offset:800
  s_waitcnt lgkmcnt(10)
  v_mfma_f32_16x16x32_bf16 v[56:59], v[88:91], v[20:23], v[56:59]
  v_mfma_f32_16x16x32_bf16 v[60:63], v[92:95], v[20:23], v[60:63]
  v_mfma_f32_16x16x32_bf16 v[64:67], v[32:35], v[20:23], v[64:67]
  ds_read_b128 v[20:23], v69 offset:10240
  ds_read_b128 v[88:91], v68 offset:4096
  ds_read_b128 v[92:95], v68 offset:10240
  ds_read_b64_tr_b16 v[44:45], v10 offset:1024
  ds_read_b64_tr_b16 v[46:47], v10 offset:1056
  s_waitcnt lgkmcnt(10)
  v_mfma_f32_16x16x32_bf16 v[56:59], v[96:99], v[24:27], v[56:59]
  v_mfma_f32_16x16x32_bf16 v[60:63], v[100:103], v[24:27], v[60:63]
  v_mfma_f32_16x16x32_bf16 v[64:67], v[36:39], v[24:27], v[64:67]
  ds_read_b128 v[24:27], v69 offset:11264
  ds_read_b128 v[96:99], v68 offset:5120
  ds_read_b128 v[100:103], v68 offset:11264
  ds_read_b64_tr_b16 v[48:49], v10 offset:1280
  ds_read_b64_tr_b16 v[50:51], v10 offset:1312
  s_waitcnt lgkmcnt(10)
  v_mfma_f32_16x16x32_bf16 v[56:59], v[80:83], v[16:19], v[56:59]
  v_mfma_f32_16x16x32_bf16 v[60:63], v[84:87], v[16:19], v[60:63]
  v_mfma_f32_16x16x32_bf16 v[64:67], v[40:43], v[16:19], v[64:67]
  s_waitcnt lgkmcnt(5)
  v_mfma_f32_16x16x32_bf16 v[56:59], v[88:91], v[20:23], v[56:59]
  v_mfma_f32_16x16x32_bf16 v[60:63], v[92:95], v[20:23], v[60:63]
  v_mfma_f32_16x16x32_bf16 v[64:67], v[44:47], v[20:23], v[64:67]
  s_waitcnt lgkmcnt(0)
  v_mfma_f32_16x16x32_bf16 v[56:59], v[96:99], v[24:27], v[56:59]
  v_mfma_f32_16x16x32_bf16 v[60:63], v[100:103], v[24:27], v[60:63]
  v_mfma_f32_16x16x32_bf16 v[64:67], v[48:51], v[24:27], v[64:67]
  s_nop 0
  v_max3_f32 v24, v56, v57, v58
  s_nop 2
  v_max3_f32 v24, v24, v59, v60
  v_max3_f32 v24, v24, v61, v62
  s_nop 0
  v_max3_f32 v24, v24, v63, v64
  v_max3_f32 v24, v24, v65, v66
  v_max_f32 v24, v24, v67
  v_mov_b32 v25, v24
  s_nop 1
  v_permlane16_swap_b32 v24, v25
  v_max_f32 v24, v24, v25
  v_mov_b32 v25, v24
  s_nop 1
  v_permlane32_swap_b32 v24, v25
  v_max_f32 v24, v24, v25
  v_mul_f32 v24, s70, v24
  v_fma_f32 v56, v56, s70, -v24
  v_fma_f32 v57, v57, s70, -v24
  v_fma_f32 v58, v58, s70, -v24
  v_fma_f32 v59, v59, s70, -v24
  v_fma_f32 v60, v60, s70, -v24
  v_fma_f32 v61, v61, s70, -v24
  v_fma_f32 v62, v62, s70, -v24
  v_fma_f32 v63, v63, s70, -v24
  v_fma_f32 v64, v64, s70, -v24
  v_fma_f32 v65, v65, s70, -v24
  v_fma_f32 v66, v66, s70, -v24
  v_fma_f32 v67, v67, s70, -v24
  v_exp_f32 v56, v56
  v_exp_f32 v57, v57
  v_exp_f32 v58, v58
  v_exp_f32 v59, v59
  v_exp_f32 v60, v60
  v_exp_f32 v61, v61
  v_exp_f32 v62, v62
  v_exp_f32 v63, v63
  v_exp_f32 v64, v64
  v_exp_f32 v65, v65
  v_exp_f32 v66, v66
  v_exp_f32 v67, v67
  v_add_f32 v26, v56, v57
  v_add_f32 v26, v26, v58
  v_add_f32 v26, v26, v59
  v_add_f32 v26, v26, v60
  v_add_f32 v26, v26, v61
  v_add_f32 v26, v26, v62
  v_add_f32 v26, v26, v63
  v_add_f32 v26, v26, v64
  v_add_f32 v26, v26, v65
  v_add_f32 v26, v26, v66
  v_add_f32 v26, v26, v67
  v_mov_b32 v25, v26
  s_nop 1
  v_permlane16_swap_b32 v26, v25
  v_add_f32 v26, v26, v25
  v_mov_b32 v25, v26
  s_nop 1
  v_permlane32_swap_b32 v26, v25
  v_add_f32 v26, v26, v25
  v_rcp_f32 v26, v26
  s_nop 0
  v_mul_f32 v56, v56, v26
  v_mul_f32 v57, v57, v26
  v_mul_f32 v58, v58, v26
  v_mul_f32 v59, v59, v26
  v_mul_f32 v60, v60, v26
  v_mul_f32 v61, v61, v26
  v_mul_f32 v62, v62, v26
  v_mul_f32 v63, v63, v26
  v_mul_f32 v64, v64, v26
  v_mul_f32 v65, v65, v26
  v_mul_f32 v66, v66, v26
  v_mul_f32 v67, v67, v26
  v_cvt_pk_bf16_f32 v16, v56, v57
  v_cvt_pk_bf16_f32 v17, v58, v59
  v_cvt_pk_bf16_f32 v18, v60, v61
  v_cvt_pk_bf16_f32 v19, v62, v63
  v_cvt_pk_bf16_f32 v20, v64, v65
  v_cvt_pk_bf16_f32 v21, v66, v67
  s_bfe_u32 s12, s10, 0x10002
  s_and_b32 s13, s10, 3
  s_lshl_b32 s13, s13, 15
  s_add_u32 s14, s13, s61
  s_add_u32 s13, s13, s60
  v_and_or_b32 v16, v16, -2, s12
  v_and_or_b32 v20, v20, -2, s12
  buffer_store_dwordx4 v[16:19], v1, s[4:7], s13 offen offset:0 sc1
  s_mov_b32 exec_lo, 0
  buffer_store_dwordx2 v[20:21], v13, s[4:7], s14 offen offset:0 sc1
  s_mov_b32 exec_lo, -1
a_end_slow:
  s_cmp_eq_u64 s[54:55], 0
  s_cbranch_scc1 kq_120
  s_add_u32 s12, s10, 2
  s_min_u32 s12, s12, 64
  s_mul_i32 s13, s26, 192
  v_bfe_u32 v40, v1, 4, 1
  v_mul_u32_u24 v40, 191, v40
  v_add_u32 v40, s13, v40
  v_lshrrev_b32 v40, 8, v40
  v_bfe_u32 v41, v1, 5, 1
  v_mad_u32_u24 v40, v41, 24, v40
  v_lshlrev_b32 v40, 7, v40
  v_add_u32 v40, 83968, v40
  s_branch wf_123
wf_122:
  s_sleep 2
  s_add_u32 s11, s11, 1
  s_cmp_gt_u32 s11, 131072
  s_cbranch_scc1 mega_done
wf_123:
  buffer_load_dword v41, v40, s[4:7], s66 offen sc1
  s_waitcnt vmcnt(0)
  v_cmp_gt_u32 vcc, s12, v41
  s_cbranch_vccnz wf_122
kq_120:
  s_add_u32 m0, s62, 0
  s_nop 0
  buffer_load_dwordx4 v1, s[4:7], s56 offen offset:0 lds
  buffer_load_dwordx4 v1, s[4:7], s56 offen offset:1024 lds
  buffer_load_dwordx4 v1, s[4:7], s56 offen offset:2048 lds
  s_add_u32 s56, s56, 393216
  s_add_u32 m0, s62, 12288
  s_nop 0
  buffer_load_dwordx4 v1, s[4:7], s57 offen offset:0 lds
  buffer_load_dwordx4 v1, s[4:7], s57 offen offset:1024 lds
  buffer_load_dwordx4 v1, s[4:7], s57 offen offset:2048 lds
  s_add_u32 s57, s57, 393216
  s_add_u32 s10, s10, 1
  s_xor_b32 s28, s28, 1
  s_add_u32 s62, s62, s64
  s_sub_u32 s64, 0, s64
  v_add_u32 v12, s64, v12
  s_cmp_lt_u32 s10, 64
  s_cbranch_scc1 a_loop_slow
  s_branch a_fin
a_fin:
  v_lshrrev_b32 v0, 4, v1
  s_branch mega_wo
mega_B:
  v_lshlrev_b32 v1, 4, v0
  s_lshl_b32 s12, s3, 10
  v_add_u32 v2, s12, v1
  s_and_b32 s32, s12, 1024
  s_xor_b32 s13, s12, 1024
  v_add_u32 v4, s13, v1
  s_xor_b32 s13, s12, 2048
  v_add_u32 v5, s13, v1
  s_xor_b32 s13, s12, 3072
  v_add_u32 v6, s13, v1
  s_mov_b32 s52, 0xff00ff00
  s_mov_b32 s53, 0xff00ff00
  v_mov_b32 v8, 0x4444
  v_mov_b32 v9, 0xeeee
  v_cndmask_b32 v8, v8, v9, s[52:53]
  s_mul_i32 s13, s3, 20480
  s_add_u32 s13, s13, 81920
  v_add_u32 v11, s13, v1
  s_lshl_b32 s26, s8, 3
  s_add_u32 s26, s26, s9
  s_mov_b32 s68, 0x00003f80
  s_mov_b32 s69, 0x3f800000
  s_lshl_b32 s27, s8, 18
  s_add_u32 s27, s27, 213909504
  s_mov_b32 s28, 0
  s_mov_b32 s29, 0
  s_add_u32 s30, s27, 0
  s_add_u32 s31, s30, 4096
  s_add_u32 s32, s32, s30
  s_add_u32 s32, s32, 8192
  s_mov_b32 s10, 0
  v_lshrrev_b32 v16, 4, v0
  v_and_b32 v17, 1, v16
  v_mul_u32_u24 v9, 1568, v17
  v_and_b32 v17, 15, v0
  v_lshl_add_u32 v9, v17, 3, v9
  v_lshrrev_b32 v17, 5, v0
  v_lshl_add_u32 v12, v17, 2, v9
  v_lshl_add_u32 v9, v17, 7, v9
  s_and_b32 s12, s3, 1
  s_mul_i32 s13, s3, 3
  s_add_u32 s14, s13, s12
  s_lshl_b32 s14, s14, 7
  v_add_u32 v9, s14, v9
  s_lshl_b32 s15, s12, 1
  s_sub_u32 s15, s13, s15
  s_add_u32 s15, s15, 2
  s_lshl_b32 s15, s15, 7
  v_add_u32 v12, s15, v12
  v_and_b32 v17, 1, v0
  v_mul_u32_u24 v10, 1568, v17
  v_bfe_u32 v17, v0, 2, 2
  v_lshl_add_u32 v10, v17, 3, v10
  v_lshl_add_u32 v10, v16, 6, v10
  v_and_b32 v17, 15, v0
  v_lshlrev_b32 v13, 4, v17
  v_and_b32 v17, 1, v16
  v_lshl_add_u32 v13, v17, 3, v13
  v_lshrrev_b32 v17, 5, v0
  v_lshl_add_u32 v13, v17, 10, v13
  s_lshr_b32 s12, s9, 2
  s_mul_i32 s12, s12, 40960
  s_mul_i32 s13, s3, 10240
  s_add_u32 s12, s12, s13
  s_and_b32 s13, s9, 3
  s_lshl_b32 s13, s13, 8
  s_add_u32 s12, s12, s13
  s_add_u32 s12, s12, s27
  s_add_u32 s56, s12, 163840
  s_add_u32 s57, s56, 4096
  s_add_u32 s58, s56, 8192
  s_lshl_b32 s59, s8, 2
  s_add_u32 s59, s59, s3
  s_lshl_b32 s59, s59, 15
  s_lshl_b32 s12, s9, 10
  s_add_u32 s59, s59, s12
  s_add_u32 s59, s59, 1048576
  s_load_dwordx4 s[20:23], s[0:1], 32
  s_mul_i32 s12, s26, 384
  s_mul_i32 s13, s26, 245760
  s_mul_i32 s14, s3, 320
  s_add_u32 s13, s13, s14
  s_waitcnt lgkmcnt(0)
  s_add_u32 s20, s20, s12
  s_addc_u32 s21, s21, 0
  s_add_u32 s22, s22, s13
  s_addc_u32 s23, s23, 0
  v_add_u32 v26, 0, v0
  v_mul_u32_u24 v27, 2731, v26
  v_lshrrev_b32 v27, 16, v27
  v_mul_u32_u24 v16, 24, v27
  v_sub_u32 v26, v26, v16
  v_lshrrev_b32 v16, 1, v27
  v_and_b32 v16, 6, v16
  v_xor_b32 v26, v26, v16
  v_mul_u32_u24 v16, 12288, v27
  v_lshl_add_u32 v16, v26, 4, v16
  v_add_u32 v26, 64, v0
  v_mul_u32_u24 v27, 2731, v26
  v_lshrrev_b32 v27, 16, v27
  v_mul_u32_u24 v17, 24, v27
  v_sub_u32 v26, v26, v17
  v_lshrrev_b32 v17, 1, v27
  v_and_b32 v17, 6, v17
  v_xor_b32 v26, v26, v17
  v_mul_u32_u24 v17, 12288, v27
  v_lshl_add_u32 v17, v26, 4, v17
  v_add_u32 v26, 128, v0
  v_mul_u32_u24 v27, 2731, v26
  v_lshrrev_b32 v27, 16, v27
  v_mul_u32_u24 v18, 24, v27
  v_sub_u32 v26, v26, v18
  v_lshrrev_b32 v18, 1, v27
  v_and_b32 v18, 6, v18
  v_xor_b32 v26, v26, v18
  v_mul_u32_u24 v18, 12288, v27
  v_lshl_add_u32 v18, v26, 4, v18
  v_add_u32 v26, 192, v0
  v_mul_u32_u24 v27, 2731, v26
  v_lshrrev_b32 v27, 16, v27
  v_mul_u32_u24 v19, 24, v27
  v_sub_u32 v26, v26, v19
  v_lshrrev_b32 v19, 1, v27
  v_and_b32 v19, 6, v19
  v_xor_b32 v26, v26, v19
  v_mul_u32_u24 v19, 12288, v27
  v_lshl_add_u32 v19, v26, 4, v19
  v_add_u32 v26, 256, v0
  v_mul_u32_u24 v27, 2731, v26
  v_lshrrev_b32 v27, 16, v27
  v_mul_u32_u24 v20, 24, v27
  v_sub_u32 v26, v26, v20
  v_lshrrev_b32 v20, 1, v27
  v_and_b32 v20, 6, v20
  v_xor_b32 v26, v26, v20
  v_mul_u32_u24 v20, 12288, v27
  v_lshl_add_u32 v20, v26, 4, v20
  v_add_u32 v26, 320, v0
  v_mul_u32_u24 v27, 2731, v26
  v_lshrrev_b32 v27, 16, v27
  v_mul_u32_u24 v21, 24, v27
  v_sub_u32 v26, v26, v21
  v_lshrrev_b32 v21, 1, v27
  v_and_b32 v21, 6, v21
  v_xor_b32 v26, v26, v21
  v_mul_u32_u24 v21, 12288, v27
  v_lshl_add_u32 v21, v26, 4, v21
  v_bfe_u32 v27, v0, 4, 1
  v_bfe_u32 v26, v0, 3, 1
  v_lshl_add_u32 v27, v26, 1, v27
  v_lshlrev_b32 v22, 1, v27
  v_bfe_u32 v26, v0, 1, 1
  v_add_u32 v26, 0, v26
  v_xor_b32 v22, v22, v26
  v_lshlrev_b32 v22, 4, v22
  v_and_b32 v26, 1, v0
  v_lshl_add_u32 v22, v26, 3, v22
  v_lshlrev_b32 v27, 2, v27
  v_bfe_u32 v26, v0, 2, 1
  v_add_u32 v27, v27, v26
  v_bfe_u32 v26, v0, 5, 1
  v_lshl_add_u32 v27, v26, 4, v27
  v_mul_u32_u24 v27, 384, v27
  v_add_u32 v22, v22, v27
  v_bfe_u32 v27, v0, 4, 1
  v_bfe_u32 v26, v0, 3, 1
  v_lshl_add_u32 v27, v26, 1, v27
  v_lshlrev_b32 v23, 1, v27
  v_bfe_u32 v26, v0, 1, 1
  v_add_u32 v26, 2, v26
  v_xor_b32 v23, v23, v26
  v_lshlrev_b32 v23, 4, v23
  v_and_b32 v26, 1, v0
  v_lshl_add_u32 v23, v26, 3, v23
  v_lshlrev_b32 v27, 2, v27
  v_bfe_u32 v26, v0, 2, 1
  v_add_u32 v27, v27, v26
  v_bfe_u32 v26, v0, 5, 1
  v_lshl_add_u32 v27, v26, 4, v27
  v_mul_u32_u24 v27, 384, v27
  v_add_u32 v23, v23, v27
  v_bfe_u32 v27, v0, 4, 1
  v_bfe_u32 v26, v0, 3, 1
  v_lshl_add_u32 v27, v26, 1, v27
  v_lshlrev_b32 v24, 1, v27
  v_bfe_u32 v26, v0, 1, 1
  v_add_u32 v26, 4, v26
  v_xor_b32 v24, v24, v26
  v_lshlrev_b32 v24, 4, v24
  v_and_b32 v26, 1, v0
  v_lshl_add_u32 v24, v26, 3, v24
  v_lshlrev_b32 v27, 2, v27
  v_bfe_u32 v26, v0, 2, 1
  v_add_u32 v27, v27, v26
  v_bfe_u32 v26, v0, 5, 1
  v_lshl_add_u32 v27, v26, 4, v27
  v_mul_u32_u24 v27, 384, v27
  v_add_u32 v24, v24, v27
  v_bfe_u32 v27, v0, 4, 1
  v_bfe_u32 v26, v0, 3, 1
  v_lshl_add_u32 v27, v26, 1, v27
  v_lshlrev_b32 v25, 1, v27
  v_bfe_u32 v26, v0, 1, 1
  v_add_u32 v26, 6, v26
  v_xor_b32 v25, v25, v26
  v_lshlrev_b32 v25, 4, v25
  v_and_b32 v26, 1, v0
  v_lshl_add_u32 v25, v26, 3, v25
  v_lshlrev_b32 v27, 2, v27
  v_bfe_u32 v26, v0, 2, 1
  v_add_u32 v27, v27, v26
  v_bfe_u32 v26, v0, 5, 1
  v_lshl_add_u32 v27, v26, 4, v27
  v_mul_u32_u24 v27, 384, v27
  v_add_u32 v25, v25, v27
  s_mul_i32 s16, s3, 6144
  s_mul_i32 s12, s3, 196608
  s_add_u32 s20, s20, s12
  s_addc_u32 s21, s21, 0
  s_add_u32 m0, s16, 0
  s_nop 0
  global_load_lds_dwordx4 v16, s[20:21]
  s_add_u32 m0, s16, 1024
  s_nop 0
  global_load_lds_dwordx4 v17, s[20:21]
  s_add_u32 m0, s16, 2048
  s_nop 0
  global_load_lds_dwordx4 v18, s[20:21]
  s_add_u32 m0, s16, 3072
  s_nop 0
  global_load_lds_dwordx4 v19, s[20:21]
  s_add_u32 m0, s16, 4096
  s_nop 0
  global_load_lds_dwordx4 v20, s[20:21]
  s_add_u32 m0, s16, 5120
  s_nop 0
  global_load_lds_dwordx4 v21, s[20:21]
  s_add_u32 s20, s20, 786432
  s_addc_u32 s21, s21, 0
  s_add_u32 m0, s16, 24576
  s_nop 0
  global_load_lds_dwordx4 v16, s[20:21]
  s_add_u32 m0, s16, 25600
  s_nop 0
  global_load_lds_dwordx4 v17, s[20:21]
  s_add_u32 m0, s16, 26624
  s_nop 0
  global_load_lds_dwordx4 v18, s[20:21]
  s_add_u32 m0, s16, 27648
  s_nop 0
  global_load_lds_dwordx4 v19, s[20:21]
  s_add_u32 m0, s16, 28672
  s_nop 0
  global_load_lds_dwordx4 v20, s[20:21]
  s_add_u32 m0, s16, 29696
  s_nop 0
  global_load_lds_dwordx4 v21, s[20:21]
  s_add_u32 s20, s20, 786432
  s_addc_u32 s21, s21, 0
  s_add_u32 m0, s16, 49152
  s_nop 0
  global_load_lds_dwordx4 v16, s[20:21]
  s_add_u32 m0, s16, 50176
  s_nop 0
  global_load_lds_dwordx4 v17, s[20:21]
  s_add_u32 m0, s16, 51200
  s_nop 0
  global_load_lds_dwordx4 v18, s[20:21]
  s_add_u32 m0, s16, 52224
  s_nop 0
  global_load_lds_dwordx4 v19, s[20:21]
  s_add_u32 m0, s16, 53248
  s_nop 0
  global_load_lds_dwordx4 v20, s[20:21]
  s_add_u32 m0, s16, 54272
  s_nop 0
  global_load_lds_dwordx4 v21, s[20:21]
  s_add_u32 s20, s20, 786432
  s_addc_u32 s21, s21, 0
  s_cmp_eq_u32 s3, 1
  s_cbranch_scc1 lw_125
  s_cmp_eq_u32 s3, 2
  s_cbranch_scc1 lw_126
  s_cmp_eq_u32 s3, 3
  s_cbranch_scc1 lw_127
lw_124:
  s_waitcnt vmcnt(12)
  s_barrier
  ds_read_b64_tr_b16 v[80:81], v22 offset:0
  ds_read_b64_tr_b16 v[82:83], v22 offset:768
  ds_read_b64_tr_b16 v[84:85], v22 offset:12288
  ds_read_b64_tr_b16 v[86:87], v22 offset:13056
  s_waitcnt lgkmcnt(0)
  ds_write_b128 v11, v[80:83] offset:0
  ds_write_b128 v11, v[84:87] offset:1024
  s_waitcnt lgkmcnt(0)
  ds_read_b64_tr_b16 v[80:81], v23 offset:0
  ds_read_b64_tr_b16 v[82:83], v23 offset:768
  ds_read_b64_tr_b16 v[84:85], v23 offset:12288
  ds_read_b64_tr_b16 v[86:87], v23 offset:13056
  s_waitcnt lgkmcnt(0)
  ds_write_b128 v11, v[80:83] offset:2048
  ds_write_b128 v11, v[84:87] offset:3072
  s_waitcnt lgkmcnt(0)
  ds_read_b64_tr_b16 v[80:81], v24 offset:0
  ds_read_b64_tr_b16 v[82:83], v24 offset:768
  ds_read_b64_tr_b16 v[84:85], v24 offset:12288
  ds_read_b64_tr_b16 v[86:87], v24 offset:13056
  s_waitcnt lgkmcnt(0)
  ds_write_b128 v11, v[80:83] offset:4096
  ds_write_b128 v11, v[84:87] offset:5120
  s_waitcnt lgkmcnt(0)
  s_waitcnt lgkmcnt(0)
  s_barrier
  s_add_u32 m0, s16, 0
  s_nop 0
  global_load_lds_dwordx4 v16, s[20:21]
  s_add_u32 m0, s16, 1024
  s_nop 0
  global_load_lds_dwordx4 v17, s[20:21]
  s_add_u32 m0, s16, 2048
  s_nop 0
  global_load_lds_dwordx4 v18, s[20:21]
  s_add_u32 m0, s16, 3072
  s_nop 0
  global_load_lds_dwordx4 v19, s[20:21]
  s_add_u32 m0, s16, 4096
  s_nop 0
  global_load_lds_dwordx4 v20, s[20:21]
  s_add_u32 m0, s16, 5120
  s_nop 0
  global_load_lds_dwordx4 v21, s[20:21]
  s_add_u32 s20, s20, 786432
  s_addc_u32 s21, s21, 0
  s_waitcnt vmcnt(12)
  s_barrier
  ds_read_b64_tr_b16 a[96:97], v22 offset:24576
  ds_read_b64_tr_b16 a[98:99], v22 offset:25344
  ds_read_b64_tr_b16 a[100:101], v22 offset:36864
  ds_read_b64_tr_b16 a[102:103], v22 offset:37632
  ds_read_b64_tr_b16 a[104:105], v23 offset:24576
  ds_read_b64_tr_b16 a[106:107], v23 offset:25344
  ds_read_b64_tr_b16 a[108:109], v23 offset:36864
  ds_read_b64_tr_b16 a[110:111], v23 offset:37632
  ds_read_b64_tr_b16 a[40:41], v24 offset:24576
  ds_read_b64_tr_b16 a[42:43], v24 offset:25344
  ds_read_b64_tr_b16 a[44:45], v24 offset:36864
  ds_read_b64_tr_b16 a[46:47], v24 offset:37632
  s_waitcnt lgkmcnt(0)
  s_barrier
  s_add_u32 m0, s16, 24576
  s_nop 0
  global_load_lds_dwordx4 v16, s[20:21]
  s_add_u32 m0, s16, 25600
  s_nop 0
  global_load_lds_dwordx4 v17, s[20:21]
  s_add_u32 m0, s16, 26624
  s_nop 0
  global_load_lds_dwordx4 v18, s[20:21]
  s_add_u32 m0, s16, 27648
  s_nop 0
  global_load_lds_dwordx4 v19, s[20:21]
  s_add_u32 m0, s16, 28672
  s_nop 0
  global_load_lds_dwordx4 v20, s[20:21]
  s_add_u32 m0, s16, 29696
  s_nop 0
  global_load_lds_dwordx4 v21, s[20:21]
  s_add_u32 s20, s20, 786432
  s_addc_u32 s21, s21, 0
  s_waitcnt vmcnt(12)
  s_barrier
  v_add_u32 v22, 49152, v22
  v_add_u32 v23, 49152, v23
  v_add_u32 v24, 49152, v24
  v_add_u32 v25, 49152, v25
  ds_read_b64_tr_b16 a[112:113], v22 offset:0
  ds_read_b64_tr_b16 a[114:115], v22 offset:768
  ds_read_b64_tr_b16 a[116:117], v22 offset:12288
  ds_read_b64_tr_b16 a[118:119], v22 offset:13056
  ds_read_b64_tr_b16 a[120:121], v23 offset:0
  ds_read_b64_tr_b16 a[122:123], v23 offset:768
  ds_read_b64_tr_b16 a[124:125], v23 offset:12288
  ds_read_b64_tr_b16 a[126:127], v23 offset:13056
  ds_read_b64_tr_b16 a[48:49], v24 offset:0
  ds_read_b64_tr_b16 a[50:51], v24 offset:768
  ds_read_b64_tr_b16 a[52:53], v24 offset:12288
  ds_read_b64_tr_b16 a[54:55], v24 offset:13056
  v_subrev_u32 v22, 49152, v22
  v_subrev_u32 v23, 49152, v23
  v_subrev_u32 v24, 49152, v24
  v_subrev_u32 v25, 49152, v25
  s_waitcnt lgkmcnt(0)
  s_barrier
  s_add_u32 m0, s16, 49152
  s_nop 0
  global_load_lds_dwordx4 v16, s[20:21]
  s_add_u32 m0, s16, 50176
  s_nop 0
  global_load_lds_dwordx4 v17, s[20:21]
  s_add_u32 m0, s16, 51200
  s_nop 0
  global_load_lds_dwordx4 v18, s[20:21]
  s_add_u32 m0, s16, 52224
  s_nop 0
  global_load_lds_dwordx4 v19, s[20:21]
  s_add_u32 m0, s16, 53248
  s_nop 0
  global_load_lds_dwordx4 v20, s[20:21]
  s_add_u32 m0, s16, 54272
  s_nop 0
  global_load_lds_dwordx4 v21, s[20:21]
  s_add_u32 s20, s20, 786432
  s_addc_u32 s21, s21, 0
  s_waitcnt vmcnt(12)
  s_barrier
  ds_read_b64_tr_b16 a[128:129], v22 offset:0
  ds_read_b64_tr_b16 a[130:131], v22 offset:768
  ds_read_b64_tr_b16 a[132:133], v22 offset:12288
  ds_read_b64_tr_b16 a[134:135], v22 offset:13056
  ds_read_b64_tr_b16 a[136:137], v23 offset:0
  ds_read_b64_tr_b16 a[138:139], v23 offset:768
  ds_read_b64_tr_b16 a[140:141], v23 offset:12288
  ds_read_b64_tr_b16 a[142:143], v23 offset:13056
  ds_read_b64_tr_b16 a[56:57], v24 offset:0
  ds_read_b64_tr_b16 a[58:59], v24 offset:768
  ds_read_b64_tr_b16 a[60:61], v24 offset:12288
  ds_read_b64_tr_b16 a[62:63], v24 offset:13056
  s_waitcnt lgkmcnt(0)
  s_barrier
  s_add_u32 m0, s16, 0
  s_nop 0
  global_load_lds_dwordx4 v16, s[20:21]
  s_add_u32 m0, s16, 1024
  s_nop 0
  global_load_lds_dwordx4 v17, s[20:21]
  s_add_u32 m0, s16, 2048
  s_nop 0
  global_load_lds_dwordx4 v18, s[20:21]
  s_add_u32 m0, s16, 3072
  s_nop 0
  global_load_lds_dwordx4 v19, s[20:21]
  s_add_u32 m0, s16, 4096
  s_nop 0
  global_load_lds_dwordx4 v20, s[20:21]
  s_add_u32 m0, s16, 5120
  s_nop 0
  global_load_lds_dwordx4 v21, s[20:21]
  s_add_u32 s20, s20, 786432
  s_addc_u32 s21, s21, 0
  s_waitcnt vmcnt(12)
  s_barrier
  ds_read_b64_tr_b16 v[80:81], v22 offset:24576
  ds_read_b64_tr_b16 v[82:83], v22 offset:25344
  ds_read_b64_tr_b16 v[84:85], v22 offset:36864
  ds_read_b64_tr_b16 v[86:87], v22 offset:37632
  s_waitcnt lgkmcnt(0)
  ds_write_b128 v11, v[80:83] offset:6144
  ds_write_b128 v11, v[84:87] offset:7168
  s_waitcnt lgkmcnt(0)
  ds_read_b64_tr_b16 a[0:1], v23 offset:24576
  ds_read_b64_tr_b16 a[2:3], v23 offset:25344
  ds_read_b64_tr_b16 a[4:5], v23 offset:36864
  ds_read_b64_tr_b16 a[6:7], v23 offset:37632
  ds_read_b64_tr_b16 a[8:9], v24 offset:24576
  ds_read_b64_tr_b16 a[10:11], v24 offset:25344
  ds_read_b64_tr_b16 a[12:13], v24 offset:36864
  ds_read_b64_tr_b16 a[14:15], v24 offset:37632
  s_waitcnt lgkmcnt(0)
  s_barrier
  s_add_u32 m0, s16, 24576
  s_nop 0
  global_load_lds_dwordx4 v16, s[20:21]
  s_add_u32 m0, s16, 25600
  s_nop 0
  global_load_lds_dwordx4 v17, s[20:21]
  s_add_u32 m0, s16, 26624
  s_nop 0
  global_load_lds_dwordx4 v18, s[20:21]
  s_add_u32 m0, s16, 27648
  s_nop 0
  global_load_lds_dwordx4 v19, s[20:21]
  s_add_u32 m0, s16, 28672
  s_nop 0
  global_load_lds_dwordx4 v20, s[20:21]
  s_add_u32 m0, s16, 29696
  s_nop 0
  global_load_lds_dwordx4 v21, s[20:21]
  s_add_u32 s20, s20, 786432
  s_addc_u32 s21, s21, 0
  s_waitcnt vmcnt(12)
  s_barrier
  v_add_u32 v22, 49152, v22
  v_add_u32 v23, 49152, v23
  v_add_u32 v24, 49152, v24
  v_add_u32 v25, 49152, v25
  ds_read_b64_tr_b16 v[80:81], v22 offset:0
  ds_read_b64_tr_b16 v[82:83], v22 offset:768
  ds_read_b64_tr_b16 v[84:85], v22 offset:12288
  ds_read_b64_tr_b16 v[86:87], v22 offset:13056
  s_waitcnt lgkmcnt(0)
  ds_write_b128 v11, v[80:83] offset:8192
  ds_write_b128 v11, v[84:87] offset:9216
  s_waitcnt lgkmcnt(0)
  ds_read_b64_tr_b16 a[144:145], v23 offset:0
  ds_read_b64_tr_b16 a[146:147], v23 offset:768
  ds_read_b64_tr_b16 a[148:149], v23 offset:12288
  ds_read_b64_tr_b16 a[150:151], v23 offset:13056
  ds_read_b64_tr_b16 a[64:65], v24 offset:0
  ds_read_b64_tr_b16 a[66:67], v24 offset:768
  ds_read_b64_tr_b16 a[68:69], v24 offset:12288
  ds_read_b64_tr_b16 a[70:71], v24 offset:13056
  v_subrev_u32 v22, 49152, v22
  v_subrev_u32 v23, 49152, v23
  v_subrev_u32 v24, 49152, v24
  v_subrev_u32 v25, 49152, v25
  s_waitcnt lgkmcnt(0)
  s_barrier
  s_add_u32 m0, s16, 49152
  s_nop 0
  global_load_lds_dwordx4 v16, s[20:21]
  s_add_u32 m0, s16, 50176
  s_nop 0
  global_load_lds_dwordx4 v17, s[20:21]
  s_add_u32 m0, s16, 51200
  s_nop 0
  global_load_lds_dwordx4 v18, s[20:21]
  s_add_u32 m0, s16, 52224
  s_nop 0
  global_load_lds_dwordx4 v19, s[20:21]
  s_add_u32 m0, s16, 53248
  s_nop 0
  global_load_lds_dwordx4 v20, s[20:21]
  s_add_u32 m0, s16, 54272
  s_nop 0
  global_load_lds_dwordx4 v21, s[20:21]
  s_add_u32 s20, s20, 786432
  s_addc_u32 s21, s21, 0
  s_waitcnt vmcnt(12)
  s_barrier
  ds_read_b64_tr_b16 v[80:81], v22 offset:0
  ds_read_b64_tr_b16 v[82:83], v22 offset:768
  ds_read_b64_tr_b16 v[84:85], v22 offset:12288
  ds_read_b64_tr_b16 v[86:87], v22 offset:13056
  s_waitcnt lgkmcnt(0)
  ds_write_b128 v11, v[80:83] offset:10240
  ds_write_b128 v11, v[84:87] offset:11264
  s_waitcnt lgkmcnt(0)
  ds_read_b64_tr_b16 a[152:153], v23 offset:0
  ds_read_b64_tr_b16 a[154:155], v23 offset:768
  ds_read_b64_tr_b16 a[156:157], v23 offset:12288
  ds_read_b64_tr_b16 a[158:159], v23 offset:13056
  ds_read_b64_tr_b16 a[72:73], v24 offset:0
  ds_read_b64_tr_b16 a[74:75], v24 offset:768
  ds_read_b64_tr_b16 a[76:77], v24 offset:12288
  ds_read_b64_tr_b16 a[78:79], v24 offset:13056
  s_waitcnt lgkmcnt(0)
  s_barrier
  s_add_u32 m0, s16, 0
  s_nop 0
  global_load_lds_dwordx4 v16, s[20:21]
  s_add_u32 m0, s16, 1024
  s_nop 0
  global_load_lds_dwordx4 v17, s[20:21]
  s_add_u32 m0, s16, 2048
  s_nop 0
  global_load_lds_dwordx4 v18, s[20:21]
  s_add_u32 m0, s16, 3072
  s_nop 0
  global_load_lds_dwordx4 v19, s[20:21]
  s_add_u32 m0, s16, 4096
  s_nop 0
  global_load_lds_dwordx4 v20, s[20:21]
  s_add_u32 m0, s16, 5120
  s_nop 0
  global_load_lds_dwordx4 v21, s[20:21]
  s_add_u32 s20, s20, 786432
  s_addc_u32 s21, s21, 0
  s_waitcnt vmcnt(12)
  s_barrier
  ds_read_b64_tr_b16 v[80:81], v22 offset:24576
  ds_read_b64_tr_b16 v[82:83], v22 offset:25344
  ds_read_b64_tr_b16 v[84:85], v22 offset:36864
  ds_read_b64_tr_b16 v[86:87], v22 offset:37632
  s_waitcnt lgkmcnt(0)
  ds_write_b128 v11, v[80:83] offset:12288
  ds_write_b128 v11, v[84:87] offset:13312
  s_waitcnt lgkmcnt(0)
  ds_read_b64_tr_b16 a[160:161], v23 offset:24576
  ds_read_b64_tr_b16 a[162:163], v23 offset:25344
  ds_read_b64_tr_b16 a[164:165], v23 offset:36864
  ds_read_b64_tr_b16 a[166:167], v23 offset:37632
  ds_read_b64_tr_b16 a[80:81], v24 offset:24576
  ds_read_b64_tr_b16 a[82:83], v24 offset:25344
  ds_read_b64_tr_b16 a[84:85], v24 offset:36864
  ds_read_b64_tr_b16 a[86:87], v24 offset:37632
  s_waitcnt lgkmcnt(0)
  s_barrier
  s_waitcnt vmcnt(6)
  s_barrier
  v_add_u32 v22, 49152, v22
  v_add_u32 v23, 49152, v23
  v_add_u32 v24, 49152, v24
  v_add_u32 v25, 49152, v25
  ds_read_b64_tr_b16 a[16:17], v22 offset:0
  ds_read_b64_tr_b16 a[18:19], v22 offset:768
  ds_read_b64_tr_b16 a[20:21], v22 offset:12288
  ds_read_b64_tr_b16 a[22:23], v22 offset:13056
  ds_read_b64_tr_b16 a[24:25], v23 offset:0
  ds_read_b64_tr_b16 a[26:27], v23 offset:768
  ds_read_b64_tr_b16 a[28:29], v23 offset:12288
  ds_read_b64_tr_b16 a[30:31], v23 offset:13056
  ds_read_b64_tr_b16 a[32:33], v24 offset:0
  ds_read_b64_tr_b16 a[34:35], v24 offset:768
  ds_read_b64_tr_b16 a[36:37], v24 offset:12288
  ds_read_b64_tr_b16 a[38:39], v24 offset:13056
  v_subrev_u32 v22, 49152, v22
  v_subrev_u32 v23, 49152, v23
  v_subrev_u32 v24, 49152, v24
  v_subrev_u32 v25, 49152, v25
  s_waitcnt lgkmcnt(0)
  s_barrier
  s_waitcnt vmcnt(0)
  s_barrier
  ds_read_b64_tr_b16 v[80:81], v22 offset:0
  ds_read_b64_tr_b16 v[82:83], v22 offset:768
  ds_read_b64_tr_b16 v[84:85], v22 offset:12288
  ds_read_b64_tr_b16 v[86:87], v22 offset:13056
  s_waitcnt lgkmcnt(0)
  ds_write_b128 v11, v[80:83] offset:14336
  ds_write_b128 v11, v[84:87] offset:15360
  s_waitcnt lgkmcnt(0)
  ds_read_b64_tr_b16 a[168:169], v23 offset:0
  ds_read_b64_tr_b16 a[170:171], v23 offset:768
  ds_read_b64_tr_b16 a[172:173], v23 offset:12288
  ds_read_b64_tr_b16 a[174:175], v23 offset:13056
  ds_read_b64_tr_b16 a[88:89], v24 offset:0
  ds_read_b64_tr_b16 a[90:91], v24 offset:768
  ds_read_b64_tr_b16 a[92:93], v24 offset:12288
  ds_read_b64_tr_b16 a[94:95], v24 offset:13056
  s_waitcnt lgkmcnt(0)
  s_barrier
  s_branch lw_128
lw_125:
  s_waitcnt vmcnt(12)
  s_barrier
  ds_read_b64_tr_b16 a[96:97], v22 offset:128
  ds_read_b64_tr_b16 a[98:99], v22 offset:896
  ds_read_b64_tr_b16 a[100:101], v22 offset:12416
  ds_read_b64_tr_b16 a[102:103], v22 offset:13184
  ds_read_b64_tr_b16 a[104:105], v23 offset:128
  ds_read_b64_tr_b16 a[106:107], v23 offset:896
  ds_read_b64_tr_b16 a[108:109], v23 offset:12416
  ds_read_b64_tr_b16 a[110:111], v23 offset:13184
  ds_read_b64_tr_b16 a[40:41], v25 offset:0
  ds_read_b64_tr_b16 a[42:43], v25 offset:768
  ds_read_b64_tr_b16 a[44:45], v25 offset:12288
  ds_read_b64_tr_b16 a[46:47], v25 offset:13056
  s_waitcnt lgkmcnt(0)
  s_barrier
  s_add_u32 m0, s16, 0
  s_nop 0
  global_load_lds_dwordx4 v16, s[20:21]
  s_add_u32 m0, s16, 1024
  s_nop 0
  global_load_lds_dwordx4 v17, s[20:21]
  s_add_u32 m0, s16, 2048
  s_nop 0
  global_load_lds_dwordx4 v18, s[20:21]
  s_add_u32 m0, s16, 3072
  s_nop 0
  global_load_lds_dwordx4 v19, s[20:21]
  s_add_u32 m0, s16, 4096
  s_nop 0
  global_load_lds_dwordx4 v20, s[20:21]
  s_add_u32 m0, s16, 5120
  s_nop 0
  global_load_lds_dwordx4 v21, s[20:21]
  s_add_u32 s20, s20, 786432
  s_addc_u32 s21, s21, 0
  s_waitcnt vmcnt(12)
  s_barrier
  ds_read_b64_tr_b16 v[80:81], v22 offset:24704
  ds_read_b64_tr_b16 v[82:83], v22 offset:25472
  ds_read_b64_tr_b16 v[84:85], v22 offset:36992
  ds_read_b64_tr_b16 v[86:87], v22 offset:37760
  s_waitcnt lgkmcnt(0)
  ds_write_b128 v11, v[80:83] offset:0
  ds_write_b128 v11, v[84:87] offset:1024
  s_waitcnt lgkmcnt(0)
  ds_read_b64_tr_b16 v[80:81], v23 offset:24704
  ds_read_b64_tr_b16 v[82:83], v23 offset:25472
  ds_read_b64_tr_b16 v[84:85], v23 offset:36992
  ds_read_b64_tr_b16 v[86:87], v23 offset:37760
  s_waitcnt lgkmcnt(0)
  ds_write_b128 v11, v[80:83] offset:2048
  ds_write_b128 v11, v[84:87] offset:3072
  s_waitcnt lgkmcnt(0)
  ds_read_b64_tr_b16 v[80:81], v25 offset:24576
  ds_read_b64_tr_b16 v[82:83], v25 offset:25344
  ds_read_b64_tr_b16 v[84:85], v25 offset:36864
  ds_read_b64_tr_b16 v[86:87], v25 offset:37632
  s_waitcnt lgkmcnt(0)
  ds_write_b128 v11, v[80:83] offset:4096
  ds_write_b128 v11, v[84:87] offset:5120
  s_waitcnt lgkmcnt(0)
  s_waitcnt lgkmcnt(0)
  s_barrier
  s_add_u32 m0, s16, 24576
  s_nop 0
  global_load_lds_dwordx4 v16, s[20:21]
  s_add_u32 m0, s16, 25600
  s_nop 0
  global_load_lds_dwordx4 v17, s[20:21]
  s_add_u32 m0, s16, 26624
  s_nop 0
  global_load_lds_dwordx4 v18, s[20:21]
  s_add_u32 m0, s16, 27648
  s_nop 0
  global_load_lds_dwordx4 v19, s[20:21]
  s_add_u32 m0, s16, 28672
  s_nop 0
  global_load_lds_dwordx4 v20, s[20:21]
  s_add_u32 m0, s16, 29696
  s_nop 0
  global_load_lds_dwordx4 v21, s[20:21]
  s_add_u32 s20, s20, 786432
  s_addc_u32 s21, s21, 0
  s_waitcnt vmcnt(12)
  s_barrier
  v_add_u32 v22, 49152, v22
  v_add_u32 v23, 49152, v23
  v_add_u32 v24, 49152, v24
  v_add_u32 v25, 49152, v25
  ds_read_b64_tr_b16 a[128:129], v22 offset:128
  ds_read_b64_tr_b16 a[130:131], v22 offset:896
  ds_read_b64_tr_b16 a[132:133], v22 offset:12416
  ds_read_b64_tr_b16 a[134:135], v22 offset:13184
  ds_read_b64_tr_b16 a[136:137], v23 offset:128
  ds_read_b64_tr_b16 a[138:139], v23 offset:896
  ds_read_b64_tr_b16 a[140:141], v23 offset:12416
  ds_read_b64_tr_b16 a[142:143], v23 offset:13184
  ds_read_b64_tr_b16 a[56:57], v25 offset:0
  ds_read_b64_tr_b16 a[58:59], v25 offset:768
  ds_read_b64_tr_b16 a[60:61], v25 offset:12288
  ds_read_b64_tr_b16 a[62:63], v25 offset:13056
  v_subrev_u32 v22, 49152, v22
  v_subrev_u32 v23, 49152, v23
  v_subrev_u32 v24, 49152, v24
  v_subrev_u32 v25, 49152, v25
  s_waitcnt lgkmcnt(0)
  s_barrier
  s_add_u32 m0, s16, 49152
  s_nop 0
  global_load_lds_dwordx4 v16, s[20:21]
  s_add_u32 m0, s16, 50176
  s_nop 0
  global_load_lds_dwordx4 v17, s[20:21]
  s_add_u32 m0, s16, 51200
  s_nop 0
  global_load_lds_dwordx4 v18, s[20:21]
  s_add_u32 m0, s16, 52224
  s_nop 0
  global_load_lds_dwordx4 v19, s[20:21]
  s_add_u32 m0, s16, 53248
  s_nop 0
  global_load_lds_dwordx4 v20, s[20:21]
  s_add_u32 m0, s16, 54272
  s_nop 0
  global_load_lds_dwordx4 v21, s[20:21]
  s_add_u32 s20, s20, 786432
  s_addc_u32 s21, s21, 0
  s_waitcnt vmcnt(12)
  s_barrier
  ds_read_b64_tr_b16 a[112:113], v22 offset:128
  ds_read_b64_tr_b16 a[114:115], v22 offset:896
  ds_read_b64_tr_b16 a[116:117], v22 offset:12416
  ds_read_b64_tr_b16 a[118:119], v22 offset:13184
  ds_read_b64_tr_b16 a[120:121], v23 offset:128
  ds_read_b64_tr_b16 a[122:123], v23 offset:896
  ds_read_b64_tr_b16 a[124:125], v23 offset:12416
  ds_read_b64_tr_b16 a[126:127], v23 offset:13184
  ds_read_b64_tr_b16 a[48:49], v25 offset:0
  ds_read_b64_tr_b16 a[50:51], v25 offset:768
  ds_read_b64_tr_b16 a[52:53], v25 offset:12288
  ds_read_b64_tr_b16 a[54:55], v25 offset:13056
  s_waitcnt lgkmcnt(0)
  s_barrier
  s_add_u32 m0, s16, 0
  s_nop 0
  global_load_lds_dwordx4 v16, s[20:21]
  s_add_u32 m0, s16, 1024
  s_nop 0
  global_load_lds_dwordx4 v17, s[20:21]
  s_add_u32 m0, s16, 2048
  s_nop 0
  global_load_lds_dwordx4 v18, s[20:21]
  s_add_u32 m0, s16, 3072
  s_nop 0
  global_load_lds_dwordx4 v19, s[20:21]
  s_add_u32 m0, s16, 4096
  s_nop 0
  global_load_lds_dwordx4 v20, s[20:21]
  s_add_u32 m0, s16, 5120
  s_nop 0
  global_load_lds_dwordx4 v21, s[20:21]
  s_add_u32 s20, s20, 786432
  s_addc_u32 s21, s21, 0
  s_waitcnt vmcnt(12)
  s_barrier
  ds_read_b64_tr_b16 v[80:81], v22 offset:24704
  ds_read_b64_tr_b16 v[82:83], v22 offset:25472
  ds_read_b64_tr_b16 v[84:85], v22 offset:36992
  ds_read_b64_tr_b16 v[86:87], v22 offset:37760
  s_waitcnt lgkmcnt(0)
  ds_write_b128 v11, v[80:83] offset:8192
  ds_write_b128 v11, v[84:87] offset:9216
  s_waitcnt lgkmcnt(0)
  ds_read_b64_tr_b16 a[144:145], v23 offset:24704
  ds_read_b64_tr_b16 a[146:147], v23 offset:25472
  ds_read_b64_tr_b16 a[148:149], v23 offset:36992
  ds_read_b64_tr_b16 a[150:151], v23 offset:37760
  ds_read_b64_tr_b16 a[64:65], v25 offset:24576
  ds_read_b64_tr_b16 a[66:67], v25 offset:25344
  ds_read_b64_tr_b16 a[68:69], v25 offset:36864
  ds_read_b64_tr_b16 a[70:71], v25 offset:37632
  s_waitcnt lgkmcnt(0)
  s_barrier
  s_add_u32 m0, s16, 24576
  s_nop 0
  global_load_lds_dwordx4 v16, s[20:21]
  s_add_u32 m0, s16, 25600
  s_nop 0
  global_load_lds_dwordx4 v17, s[20:21]
  s_add_u32 m0, s16, 26624
  s_nop 0
  global_load_lds_dwordx4 v18, s[20:21]
  s_add_u32 m0, s16, 27648
  s_nop 0
  global_load_lds_dwordx4 v19, s[20:21]
  s_add_u32 m0, s16, 28672
  s_nop 0
  global_load_lds_dwordx4 v20, s[20:21]
  s_add_u32 m0, s16, 29696
  s_nop 0
  global_load_lds_dwordx4 v21, s[20:21]
  s_add_u32 s20, s20, 786432
  s_addc_u32 s21, s21, 0
  s_waitcnt vmcnt(12)
  s_barrier
  v_add_u32 v22, 49152, v22
  v_add_u32 v23, 49152, v23
  v_add_u32 v24, 49152, v24
  v_add_u32 v25, 49152, v25
  ds_read_b64_tr_b16 v[80:81], v22 offset:128
  ds_read_b64_tr_b16 v[82:83], v22 offset:896
  ds_read_b64_tr_b16 v[84:85], v22 offset:12416
  ds_read_b64_tr_b16 v[86:87], v22 offset:13184
  s_waitcnt lgkmcnt(0)
  ds_write_b128 v11, v[80:83] offset:6144
  ds_write_b128 v11, v[84:87] offset:7168
  s_waitcnt lgkmcnt(0)
  ds_read_b64_tr_b16 a[0:1], v23 offset:128
  ds_read_b64_tr_b16 a[2:3], v23 offset:896
  ds_read_b64_tr_b16 a[4:5], v23 offset:12416
  ds_read_b64_tr_b16 a[6:7], v23 offset:13184
  ds_read_b64_tr_b16 a[8:9], v25 offset:0
  ds_read_b64_tr_b16 a[10:11], v25 offset:768
  ds_read_b64_tr_b16 a[12:13], v25 offset:12288
  ds_read_b64_tr_b16 a[14:15], v25 offset:13056
  v_subrev_u32 v22, 49152, v22
  v_subrev_u32 v23, 49152, v23
  v_subrev_u32 v24, 49152, v24
  v_subrev_u32 v25, 49152, v25
  s_waitcnt lgkmcnt(0)
  s_barrier
  s_add_u32 m0, s16, 49152
  s_nop 0
  global_load_lds_dwordx4 v16, s[20:21]
  s_add_u32 m0, s16, 50176
  s_nop 0
  global_load_lds_dwordx4 v17, s[20:21]
  s_add_u32 m0, s16, 51200
  s_nop 0
  global_load_lds_dwordx4 v18, s[20:21]
  s_add_u32 m0, s16, 52224
  s_nop 0
  global_load_lds_dwordx4 v19, s[20:21]
  s_add_u32 m0, s16, 53248
  s_nop 0
  global_load_lds_dwordx4 v20, s[20:21]
  s_add_u32 m0, s16, 54272
  s_nop 0
  global_load_lds_dwordx4 v21, s[20:21]
  s_add_u32 s20, s20, 786432
  s_addc_u32 s21, s21, 0
  s_waitcnt vmcnt(12)
  s_barrier
  ds_read_b64_tr_b16 v[80:81], v22 offset:128
  ds_read_b64_tr_b16 v[82:83], v22 offset:896
  ds_read_b64_tr_b16 v[84:85], v22 offset:12416
  ds_read_b64_tr_b16 v[86:87], v22 offset:13184
  s_waitcnt lgkmcnt(0)
  ds_write_b128 v11, v[80:83] offset:12288
  ds_write_b128 v11, v[84:87] offset:13312
  s_waitcnt lgkmcnt(0)
  ds_read_b64_tr_b16 a[160:161], v23 offset:128
  ds_read_b64_tr_b16 a[162:163], v23 offset:896
  ds_read_b64_tr_b16 a[164:165], v23 offset:12416
  ds_read_b64_tr_b16 a[166:167], v23 offset:13184
  ds_read_b64_tr_b16 a[80:81], v25 offset:0
  ds_read_b64_tr_b16 a[82:83], v25 offset:768
  ds_read_b64_tr_b16 a[84:85], v25 offset:12288
  ds_read_b64_tr_b16 a[86:87], v25 offset:13056
  s_waitcnt lgkmcnt(0)
  s_barrier
  s_add_u32 m0, s16, 0
  s_nop 0
  global_load_lds_dwordx4 v16, s[20:21]
  s_add_u32 m0, s16, 1024
  s_nop 0
  global_load_lds_dwordx4 v17, s[20:21]
  s_add_u32 m0, s16, 2048
  s_nop 0
  global_load_lds_dwordx4 v18, s[20:21]
  s_add_u32 m0, s16, 3072
  s_nop 0
  global_load_lds_dwordx4 v19, s[20:21]
  s_add_u32 m0, s16, 4096
  s_nop 0
  global_load_lds_dwordx4 v20, s[20:21]
  s_add_u32 m0, s16, 5120
  s_nop 0
  global_load_lds_dwordx4 v21, s[20:21]
  s_add_u32 s20, s20, 786432
  s_addc_u32 s21, s21, 0
  s_waitcnt vmcnt(12)
  s_barrier
  ds_read_b64_tr_b16 v[80:81], v22 offset:24704
  ds_read_b64_tr_b16 v[82:83], v22 offset:25472
  ds_read_b64_tr_b16 v[84:85], v22 offset:36992
  ds_read_b64_tr_b16 v[86:87], v22 offset:37760
  s_waitcnt lgkmcnt(0)
  ds_write_b128 v11, v[80:83] offset:10240
  ds_write_b128 v11, v[84:87] offset:11264
  s_waitcnt lgkmcnt(0)
  ds_read_b64_tr_b16 a[152:153], v23 offset:24704
  ds_read_b64_tr_b16 a[154:155], v23 offset:25472
  ds_read_b64_tr_b16 a[156:157], v23 offset:36992
  ds_read_b64_tr_b16 a[158:159], v23 offset:37760
  ds_read_b64_tr_b16 a[72:73], v25 offset:24576
  ds_read_b64_tr_b16 a[74:75], v25 offset:25344
  ds_read_b64_tr_b16 a[76:77], v25 offset:36864
  ds_read_b64_tr_b16 a[78:79], v25 offset:37632
  s_waitcnt lgkmcnt(0)
  s_barrier
  s_waitcnt vmcnt(6)
  s_barrier
  v_add_u32 v22, 49152, v22
  v_add_u32 v23, 49152, v23
  v_add_u32 v24, 49152, v24
  v_add_u32 v25, 49152, v25
  ds_read_b64_tr_b16 v[80:81], v22 offset:128
  ds_read_b64_tr_b16 v[82:83], v22 offset:896
  ds_read_b64_tr_b16 v[84:85], v22 offset:12416
  ds_read_b64_tr_b16 v[86:87], v22 offset:13184
  s_waitcnt lgkmcnt(0)
  ds_write_b128 v11, v[80:83] offset:14336
  ds_write_b128 v11, v[84:87] offset:15360
  s_waitcnt lgkmcnt(0)
  ds_read_b64_tr_b16 a[168:169], v23 offset:128
  ds_read_b64_tr_b16 a[170:171], v23 offset:896
  ds_read_b64_tr_b16 a[172:173], v23 offset:12416
  ds_read_b64_tr_b16 a[174:175], v23 offset:13184
  ds_read_b64_tr_b16 a[88:89], v25 offset:0
  ds_read_b64_tr_b16 a[90:91], v25 offset:768
  ds_read_b64_tr_b16 a[92:93], v25 offset:12288
  ds_read_b64_tr_b16 a[94:95], v25 offset:13056
  v_subrev_u32 v22, 49152, v22
  v_subrev_u32 v23, 49152, v23
  v_subrev_u32 v24, 49152, v24
  v_subrev_u32 v25, 49152, v25
  s_waitcnt lgkmcnt(0)
  s_barrier
  s_waitcnt vmcnt(0)
  s_barrier
  ds_read_b64_tr_b16 a[16:17], v22 offset:128
  ds_read_b64_tr_b16 a[18:19], v22 offset:896
  ds_read_b64_tr_b16 a[20:21], v22 offset:12416
  ds_read_b64_tr_b16 a[22:23], v22 offset:13184
  ds_read_b64_tr_b16 a[24:25], v23 offset:128
  ds_read_b64_tr_b16 a[26:27], v23 offset:896
  ds_read_b64_tr_b16 a[28:29], v23 offset:12416
  ds_read_b64_tr_b16 a[30:31], v23 offset:13184
  ds_read_b64_tr_b16 a[32:33], v25 offset:0
  ds_read_b64_tr_b16 a[34:35], v25 offset:768
  ds_read_b64_tr_b16 a[36:37], v25 offset:12288
  ds_read_b64_tr_b16 a[38:39], v25 offset:13056
  s_waitcnt lgkmcnt(0)
  s_barrier
  s_branch lw_128
lw_126:
  s_waitcnt vmcnt(12)
  s_barrier
  ds_read_b64_tr_b16 a[112:113], v24 offset:128
  ds_read_b64_tr_b16 a[114:115], v24 offset:896
  ds_read_b64_tr_b16 a[116:117], v24 offset:12416
  ds_read_b64_tr_b16 a[118:119], v24 offset:13184
  ds_read_b64_tr_b16 a[120:121], v25 offset:128
  ds_read_b64_tr_b16 a[122:123], v25 offset:896
  ds_read_b64_tr_b16 a[124:125], v25 offset:12416
  ds_read_b64_tr_b16 a[126:127], v25 offset:13184
  ds_read_b64_tr_b16 a[48:49], v22 offset:256
  ds_read_b64_tr_b16 a[50:51], v22 offset:1024
  ds_read_b64_tr_b16 a[52:53], v22 offset:12544
  ds_read_b64_tr_b16 a[54:55], v22 offset:13312
  s_waitcnt lgkmcnt(0)
  s_barrier
  s_add_u32 m0, s16, 0
  s_nop 0
  global_load_lds_dwordx4 v16, s[20:21]
  s_add_u32 m0, s16, 1024
  s_nop 0
  global_load_lds_dwordx4 v17, s[20:21]
  s_add_u32 m0, s16, 2048
  s_nop 0
  global_load_lds_dwordx4 v18, s[20:21]
  s_add_u32 m0, s16, 3072
  s_nop 0
  global_load_lds_dwordx4 v19, s[20:21]
  s_add_u32 m0, s16, 4096
  s_nop 0
  global_load_lds_dwordx4 v20, s[20:21]
  s_add_u32 m0, s16, 5120
  s_nop 0
  global_load_lds_dwordx4 v21, s[20:21]
  s_add_u32 s20, s20, 786432
  s_addc_u32 s21, s21, 0
  s_waitcnt vmcnt(12)
  s_barrier
  ds_read_b64_tr_b16 a[128:129], v24 offset:24704
  ds_read_b64_tr_b16 a[130:131], v24 offset:25472
  ds_read_b64_tr_b16 a[132:133], v24 offset:36992
  ds_read_b64_tr_b16 a[134:135], v24 offset:37760
  ds_read_b64_tr_b16 a[136:137], v25 offset:24704
  ds_read_b64_tr_b16 a[138:139], v25 offset:25472
  ds_read_b64_tr_b16 a[140:141], v25 offset:36992
  ds_read_b64_tr_b16 a[142:143], v25 offset:37760
  ds_read_b64_tr_b16 a[56:57], v22 offset:24832
  ds_read_b64_tr_b16 a[58:59], v22 offset:25600
  ds_read_b64_tr_b16 a[60:61], v22 offset:37120
  ds_read_b64_tr_b16 a[62:63], v22 offset:37888
  s_waitcnt lgkmcnt(0)
  s_barrier
  s_add_u32 m0, s16, 24576
  s_nop 0
  global_load_lds_dwordx4 v16, s[20:21]
  s_add_u32 m0, s16, 25600
  s_nop 0
  global_load_lds_dwordx4 v17, s[20:21]
  s_add_u32 m0, s16, 26624
  s_nop 0
  global_load_lds_dwordx4 v18, s[20:21]
  s_add_u32 m0, s16, 27648
  s_nop 0
  global_load_lds_dwordx4 v19, s[20:21]
  s_add_u32 m0, s16, 28672
  s_nop 0
  global_load_lds_dwordx4 v20, s[20:21]
  s_add_u32 m0, s16, 29696
  s_nop 0
  global_load_lds_dwordx4 v21, s[20:21]
  s_add_u32 s20, s20, 786432
  s_addc_u32 s21, s21, 0
  s_waitcnt vmcnt(12)
  s_barrier
  v_add_u32 v22, 49152, v22
  v_add_u32 v23, 49152, v23
  v_add_u32 v24, 49152, v24
  v_add_u32 v25, 49152, v25
  ds_read_b64_tr_b16 v[80:81], v24 offset:128
  ds_read_b64_tr_b16 v[82:83], v24 offset:896
  ds_read_b64_tr_b16 v[84:85], v24 offset:12416
  ds_read_b64_tr_b16 v[86:87], v24 offset:13184
  s_waitcnt lgkmcnt(0)
  ds_write_b128 v11, v[80:83] offset:0
  ds_write_b128 v11, v[84:87] offset:1024
  s_waitcnt lgkmcnt(0)
  ds_read_b64_tr_b16 v[80:81], v25 offset:128
  ds_read_b64_tr_b16 v[82:83], v25 offset:896
  ds_read_b64_tr_b16 v[84:85], v25 offset:12416
  ds_read_b64_tr_b16 v[86:87], v25 offset:13184
  s_waitcnt lgkmcnt(0)
  ds_write_b128 v11, v[80:83] offset:2048
  ds_write_b128 v11, v[84:87] offset:3072
  s_waitcnt lgkmcnt(0)
  ds_read_b64_tr_b16 v[80:81], v22 offset:256
  ds_read_b64_tr_b16 v[82:83], v22 offset:1024
  ds_read_b64_tr_b16 v[84:85], v22 offset:12544
  ds_read_b64_tr_b16 v[86:87], v22 offset:13312
  s_waitcnt lgkmcnt(0)
  ds_write_b128 v11, v[80:83] offset:4096
  ds_write_b128 v11, v[84:87] offset:5120
  s_waitcnt lgkmcnt(0)
  v_subrev_u32 v22, 49152, v22
  v_subrev_u32 v23, 49152, v23
  v_subrev_u32 v24, 49152, v24
  v_subrev_u32 v25, 49152, v25
  s_waitcnt lgkmcnt(0)
  s_barrier
  s_add_u32 m0, s16, 49152
  s_nop 0
  global_load_lds_dwordx4 v16, s[20:21]
  s_add_u32 m0, s16, 50176
  s_nop 0
  global_load_lds_dwordx4 v17, s[20:21]
  s_add_u32 m0, s16, 51200
  s_nop 0
  global_load_lds_dwordx4 v18, s[20:21]
  s_add_u32 m0, s16, 52224
  s_nop 0
  global_load_lds_dwordx4 v19, s[20:21]
  s_add_u32 m0, s16, 53248
  s_nop 0
  global_load_lds_dwordx4 v20, s[20:21]
  s_add_u32 m0, s16, 54272
  s_nop 0
  global_load_lds_dwordx4 v21, s[20:21]
  s_add_u32 s20, s20, 786432
  s_addc_u32 s21, s21, 0
  s_waitcnt vmcnt(12)
  s_barrier
  ds_read_b64_tr_b16 a[96:97], v24 offset:128
  ds_read_b64_tr_b16 a[98:99], v24 offset:896
  ds_read_b64_tr_b16 a[100:101], v24 offset:12416
  ds_read_b64_tr_b16 a[102:103], v24 offset:13184
  ds_read_b64_tr_b16 a[104:105], v25 offset:128
  ds_read_b64_tr_b16 a[106:107], v25 offset:896
  ds_read_b64_tr_b16 a[108:109], v25 offset:12416
  ds_read_b64_tr_b16 a[110:111], v25 offset:13184
  ds_read_b64_tr_b16 a[40:41], v22 offset:256
  ds_read_b64_tr_b16 a[42:43], v22 offset:1024
  ds_read_b64_tr_b16 a[44:45], v22 offset:12544
  ds_read_b64_tr_b16 a[46:47], v22 offset:13312
  s_waitcnt lgkmcnt(0)
  s_barrier
  s_add_u32 m0, s16, 0
  s_nop 0
  global_load_lds_dwordx4 v16, s[20:21]
  s_add_u32 m0, s16, 1024
  s_nop 0
  global_load_lds_dwordx4 v17, s[20:21]
  s_add_u32 m0, s16, 2048
  s_nop 0
  global_load_lds_dwordx4 v18, s[20:21]
  s_add_u32 m0, s16, 3072
  s_nop 0
  global_load_lds_dwordx4 v19, s[20:21]
  s_add_u32 m0, s16, 4096
  s_nop 0
  global_load_lds_dwordx4 v20, s[20:21]
  s_add_u32 m0, s16, 5120
  s_nop 0
  global_load_lds_dwordx4 v21, s[20:21]
  s_add_u32 s20, s20, 786432
  s_addc_u32 s21, s21, 0
  s_waitcnt vmcnt(12)
  s_barrier
  ds_read_b64_tr_b16 v[80:81], v24 offset:24704
  ds_read_b64_tr_b16 v[82:83], v24 offset:25472
  ds_read_b64_tr_b16 v[84:85], v24 offset:36992
  ds_read_b64_tr_b16 v[86:87], v24 offset:37760
  s_waitcnt lgkmcnt(0)
  ds_write_b128 v11, v[80:83] offset:10240
  ds_write_b128 v11, v[84:87] offset:11264
  s_waitcnt lgkmcnt(0)
  ds_read_b64_tr_b16 a[152:153], v25 offset:24704
  ds_read_b64_tr_b16 a[154:155], v25 offset:25472
  ds_read_b64_tr_b16 a[156:157], v25 offset:36992
  ds_read_b64_tr_b16 a[158:159], v25 offset:37760
  ds_read_b64_tr_b16 a[72:73], v22 offset:24832
  ds_read_b64_tr_b16 a[74:75], v22 offset:25600
  ds_read_b64_tr_b16 a[76:77], v22 offset:37120
  ds_read_b64_tr_b16 a[78:79], v22 offset:37888
  s_waitcnt lgkmcnt(0)
  s_barrier
  s_add_u32 m0, s16, 24576
  s_nop 0
  global_load_lds_dwordx4 v16, s[20:21]
  s_add_u32 m0, s16, 25600
  s_nop 0
  global_load_lds_dwordx4 v17, s[20:21]
  s_add_u32 m0, s16, 26624
  s_nop 0
  global_load_lds_dwordx4 v18, s[20:21]
  s_add_u32 m0, s16, 27648
  s_nop 0
  global_load_lds_dwordx4 v19, s[20:21]
  s_add_u32 m0, s16, 28672
  s_nop 0
  global_load_lds_dwordx4 v20, s[20:21]
  s_add_u32 m0, s16, 29696
  s_nop 0
  global_load_lds_dwordx4 v21, s[20:21]
  s_add_u32 s20, s20, 786432
  s_addc_u32 s21, s21, 0
  s_waitcnt vmcnt(12)
  s_barrier
  v_add_u32 v22, 49152, v22
  v_add_u32 v23, 49152, v23
  v_add_u32 v24, 49152, v24
  v_add_u32 v25, 49152, v25
  ds_read_b64_tr_b16 v[80:81], v24 offset:128
  ds_read_b64_tr_b16 v[82:83], v24 offset:896
  ds_read_b64_tr_b16 v[84:85], v24 offset:12416
  ds_read_b64_tr_b16 v[86:87], v24 offset:13184
  s_waitcnt lgkmcnt(0)
  ds_write_b128 v11, v[80:83] offset:12288
  ds_write_b128 v11, v[84:87] offset:13312
  s_waitcnt lgkmcnt(0)
  ds_read_b64_tr_b16 a[160:161], v25 offset:128
  ds_read_b64_tr_b16 a[162:163], v25 offset:896
  ds_read_b64_tr_b16 a[164:165], v25 offset:12416
  ds_read_b64_tr_b16 a[166:167], v25 offset:13184
  ds_read_b64_tr_b16 a[80:81], v22 offset:256
  ds_read_b64_tr_b16 a[82:83], v22 offset:1024
  ds_read_b64_tr_b16 a[84:85], v22 offset:12544
  ds_read_b64_tr_b16 a[86:87], v22 offset:13312
  v_subrev_u32 v22, 49152, v22
  v_subrev_u32 v23, 49152, v23
  v_subrev_u32 v24, 49152, v24
  v_subrev_u32 v25, 49152, v25
  s_waitcnt lgkmcnt(0)
  s_barrier
  s_add_u32 m0, s16, 49152
  s_nop 0
  global_load_lds_dwordx4 v16, s[20:21]
  s_add_u32 m0, s16, 50176
  s_nop 0
  global_load_lds_dwordx4 v17, s[20:21]
  s_add_u32 m0, s16, 51200
  s_nop 0
  global_load_lds_dwordx4 v18, s[20:21]
  s_add_u32 m0, s16, 52224
  s_nop 0
  global_load_lds_dwordx4 v19, s[20:21]
  s_add_u32 m0, s16, 53248
  s_nop 0
  global_load_lds_dwordx4 v20, s[20:21]
  s_add_u32 m0, s16, 54272
  s_nop 0
  global_load_lds_dwordx4 v21, s[20:21]
  s_add_u32 s20, s20, 786432
  s_addc_u32 s21, s21, 0
  s_waitcnt vmcnt(12)
  s_barrier
  ds_read_b64_tr_b16 v[80:81], v24 offset:128
  ds_read_b64_tr_b16 v[82:83], v24 offset:896
  ds_read_b64_tr_b16 v[84:85], v24 offset:12416
  ds_read_b64_tr_b16 v[86:87], v24 offset:13184
  s_waitcnt lgkmcnt(0)
  ds_write_b128 v11, v[80:83] offset:6144
  ds_write_b128 v11, v[84:87] offset:7168
  s_waitcnt lgkmcnt(0)
  ds_read_b64_tr_b16 a[0:1], v25 offset:128
  ds_read_b64_tr_b16 a[2:3], v25 offset:896
  ds_read_b64_tr_b16 a[4:5], v25 offset:12416
  ds_read_b64_tr_b16 a[6:7], v25 offset:13184
  ds_read_b64_tr_b16 a[8:9], v22 offset:256
  ds_read_b64_tr_b16 a[10:11], v22 offset:1024
  ds_read_b64_tr_b16 a[12:13], v22 offset:12544
  ds_read_b64_tr_b16 a[14:15], v22 offset:13312
  s_waitcnt lgkmcnt(0)
  s_barrier
  s_add_u32 m0, s16, 0
  s_nop 0
  global_load_lds_dwordx4 v16, s[20:21]
  s_add_u32 m0, s16, 1024
  s_nop 0
  global_load_lds_dwordx4 v17, s[20:21]
  s_add_u32 m0, s16, 2048
  s_nop 0
  global_load_lds_dwordx4 v18, s[20:21]
  s_add_u32 m0, s16, 3072
  s_nop 0
  global_load_lds_dwordx4 v19, s[20:21]
  s_add_u32 m0, s16, 4096
  s_nop 0
  global_load_lds_dwordx4 v20, s[20:21]
  s_add_u32 m0, s16, 5120
  s_nop 0
  global_load_lds_dwordx4 v21, s[20:21]
  s_add_u32 s20, s20, 786432
  s_addc_u32 s21, s21, 0
  s_waitcnt vmcnt(12)
  s_barrier
  ds_read_b64_tr_b16 v[80:81], v24 offset:24704
  ds_read_b64_tr_b16 v[82:83], v24 offset:25472
  ds_read_b64_tr_b16 v[84:85], v24 offset:36992
  ds_read_b64_tr_b16 v[86:87], v24 offset:37760
  s_waitcnt lgkmcnt(0)
  ds_write_b128 v11, v[80:83] offset:8192
  ds_write_b128 v11, v[84:87] offset:9216
  s_waitcnt lgkmcnt(0)
  ds_read_b64_tr_b16 a[144:145], v25 offset:24704
  ds_read_b64_tr_b16 a[146:147], v25 offset:25472
  ds_read_b64_tr_b16 a[148:149], v25 offset:36992
  ds_read_b64_tr_b16 a[150:151], v25 offset:37760
  ds_read_b64_tr_b16 a[64:65], v22 offset:24832
  ds_read_b64_tr_b16 a[66:67], v22 offset:25600
  ds_read_b64_tr_b16 a[68:69], v22 offset:37120
  ds_read_b64_tr_b16 a[70:71], v22 offset:37888
  s_waitcnt lgkmcnt(0)
  s_barrier
  s_waitcnt vmcnt(6)
  s_barrier
  v_add_u32 v22, 49152, v22
  v_add_u32 v23, 49152, v23
  v_add_u32 v24, 49152, v24
  v_add_u32 v25, 49152, v25
  ds_read_b64_tr_b16 a[16:17], v24 offset:128
  ds_read_b64_tr_b16 a[18:19], v24 offset:896
  ds_read_b64_tr_b16 a[20:21], v24 offset:12416
  ds_read_b64_tr_b16 a[22:23], v24 offset:13184
  ds_read_b64_tr_b16 a[24:25], v25 offset:128
  ds_read_b64_tr_b16 a[26:27], v25 offset:896
  ds_read_b64_tr_b16 a[28:29], v25 offset:12416
  ds_read_b64_tr_b16 a[30:31], v25 offset:13184
  ds_read_b64_tr_b16 a[32:33], v22 offset:256
  ds_read_b64_tr_b16 a[34:35], v22 offset:1024
  ds_read_b64_tr_b16 a[36:37], v22 offset:12544
  ds_read_b64_tr_b16 a[38:39], v22 offset:13312
  v_subrev_u32 v22, 49152, v22
  v_subrev_u32 v23, 49152, v23
  v_subrev_u32 v24, 49152, v24
  v_subrev_u32 v25, 49152, v25
  s_waitcnt lgkmcnt(0)
  s_barrier
  s_waitcnt vmcnt(0)
  s_barrier
  ds_read_b64_tr_b16 v[80:81], v24 offset:128
  ds_read_b64_tr_b16 v[82:83], v24 offset:896
  ds_read_b64_tr_b16 v[84:85], v24 offset:12416
  ds_read_b64_tr_b16 v[86:87], v24 offset:13184
  s_waitcnt lgkmcnt(0)
  ds_write_b128 v11, v[80:83] offset:14336
  ds_write_b128 v11, v[84:87] offset:15360
  s_waitcnt lgkmcnt(0)
  ds_read_b64_tr_b16 a[168:169], v25 offset:128
  ds_read_b64_tr_b16 a[170:171], v25 offset:896
  ds_read_b64_tr_b16 a[172:173], v25 offset:12416
  ds_read_b64_tr_b16 a[174:175], v25 offset:13184
  ds_read_b64_tr_b16 a[88:89], v22 offset:256
  ds_read_b64_tr_b16 a[90:91], v22 offset:1024
  ds_read_b64_tr_b16 a[92:93], v22 offset:12544
  ds_read_b64_tr_b16 a[94:95], v22 offset:13312
  s_waitcnt lgkmcnt(0)
  s_barrier
  s_branch lw_128
lw_127:
  s_waitcnt vmcnt(12)
  s_barrier
  ds_read_b64_tr_b16 a[128:129], v24 offset:256
  ds_read_b64_tr_b16 a[130:131], v24 offset:1024
  ds_read_b64_tr_b16 a[132:133], v24 offset:12544
  ds_read_b64_tr_b16 a[134:135], v24 offset:13312
  ds_read_b64_tr_b16 a[136:137], v25 offset:256
  ds_read_b64_tr_b16 a[138:139], v25 offset:1024
  ds_read_b64_tr_b16 a[140:141], v25 offset:12544
  ds_read_b64_tr_b16 a[142:143], v25 offset:13312
  ds_read_b64_tr_b16 a[56:57], v23 offset:256
  ds_read_b64_tr_b16 a[58:59], v23 offset:1024
  ds_read_b64_tr_b16 a[60:61], v23 offset:12544
  ds_read_b64_tr_b16 a[62:63], v23 offset:13312
  s_waitcnt lgkmcnt(0)
  s_barrier
  s_add_u32 m0, s16, 0
  s_nop 0
  global_load_lds_dwordx4 v16, s[20:21]
  s_add_u32 m0, s16, 1024
  s_nop 0
  global_load_lds_dwordx4 v17, s[20:21]
  s_add_u32 m0, s16, 2048
  s_nop 0
  global_load_lds_dwordx4 v18, s[20:21]
  s_add_u32 m0, s16, 3072
  s_nop 0
  global_load_lds_dwordx4 v19, s[20:21]
  s_add_u32 m0, s16, 4096
  s_nop 0
  global_load_lds_dwordx4 v20, s[20:21]
  s_add_u32 m0, s16, 5120
  s_nop 0
  global_load_lds_dwordx4 v21, s[20:21]
  s_add_u32 s20, s20, 786432
  s_addc_u32 s21, s21, 0
  s_waitcnt vmcnt(12)
  s_barrier
  ds_read_b64_tr_b16 a[112:113], v24 offset:24832
  ds_read_b64_tr_b16 a[114:115], v24 offset:25600
  ds_read_b64_tr_b16 a[116:117], v24 offset:37120
  ds_read_b64_tr_b16 a[118:119], v24 offset:37888
  ds_read_b64_tr_b16 a[120:121], v25 offset:24832
  ds_read_b64_tr_b16 a[122:123], v25 offset:25600
  ds_read_b64_tr_b16 a[124:125], v25 offset:37120
  ds_read_b64_tr_b16 a[126:127], v25 offset:37888
  ds_read_b64_tr_b16 a[48:49], v23 offset:24832
  ds_read_b64_tr_b16 a[50:51], v23 offset:25600
  ds_read_b64_tr_b16 a[52:53], v23 offset:37120
  ds_read_b64_tr_b16 a[54:55], v23 offset:37888
  s_waitcnt lgkmcnt(0)
  s_barrier
  s_add_u32 m0, s16, 24576
  s_nop 0
  global_load_lds_dwordx4 v16, s[20:21]
  s_add_u32 m0, s16, 25600
  s_nop 0
  global_load_lds_dwordx4 v17, s[20:21]
  s_add_u32 m0, s16, 26624
  s_nop 0
  global_load_lds_dwordx4 v18, s[20:21]
  s_add_u32 m0, s16, 27648
  s_nop 0
  global_load_lds_dwordx4 v19, s[20:21]
  s_add_u32 m0, s16, 28672
  s_nop 0
  global_load_lds_dwordx4 v20, s[20:21]
  s_add_u32 m0, s16, 29696
  s_nop 0
  global_load_lds_dwordx4 v21, s[20:21]
  s_add_u32 s20, s20, 786432
  s_addc_u32 s21, s21, 0
  s_waitcnt vmcnt(12)
  s_barrier
  v_add_u32 v22, 49152, v22
  v_add_u32 v23, 49152, v23
  v_add_u32 v24, 49152, v24
  v_add_u32 v25, 49152, v25
  ds_read_b64_tr_b16 a[96:97], v24 offset:256
  ds_read_b64_tr_b16 a[98:99], v24 offset:1024
  ds_read_b64_tr_b16 a[100:101], v24 offset:12544
  ds_read_b64_tr_b16 a[102:103], v24 offset:13312
  ds_read_b64_tr_b16 a[104:105], v25 offset:256
  ds_read_b64_tr_b16 a[106:107], v25 offset:1024
  ds_read_b64_tr_b16 a[108:109], v25 offset:12544
  ds_read_b64_tr_b16 a[110:111], v25 offset:13312
  ds_read_b64_tr_b16 a[40:41], v23 offset:256
  ds_read_b64_tr_b16 a[42:43], v23 offset:1024
  ds_read_b64_tr_b16 a[44:45], v23 offset:12544
  ds_read_b64_tr_b16 a[46:47], v23 offset:13312
  v_subrev_u32 v22, 49152, v22
  v_subrev_u32 v23, 49152, v23
  v_subrev_u32 v24, 49152, v24
  v_subrev_u32 v25, 49152, v25
  s_waitcnt lgkmcnt(0)
  s_barrier
  s_add_u32 m0, s16, 49152
  s_nop 0
  global_load_lds_dwordx4 v16, s[20:21]
  s_add_u32 m0, s16, 50176
  s_nop 0
  global_load_lds_dwordx4 v17, s[20:21]
  s_add_u32 m0, s16, 51200
  s_nop 0
  global_load_lds_dwordx4 v18, s[20:21]
  s_add_u32 m0, s16, 52224
  s_nop 0
  global_load_lds_dwordx4 v19, s[20:21]
  s_add_u32 m0, s16, 53248
  s_nop 0
  global_load_lds_dwordx4 v20, s[20:21]
  s_add_u32 m0, s16, 54272
  s_nop 0
  global_load_lds_dwordx4 v21, s[20:21]
  s_add_u32 s20, s20, 786432
  s_addc_u32 s21, s21, 0
  s_waitcnt vmcnt(12)
  s_barrier
  ds_read_b64_tr_b16 v[80:81], v24 offset:256
  ds_read_b64_tr_b16 v[82:83], v24 offset:1024
  ds_read_b64_tr_b16 v[84:85], v24 offset:12544
  ds_read_b64_tr_b16 v[86:87], v24 offset:13312
  s_waitcnt lgkmcnt(0)
  ds_write_b128 v11, v[80:83] offset:0
  ds_write_b128 v11, v[84:87] offset:1024
  s_waitcnt lgkmcnt(0)
  ds_read_b64_tr_b16 v[80:81], v25 offset:256
  ds_read_b64_tr_b16 v[82:83], v25 offset:1024
  ds_read_b64_tr_b16 v[84:85], v25 offset:12544
  ds_read_b64_tr_b16 v[86:87], v25 offset:13312
  s_waitcnt lgkmcnt(0)
  ds_write_b128 v11, v[80:83] offset:2048
  ds_write_b128 v11, v[84:87] offset:3072
  s_waitcnt lgkmcnt(0)
  ds_read_b64_tr_b16 v[80:81], v23 offset:256
  ds_read_b64_tr_b16 v[82:83], v23 offset:1024
  ds_read_b64_tr_b16 v[84:85], v23 offset:12544
  ds_read_b64_tr_b16 v[86:87], v23 offset:13312
  s_waitcnt lgkmcnt(0)
  ds_write_b128 v11, v[80:83] offset:4096
  ds_write_b128 v11, v[84:87] offset:5120
  s_waitcnt lgkmcnt(0)
  s_waitcnt lgkmcnt(0)
  s_barrier
  s_add_u32 m0, s16, 0
  s_nop 0
  global_load_lds_dwordx4 v16, s[20:21]
  s_add_u32 m0, s16, 1024
  s_nop 0
  global_load_lds_dwordx4 v17, s[20:21]
  s_add_u32 m0, s16, 2048
  s_nop 0
  global_load_lds_dwordx4 v18, s[20:21]
  s_add_u32 m0, s16, 3072
  s_nop 0
  global_load_lds_dwordx4 v19, s[20:21]
  s_add_u32 m0, s16, 4096
  s_nop 0
  global_load_lds_dwordx4 v20, s[20:21]
  s_add_u32 m0, s16, 5120
  s_nop 0
  global_load_lds_dwordx4 v21, s[20:21]
  s_add_u32 s20, s20, 786432
  s_addc_u32 s21, s21, 0
  s_waitcnt vmcnt(12)
  s_barrier
  ds_read_b64_tr_b16 v[80:81], v24 offset:24832
  ds_read_b64_tr_b16 v[82:83], v24 offset:25600
  ds_read_b64_tr_b16 v[84:85], v24 offset:37120
  ds_read_b64_tr_b16 v[86:87], v24 offset:37888
  s_waitcnt lgkmcnt(0)
  ds_write_b128 v11, v[80:83] offset:12288
  ds_write_b128 v11, v[84:87] offset:13312
  s_waitcnt lgkmcnt(0)
  ds_read_b64_tr_b16 a[160:161], v25 offset:24832
  ds_read_b64_tr_b16 a[162:163], v25 offset:25600
  ds_read_b64_tr_b16 a[164:165], v25 offset:37120
  ds_read_b64_tr_b16 a[166:167], v25 offset:37888
  ds_read_b64_tr_b16 a[80:81], v23 offset:24832
  ds_read_b64_tr_b16 a[82:83], v23 offset:25600
  ds_read_b64_tr_b16 a[84:85], v23 offset:37120
  ds_read_b64_tr_b16 a[86:87], v23 offset:37888
  s_waitcnt lgkmcnt(0)
  s_barrier
  s_add_u32 m0, s16, 24576
  s_nop 0
  global_load_lds_dwordx4 v16, s[20:21]
  s_add_u32 m0, s16, 25600
  s_nop 0
  global_load_lds_dwordx4 v17, s[20:21]
  s_add_u32 m0, s16, 26624
  s_nop 0
  global_load_lds_dwordx4 v18, s[20:21]
  s_add_u32 m0, s16, 27648
  s_nop 0
  global_load_lds_dwordx4 v19, s[20:21]
  s_add_u32 m0, s16, 28672
  s_nop 0
  global_load_lds_dwordx4 v20, s[20:21]
  s_add_u32 m0, s16, 29696
  s_nop 0
  global_load_lds_dwordx4 v21, s[20:21]
  s_add_u32 s20, s20, 786432
  s_addc_u32 s21, s21, 0
  s_waitcnt vmcnt(12)
  s_barrier
  v_add_u32 v22, 49152, v22
  v_add_u32 v23, 49152, v23
  v_add_u32 v24, 49152, v24
  v_add_u32 v25, 49152, v25
  ds_read_b64_tr_b16 v[80:81], v24 offset:256
  ds_read_b64_tr_b16 v[82:83], v24 offset:1024
  ds_read_b64_tr_b16 v[84:85], v24 offset:12544
  ds_read_b64_tr_b16 v[86:87], v24 offset:13312
  s_waitcnt lgkmcnt(0)
  ds_write_b128 v11, v[80:83] offset:10240
  ds_write_b128 v11, v[84:87] offset:11264
  s_waitcnt lgkmcnt(0)
  ds_read_b64_tr_b16 a[152:153], v25 offset:256
  ds_read_b64_tr_b16 a[154:155], v25 offset:1024
  ds_read_b64_tr_b16 a[156:157], v25 offset:12544
  ds_read_b64_tr_b16 a[158:159], v25 offset:13312
  ds_read_b64_tr_b16 a[72:73], v23 offset:256
  ds_read_b64_tr_b16 a[74:75], v23 offset:1024
  ds_read_b64_tr_b16 a[76:77], v23 offset:12544
  ds_read_b64_tr_b16 a[78:79], v23 offset:13312
  v_subrev_u32 v22, 49152, v22
  v_subrev_u32 v23, 49152, v23
  v_subrev_u32 v24, 49152, v24
  v_subrev_u32 v25, 49152, v25
  s_waitcnt lgkmcnt(0)
  s_barrier
  s_add_u32 m0, s16, 49152
  s_nop 0
  global_load_lds_dwordx4 v16, s[20:21]
  s_add_u32 m0, s16, 50176
  s_nop 0
  global_load_lds_dwordx4 v17, s[20:21]
  s_add_u32 m0, s16, 51200
  s_nop 0
  global_load_lds_dwordx4 v18, s[20:21]
  s_add_u32 m0, s16, 52224
  s_nop 0
  global_load_lds_dwordx4 v19, s[20:21]
  s_add_u32 m0, s16, 53248
  s_nop 0
  global_load_lds_dwordx4 v20, s[20:21]
  s_add_u32 m0, s16, 54272
  s_nop 0
  global_load_lds_dwordx4 v21, s[20:21]
  s_add_u32 s20, s20, 786432
  s_addc_u32 s21, s21, 0
  s_waitcnt vmcnt(12)
  s_barrier
  ds_read_b64_tr_b16 v[80:81], v24 offset:256
  ds_read_b64_tr_b16 v[82:83], v24 offset:1024
  ds_read_b64_tr_b16 v[84:85], v24 offset:12544
  ds_read_b64_tr_b16 v[86:87], v24 offset:13312
  s_waitcnt lgkmcnt(0)
  ds_write_b128 v11, v[80:83] offset:8192
  ds_write_b128 v11, v[84:87] offset:9216
  s_waitcnt lgkmcnt(0)
  ds_read_b64_tr_b16 a[144:145], v25 offset:256
  ds_read_b64_tr_b16 a[146:147], v25 offset:1024
  ds_read_b64_tr_b16 a[148:149], v25 offset:12544
  ds_read_b64_tr_b16 a[150:151], v25 offset:13312
  ds_read_b64_tr_b16 a[64:65], v23 offset:256
  ds_read_b64_tr_b16 a[66:67], v23 offset:1024
  ds_read_b64_tr_b16 a[68:69], v23 offset:12544
  ds_read_b64_tr_b16 a[70:71], v23 offset:13312
  s_waitcnt lgkmcnt(0)
  s_barrier
  s_add_u32 m0, s16, 0
  s_nop 0
  global_load_lds_dwordx4 v16, s[20:21]
  s_add_u32 m0, s16, 1024
  s_nop 0
  global_load_lds_dwordx4 v17, s[20:21]
  s_add_u32 m0, s16, 2048
  s_nop 0
  global_load_lds_dwordx4 v18, s[20:21]
  s_add_u32 m0, s16, 3072
  s_nop 0
  global_load_lds_dwordx4 v19, s[20:21]
  s_add_u32 m0, s16, 4096
  s_nop 0
  global_load_lds_dwordx4 v20, s[20:21]
  s_add_u32 m0, s16, 5120
  s_nop 0
  global_load_lds_dwordx4 v21, s[20:21]
  s_add_u32 s20, s20, 786432
  s_addc_u32 s21, s21, 0
  s_waitcnt vmcnt(12)
  s_barrier
  ds_read_b64_tr_b16 v[80:81], v24 offset:24832
  ds_read_b64_tr_b16 v[82:83], v24 offset:25600
  ds_read_b64_tr_b16 v[84:85], v24 offset:37120
  ds_read_b64_tr_b16 v[86:87], v24 offset:37888
  s_waitcnt lgkmcnt(0)
  ds_write_b128 v11, v[80:83] offset:6144
  ds_write_b128 v11, v[84:87] offset:7168
  s_waitcnt lgkmcnt(0)
  ds_read_b64_tr_b16 a[0:1], v25 offset:24832
  ds_read_b64_tr_b16 a[2:3], v25 offset:25600
  ds_read_b64_tr_b16 a[4:5], v25 offset:37120
  ds_read_b64_tr_b16 a[6:7], v25 offset:37888
  ds_read_b64_tr_b16 a[8:9], v23 offset:24832
  ds_read_b64_tr_b16 a[10:11], v23 offset:25600
  ds_read_b64_tr_b16 a[12:13], v23 offset:37120
  ds_read_b64_tr_b16 a[14:15], v23 offset:37888
  s_waitcnt lgkmcnt(0)
  s_barrier
  s_waitcnt vmcnt(6)
  s_barrier
  v_add_u32 v22, 49152, v22
  v_add_u32 v23, 49152, v23
  v_add_u32 v24, 49152, v24
  v_add_u32 v25, 49152, v25
  ds_read_b64_tr_b16 v[80:81], v24 offset:256
  ds_read_b64_tr_b16 v[82:83], v24 offset:1024
  ds_read_b64_tr_b16 v[84:85], v24 offset:12544
  ds_read_b64_tr_b16 v[86:87], v24 offset:13312
  s_waitcnt lgkmcnt(0)
  ds_write_b128 v11, v[80:83] offset:14336
  ds_write_b128 v11, v[84:87] offset:15360
  s_waitcnt lgkmcnt(0)
  ds_read_b64_tr_b16 a[168:169], v25 offset:256
  ds_read_b64_tr_b16 a[170:171], v25 offset:1024
  ds_read_b64_tr_b16 a[172:173], v25 offset:12544
  ds_read_b64_tr_b16 a[174:175], v25 offset:13312
  ds_read_b64_tr_b16 a[88:89], v23 offset:256
  ds_read_b64_tr_b16 a[90:91], v23 offset:1024
  ds_read_b64_tr_b16 a[92:93], v23 offset:12544
  ds_read_b64_tr_b16 a[94:95], v23 offset:13312
  v_subrev_u32 v22, 49152, v22
  v_subrev_u32 v23, 49152, v23
  v_subrev_u32 v24, 49152, v24
  v_subrev_u32 v25, 49152, v25
  s_waitcnt lgkmcnt(0)
  s_barrier
  s_waitcnt vmcnt(0)
  s_barrier
  ds_read_b64_tr_b16 a[16:17], v24 offset:256
  ds_read_b64_tr_b16 a[18:19], v24 offset:1024
  ds_read_b64_tr_b16 a[20:21], v24 offset:12544
  ds_read_b64_tr_b16 a[22:23], v24 offset:13312
  ds_read_b64_tr_b16 a[24:25], v25 offset:256
  ds_read_b64_tr_b16 a[26:27], v25 offset:1024
  ds_read_b64_tr_b16 a[28:29], v25 offset:12544
  ds_read_b64_tr_b16 a[30:31], v25 offset:13312
  ds_read_b64_tr_b16 a[32:33], v23 offset:256
  ds_read_b64_tr_b16 a[34:35], v23 offset:1024
  ds_read_b64_tr_b16 a[36:37], v23 offset:12544
  ds_read_b64_tr_b16 a[38:39], v23 offset:13312
  s_waitcnt lgkmcnt(0)
  s_barrier
lw_128:
  s_mul_i32 s16, s3, 20480
  v_bfe_u32 v18, v0, 2, 1
  v_lshrrev_b32 v19, 4, v0
  v_lshl_add_u32 v18, v19, 2, v18
  v_mul_u32_u24 v18, 320, v18
  v_bfe_u32 v19, v0, 3, 1
  v_lshl_add_u32 v18, v19, 5, v18
  v_and_b32 v19, 3, v0
  v_lshl_add_u32 v18, v19, 3, v18
  v_add_u32 v18, s16, v18
  v_mul_u32_u24 v17, 3277, v0
  v_lshrrev_b32 v17, 16, v17
  s_mov_b32 s12, 960
  v_mul_lo_u32 v16, v17, s12
  v_lshl_add_u32 v16, v0, 4, v16
  s_mov_b32 exec_lo, 0xffffffff
  s_mov_b32 exec_hi, 0xfffffff
  s_add_u32 m0, s16, 0
  s_nop 0
  global_load_lds_dwordx4 v16, s[22:23]
  s_add_u32 s22, s22, 3840
  s_addc_u32 s23, s23, 0
  s_add_u32 m0, s16, 960
  s_nop 0
  global_load_lds_dwordx4 v16, s[22:23]
  s_add_u32 s22, s22, 3840
  s_addc_u32 s23, s23, 0
  s_add_u32 m0, s16, 1920
  s_nop 0
  global_load_lds_dwordx4 v16, s[22:23]
  s_add_u32 s22, s22, 3840
  s_addc_u32 s23, s23, 0
  s_add_u32 m0, s16, 2880
  s_nop 0
  global_load_lds_dwordx4 v16, s[22:23]
  s_add_u32 s22, s22, 3840
  s_addc_u32 s23, s23, 0
  s_add_u32 m0, s16, 3840
  s_nop 0
  global_load_lds_dwordx4 v16, s[22:23]
  s_add_u32 s22, s22, 3840
  s_addc_u32 s23, s23, 0
  s_add_u32 m0, s16, 4800
  s_nop 0
  global_load_lds_dwordx4 v16, s[22:23]
  s_add_u32 s22, s22, 3840
  s_addc_u32 s23, s23, 0
  s_add_u32 m0, s16, 5760
  s_nop 0
  global_load_lds_dwordx4 v16, s[22:23]
  s_add_u32 s22, s22, 3840
  s_addc_u32 s23, s23, 0
  s_add_u32 m0, s16, 6720
  s_nop 0
  global_load_lds_dwordx4 v16, s[22:23]
  s_add_u32 s22, s22, 3840
  s_addc_u32 s23, s23, 0
  s_add_u32 m0, s16, 7680
  s_nop 0
  global_load_lds_dwordx4 v16, s[22:23]
  s_add_u32 s22, s22, 3840
  s_addc_u32 s23, s23, 0
  s_add_u32 m0, s16, 8640
  s_nop 0
  global_load_lds_dwordx4 v16, s[22:23]
  s_add_u32 s22, s22, 3840
  s_addc_u32 s23, s23, 0
  s_mov_b32 exec_lo, 0xffffffff
  s_mov_b32 exec_hi, 0xff
  s_add_u32 m0, s16, 9600
  s_nop 0
  global_load_lds_dwordx4 v16, s[22:23]
  s_add_u32 s22, s22, 2560
  s_addc_u32 s23, s23, 0
  s_mov_b64 exec, -1
  s_mov_b32 exec_lo, 0xffffffff
  s_mov_b32 exec_hi, 0xfffffff
  s_add_u32 m0, s16, 10240
  s_nop 0
  global_load_lds_dwordx4 v16, s[22:23]
  s_add_u32 s22, s22, 3840
  s_addc_u32 s23, s23, 0
  s_add_u32 m0, s16, 11200
  s_nop 0
  global_load_lds_dwordx4 v16, s[22:23]
  s_add_u32 s22, s22, 3840
  s_addc_u32 s23, s23, 0
  s_add_u32 m0, s16, 12160
  s_nop 0
  global_load_lds_dwordx4 v16, s[22:23]
  s_add_u32 s22, s22, 3840
  s_addc_u32 s23, s23, 0
  s_add_u32 m0, s16, 13120
  s_nop 0
  global_load_lds_dwordx4 v16, s[22:23]
  s_add_u32 s22, s22, 3840
  s_addc_u32 s23, s23, 0
  s_add_u32 m0, s16, 14080
  s_nop 0
  global_load_lds_dwordx4 v16, s[22:23]
  s_add_u32 s22, s22, 3840
  s_addc_u32 s23, s23, 0
  s_add_u32 m0, s16, 15040
  s_nop 0
  global_load_lds_dwordx4 v16, s[22:23]
  s_add_u32 s22, s22, 3840
  s_addc_u32 s23, s23, 0
  s_add_u32 m0, s16, 16000
  s_nop 0
  global_load_lds_dwordx4 v16, s[22:23]
  s_add_u32 s22, s22, 3840
  s_addc_u32 s23, s23, 0
  s_add_u32 m0, s16, 16960
  s_nop 0
  global_load_lds_dwordx4 v16, s[22:23]
  s_add_u32 s22, s22, 3840
  s_addc_u32 s23, s23, 0
  s_add_u32 m0, s16, 17920
  s_nop 0
  global_load_lds_dwordx4 v16, s[22:23]
  s_add_u32 s22, s22, 3840
  s_addc_u32 s23, s23, 0
  s_add_u32 m0, s16, 18880
  s_nop 0
  global_load_lds_dwordx4 v16, s[22:23]
  s_add_u32 s22, s22, 3840
  s_addc_u32 s23, s23, 0
  s_mov_b32 exec_lo, 0xffffffff
  s_mov_b32 exec_hi, 0xff
  s_add_u32 m0, s16, 19840
  s_nop 0
  global_load_lds_dwordx4 v16, s[22:23]
  s_add_u32 s22, s22, 2560
  s_addc_u32 s23, s23, 0
  s_mov_b64 exec, -1
  s_waitcnt vmcnt(11)
  ds_read_b64_tr_b16 v[112:113], v18 offset:0
  ds_read_b64_tr_b16 v[114:115], v18 offset:640
  ds_read_b64_tr_b16 v[116:117], v18 offset:5120
  ds_read_b64_tr_b16 v[118:119], v18 offset:5760
  ds_read_b64_tr_b16 v[120:121], v18 offset:64
  ds_read_b64_tr_b16 v[122:123], v18 offset:704
  ds_read_b64_tr_b16 v[124:125], v18 offset:5184
  ds_read_b64_tr_b16 v[126:127], v18 offset:5824
  ds_read_b64_tr_b16 v[176:177], v18 offset:128
  ds_read_b64_tr_b16 v[178:179], v18 offset:768
  ds_read_b64_tr_b16 v[180:181], v18 offset:5248
  ds_read_b64_tr_b16 v[182:183], v18 offset:5888
  ds_read_b64_tr_b16 v[192:193], v18 offset:192
  ds_read_b64_tr_b16 v[194:195], v18 offset:832
  ds_read_b64_tr_b16 v[196:197], v18 offset:5312
  ds_read_b64_tr_b16 v[198:199], v18 offset:5952
  ds_read_b64_tr_b16 v[224:225], v18 offset:256
  ds_read_b64_tr_b16 v[226:227], v18 offset:896
  ds_read_b64_tr_b16 v[228:229], v18 offset:5376
  ds_read_b64_tr_b16 v[230:231], v18 offset:6016
  s_waitcnt lgkmcnt(0)
  s_mov_b32 exec_lo, 0xffffffff
  s_mov_b32 exec_hi, 0xfffffff
  s_add_u32 m0, s16, 0
  s_nop 0
  global_load_lds_dwordx4 v16, s[22:23]
  s_add_u32 s22, s22, 3840
  s_addc_u32 s23, s23, 0
  s_add_u32 m0, s16, 960
  s_nop 0
  global_load_lds_dwordx4 v16, s[22:23]
  s_add_u32 s22, s22, 3840
  s_addc_u32 s23, s23, 0
  s_add_u32 m0, s16, 1920
  s_nop 0
  global_load_lds_dwordx4 v16, s[22:23]
  s_add_u32 s22, s22, 3840
  s_addc_u32 s23, s23, 0
  s_add_u32 m0, s16, 2880
  s_nop 0
  global_load_lds_dwordx4 v16, s[22:23]
  s_add_u32 s22, s22, 3840
  s_addc_u32 s23, s23, 0
  s_add_u32 m0, s16, 3840
  s_nop 0
  global_load_lds_dwordx4 v16, s[22:23]
  s_add_u32 s22, s22, 3840
  s_addc_u32 s23, s23, 0
  s_add_u32 m0, s16, 4800
  s_nop 0
  global_load_lds_dwordx4 v16, s[22:23]
  s_add_u32 s22, s22, 3840
  s_addc_u32 s23, s23, 0
  s_add_u32 m0, s16, 5760
  s_nop 0
  global_load_lds_dwordx4 v16, s[22:23]
  s_add_u32 s22, s22, 3840
  s_addc_u32 s23, s23, 0
  s_add_u32 m0, s16, 6720
  s_nop 0
  global_load_lds_dwordx4 v16, s[22:23]
  s_add_u32 s22, s22, 3840
  s_addc_u32 s23, s23, 0
  s_add_u32 m0, s16, 7680
  s_nop 0
  global_load_lds_dwordx4 v16, s[22:23]
  s_add_u32 s22, s22, 3840
  s_addc_u32 s23, s23, 0
  s_add_u32 m0, s16, 8640
  s_nop 0
  global_load_lds_dwordx4 v16, s[22:23]
  s_add_u32 s22, s22, 3840
  s_addc_u32 s23, s23, 0
  s_mov_b32 exec_lo, 0xffffffff
  s_mov_b32 exec_hi, 0xff
  s_add_u32 m0, s16, 9600
  s_nop 0
  global_load_lds_dwordx4 v16, s[22:23]
  s_add_u32 s22, s22, 2560
  s_addc_u32 s23, s23, 0
  s_mov_b64 exec, -1
  s_waitcnt vmcnt(11)
  ds_read_b64_tr_b16 a[176:177], v18 offset:10240
  ds_read_b64_tr_b16 a[178:179], v18 offset:10880
  ds_read_b64_tr_b16 a[180:181], v18 offset:15360
  ds_read_b64_tr_b16 a[182:183], v18 offset:16000
  ds_read_b64_tr_b16 a[184:185], v18 offset:10304
  ds_read_b64_tr_b16 a[186:187], v18 offset:10944
  ds_read_b64_tr_b16 a[188:189], v18 offset:15424
  ds_read_b64_tr_b16 a[190:191], v18 offset:16064
  ds_read_b64_tr_b16 a[192:193], v18 offset:10368
  ds_read_b64_tr_b16 a[194:195], v18 offset:11008
  ds_read_b64_tr_b16 a[196:197], v18 offset:15488
  ds_read_b64_tr_b16 a[198:199], v18 offset:16128
  ds_read_b64_tr_b16 a[200:201], v18 offset:10432
  ds_read_b64_tr_b16 a[202:203], v18 offset:11072
  ds_read_b64_tr_b16 a[204:205], v18 offset:15552
  ds_read_b64_tr_b16 a[206:207], v18 offset:16192
  ds_read_b64_tr_b16 a[208:209], v18 offset:10496
  ds_read_b64_tr_b16 a[210:211], v18 offset:11136
  ds_read_b64_tr_b16 a[212:213], v18 offset:15616
  ds_read_b64_tr_b16 a[214:215], v18 offset:16256
  s_waitcnt lgkmcnt(0)
  s_mov_b32 exec_lo, 0xffffffff
  s_mov_b32 exec_hi, 0xfffffff
  s_add_u32 m0, s16, 10240
  s_nop 0
  global_load_lds_dwordx4 v16, s[22:23]
  s_add_u32 s22, s22, 3840
  s_addc_u32 s23, s23, 0
  s_add_u32 m0, s16, 11200
  s_nop 0
  global_load_lds_dwordx4 v16, s[22:23]
  s_add_u32 s22, s22, 3840
  s_addc_u32 s23, s23, 0
  s_add_u32 m0, s16, 12160
  s_nop 0
  global_load_lds_dwordx4 v16, s[22:23]
  s_add_u32 s22, s22, 3840
  s_addc_u32 s23, s23, 0
  s_add_u32 m0, s16, 13120
  s_nop 0
  global_load_lds_dwordx4 v16, s[22:23]
  s_add_u32 s22, s22, 3840
  s_addc_u32 s23, s23, 0
  s_add_u32 m0, s16, 14080
  s_nop 0
  global_load_lds_dwordx4 v16, s[22:23]
  s_add_u32 s22, s22, 3840
  s_addc_u32 s23, s23, 0
  s_add_u32 m0, s16, 15040
  s_nop 0
  global_load_lds_dwordx4 v16, s[22:23]
  s_add_u32 s22, s22, 3840
  s_addc_u32 s23, s23, 0
  s_add_u32 m0, s16, 16000
  s_nop 0
  global_load_lds_dwordx4 v16, s[22:23]
  s_add_u32 s22, s22, 3840
  s_addc_u32 s23, s23, 0
  s_add_u32 m0, s16, 16960
  s_nop 0
  global_load_lds_dwordx4 v16, s[22:23]
  s_add_u32 s22, s22, 3840
  s_addc_u32 s23, s23, 0
  s_add_u32 m0, s16, 17920
  s_nop 0
  global_load_lds_dwordx4 v16, s[22:23]
  s_add_u32 s22, s22, 3840
  s_addc_u32 s23, s23, 0
  s_add_u32 m0, s16, 18880
  s_nop 0
  global_load_lds_dwordx4 v16, s[22:23]
  s_add_u32 s22, s22, 3840
  s_addc_u32 s23, s23, 0
  s_mov_b32 exec_lo, 0xffffffff
  s_mov_b32 exec_hi, 0xff
  s_add_u32 m0, s16, 19840
  s_nop 0
  global_load_lds_dwordx4 v16, s[22:23]
  s_add_u32 s22, s22, 2560
  s_addc_u32 s23, s23, 0
  s_mov_b64 exec, -1
  s_waitcnt vmcnt(11)
  ds_read_b64_tr_b16 v[128:129], v18 offset:0
  ds_read_b64_tr_b16 v[130:131], v18 offset:640
  ds_read_b64_tr_b16 v[132:133], v18 offset:5120
  ds_read_b64_tr_b16 v[134:135], v18 offset:5760
  ds_read_b64_tr_b16 v[136:137], v18 offset:64
  ds_read_b64_tr_b16 v[138:139], v18 offset:704
  ds_read_b64_tr_b16 v[140:141], v18 offset:5184
  ds_read_b64_tr_b16 v[142:143], v18 offset:5824
  ds_read_b64_tr_b16 v[80:81], v18 offset:128
  ds_read_b64_tr_b16 v[82:83], v18 offset:768
  ds_read_b64_tr_b16 v[84:85], v18 offset:5248
  ds_read_b64_tr_b16 v[86:87], v18 offset:5888
  s_waitcnt lgkmcnt(0)
  ds_write_b128 v11, v[80:83] offset:16384
  ds_write_b128 v11, v[84:87] offset:17408
  s_waitcnt lgkmcnt(0)
  ds_read_b64_tr_b16 v[200:201], v18 offset:192
  ds_read_b64_tr_b16 v[202:203], v18 offset:832
  ds_read_b64_tr_b16 v[204:205], v18 offset:5312
  ds_read_b64_tr_b16 v[206:207], v18 offset:5952
  ds_read_b64_tr_b16 v[232:233], v18 offset:256
  ds_read_b64_tr_b16 v[234:235], v18 offset:896
  ds_read_b64_tr_b16 v[236:237], v18 offset:5376
  ds_read_b64_tr_b16 v[238:239], v18 offset:6016
  s_waitcnt lgkmcnt(0)
  s_mov_b32 exec_lo, 0xffffffff
  s_mov_b32 exec_hi, 0xfffffff
  s_add_u32 m0, s16, 0
  s_nop 0
  global_load_lds_dwordx4 v16, s[22:23]
  s_add_u32 s22, s22, 3840
  s_addc_u32 s23, s23, 0
  s_add_u32 m0, s16, 960
  s_nop 0
  global_load_lds_dwordx4 v16, s[22:23]
  s_add_u32 s22, s22, 3840
  s_addc_u32 s23, s23, 0
  s_add_u32 m0, s16, 1920
  s_nop 0
  global_load_lds_dwordx4 v16, s[22:23]
  s_add_u32 s22, s22, 3840
  s_addc_u32 s23, s23, 0
  s_add_u32 m0, s16, 2880
  s_nop 0
  global_load_lds_dwordx4 v16, s[22:23]
  s_add_u32 s22, s22, 3840
  s_addc_u32 s23, s23, 0
  s_add_u32 m0, s16, 3840
  s_nop 0
  global_load_lds_dwordx4 v16, s[22:23]
  s_add_u32 s22, s22, 3840
  s_addc_u32 s23, s23, 0
  s_add_u32 m0, s16, 4800
  s_nop 0
  global_load_lds_dwordx4 v16, s[22:23]
  s_add_u32 s22, s22, 3840
  s_addc_u32 s23, s23, 0
  s_add_u32 m0, s16, 5760
  s_nop 0
  global_load_lds_dwordx4 v16, s[22:23]
  s_add_u32 s22, s22, 3840
  s_addc_u32 s23, s23, 0
  s_add_u32 m0, s16, 6720
  s_nop 0
  global_load_lds_dwordx4 v16, s[22:23]
  s_add_u32 s22, s22, 3840
  s_addc_u32 s23, s23, 0
  s_add_u32 m0, s16, 7680
  s_nop 0
  global_load_lds_dwordx4 v16, s[22:23]
  s_add_u32 s22, s22, 3840
  s_addc_u32 s23, s23, 0
  s_add_u32 m0, s16, 8640
  s_nop 0
  global_load_lds_dwordx4 v16, s[22:23]
  s_add_u32 s22, s22, 3840
  s_addc_u32 s23, s23, 0
  s_mov_b32 exec_lo, 0xffffffff
  s_mov_b32 exec_hi, 0xff
  s_add_u32 m0, s16, 9600
  s_nop 0
  global_load_lds_dwordx4 v16, s[22:23]
  s_add_u32 s22, s22, 2560
  s_addc_u32 s23, s23, 0
  s_mov_b64 exec, -1
  s_waitcnt vmcnt(11)
  ds_read_b64_tr_b16 v[144:145], v18 offset:10240
  ds_read_b64_tr_b16 v[146:147], v18 offset:10880
  ds_read_b64_tr_b16 v[148:149], v18 offset:15360
  ds_read_b64_tr_b16 v[150:151], v18 offset:16000
  ds_read_b64_tr_b16 v[152:153], v18 offset:10304
  ds_read_b64_tr_b16 v[154:155], v18 offset:10944
  ds_read_b64_tr_b16 v[156:157], v18 offset:15424
  ds_read_b64_tr_b16 v[158:159], v18 offset:16064
  ds_read_b64_tr_b16 v[184:185], v18 offset:10368
  ds_read_b64_tr_b16 v[186:187], v18 offset:11008
  ds_read_b64_tr_b16 v[188:189], v18 offset:15488
  ds_read_b64_tr_b16 v[190:191], v18 offset:16128
  ds_read_b64_tr_b16 v[208:209], v18 offset:10432
  ds_read_b64_tr_b16 v[210:211], v18 offset:11072
  ds_read_b64_tr_b16 v[212:213], v18 offset:15552
  ds_read_b64_tr_b16 v[214:215], v18 offset:16192
  ds_read_b64_tr_b16 v[240:241], v18 offset:10496
  ds_read_b64_tr_b16 v[242:243], v18 offset:11136
  ds_read_b64_tr_b16 v[244:245], v18 offset:15616
  ds_read_b64_tr_b16 v[246:247], v18 offset:16256
  s_waitcnt lgkmcnt(0)
  s_mov_b32 exec_lo, 0xffffffff
  s_mov_b32 exec_hi, 0xfffffff
  s_add_u32 m0, s16, 10240
  s_nop 0
  global_load_lds_dwordx4 v16, s[22:23]
  s_add_u32 s22, s22, 3840
  s_addc_u32 s23, s23, 0
  s_add_u32 m0, s16, 11200
  s_nop 0
  global_load_lds_dwordx4 v16, s[22:23]
  s_add_u32 s22, s22, 3840
  s_addc_u32 s23, s23, 0
  s_add_u32 m0, s16, 12160
  s_nop 0
  global_load_lds_dwordx4 v16, s[22:23]
  s_add_u32 s22, s22, 3840
  s_addc_u32 s23, s23, 0
  s_add_u32 m0, s16, 13120
  s_nop 0
  global_load_lds_dwordx4 v16, s[22:23]
  s_add_u32 s22, s22, 3840
  s_addc_u32 s23, s23, 0
  s_add_u32 m0, s16, 14080
  s_nop 0
  global_load_lds_dwordx4 v16, s[22:23]
  s_add_u32 s22, s22, 3840
  s_addc_u32 s23, s23, 0
  s_add_u32 m0, s16, 15040
  s_nop 0
  global_load_lds_dwordx4 v16, s[22:23]
  s_add_u32 s22, s22, 3840
  s_addc_u32 s23, s23, 0
  s_add_u32 m0, s16, 16000
  s_nop 0
  global_load_lds_dwordx4 v16, s[22:23]
  s_add_u32 s22, s22, 3840
  s_addc_u32 s23, s23, 0
  s_add_u32 m0, s16, 16960
  s_nop 0
  global_load_lds_dwordx4 v16, s[22:23]
  s_add_u32 s22, s22, 3840
  s_addc_u32 s23, s23, 0
  s_add_u32 m0, s16, 17920
  s_nop 0
  global_load_lds_dwordx4 v16, s[22:23]
  s_add_u32 s22, s22, 3840
  s_addc_u32 s23, s23, 0
  s_add_u32 m0, s16, 18880
  s_nop 0
  global_load_lds_dwordx4 v16, s[22:23]
  s_add_u32 s22, s22, 3840
  s_addc_u32 s23, s23, 0
  s_mov_b32 exec_lo, 0xffffffff
  s_mov_b32 exec_hi, 0xff
  s_add_u32 m0, s16, 19840
  s_nop 0
  global_load_lds_dwordx4 v16, s[22:23]
  s_add_u32 s22, s22, 2560
  s_addc_u32 s23, s23, 0
  s_mov_b64 exec, -1
  s_waitcnt vmcnt(11)
  ds_read_b64_tr_b16 a[216:217], v18 offset:0
  ds_read_b64_tr_b16 a[218:219], v18 offset:640
  ds_read_b64_tr_b16 a[220:221], v18 offset:5120
  ds_read_b64_tr_b16 a[222:223], v18 offset:5760
  ds_read_b64_tr_b16 a[224:225], v18 offset:64
  ds_read_b64_tr_b16 a[226:227], v18 offset:704
  ds_read_b64_tr_b16 a[228:229], v18 offset:5184
  ds_read_b64_tr_b16 a[230:231], v18 offset:5824
  ds_read_b64_tr_b16 a[232:233], v18 offset:128
  ds_read_b64_tr_b16 a[234:235], v18 offset:768
  ds_read_b64_tr_b16 a[236:237], v18 offset:5248
  ds_read_b64_tr_b16 a[238:239], v18 offset:5888
  ds_read_b64_tr_b16 a[240:241], v18 offset:192
  ds_read_b64_tr_b16 a[242:243], v18 offset:832
  ds_read_b64_tr_b16 a[244:245], v18 offset:5312
  ds_read_b64_tr_b16 a[246:247], v18 offset:5952
  ds_read_b64_tr_b16 a[248:249], v18 offset:256
  ds_read_b64_tr_b16 a[250:251], v18 offset:896
  ds_read_b64_tr_b16 a[252:253], v18 offset:5376
  ds_read_b64_tr_b16 a[254:255], v18 offset:6016
  s_waitcnt lgkmcnt(0)
  s_waitcnt vmcnt(0)
  ds_read_b64_tr_b16 v[160:161], v18 offset:10240
  ds_read_b64_tr_b16 v[162:163], v18 offset:10880
  ds_read_b64_tr_b16 v[164:165], v18 offset:15360
  ds_read_b64_tr_b16 v[166:167], v18 offset:16000
  ds_read_b64_tr_b16 v[168:169], v18 offset:10304
  ds_read_b64_tr_b16 v[170:171], v18 offset:10944
  ds_read_b64_tr_b16 v[172:173], v18 offset:15424
  ds_read_b64_tr_b16 v[174:175], v18 offset:16064
  ds_read_b64_tr_b16 v[80:81], v18 offset:10368
  ds_read_b64_tr_b16 v[82:83], v18 offset:11008
  ds_read_b64_tr_b16 v[84:85], v18 offset:15488
  ds_read_b64_tr_b16 v[86:87], v18 offset:16128
  s_waitcnt lgkmcnt(0)
  ds_write_b128 v11, v[80:83] offset:18432
  ds_write_b128 v11, v[84:87] offset:19456
  s_waitcnt lgkmcnt(0)
  ds_read_b64_tr_b16 v[216:217], v18 offset:10432
  ds_read_b64_tr_b16 v[218:219], v18 offset:11072
  ds_read_b64_tr_b16 v[220:221], v18 offset:15552
  ds_read_b64_tr_b16 v[222:223], v18 offset:16192
  ds_read_b64_tr_b16 v[248:249], v18 offset:10496
  ds_read_b64_tr_b16 v[250:251], v18 offset:11136
  ds_read_b64_tr_b16 v[252:253], v18 offset:15616
  ds_read_b64_tr_b16 v[254:255], v18 offset:16256
  s_waitcnt lgkmcnt(0)
  s_barrier
  v_lshrrev_b32 v16, 2, v1
  v_mov_b32 v17, 0
  s_mov_b32 exec_lo, 0x00030003
  s_mov_b32 exec_hi, 0x00030003
  v_mov_b32 v17, 32
  s_mov_b32 exec_lo, 0x00100010
  s_mov_b32 exec_hi, 0x00100010
  v_mov_b32 v17, 64
  s_mov_b64 exec, 4
  v_mov_b32 v17, 56
  s_mov_b32 exec_lo, 0
  s_mov_b32 exec_hi, 4
  v_mov_b32 v17, 268435456
  s_mov_b64 exec, -1
  s_branch isync_130
isync_129:
  s_sleep 4
  s_add_u32 s11, s11, 1
  s_cmp_gt_u32 s11, 131072
  s_cbranch_scc1 mega_done
isync_130:
  global_load_dword v18, v16, s[90:91] sc1
  s_waitcnt vmcnt(0)
  v_cmp_gt_u32 vcc, v17, v18
  s_cbranch_vccnz isync_129
  v_readlane_b32 s66, v18, 34
  s_nop 0
  s_cmp_lt_u32 s66, 268468224
  s_cselect_b32 s66, 0, 8192
  global_load_dword v18, v16, s[90:91] sc1
  s_waitcnt vmcnt(0)
  v_readlane_b32 s25, v18, 18
  s_xor_b32 s24, s66, 8192
  s_add_u32 s59, s59, s24
  s_mul_i32 s60, s8, 1280
  s_add_u32 s60, s60, 18432
  s_add_u32 s60, s60, s24
  v_lshlrev_b32 v15, 6, v0
  s_cmp_lg_u32 s25, 0
  s_cbranch_scc1 b_loop_slow
b_loop:
  ds_read_b128 v[80:83], v11 offset:0
  ds_read_b128 v[84:87], v11 offset:1024
  ds_read_b128 v[88:91], v11 offset:2048
  ds_read_b128 v[92:95], v11 offset:3072
  ds_read_b128 v[96:99], v11 offset:4096
  ds_read_b128 v[100:103], v11 offset:5120
  ds_read_b128 v[104:107], v11 offset:6144
  ds_read_b128 v[108:111], v11 offset:7168
  v_mov_b32 v56, 0
  v_mov_b32 v57, 0
  v_mov_b32 v58, 0
  v_mov_b32 v59, 0
  v_mov_b32 v60, 0
  v_mov_b32 v61, 0
  v_mov_b32 v62, 0
  v_mov_b32 v63, 0
  v_mov_b32 v64, 0
  v_mov_b32 v65, 0
  v_mov_b32 v66, 0
  v_mov_b32 v67, 0
  v_mov_b32 v68, 0
  v_mov_b32 v69, 0
  v_mov_b32 v70, 0
  v_mov_b32 v71, 0
  v_mov_b32 v72, 0
  v_mov_b32 v73, 0
  v_mov_b32 v74, 0
  v_mov_b32 v75, 0
  v_mov_b32 v76, 0
  v_mov_b32 v77, 0
  v_mov_b32 v78, 0
  v_mov_b32 v79, 0
  s_sleep 24
  s_waitcnt lgkmcnt(0)
pm_131:
  buffer_load_dwordx4 v[16:19], v2, s[4:7], s30 offen offset:0 sc1
  buffer_load_dwordx4 v[20:23], v2, s[4:7], s31 offen offset:0 sc1
  buffer_load_dwordx4 v[24:27], v1, s[4:7], s32 offen offset:0 sc1
  s_add_u32 s11, s11, 1
  s_cmp_gt_u32 s11, 131072
  s_cbranch_scc1 mega_done
  s_waitcnt vmcnt(0)
  v_bitop3_b32 v14, v16, v20, s28 bitop3:0x7e
  v_bitop3_b32 v14, v24, v14, s28 bitop3:0xde
  v_and_b32 v14, 1, v14
  v_cmp_ne_u32 vcc, 0, v14
  s_cbranch_vccnz pm_131
  v_smfmac_f32_16x16x64_bf16 v[56:59], v[16:19], v[80:87], v8
  ds_write_b128 v2, v[16:19] offset:12288
  v_smfmac_f32_16x16x64_bf16 v[60:63], v[16:19], v[88:95], v8
  v_smfmac_f32_16x16x64_bf16 v[64:67], v[16:19], v[96:103], v8
  ds_write_b128 v2, v[20:23] offset:16384
  v_smfmac_f32_16x16x64_bf16 v[56:59], v[20:23], v[104:111], v8
  v_smfmac_f32_16x16x64_bf16 v[60:63], v[20:23], a[0:7], v8
  ds_write_b128 v2, v[24:27] offset:20480
  v_smfmac_f32_16x16x64_bf16 v[64:67], v[20:23], a[8:15], v8
  v_smfmac_f32_16x16x64_bf16 v[56:59], v[24:27], a[16:23], v8
  v_smfmac_f32_16x16x64_bf16 v[60:63], v[24:27], a[24:31], v8
  s_waitcnt lgkmcnt(0)
  s_barrier
  ds_read_b128 v[28:31], v4 offset:12288
  ds_read_b128 v[32:35], v5 offset:12288
  ds_read_b128 v[36:39], v6 offset:12288
  ds_read_b128 v[40:43], v4 offset:16384
  ds_read_b128 v[44:47], v5 offset:16384
  v_smfmac_f32_16x16x64_bf16 v[64:67], v[24:27], a[32:39], v8
  ds_read_b128 v[48:51], v6 offset:16384
  s_waitcnt lgkmcnt(5)
  v_smfmac_f32_16x16x64_bf16 v[64:67], v[28:31], a[40:47], v8
  ds_read_b128 v[52:55], v4 offset:20480
  s_waitcnt lgkmcnt(5)
  v_smfmac_f32_16x16x64_bf16 v[64:67], v[32:35], a[48:55], v8
  s_waitcnt lgkmcnt(4)
  v_smfmac_f32_16x16x64_bf16 v[64:67], v[36:39], a[56:63], v8
  s_waitcnt lgkmcnt(3)
  v_smfmac_f32_16x16x64_bf16 v[64:67], v[40:43], a[64:71], v8
  s_waitcnt lgkmcnt(2)
  v_smfmac_f32_16x16x64_bf16 v[64:67], v[44:47], a[72:79], v8
  s_waitcnt lgkmcnt(1)
  v_smfmac_f32_16x16x64_bf16 v[64:67], v[48:51], a[80:87], v8
  ds_read_b128 v[80:83], v11 offset:8192
  v_mov_b32 v24, 0
  s_waitcnt lgkmcnt(1)
  v_smfmac_f32_16x16x64_bf16 v[64:67], v[52:55], a[88:95], v8
  ds_read_b128 v[84:87], v11 offset:9216
  v_mov_b32 v25, 0
  v_smfmac_f32_16x16x64_bf16 v[56:59], v[28:31], a[96:103], v8
  ds_read_b128 v[88:91], v11 offset:10240
  v_mov_b32 v26, 0
  v_smfmac_f32_16x16x64_bf16 v[60:63], v[28:31], a[104:111], v8
  ds_read_b128 v[92:95], v11 offset:11264
  v_mov_b32 v27, 0
  v_smfmac_f32_16x16x64_bf16 v[56:59], v[32:35], a[112:119], v8
  ds_read_b128 v[96:99], v11 offset:12288
  v_permlane32_swap_b32 v64, v66
  v_smfmac_f32_16x16x64_bf16 v[60:63], v[32:35], a[120:127], v8
  ds_read_b128 v[100:103], v11 offset:13312
  v_permlane32_swap_b32 v65, v67
  v_smfmac_f32_16x16x64_bf16 v[56:59], v[36:39], a[128:135], v8
  ds_read_b128 v[104:107], v11 offset:14336
  v_add_f32 v64, v64, v66
  v_smfmac_f32_16x16x64_bf16 v[60:63], v[36:39], a[136:143], v8
  ds_read_b128 v[108:111], v11 offset:15360
  v_add_f32 v65, v65, v67
  s_waitcnt lgkmcnt(6)
  v_smfmac_f32_16x16x64_bf16 v[56:59], v[40:43], v[80:87], v8
  v_cvt_pk_bf16_f32 v14, v64, v65
  v_smfmac_f32_16x16x64_bf16 v[60:63], v[40:43], a[144:151], v8
  ds_write_b32 v12, v14 offset:0
  v_mov_b32 v64, 0
  s_waitcnt lgkmcnt(5)
  v_smfmac_f32_16x16x64_bf16 v[56:59], v[44:47], v[88:95], v8
  v_mov_b32 v65, 0
  v_smfmac_f32_16x16x64_bf16 v[60:63], v[44:47], a[152:159], v8
  v_mov_b32 v66, 0
  s_waitcnt lgkmcnt(3)
  v_smfmac_f32_16x16x64_bf16 v[56:59], v[48:51], v[96:103], v8
  v_mov_b32 v67, 0
  v_smfmac_f32_16x16x64_bf16 v[60:63], v[48:51], a[160:167], v8
  s_waitcnt lgkmcnt(0)
  s_barrier
  ds_read_b64_tr_b16 v[16:17], v10 offset:256
  ds_read_b64_tr_b16 v[18:19], v10 offset:288
  v_smfmac_f32_16x16x64_bf16 v[56:59], v[52:55], v[104:111], v8
  ds_read_b64_tr_b16 v[20:21], v10 offset:1024
  v_smfmac_f32_16x16x64_bf16 v[60:63], v[52:55], a[168:175], v8
  ds_read_b64_tr_b16 v[22:23], v10 offset:1056
  s_waitcnt lgkmcnt(2)
  v_smfmac_f32_16x16x64_bf16 v[68:71], v[16:19], a[176:183], v8
  v_smfmac_f32_16x16x64_bf16 v[72:75], v[16:19], a[184:191], v8
  s_nop 0
  v_permlane32_swap_b32 v56, v60
  v_permlane32_swap_b32 v57, v61
  v_permlane32_swap_b32 v58, v62
  v_smfmac_f32_16x16x64_bf16 v[76:79], v[16:19], a[192:199], v8
  v_permlane32_swap_b32 v59, v63
  v_add_f32 v56, v56, v60
  v_add_f32 v57, v57, v61
  v_smfmac_f32_16x16x64_bf16 v[24:27], v[16:19], a[200:207], v8
  v_add_f32 v58, v58, v62
  v_add_f32 v59, v59, v63
  v_cvt_pk_bf16_f32 v60, v56, v57
  v_smfmac_f32_16x16x64_bf16 v[64:67], v[16:19], a[208:215], v8
  v_cvt_pk_bf16_f32 v61, v58, v59
  s_waitcnt lgkmcnt(0)
  v_smfmac_f32_16x16x64_bf16 v[68:71], v[20:23], a[216:223], v8
  ds_write_b64 v9, v[60:61] offset:0
  v_smfmac_f32_16x16x64_bf16 v[72:75], v[20:23], a[224:231], v8
  v_smfmac_f32_16x16x64_bf16 v[76:79], v[20:23], a[232:239], v8
  s_waitcnt lgkmcnt(0)
  s_barrier
  ds_read_b64_tr_b16 v[28:29], v10 offset:0
  ds_read_b64_tr_b16 v[30:31], v10 offset:32
  ds_read_b64_tr_b16 v[32:33], v10 offset:512
  ds_read_b64_tr_b16 v[34:35], v10 offset:544
  ds_read_b64_tr_b16 v[36:37], v10 offset:768
  ds_read_b64_tr_b16 v[38:39], v10 offset:800
  ds_read_b64_tr_b16 v[40:41], v10 offset:1280
  ds_read_b64_tr_b16 v[42:43], v10 offset:1312
  v_smfmac_f32_16x16x64_bf16 v[24:27], v[20:23], a[240:247], v8
  v_smfmac_f32_16x16x64_bf16 v[64:67], v[20:23], a[248:255], v8
  s_waitcnt lgkmcnt(6)
  v_smfmac_f32_16x16x64_bf16 v[68:71], v[28:31], v[112:119], v8
  v_smfmac_f32_16x16x64_bf16 v[72:75], v[28:31], v[120:127], v8
  ds_read_b128 v[80:83], v11 offset:16384
  s_waitcnt lgkmcnt(5)
  v_smfmac_f32_16x16x64_bf16 v[68:71], v[32:35], v[128:135], v8
  ds_read_b128 v[84:87], v11 offset:17408
  v_smfmac_f32_16x16x64_bf16 v[72:75], v[32:35], v[136:143], v8
  ds_read_b128 v[88:91], v11 offset:18432
  s_waitcnt lgkmcnt(5)
  v_smfmac_f32_16x16x64_bf16 v[68:71], v[36:39], v[144:151], v8
  ds_read_b128 v[92:95], v11 offset:19456
  v_smfmac_f32_16x16x64_bf16 v[72:75], v[36:39], v[152:159], v8
  s_waitcnt lgkmcnt(4)
  v_smfmac_f32_16x16x64_bf16 v[68:71], v[40:43], v[160:167], v8
  v_smfmac_f32_16x16x64_bf16 v[72:75], v[40:43], v[168:175], v8
  v_smfmac_f32_16x16x64_bf16 v[76:79], v[28:31], v[176:183], v8
  s_waitcnt lgkmcnt(2)
  v_smfmac_f32_16x16x64_bf16 v[76:79], v[32:35], v[80:87], v8
  v_cvt_pk_bf16_f32 v68, v68, v69
  v_smfmac_f32_16x16x64_bf16 v[76:79], v[36:39], v[184:191], v8
  v_cvt_pk_bf16_f32 v69, v70, v71
  s_waitcnt lgkmcnt(0)
  v_smfmac_f32_16x16x64_bf16 v[76:79], v[40:43], v[88:95], v8
  v_and_or_b32 v68, v68, -2, s28
  v_smfmac_f32_16x16x64_bf16 v[24:27], v[28:31], v[192:199], v8
  buffer_store_dwordx2 v[68:69], v13, s[4:7], s56 offen offset:0
  v_cvt_pk_bf16_f32 v72, v72, v73
  v_smfmac_f32_16x16x64_bf16 v[24:27], v[32:35], v[200:207], v8
  v_cvt_pk_bf16_f32 v73, v74, v75
  v_smfmac_f32_16x16x64_bf16 v[24:27], v[36:39], v[208:215], v8
  v_and_or_b32 v72, v72, -2, s28
  v_smfmac_f32_16x16x64_bf16 v[24:27], v[40:43], v[216:223], v8
  buffer_store_dwordx2 v[72:73], v13, s[4:7], s56 offen offset:2048
  v_cvt_pk_bf16_f32 v76, v76, v77
  v_smfmac_f32_16x16x64_bf16 v[64:67], v[28:31], v[224:231], v8
  v_cvt_pk_bf16_f32 v77, v78, v79
  v_smfmac_f32_16x16x64_bf16 v[64:67], v[32:35], v[232:239], v8
  v_and_or_b32 v76, v76, -2, s28
  v_smfmac_f32_16x16x64_bf16 v[64:67], v[36:39], v[240:247], v8
  buffer_store_dwordx2 v[76:77], v13, s[4:7], s57 offen offset:0
  v_cvt_pk_bf16_f32 v24, v24, v25
  v_smfmac_f32_16x16x64_bf16 v[64:67], v[40:43], v[248:255], v8
  v_cvt_pk_bf16_f32 v25, v26, v27
  v_and_or_b32 v24, v24, -2, s28
  buffer_store_dwordx2 v[24:25], v13, s[4:7], s57 offen offset:2048
  s_nop 4
  v_cvt_pk_bf16_f32 v64, v64, v65
  v_cvt_pk_bf16_f32 v65, v66, v67
  v_and_or_b32 v64, v64, -2, s28
  buffer_store_dwordx2 v[64:65], v13, s[4:7], s58 offen offset:0
  s_add_u32 s10, s10, 1
  s_xor_b32 s28, s28, 1
  s_cmp_lt_u32 s10, 64
  s_cbranch_scc1 b_loop
  s_branch b_fin
b_loop_slow:
  ds_read_b128 v[80:83], v11 offset:0
  ds_read_b128 v[84:87], v11 offset:1024
  ds_read_b128 v[88:91], v11 offset:2048
  ds_read_b128 v[92:95], v11 offset:3072
  ds_read_b128 v[96:99], v11 offset:4096
  ds_read_b128 v[100:103], v11 offset:5120
  ds_read_b128 v[104:107], v11 offset:6144
  ds_read_b128 v[108:111], v11 offset:7168
  v_mov_b32 v56, 0
  v_mov_b32 v57, 0
  v_mov_b32 v58, 0
  v_mov_b32 v59, 0
  v_mov_b32 v60, 0
  v_mov_b32 v61, 0
  v_mov_b32 v62, 0
  v_mov_b32 v63, 0
  v_mov_b32 v64, 0
  v_mov_b32 v65, 0
  v_mov_b32 v66, 0
  v_mov_b32 v67, 0
  v_mov_b32 v68, 0
  v_mov_b32 v69, 0
  v_mov_b32 v70, 0
  v_mov_b32 v71, 0
  v_mov_b32 v72, 0
  v_mov_b32 v73, 0
  v_mov_b32 v74, 0
  v_mov_b32 v75, 0
  v_mov_b32 v76, 0
  v_mov_b32 v77, 0
  v_mov_b32 v78, 0
  v_mov_b32 v79, 0
  s_sleep 24
  s_waitcnt lgkmcnt(0)
pm_132:
  buffer_load_dwordx4 v[16:19], v2, s[4:7], s30 offen offset:0 sc1
  buffer_load_dwordx4 v[20:23], v2, s[4:7], s31 offen offset:0 sc1
  buffer_load_dwordx4 v[24:27], v1, s[4:7], s32 offen offset:0 sc1
  s_add_u32 s11, s11, 1
  s_cmp_gt_u32 s11, 131072
  s_cbranch_scc1 mega_done
  s_waitcnt vmcnt(0)
  v_bitop3_b32 v14, v16, v20, s28 bitop3:0x7e
  v_bitop3_b32 v14, v24, v14, s28 bitop3:0xde
  v_and_b32 v14, 1, v14
  v_cmp_ne_u32 vcc, 0, v14
  s_cbranch_vccnz pm_132
  v_smfmac_f32_16x16x64_bf16 v[56:59], v[16:19], v[80:87], v8
  ds_write_b128 v2, v[16:19] offset:12288
  v_smfmac_f32_16x16x64_bf16 v[60:63], v[16:19], v[88:95], v8
  v_smfmac_f32_16x16x64_bf16 v[64:67], v[16:19], v[96:103], v8
  ds_write_b128 v2, v[20:23] offset:16384
  v_smfmac_f32_16x16x64_bf16 v[56:59], v[20:23], v[104:111], v8
  v_smfmac_f32_16x16x64_bf16 v[60:63], v[20:23], a[0:7], v8
  ds_write_b128 v2, v[24:27] offset:20480
  v_smfmac_f32_16x16x64_bf16 v[64:67], v[20:23], a[8:15], v8
  v_smfmac_f32_16x16x64_bf16 v[56:59], v[24:27], a[16:23], v8
  v_smfmac_f32_16x16x64_bf16 v[60:63], v[24:27], a[24:31], v8
  s_waitcnt lgkmcnt(0)
  s_barrier
  ds_read_b128 v[28:31], v4 offset:12288
  ds_read_b128 v[32:35], v5 offset:12288
  ds_read_b128 v[36:39], v6 offset:12288
  ds_read_b128 v[40:43], v4 offset:16384
  ds_read_b128 v[44:47], v5 offset:16384
  v_smfmac_f32_16x16x64_bf16 v[64:67], v[24:27], a[32:39], v8
  ds_read_b128 v[48:51], v6 offset:16384
  s_waitcnt lgkmcnt(5)
  v_smfmac_f32_16x16x64_bf16 v[64:67], v[28:31], a[40:47], v8
  ds_read_b128 v[52:55], v4 offset:20480
  s_waitcnt lgkmcnt(5)
  v_smfmac_f32_16x16x64_bf16 v[64:67], v[32:35], a[48:55], v8
  s_waitcnt lgkmcnt(4)
  v_smfmac_f32_16x16x64_bf16 v[64:67], v[36:39], a[56:63], v8
  s_waitcnt lgkmcnt(3)
  v_smfmac_f32_16x16x64_bf16 v[64:67], v[40:43], a[64:71], v8
  s_waitcnt lgkmcnt(2)
  v_smfmac_f32_16x16x64_bf16 v[64:67], v[44:47], a[72:79], v8
  s_waitcnt lgkmcnt(1)
  v_smfmac_f32_16x16x64_bf16 v[64:67], v[48:51], a[80:87], v8
  ds_read_b128 v[80:83], v11 offset:8192
  v_mov_b32 v24, 0
  s_waitcnt lgkmcnt(1)
  v_smfmac_f32_16x16x64_bf16 v[64:67], v[52:55], a[88:95], v8
  ds_read_b128 v[84:87], v11 offset:9216
  v_mov_b32 v25, 0
  v_smfmac_f32_16x16x64_bf16 v[56:59], v[28:31], a[96:103], v8
  ds_read_b128 v[88:91], v11 offset:10240
  v_mov_b32 v26, 0
  v_smfmac_f32_16x16x64_bf16 v[60:63], v[28:31], a[104:111], v8
  ds_read_b128 v[92:95], v11 offset:11264
  v_mov_b32 v27, 0
  v_smfmac_f32_16x16x64_bf16 v[56:59], v[32:35], a[112:119], v8
  ds_read_b128 v[96:99], v11 offset:12288
  v_permlane32_swap_b32 v64, v66
  v_smfmac_f32_16x16x64_bf16 v[60:63], v[32:35], a[120:127], v8
  ds_read_b128 v[100:103], v11 offset:13312
  v_permlane32_swap_b32 v65, v67
  v_smfmac_f32_16x16x64_bf16 v[56:59], v[36:39], a[128:135], v8
  ds_read_b128 v[104:107], v11 offset:14336
  v_add_f32 v64, v64, v66
  v_smfmac_f32_16x16x64_bf16 v[60:63], v[36:39], a[136:143], v8
  ds_read_b128 v[108:111], v11 offset:15360
  v_add_f32 v65, v65, v67
  s_waitcnt lgkmcnt(6)
  v_smfmac_f32_16x16x64_bf16 v[56:59], v[40:43], v[80:87], v8
  v_cvt_pk_bf16_f32 v14, v64, v65
  v_smfmac_f32_16x16x64_bf16 v[60:63], v[40:43], a[144:151], v8
  ds_write_b32 v12, v14 offset:0
  v_mov_b32 v64, 0
  s_waitcnt lgkmcnt(5)
  v_smfmac_f32_16x16x64_bf16 v[56:59], v[44:47], v[88:95], v8
  v_mov_b32 v65, 0
  v_smfmac_f32_16x16x64_bf16 v[60:63], v[44:47], a[152:159], v8
  v_mov_b32 v66, 0
  s_waitcnt lgkmcnt(3)
  v_smfmac_f32_16x16x64_bf16 v[56:59], v[48:51], v[96:103], v8
  v_mov_b32 v67, 0
  v_smfmac_f32_16x16x64_bf16 v[60:63], v[48:51], a[160:167], v8
  s_waitcnt lgkmcnt(0)
  s_barrier
  ds_read_b64_tr_b16 v[16:17], v10 offset:256
  ds_read_b64_tr_b16 v[18:19], v10 offset:288
  v_smfmac_f32_16x16x64_bf16 v[56:59], v[52:55], v[104:111], v8
  ds_read_b64_tr_b16 v[20:21], v10 offset:1024
  v_smfmac_f32_16x16x64_bf16 v[60:63], v[52:55], a[168:175], v8
  ds_read_b64_tr_b16 v[22:23], v10 offset:1056
  s_waitcnt lgkmcnt(2)
  v_smfmac_f32_16x16x64_bf16 v[68:71], v[16:19], a[176:183], v8
  v_smfmac_f32_16x16x64_bf16 v[72:75], v[16:19], a[184:191], v8
  s_nop 0
  v_permlane32_swap_b32 v56, v60
  v_permlane32_swap_b32 v57, v61
  v_permlane32_swap_b32 v58, v62
  v_smfmac_f32_16x16x64_bf16 v[76:79], v[16:19], a[192:199], v8
  v_permlane32_swap_b32 v59, v63
  v_add_f32 v56, v56, v60
  v_add_f32 v57, v57, v61
  v_smfmac_f32_16x16x64_bf16 v[24:27], v[16:19], a[200:207], v8
  v_add_f32 v58, v58, v62
  v_add_f32 v59, v59, v63
  v_cvt_pk_bf16_f32 v60, v56, v57
  v_smfmac_f32_16x16x64_bf16 v[64:67], v[16:19], a[208:215], v8
  v_cvt_pk_bf16_f32 v61, v58, v59
  s_waitcnt lgkmcnt(0)
  v_smfmac_f32_16x16x64_bf16 v[68:71], v[20:23], a[216:223], v8
  ds_write_b64 v9, v[60:61] offset:0
  v_smfmac_f32_16x16x64_bf16 v[72:75], v[20:23], a[224:231], v8
  v_smfmac_f32_16x16x64_bf16 v[76:79], v[20:23], a[232:239], v8
  s_waitcnt lgkmcnt(0)
  s_barrier
  ds_read_b64_tr_b16 v[28:29], v10 offset:0
  ds_read_b64_tr_b16 v[30:31], v10 offset:32
  ds_read_b64_tr_b16 v[32:33], v10 offset:512
  ds_read_b64_tr_b16 v[34:35], v10 offset:544
  ds_read_b64_tr_b16 v[36:37], v10 offset:768
  ds_read_b64_tr_b16 v[38:39], v10 offset:800
  ds_read_b64_tr_b16 v[40:41], v10 offset:1280
  ds_read_b64_tr_b16 v[42:43], v10 offset:1312
  v_smfmac_f32_16x16x64_bf16 v[24:27], v[20:23], a[240:247], v8
  v_smfmac_f32_16x16x64_bf16 v[64:67], v[20:23], a[248:255], v8
  s_waitcnt lgkmcnt(6)
  v_smfmac_f32_16x16x64_bf16 v[68:71], v[28:31], v[112:119], v8
  v_smfmac_f32_16x16x64_bf16 v[72:75], v[28:31], v[120:127], v8
  ds_read_b128 v[80:83], v11 offset:16384
  s_waitcnt lgkmcnt(5)
  v_smfmac_f32_16x16x64_bf16 v[68:71], v[32:35], v[128:135], v8
  ds_read_b128 v[84:87], v11 offset:17408
  v_smfmac_f32_16x16x64_bf16 v[72:75], v[32:35], v[136:143], v8
  ds_read_b128 v[88:91], v11 offset:18432
  s_waitcnt lgkmcnt(5)
  v_smfmac_f32_16x16x64_bf16 v[68:71], v[36:39], v[144:151], v8
  ds_read_b128 v[92:95], v11 offset:19456
  v_smfmac_f32_16x16x64_bf16 v[72:75], v[36:39], v[152:159], v8
  s_waitcnt lgkmcnt(4)
  v_smfmac_f32_16x16x64_bf16 v[68:71], v[40:43], v[160:167], v8
  v_smfmac_f32_16x16x64_bf16 v[72:75], v[40:43], v[168:175], v8
  v_smfmac_f32_16x16x64_bf16 v[76:79], v[28:31], v[176:183], v8
  s_waitcnt lgkmcnt(2)
  v_smfmac_f32_16x16x64_bf16 v[76:79], v[32:35], v[80:87], v8
  v_cvt_pk_bf16_f32 v68, v68, v69
  v_smfmac_f32_16x16x64_bf16 v[76:79], v[36:39], v[184:191], v8
  v_cvt_pk_bf16_f32 v69, v70, v71
  s_waitcnt lgkmcnt(0)
  v_smfmac_f32_16x16x64_bf16 v[76:79], v[40:43], v[88:95], v8
  v_and_or_b32 v68, v68, -2, s28
  v_smfmac_f32_16x16x64_bf16 v[24:27], v[28:31], v[192:199], v8
  buffer_store_dwordx2 v[68:69], v13, s[4:7], s56 offen offset:0 sc1
  v_cvt_pk_bf16_f32 v72, v72, v73
  v_smfmac_f32_16x16x64_bf16 v[24:27], v[32:35], v[200:207], v8
  v_cvt_pk_bf16_f32 v73, v74, v75
  v_smfmac_f32_16x16x64_bf16 v[24:27], v[36:39], v[208:215], v8
  v_and_or_b32 v72, v72, -2, s28
  v_smfmac_f32_16x16x64_bf16 v[24:27], v[40:43], v[216:223], v8
  buffer_store_dwordx2 v[72:73], v13, s[4:7], s56 offen offset:2048 sc1
  v_cvt_pk_bf16_f32 v76, v76, v77
  v_smfmac_f32_16x16x64_bf16 v[64:67], v[28:31], v[224:231], v8
  v_cvt_pk_bf16_f32 v77, v78, v79
  v_smfmac_f32_16x16x64_bf16 v[64:67], v[32:35], v[232:239], v8
  v_and_or_b32 v76, v76, -2, s28
  v_smfmac_f32_16x16x64_bf16 v[64:67], v[36:39], v[240:247], v8
  buffer_store_dwordx2 v[76:77], v13, s[4:7], s57 offen offset:0 sc1
  v_cvt_pk_bf16_f32 v24, v24, v25
  v_smfmac_f32_16x16x64_bf16 v[64:67], v[40:43], v[248:255], v8
  v_cvt_pk_bf16_f32 v25, v26, v27
  v_and_or_b32 v24, v24, -2, s28
  buffer_store_dwordx2 v[24:25], v13, s[4:7], s57 offen offset:2048 sc1
  s_nop 4
  v_cvt_pk_bf16_f32 v64, v64, v65
  v_cvt_pk_bf16_f32 v65, v66, v67
  v_and_or_b32 v64, v64, -2, s28
  buffer_store_dwordx2 v[64:65], v13, s[4:7], s58 offen offset:0 sc1
  s_add_u32 s10, s10, 1
  s_xor_b32 s28, s28, 1
  s_cmp_lt_u32 s10, 64
  s_cbranch_scc1 b_loop_slow
  s_branch b_fin
b_fin:
  s_branch mega_wo
mega_R:
  s_sub_u32 s9, s2, 16
  s_mul_i32 s65, s8, 10
  s_add_u32 s65, s65, s9
  s_lshl_b32 s65, s65, 7
  s_add_u32 s65, s65, 18432
  s_and_b32 s12, s3, 1
  s_lshl_b32 s12, s12, 6
  s_add_u32 s65, s65, s12
  v_lshlrev_b32 v1, 4, v0
  s_mov_b32 s52, 0xff00ff00
  s_mov_b32 s53, 0xff00ff00
  v_mov_b32 v8, 0x4444
  v_mov_b32 v2, 0xeeee
  v_cndmask_b32 v8, v8, v2, s[52:53]
  s_mov_b32 s68, 0x00003f80
  s_mov_b32 s69, 0x3f800000
  s_lshl_b32 s27, s8, 18
  s_add_u32 s27, s27, 213909504
  s_mov_b32 s28, 0
  s_mov_b32 s10, 0
  s_mov_b32 s54, 0x55555555
  s_mov_b32 s55, 0x55555555
  s_lshl_b32 s12, s9, 2
  s_add_u32 s12, s12, s3
  s_mul_i32 s12, s12, 6144
  s_add_u32 s12, s12, s27
  s_add_u32 s12, s12, 16384
  s_add_u32 s13, s12, 3072
  v_mov_b32 v20, -1
  v_mov_b32 v21, -1
  v_mov_b32 v22, -1
  v_mov_b32 v23, -1
  buffer_store_dwordx4 v[20:23], v1, s[4:7], s12 offen offset:0 sc1
  buffer_store_dwordx4 v[20:23], v1, s[4:7], s12 offen offset:1024 sc1
  buffer_store_dwordx4 v[20:23], v1, s[4:7], s12 offen offset:2048 sc1
  buffer_store_dwordx4 v[20:23], v1, s[4:7], s13 offen offset:0 sc1
  buffer_store_dwordx4 v[20:23], v1, s[4:7], s13 offen offset:1024 sc1
  buffer_store_dwordx4 v[20:23], v1, s[4:7], s13 offen offset:2048 sc1
  s_cmp_ge_u32 s3, 2
  s_cbranch_scc1 r_x
  s_mul_i32 s42, s8, 327680
  s_lshl_b32 s13, s9, 1
  s_add_u32 s13, s13, s3
  s_lshl_b32 s13, s13, 11
  s_add_u32 s42, s42, s13
  s_add_u32 s42, s42, 81788928
  s_lshl_b32 s44, s3, 14
  s_mov_b32 s43, 0
  s_load_dwordx2 s[20:21], s[0:1], 8
  s_lshl_b32 s12, s9, 1
  s_add_u32 s12, s12, s3
  s_lshr_b32 s13, s12, 4
  s_lshl_b32 s13, s13, 14
  s_and_b32 s14, s12, 15
  s_lshl_b32 s14, s14, 9
  s_add_u32 s13, s13, s14
  s_xor_b32 s14, s8, 0
  s_lshl_b32 s14, s14, 17
  s_add_u32 s34, s14, s13
  s_xor_b32 s14, s8, 1
  s_lshl_b32 s14, s14, 17
  s_add_u32 s35, s14, s13
  s_xor_b32 s14, s8, 2
  s_lshl_b32 s14, s14, 17
  s_add_u32 s36, s14, s13
  s_xor_b32 s14, s8, 3
  s_lshl_b32 s14, s14, 17
  s_add_u32 s37, s14, s13
  s_lshl_b32 s13, s12, 11
  s_add_u32 s56, s13, s27
  s_add_u32 s56, s56, 163840
  s_add_u32 s57, s56, 40960
  s_add_u32 s58, s27, 16384
  s_add_u32 s63, s58, 4096
  s_lshl_b32 s59, s12, 9
  s_add_u32 s59, s59, s27
  s_add_u32 s59, s59, 0
  s_mov_b32 s60, 0
  s_mov_b32 s62, 524288
  v_lshlrev_b32 v3, 3, v0
  s_lshl_b32 s13, s3, 11
  v_add_u32 v6, s13, v1
  s_lshl_b32 s13, s3, 12
  s_add_u32 s13, s13, 98304
  v_add_u32 v7, s13, v1
  v_bfe_u32 v4, v0, 5, 1
  v_bfe_u32 v16, v0, 3, 1
  v_lshl_add_u32 v4, v4, 1, v16
  v_bfe_u32 v16, v0, 4, 1
  v_lshl_add_u32 v4, v4, 1, v16
  v_and_b32 v16, 1, v0
  v_lshl_add_u32 v4, v4, 1, v16
  v_bfe_u32 v16, v0, 1, 2
  v_lshl_add_u32 v4, v4, 3, v16
  v_lshlrev_b32 v4, 2, v4
  v_cmp_eq_u32 vcc, 0, v16
  s_nop 1
  v_cndmask_b32 v5, 0, 1, vcc
  v_bfe_u32 v16, v0, 1, 3
  v_mul_u32_u24 v16, 1280, v16
  v_lshrrev_b32 v17, 4, v0
  v_lshl_add_u32 v16, v17, 4, v16
  v_and_b32 v17, 1, v0
  v_lshl_add_u32 v16, v17, 3, v16
  s_lshl_b32 s12, s12, 6
  v_add_u32 v16, s12, v16
  s_waitcnt lgkmcnt(0)
  global_load_dwordx2 v[18:19], v16, s[20:21]
  v_cndmask_b32 v17, -1, -2, s[54:55]
  v_mov_b32 v20, -1
  v_mov_b32 v21, -1
  s_waitcnt vmcnt(0)
  v_and_b32 v18, v17, v18
  buffer_store_dwordx2 v[18:19], v3, s[4:7], s59 offen offset:0 sc1
  v_add_u32 v240, 0, v3
  v_add_u32 v241, 32768, v3
  v_add_u32 v242, 65536, v3
  v_add_u32 v243, 98304, v3
  s_add_u32 s12, s34, 0
  buffer_store_dwordx2 v[20:21], v240, s[4:7], s12 offen offset:0 sc1
  buffer_store_dwordx2 v[20:21], v241, s[4:7], s12 offen offset:0 sc1
  buffer_store_dwordx2 v[20:21], v242, s[4:7], s12 offen offset:0 sc1
  buffer_store_dwordx2 v[20:21], v243, s[4:7], s12 offen offset:0 sc1
  s_add_u32 s12, s34, 8192
  buffer_store_dwordx2 v[20:21], v240, s[4:7], s12 offen offset:0 sc1
  buffer_store_dwordx2 v[20:21], v241, s[4:7], s12 offen offset:0 sc1
  buffer_store_dwordx2 v[20:21], v242, s[4:7], s12 offen offset:0 sc1
  buffer_store_dwordx2 v[20:21], v243, s[4:7], s12 offen offset:0 sc1
  s_add_u32 s12, s34, 524288
  buffer_store_dwordx2 v[20:21], v240, s[4:7], s12 offen offset:0 sc1
  buffer_store_dwordx2 v[20:21], v241, s[4:7], s12 offen offset:0 sc1
  buffer_store_dwordx2 v[20:21], v242, s[4:7], s12 offen offset:0 sc1
  buffer_store_dwordx2 v[20:21], v243, s[4:7], s12 offen offset:0 sc1
  s_add_u32 s12, s34, 532480
  buffer_store_dwordx2 v[20:21], v240, s[4:7], s12 offen offset:0 sc1
  buffer_store_dwordx2 v[20:21], v241, s[4:7], s12 offen offset:0 sc1
  buffer_store_dwordx2 v[20:21], v242, s[4:7], s12 offen offset:0 sc1
  buffer_store_dwordx2 v[20:21], v243, s[4:7], s12 offen offset:0 sc1
  s_add_u32 s12, s34, 1048576
  buffer_store_dwordx2 v[20:21], v240, s[4:7], s12 offen offset:0 sc1
  buffer_store_dwordx2 v[20:21], v241, s[4:7], s12 offen offset:0 sc1
  buffer_store_dwordx2 v[20:21], v242, s[4:7], s12 offen offset:0 sc1
  buffer_store_dwordx2 v[20:21], v243, s[4:7], s12 offen offset:0 sc1
  s_add_u32 s12, s34, 1056768
  buffer_store_dwordx2 v[20:21], v240, s[4:7], s12 offen offset:0 sc1
  buffer_store_dwordx2 v[20:21], v241, s[4:7], s12 offen offset:0 sc1
  buffer_store_dwordx2 v[20:21], v242, s[4:7], s12 offen offset:0 sc1
  buffer_store_dwordx2 v[20:21], v243, s[4:7], s12 offen offset:0 sc1
  s_add_u32 s12, s34, 1572864
  buffer_store_dwordx2 v[20:21], v240, s[4:7], s12 offen offset:0 sc1
  buffer_store_dwordx2 v[20:21], v241, s[4:7], s12 offen offset:0 sc1
  buffer_store_dwordx2 v[20:21], v242, s[4:7], s12 offen offset:0 sc1
  buffer_store_dwordx2 v[20:21], v243, s[4:7], s12 offen offset:0 sc1
  s_add_u32 s12, s34, 1581056
  buffer_store_dwordx2 v[20:21], v240, s[4:7], s12 offen offset:0 sc1
  buffer_store_dwordx2 v[20:21], v241, s[4:7], s12 offen offset:0 sc1
  buffer_store_dwordx2 v[20:21], v242, s[4:7], s12 offen offset:0 sc1
  buffer_store_dwordx2 v[20:21], v243, s[4:7], s12 offen offset:0 sc1
  s_waitcnt vmcnt(0)
  s_barrier
  s_cmp_lg_u32 s3, 0
  s_cbranch_scc1 isk_133
  v_mov_b32 v16, 8
  v_mov_b32 v17, 1
  s_mov_b64 exec, 1
  global_atomic_add v16, v17, s[90:91]
  s_mov_b64 exec, -1
isk_133:
  s_and_b32 s18, s2, 8
  s_lshl_b32 s18, s18, 1
  s_add_u32 s18, s18, 16
  s_load_dwordx4 s[12:15], s[0:1], s18
  s_and_b32 s16, s2, 7
  s_lshl_b32 s17, s8, 3
  s_add_u32 s16, s16, s17
  v_mul_u32_u24 v24, 21846, v0
  v_lshrrev_b32 v24, 16, v24
  v_mul_u32_u24 v25, 3, v24
  v_sub_u32 v25, v0, v25
  v_min_u32 v24, 15, v24
  v_mul_u32_u24 v24, 12288, v24
  v_lshl_add_u32 v24, v25, 7, v24
  s_mul_i32 s17, s16, 384
  s_mul_i32 s19, s3, 196608
  s_add_u32 s17, s17, s19
  s_add_u32 s17, s17, 786432
  s_waitcnt lgkmcnt(0)
  s_mov_b32 exec_hi, 0xffff
  s_add_u32 s12, s12, s17
  s_addc_u32 s13, s13, 0
  global_load_dword v26, v24, s[12:13]
  s_add_u32 s12, s12, 1572864
  s_addc_u32 s13, s13, 0
  global_load_dword v26, v24, s[12:13]
  s_add_u32 s12, s12, 1572864
  s_addc_u32 s13, s13, 0
  global_load_dword v26, v24, s[12:13]
  s_add_u32 s12, s12, 1572864
  s_addc_u32 s13, s13, 0
  global_load_dword v26, v24, s[12:13]
  s_add_u32 s12, s12, 1572864
  s_addc_u32 s13, s13, 0
  global_load_dword v26, v24, s[12:13]
  s_cmp_lg_u32 s18, 16
  s_cbranch_scc1 pf_134
  s_add_u32 s14, s14, s17
  s_addc_u32 s15, s15, 0
  global_load_dword v26, v24, s[14:15]
  s_add_u32 s14, s14, 1572864
  s_addc_u32 s15, s15, 0
  global_load_dword v26, v24, s[14:15]
  s_add_u32 s14, s14, 1572864
  s_addc_u32 s15, s15, 0
  global_load_dword v26, v24, s[14:15]
  s_add_u32 s14, s14, 1572864
  s_addc_u32 s15, s15, 0
  global_load_dword v26, v24, s[14:15]
  s_add_u32 s14, s14, 1572864
  s_addc_u32 s15, s15, 0
  global_load_dword v26, v24, s[14:15]
  s_branch pf_135
pf_134:
  s_mov_b32 exec_hi, 0xff
  v_lshlrev_b32 v24, 7, v0
  s_mul_i32 s17, s16, 245760
  s_mul_i32 s19, s3, 10240
  s_add_u32 s17, s17, s19
  s_add_u32 s17, s17, 40960
  s_add_u32 s14, s14, s17
  s_addc_u32 s15, s15, 0
  global_load_dword v26, v24, s[14:15]
  s_add_u32 s14, s14, 5120
  s_addc_u32 s15, s15, 0
  global_load_dword v26, v24, s[14:15]
  s_add_u32 s14, s14, 76800
  s_addc_u32 s15, s15, 0
  global_load_dword v26, v24, s[14:15]
  s_add_u32 s14, s14, 5120
  s_addc_u32 s15, s15, 0
  global_load_dword v26, v24, s[14:15]
  s_add_u32 s14, s14, 76800
  s_addc_u32 s15, s15, 0
  global_load_dword v26, v24, s[14:15]
  s_add_u32 s14, s14, 5120
  s_addc_u32 s15, s15, 0
  global_load_dword v26, v24, s[14:15]
pf_135:
  s_mov_b64 exec, -1
  v_lshrrev_b32 v16, 2, v1
  v_mov_b32 v17, 0
  s_mov_b32 exec_lo, 0x00030003
  s_mov_b32 exec_hi, 0x00030003
  v_mov_b32 v17, 32
  s_mov_b32 exec_lo, 0x00100010
  s_mov_b32 exec_hi, 0x00100010
  v_mov_b32 v17, 64
  s_mov_b64 exec, 4
  v_mov_b32 v17, 56
  s_mov_b32 exec_lo, 0
  s_mov_b32 exec_hi, 4
  v_mov_b32 v17, 268435456
  s_mov_b64 exec, -1
  s_branch isync_137
isync_136:
  s_sleep 4
  s_add_u32 s11, s11, 1
  s_cmp_gt_u32 s11, 131072
  s_cbranch_scc1 mega_done
isync_137:
  global_load_dword v18, v16, s[90:91] sc1
  s_waitcnt vmcnt(0)
  v_cmp_gt_u32 vcc, v17, v18
  s_cbranch_vccnz isync_136
  v_readlane_b32 s66, v18, 34
  s_nop 0
  s_cmp_lt_u32 s66, 268468224
  s_cselect_b32 s66, 0, 8192
  global_load_dword v18, v16, s[90:91] sc1
  s_waitcnt vmcnt(0)
  v_readlane_b32 s25, v18, 18
  s_xor_b32 s24, s66, 8192
  s_add_u32 s34, s34, s24
  s_add_u32 s35, s35, s24
  s_add_u32 s36, s36, s24
  s_add_u32 s37, s37, s24
  s_lshl_b32 s12, s9, 1
  s_add_u32 s12, s12, s3
  s_mul_hi_u32 s12, s12, 858993460
  s_lshl_b32 s12, s12, 2
  s_lshl_b32 s13, s8, 10
  s_add_u32 s12, s12, s13
  s_add_u32 s12, s12, 149504
  v_and_b32 v10, 7, v0
  v_lshlrev_b32 v10, 7, v10
  v_add_u32 v10, s12, v10
  s_add_u32 s12, s10, 1
  s_min_u32 s12, s12, 64
  s_branch wf_139
wf_138:
  s_sleep 2
  s_add_u32 s11, s11, 1
  s_cmp_gt_u32 s11, 131072
  s_cbranch_scc1 mega_done
wf_139:
  buffer_load_dword v11, v10, s[4:7], s66 offen sc1
  s_waitcnt vmcnt(0)
  v_cmp_gt_u32 vcc, s12, v11
  s_cbranch_vccnz wf_138
  s_cmp_lg_u32 s25, 0
  s_cbranch_scc1 r_loop_slow
r_loop:
  s_bfe_u32 s29, s10, 0x10002
  s_xor_b32 s61, s28, 1
  s_xor_b32 s12, s29, 1
  v_mov_b32 v26, s12
  s_sleep 3
  s_add_u32 s12, s10, 1
  v_cmp_gt_u32 vcc, s12, v11
  s_cbranch_vccz cu_140
  s_branch wf_142
wf_141:
  s_sleep 1
  s_add_u32 s11, s11, 1
  s_cmp_gt_u32 s11, 131072
  s_cbranch_scc1 mega_done
wf_142:
  buffer_load_dword v11, v10, s[4:7], s66 offen sc1
  s_waitcnt vmcnt(0)
  v_cmp_gt_u32 vcc, s12, v11
  s_cbranch_vccnz wf_141
cu_140:
  buffer_load_dwordx4 v[32:35], v1, s[4:7], s42 offen offset:0
  buffer_load_dwordx4 v[64:67], v1, s[4:7], s42 offen offset:1024
  s_add_u32 s42, s42, 40960
  buffer_load_dwordx4 v[36:39], v1, s[4:7], s42 offen offset:0
  buffer_load_dwordx4 v[68:71], v1, s[4:7], s42 offen offset:1024
  s_add_u32 s42, s42, 40960
  buffer_load_dwordx4 v[40:43], v1, s[4:7], s42 offen offset:0
  buffer_load_dwordx4 v[72:75], v1, s[4:7], s42 offen offset:1024
  s_add_u32 s42, s42, 40960
  buffer_load_dwordx4 v[44:47], v1, s[4:7], s42 offen offset:0
  buffer_load_dwordx4 v[76:79], v1, s[4:7], s42 offen offset:1024
  s_add_u32 s42, s42, 40960
  buffer_store_dwordx2 v[26:27], v240, s[4:7], s34 offen offset:0 sc1
  buffer_store_dwordx2 v[26:27], v241, s[4:7], s34 offen offset:0 sc1
  buffer_store_dwordx2 v[26:27], v242, s[4:7], s34 offen offset:0 sc1
  buffer_store_dwordx2 v[26:27], v243, s[4:7], s34 offen offset:0 sc1
  buffer_load_dwordx4 v[48:51], v1, s[4:7], s42 offen offset:0
  buffer_load_dwordx4 v[80:83], v1, s[4:7], s42 offen offset:1024
  s_add_u32 s42, s42, 40960
  buffer_load_dwordx4 v[52:55], v1, s[4:7], s42 offen offset:0
  buffer_load_dwordx4 v[84:87], v1, s[4:7], s42 offen offset:1024
  s_add_u32 s42, s42, 40960
  buffer_load_dwordx4 v[56:59], v1, s[4:7], s42 offen offset:0
  buffer_load_dwordx4 v[88:91], v1, s[4:7], s42 offen offset:1024
  s_add_u32 s42, s42, 40960
  buffer_load_dwordx4 v[60:63], v1, s[4:7], s42 offen offset:0
  buffer_load_dwordx4 v[92:95], v1, s[4:7], s42 offen offset:1024
  s_add_u32 s42, s42, 1024000
  s_add_u32 s12, s10, 3
  s_min_u32 s12, s12, 64
  v_cmp_gt_u32 vcc, s12, v11
  s_cbranch_vccz pk_143
  buffer_load_dword v11, v10, s[4:7], s66 offen sc1
pk_143:
  s_waitcnt vmcnt(0)
  s_cmp_lt_u32 s10, 63
  s_cbranch_scc1 r_up_144
  ds_write_b128 v6, v[32:35] offset:0
  ds_write_b128 v6, v[64:67] offset:1024
  ds_write_b128 v6, v[36:39] offset:4096
  ds_write_b128 v6, v[68:71] offset:5120
  ds_write_b128 v6, v[40:43] offset:8192
  ds_write_b128 v6, v[72:75] offset:9216
  ds_write_b128 v6, v[44:47] offset:12288
  ds_write_b128 v6, v[76:79] offset:13312
  ds_write_b128 v6, v[48:51] offset:16384
  ds_write_b128 v6, v[80:83] offset:17408
  ds_write_b128 v6, v[52:55] offset:20480
  ds_write_b128 v6, v[84:87] offset:21504
  ds_write_b128 v6, v[56:59] offset:24576
  ds_write_b128 v6, v[88:91] offset:25600
  ds_write_b128 v6, v[60:63] offset:28672
  ds_write_b128 v6, v[92:95] offset:29696
  s_nop 0
  v_xor_b32 v6, 32768, v6
r_up_144:
  buffer_load_dwordx4 v[220:223], v1, s[4:7], s56 offen offset:0 sc1
  buffer_load_dwordx4 v[224:227], v1, s[4:7], s57 offen offset:0 sc1
  buffer_load_dwordx4 v[228:231], v1, s[4:7], s56 offen offset:1024 sc1
  buffer_load_dwordx4 v[232:235], v1, s[4:7], s57 offen offset:1024 sc1
  s_sleep 2
py_145:
  buffer_load_dwordx4 v[96:99], v1, s[4:7], s56 offen offset:0 sc1
  buffer_load_dwordx4 v[100:103], v1, s[4:7], s57 offen offset:0 sc1
  buffer_load_dwordx4 v[104:107], v1, s[4:7], s56 offen offset:1024 sc1
  buffer_load_dwordx4 v[108:111], v1, s[4:7], s57 offen offset:1024 sc1
  s_add_u32 s11, s11, 1
  s_cmp_gt_u32 s11, 131072
  s_cbranch_scc1 mega_done
  s_waitcnt vmcnt(4)
  v_bitop3_b32 v14, v220, v222, s28 bitop3:0x7e
  v_bitop3_b32 v14, v224, v14, s28 bitop3:0xde
  v_bitop3_b32 v14, v226, v14, s28 bitop3:0xde
  v_bitop3_b32 v14, v228, v14, s28 bitop3:0xde
  v_bitop3_b32 v14, v230, v14, s28 bitop3:0xde
  v_bitop3_b32 v14, v232, v14, s28 bitop3:0xde
  v_bitop3_b32 v14, v234, v14, s28 bitop3:0xde
  v_and_b32 v14, 1, v14
  v_cmp_ne_u32 vcc, 0, v14
  s_cbranch_vccnz py_146
  s_branch py_147
py_146:
  buffer_load_dwordx4 v[220:223], v1, s[4:7], s56 offen offset:0 sc1
  buffer_load_dwordx4 v[224:227], v1, s[4:7], s57 offen offset:0 sc1
  buffer_load_dwordx4 v[228:231], v1, s[4:7], s56 offen offset:1024 sc1
  buffer_load_dwordx4 v[232:235], v1, s[4:7], s57 offen offset:1024 sc1
  s_waitcnt vmcnt(4)
  v_bitop3_b32 v14, v96, v98, s28 bitop3:0x7e
  v_bitop3_b32 v14, v100, v14, s28 bitop3:0xde
  v_bitop3_b32 v14, v102, v14, s28 bitop3:0xde
  v_bitop3_b32 v14, v104, v14, s28 bitop3:0xde
  v_bitop3_b32 v14, v106, v14, s28 bitop3:0xde
  v_bitop3_b32 v14, v108, v14, s28 bitop3:0xde
  v_bitop3_b32 v14, v110, v14, s28 bitop3:0xde
  v_and_b32 v14, 1, v14
  v_cmp_ne_u32 vcc, 0, v14
  s_cbranch_vccnz py_145
py_147:
  s_cmp_ge_u32 s10, 63
  s_cbranch_scc1 r_last
  buffer_load_dwordx4 v[112:115], v1, s[4:7], s58 offen offset:0 sc1
  buffer_load_dwordx4 v[116:119], v1, s[4:7], s58 offen offset:1024 sc1
  buffer_load_dwordx4 v[120:123], v1, s[4:7], s58 offen offset:2048 sc1
  buffer_load_dwordx4 v[124:127], v1, s[4:7], s58 offen offset:3072 sc1
  buffer_load_dwordx4 v[128:131], v1, s[4:7], s63 offen offset:0 sc1
  s_waitcnt lgkmcnt(0)
  v_mov_b32 v16, 0
  v_mov_b32 v17, 0
  v_mov_b32 v18, 0
  v_mov_b32 v19, 0
  v_mov_b32 v20, 0
  v_mov_b32 v21, 0
  v_mov_b32 v22, 0
  v_mov_b32 v23, 0
rp_148:
  buffer_load_dwordx4 v[132:135], v1, s[4:7], s58 offen offset:0 sc1
  buffer_load_dwordx4 v[136:139], v1, s[4:7], s58 offen offset:1024 sc1
  buffer_load_dwordx4 v[140:143], v1, s[4:7], s58 offen offset:2048 sc1
  buffer_load_dwordx4 v[144:147], v1, s[4:7], s58 offen offset:3072 sc1
  buffer_load_dwordx4 v[148:151], v1, s[4:7], s63 offen offset:0 sc1
  s_add_u32 s11, s11, 1
  s_cmp_gt_u32 s11, 131072
  s_cbranch_scc1 mega_done
  s_waitcnt vmcnt(5)
  v_bitop3_b32 v14, v128, v130, s28 bitop3:0x7e
  v_and_b32 v14, 1, v14
  v_cmp_ne_u32 vcc, 0, v14
  s_cbranch_vccnz rn_150
  v_smfmac_f32_16x16x64_bf16 v[16:19], v[112:115], v[32:39], v8
  v_bitop3_b32 v14, v112, v114, s28 bitop3:0x7e
  v_smfmac_f32_16x16x64_bf16 v[20:23], v[112:115], v[64:71], v8
  v_bitop3_b32 v14, v116, v14, s28 bitop3:0xde
  v_smfmac_f32_16x16x64_bf16 v[16:19], v[116:119], v[40:47], v8
  v_bitop3_b32 v14, v118, v14, s28 bitop3:0xde
  v_smfmac_f32_16x16x64_bf16 v[20:23], v[116:119], v[72:79], v8
  v_bitop3_b32 v14, v120, v14, s28 bitop3:0xde
  v_smfmac_f32_16x16x64_bf16 v[16:19], v[120:123], v[48:55], v8
  v_bitop3_b32 v14, v122, v14, s28 bitop3:0xde
  v_smfmac_f32_16x16x64_bf16 v[20:23], v[120:123], v[80:87], v8
  v_bitop3_b32 v14, v124, v14, s28 bitop3:0xde
  v_smfmac_f32_16x16x64_bf16 v[16:19], v[124:127], v[56:63], v8
  v_bitop3_b32 v14, v126, v14, s28 bitop3:0xde
  v_smfmac_f32_16x16x64_bf16 v[20:23], v[124:127], v[88:95], v8
  v_bitop3_b32 v14, v129, v14, s28 bitop3:0xde
  v_smfmac_f32_16x16x64_bf16 v[16:19], v[128:131], v[96:103], v8
  v_bitop3_b32 v14, v131, v14, s28 bitop3:0xde
  v_smfmac_f32_16x16x64_bf16 v[20:23], v[128:131], v[104:111], v8
  v_and_b32 v14, 1, v14
  v_cmp_ne_u32 vcc, 0, v14
  s_nop 4
  s_cbranch_vccz rok_149
  v_mov_b32 v16, 0
  v_mov_b32 v17, 0
  v_mov_b32 v18, 0
  v_mov_b32 v19, 0
  v_mov_b32 v20, 0
  v_mov_b32 v21, 0
  v_mov_b32 v22, 0
  v_mov_b32 v23, 0
rn_150:
  buffer_load_dwordx4 v[112:115], v1, s[4:7], s58 offen offset:0 sc1
  buffer_load_dwordx4 v[116:119], v1, s[4:7], s58 offen offset:1024 sc1
  buffer_load_dwordx4 v[120:123], v1, s[4:7], s58 offen offset:2048 sc1
  buffer_load_dwordx4 v[124:127], v1, s[4:7], s58 offen offset:3072 sc1
  buffer_load_dwordx4 v[128:131], v1, s[4:7], s63 offen offset:0 sc1
  s_waitcnt vmcnt(5)
  v_bitop3_b32 v14, v148, v150, s28 bitop3:0x7e
  v_and_b32 v14, 1, v14
  v_cmp_ne_u32 vcc, 0, v14
  s_cbranch_vccnz rp_148
  v_smfmac_f32_16x16x64_bf16 v[16:19], v[132:135], v[32:39], v8
  v_bitop3_b32 v14, v132, v134, s28 bitop3:0x7e
  v_smfmac_f32_16x16x64_bf16 v[20:23], v[132:135], v[64:71], v8
  v_bitop3_b32 v14, v136, v14, s28 bitop3:0xde
  v_smfmac_f32_16x16x64_bf16 v[16:19], v[136:139], v[40:47], v8
  v_bitop3_b32 v14, v138, v14, s28 bitop3:0xde
  v_smfmac_f32_16x16x64_bf16 v[20:23], v[136:139], v[72:79], v8
  v_bitop3_b32 v14, v140, v14, s28 bitop3:0xde
  v_smfmac_f32_16x16x64_bf16 v[16:19], v[140:143], v[48:55], v8
  v_bitop3_b32 v14, v142, v14, s28 bitop3:0xde
  v_smfmac_f32_16x16x64_bf16 v[20:23], v[140:143], v[80:87], v8
  v_bitop3_b32 v14, v144, v14, s28 bitop3:0xde
  v_smfmac_f32_16x16x64_bf16 v[16:19], v[144:147], v[56:63], v8
  v_bitop3_b32 v14, v146, v14, s28 bitop3:0xde
  v_smfmac_f32_16x16x64_bf16 v[20:23], v[144:147], v[88:95], v8
  v_bitop3_b32 v14, v149, v14, s28 bitop3:0xde
  v_smfmac_f32_16x16x64_bf16 v[16:19], v[148:151], v[96:103], v8
  v_bitop3_b32 v14, v151, v14, s28 bitop3:0xde
  v_smfmac_f32_16x16x64_bf16 v[20:23], v[148:151], v[104:111], v8
  v_and_b32 v14, 1, v14
  v_cmp_ne_u32 vcc, 0, v14
  s_nop 4
  s_cbranch_vccz rok_149
  v_mov_b32 v16, 0
  v_mov_b32 v17, 0
  v_mov_b32 v18, 0
  v_mov_b32 v19, 0
  v_mov_b32 v20, 0
  v_mov_b32 v21, 0
  v_mov_b32 v22, 0
  v_mov_b32 v23, 0
  s_branch rp_148
rok_149:
  s_mov_b64 vcc, s[54:55]
  v_permlane32_swap_b32 v16, v20
  v_permlane32_swap_b32 v17, v21
  v_permlane32_swap_b32 v18, v22
  v_permlane32_swap_b32 v19, v23
  v_pk_add_f32 v[16:17], v[16:17], v[20:21]
  v_pk_add_f32 v[18:19], v[18:19], v[22:23]
  v_cvt_pk_bf16_f32 v20, v16, v17
  v_cvt_pk_bf16_f32 v21, v18, v19
  s_nop 1
  v_cndmask_b32_dpp v24, v21, v20, vcc quad_perm:[0,0,2,2] row_mask:0xf bank_mask:0xf
  s_not_b64 vcc, vcc
  v_and_or_b32 v24, v24, -2, s29
  v_cndmask_b32_dpp v25, v20, v21, vcc quad_perm:[1,1,3,3] row_mask:0xf bank_mask:0xf
  buffer_store_dwordx2 v[24:25], v240, s[4:7], s34 offen offset:0 sc1
  buffer_store_dwordx2 v[24:25], v241, s[4:7], s34 offen offset:0 sc1
  buffer_store_dwordx2 v[24:25], v242, s[4:7], s34 offen offset:0 sc1
  buffer_store_dwordx2 v[24:25], v243, s[4:7], s34 offen offset:0 sc1
  ds_write_b128 v7, v[96:99] offset:0
  ds_write_b128 v7, v[100:103] offset:1024
  ds_write_b128 v7, v[104:107] offset:2048
  ds_write_b128 v7, v[108:111] offset:3072
  s_nop 0
  v_xor_b32 v7, 8192, v7
  v_lshlrev_b32 v26, 16, v24
  v_and_b32 v27, 0xffff0000, v24
  v_lshlrev_b32 v28, 16, v25
  v_and_b32 v29, 0xffff0000, v25
  ds_write_b128 v6, v[32:35] offset:0
  ds_write_b128 v6, v[64:67] offset:1024
  ds_write_b128 v6, v[36:39] offset:4096
  ds_write_b128 v6, v[68:71] offset:5120
  ds_write_b128 v6, v[40:43] offset:8192
  ds_write_b128 v6, v[72:75] offset:9216
  buffer_load_dwordx2 v[174:175], v240, s[4:7], s35 offen offset:0 sc1
  buffer_load_dwordx2 v[176:177], v240, s[4:7], s36 offen offset:0 sc1
  buffer_load_dwordx2 v[178:179], v240, s[4:7], s37 offen offset:0 sc1
  ds_write_b128 v6, v[44:47] offset:12288
  ds_write_b128 v6, v[76:79] offset:13312
  ds_write_b128 v6, v[48:51] offset:16384
  ds_write_b128 v6, v[80:83] offset:17408
  ds_write_b128 v6, v[52:55] offset:20480
  ds_write_b128 v6, v[84:87] offset:21504
  ds_write_b128 v6, v[56:59] offset:24576
  ds_write_b128 v6, v[88:91] offset:25600
  ds_write_b128 v6, v[60:63] offset:28672
  ds_write_b128 v6, v[92:95] offset:29696
  s_nop 0
  v_xor_b32 v6, 32768, v6
  s_sleep 1
  buffer_load_dwordx2 v[182:183], v241, s[4:7], s35 offen offset:0 sc1
  buffer_load_dwordx2 v[184:185], v241, s[4:7], s36 offen offset:0 sc1
  buffer_load_dwordx2 v[186:187], v241, s[4:7], s37 offen offset:0 sc1
  s_waitcnt vmcnt(3)
  v_bitop3_b32 v14, v174, v176, s29 bitop3:0x7e
  v_bitop3_b32 v14, v178, v14, s29 bitop3:0xde
  v_and_b32 v14, 1, v14
  v_cmp_ne_u32 vcc, 0, v14
  s_cbranch_vccz rgo_154
  buffer_load_dwordx2 v[190:191], v242, s[4:7], s35 offen offset:0 sc1
  buffer_load_dwordx2 v[192:193], v242, s[4:7], s36 offen offset:0 sc1
  buffer_load_dwordx2 v[194:195], v242, s[4:7], s37 offen offset:0 sc1
  s_waitcnt vmcnt(3)
  v_bitop3_b32 v14, v182, v184, s29 bitop3:0x7e
  v_bitop3_b32 v14, v186, v14, s29 bitop3:0xde
  v_and_b32 v14, 1, v14
  v_cmp_ne_u32 vcc, 0, v14
  s_cbranch_vccz rgo_155
  buffer_load_dwordx2 v[198:199], v243, s[4:7], s35 offen offset:0 sc1
  buffer_load_dwordx2 v[200:201], v243, s[4:7], s36 offen offset:0 sc1
  buffer_load_dwordx2 v[202:203], v243, s[4:7], s37 offen offset:0 sc1
  s_waitcnt vmcnt(3)
  v_bitop3_b32 v14, v190, v192, s29 bitop3:0x7e
  v_bitop3_b32 v14, v194, v14, s29 bitop3:0xde
  v_and_b32 v14, 1, v14
  v_cmp_ne_u32 vcc, 0, v14
  s_cbranch_vccz rgo_156
  s_waitcnt vmcnt(0)
  v_bitop3_b32 v14, v198, v200, s29 bitop3:0x7e
  v_bitop3_b32 v14, v202, v14, s29 bitop3:0xde
  v_and_b32 v14, 1, v14
  v_cmp_ne_u32 vcc, 0, v14
  s_cbranch_vccz rgo_157
rg_152:
  buffer_load_dwordx2 v[174:175], v240, s[4:7], s35 offen offset:0 sc1
  buffer_load_dwordx2 v[176:177], v240, s[4:7], s36 offen offset:0 sc1
  buffer_load_dwordx2 v[178:179], v240, s[4:7], s37 offen offset:0 sc1
  s_add_u32 s11, s11, 1
  s_cmp_gt_u32 s11, 131072
  s_cbranch_scc1 mega_done
  s_waitcnt vmcnt(0)
  v_bitop3_b32 v14, v174, v176, s29 bitop3:0x7e
  v_bitop3_b32 v14, v178, v14, s29 bitop3:0xde
  v_and_b32 v14, 1, v14
  v_cmp_ne_u32 vcc, 0, v14
  s_cbranch_vccz rgo_154
  s_branch rg_152
rgo_154:
  v_dot2_f32_bf16 v26, v174, s68, v26
  v_dot2_f32_bf16 v27, v174, s69, v27
  v_dot2_f32_bf16 v28, v175, s68, v28
  v_dot2_f32_bf16 v29, v175, s69, v29
  v_dot2_f32_bf16 v26, v176, s68, v26
  v_dot2_f32_bf16 v27, v176, s69, v27
  v_dot2_f32_bf16 v28, v177, s68, v28
  v_dot2_f32_bf16 v29, v177, s69, v29
  v_dot2_f32_bf16 v26, v178, s68, v26
  v_dot2_f32_bf16 v27, v178, s69, v27
  v_dot2_f32_bf16 v28, v179, s68, v28
  v_dot2_f32_bf16 v29, v179, s69, v29
  s_nop 1
  v_cvt_pk_bf16_f32 v24, v26, v28
  v_cvt_pk_bf16_f32 v25, v27, v29
  v_bfi_b32 v24, v5, s61, v24
  v_bfi_b32 v25, v5, s61, v25
  buffer_store_dword v24, v4, s[4:7], s59 offen offset:0
  buffer_store_dword v25, v4, s[4:7], s59 offen offset:16
  s_branch rj_153
rgo_155:
  v_dot2_f32_bf16 v26, v182, s68, v26
  v_dot2_f32_bf16 v27, v182, s69, v27
  v_dot2_f32_bf16 v28, v183, s68, v28
  v_dot2_f32_bf16 v29, v183, s69, v29
  v_dot2_f32_bf16 v26, v184, s68, v26
  v_dot2_f32_bf16 v27, v184, s69, v27
  v_dot2_f32_bf16 v28, v185, s68, v28
  v_dot2_f32_bf16 v29, v185, s69, v29
  v_dot2_f32_bf16 v26, v186, s68, v26
  v_dot2_f32_bf16 v27, v186, s69, v27
  v_dot2_f32_bf16 v28, v187, s68, v28
  v_dot2_f32_bf16 v29, v187, s69, v29
  s_nop 1
  v_cvt_pk_bf16_f32 v24, v26, v28
  v_cvt_pk_bf16_f32 v25, v27, v29
  v_bfi_b32 v24, v5, s61, v24
  v_bfi_b32 v25, v5, s61, v25
  buffer_store_dword v24, v4, s[4:7], s59 offen offset:0
  buffer_store_dword v25, v4, s[4:7], s59 offen offset:16
  s_branch rj_153
rgo_156:
  v_dot2_f32_bf16 v26, v190, s68, v26
  v_dot2_f32_bf16 v27, v190, s69, v27
  v_dot2_f32_bf16 v28, v191, s68, v28
  v_dot2_f32_bf16 v29, v191, s69, v29
  v_dot2_f32_bf16 v26, v192, s68, v26
  v_dot2_f32_bf16 v27, v192, s69, v27
  v_dot2_f32_bf16 v28, v193, s68, v28
  v_dot2_f32_bf16 v29, v193, s69, v29
  v_dot2_f32_bf16 v26, v194, s68, v26
  v_dot2_f32_bf16 v27, v194, s69, v27
  v_dot2_f32_bf16 v28, v195, s68, v28
  v_dot2_f32_bf16 v29, v195, s69, v29
  s_nop 1
  v_cvt_pk_bf16_f32 v24, v26, v28
  v_cvt_pk_bf16_f32 v25, v27, v29
  v_bfi_b32 v24, v5, s61, v24
  v_bfi_b32 v25, v5, s61, v25
  buffer_store_dword v24, v4, s[4:7], s59 offen offset:0
  buffer_store_dword v25, v4, s[4:7], s59 offen offset:16
  s_branch rj_153
rgo_157:
  v_dot2_f32_bf16 v26, v198, s68, v26
  v_dot2_f32_bf16 v27, v198, s69, v27
  v_dot2_f32_bf16 v28, v199, s68, v28
  v_dot2_f32_bf16 v29, v199, s69, v29
  v_dot2_f32_bf16 v26, v200, s68, v26
  v_dot2_f32_bf16 v27, v200, s69, v27
  v_dot2_f32_bf16 v28, v201, s68, v28
  v_dot2_f32_bf16 v29, v201, s69, v29
  v_dot2_f32_bf16 v26, v202, s68, v26
  v_dot2_f32_bf16 v27, v202, s69, v27
  v_dot2_f32_bf16 v28, v203, s68, v28
  v_dot2_f32_bf16 v29, v203, s69, v29
  s_nop 1
  v_cvt_pk_bf16_f32 v24, v26, v28
  v_cvt_pk_bf16_f32 v25, v27, v29
  v_bfi_b32 v24, v5, s61, v24
  v_bfi_b32 v25, v5, s61, v25
  buffer_store_dword v24, v4, s[4:7], s59 offen offset:0
  buffer_store_dword v25, v4, s[4:7], s59 offen offset:16
rj_153:
  s_add_u32 s34, s34, 524288
  s_and_b32 s34, s34, 2097151
  s_add_u32 s35, s35, 524288
  s_and_b32 s35, s35, 2097151
  s_add_u32 s36, s36, 524288
  s_and_b32 s36, s36, 2097151
  s_add_u32 s37, s37, 524288
  s_and_b32 s37, s37, 2097151
  s_add_u32 s10, s10, 1
  s_xor_b32 s28, s28, 1
  s_waitcnt lgkmcnt(0)
  s_barrier
  s_branch r_loop
r_loop_slow:
  s_bfe_u32 s29, s10, 0x10002
  s_xor_b32 s61, s28, 1
  s_xor_b32 s12, s29, 1
  v_mov_b32 v26, s12
  s_sleep 3
  s_add_u32 s12, s10, 1
  v_cmp_gt_u32 vcc, s12, v11
  s_cbranch_vccz cu_158
  s_branch wf_160
wf_159:
  s_sleep 1
  s_add_u32 s11, s11, 1
  s_cmp_gt_u32 s11, 131072
  s_cbranch_scc1 mega_done
wf_160:
  buffer_load_dword v11, v10, s[4:7], s66 offen sc1
  s_waitcnt vmcnt(0)
  v_cmp_gt_u32 vcc, s12, v11
  s_cbranch_vccnz wf_159
cu_158:
  buffer_load_dwordx4 v[32:35], v1, s[4:7], s42 offen offset:0
  buffer_load_dwordx4 v[64:67], v1, s[4:7], s42 offen offset:1024
  s_add_u32 s42, s42, 40960
  buffer_load_dwordx4 v[36:39], v1, s[4:7], s42 offen offset:0
  buffer_load_dwordx4 v[68:71], v1, s[4:7], s42 offen offset:1024
  s_add_u32 s42, s42, 40960
  buffer_load_dwordx4 v[40:43], v1, s[4:7], s42 offen offset:0
  buffer_load_dwordx4 v[72:75], v1, s[4:7], s42 offen offset:1024
  s_add_u32 s42, s42, 40960
  buffer_load_dwordx4 v[44:47], v1, s[4:7], s42 offen offset:0
  buffer_load_dwordx4 v[76:79], v1, s[4:7], s42 offen offset:1024
  s_add_u32 s42, s42, 40960
  buffer_store_dwordx2 v[26:27], v240, s[4:7], s34 offen offset:0 sc1
  buffer_store_dwordx2 v[26:27], v241, s[4:7], s34 offen offset:0 sc1
  buffer_store_dwordx2 v[26:27], v242, s[4:7], s34 offen offset:0 sc1
  buffer_store_dwordx2 v[26:27], v243, s[4:7], s34 offen offset:0 sc1
  buffer_load_dwordx4 v[48:51], v1, s[4:7], s42 offen offset:0
  buffer_load_dwordx4 v[80:83], v1, s[4:7], s42 offen offset:1024
  s_add_u32 s42, s42, 40960
  buffer_load_dwordx4 v[52:55], v1, s[4:7], s42 offen offset:0
  buffer_load_dwordx4 v[84:87], v1, s[4:7], s42 offen offset:1024
  s_add_u32 s42, s42, 40960
  buffer_load_dwordx4 v[56:59], v1, s[4:7], s42 offen offset:0
  buffer_load_dwordx4 v[88:91], v1, s[4:7], s42 offen offset:1024
  s_add_u32 s42, s42, 40960
  buffer_load_dwordx4 v[60:63], v1, s[4:7], s42 offen offset:0
  buffer_load_dwordx4 v[92:95], v1, s[4:7], s42 offen offset:1024
  s_add_u32 s42, s42, 1024000
  s_add_u32 s12, s10, 3
  s_min_u32 s12, s12, 64
  v_cmp_gt_u32 vcc, s12, v11
  s_cbranch_vccz pk_161
  buffer_load_dword v11, v10, s[4:7], s66 offen sc1
pk_161:
  s_waitcnt vmcnt(0)
  s_cmp_lt_u32 s10, 63
  s_cbranch_scc1 r_up_162
  ds_write_b128 v6, v[32:35] offset:0
  ds_write_b128 v6, v[64:67] offset:1024
  ds_write_b128 v6, v[36:39] offset:4096
  ds_write_b128 v6, v[68:71] offset:5120
  ds_write_b128 v6, v[40:43] offset:8192
  ds_write_b128 v6, v[72:75] offset:9216
  ds_write_b128 v6, v[44:47] offset:12288
  ds_write_b128 v6, v[76:79] offset:13312
  ds_write_b128 v6, v[48:51] offset:16384
  ds_write_b128 v6, v[80:83] offset:17408
  ds_write_b128 v6, v[52:55] offset:20480
  ds_write_b128 v6, v[84:87] offset:21504
  ds_write_b128 v6, v[56:59] offset:24576
  ds_write_b128 v6, v[88:91] offset:25600
  ds_write_b128 v6, v[60:63] offset:28672
  ds_write_b128 v6, v[92:95] offset:29696
  s_nop 0
  v_xor_b32 v6, 32768, v6
r_up_162:
  buffer_load_dwordx4 v[220:223], v1, s[4:7], s56 offen offset:0 sc1
  buffer_load_dwordx4 v[224:227], v1, s[4:7], s57 offen offset:0 sc1
  buffer_load_dwordx4 v[228:231], v1, s[4:7], s56 offen offset:1024 sc1
  buffer_load_dwordx4 v[232:235], v1, s[4:7], s57 offen offset:1024 sc1
  s_sleep 2
py_163:
  buffer_load_dwordx4 v[96:99], v1, s[4:7], s56 offen offset:0 sc1
  buffer_load_dwordx4 v[100:103], v1, s[4:7], s57 offen offset:0 sc1
  buffer_load_dwordx4 v[104:107], v1, s[4:7], s56 offen offset:1024 sc1
  buffer_load_dwordx4 v[108:111], v1, s[4:7], s57 offen offset:1024 sc1
  s_add_u32 s11, s11, 1
  s_cmp_gt_u32 s11, 131072
  s_cbranch_scc1 mega_done
  s_waitcnt vmcnt(4)
  v_bitop3_b32 v14, v220, v222, s28 bitop3:0x7e
  v_bitop3_b32 v14, v224, v14, s28 bitop3:0xde
  v_bitop3_b32 v14, v226, v14, s28 bitop3:0xde
  v_bitop3_b32 v14, v228, v14, s28 bitop3:0xde
  v_bitop3_b32 v14, v230, v14, s28 bitop3:0xde
  v_bitop3_b32 v14, v232, v14, s28 bitop3:0xde
  v_bitop3_b32 v14, v234, v14, s28 bitop3:0xde
  v_and_b32 v14, 1, v14
  v_cmp_ne_u32 vcc, 0, v14
  s_cbranch_vccnz py_164
  s_branch py_165
py_164:
  buffer_load_dwordx4 v[220:223], v1, s[4:7], s56 offen offset:0 sc1
  buffer_load_dwordx4 v[224:227], v1, s[4:7], s57 offen offset:0 sc1
  buffer_load_dwordx4 v[228:231], v1, s[4:7], s56 offen offset:1024 sc1
  buffer_load_dwordx4 v[232:235], v1, s[4:7], s57 offen offset:1024 sc1
  s_waitcnt vmcnt(4)
  v_bitop3_b32 v14, v96, v98, s28 bitop3:0x7e
  v_bitop3_b32 v14, v100, v14, s28 bitop3:0xde
  v_bitop3_b32 v14, v102, v14, s28 bitop3:0xde
  v_bitop3_b32 v14, v104, v14, s28 bitop3:0xde
  v_bitop3_b32 v14, v106, v14, s28 bitop3:0xde
  v_bitop3_b32 v14, v108, v14, s28 bitop3:0xde
  v_bitop3_b32 v14, v110, v14, s28 bitop3:0xde
  v_and_b32 v14, 1, v14
  v_cmp_ne_u32 vcc, 0, v14
  s_cbranch_vccnz py_163
py_165:
  s_cmp_ge_u32 s10, 63
  s_cbranch_scc1 r_last
  buffer_load_dwordx4 v[112:115], v1, s[4:7], s58 offen offset:0 sc1
  buffer_load_dwordx4 v[116:119], v1, s[4:7], s58 offen offset:1024 sc1
  buffer_load_dwordx4 v[120:123], v1, s[4:7], s58 offen offset:2048 sc1
  buffer_load_dwordx4 v[124:127], v1, s[4:7], s58 offen offset:3072 sc1
  buffer_load_dwordx4 v[128:131], v1, s[4:7], s63 offen offset:0 sc1
  s_waitcnt lgkmcnt(0)
  v_mov_b32 v16, 0
  v_mov_b32 v17, 0
  v_mov_b32 v18, 0
  v_mov_b32 v19, 0
  v_mov_b32 v20, 0
  v_mov_b32 v21, 0
  v_mov_b32 v22, 0
  v_mov_b32 v23, 0
rp_166:
  buffer_load_dwordx4 v[132:135], v1, s[4:7], s58 offen offset:0 sc1
  buffer_load_dwordx4 v[136:139], v1, s[4:7], s58 offen offset:1024 sc1
  buffer_load_dwordx4 v[140:143], v1, s[4:7], s58 offen offset:2048 sc1
  buffer_load_dwordx4 v[144:147], v1, s[4:7], s58 offen offset:3072 sc1
  buffer_load_dwordx4 v[148:151], v1, s[4:7], s63 offen offset:0 sc1
  s_add_u32 s11, s11, 1
  s_cmp_gt_u32 s11, 131072
  s_cbranch_scc1 mega_done
  s_waitcnt vmcnt(5)
  v_bitop3_b32 v14, v128, v130, s28 bitop3:0x7e
  v_and_b32 v14, 1, v14
  v_cmp_ne_u32 vcc, 0, v14
  s_cbranch_vccnz rn_168
  v_smfmac_f32_16x16x64_bf16 v[16:19], v[112:115], v[32:39], v8
  v_bitop3_b32 v14, v112, v114, s28 bitop3:0x7e
  v_smfmac_f32_16x16x64_bf16 v[20:23], v[112:115], v[64:71], v8
  v_bitop3_b32 v14, v116, v14, s28 bitop3:0xde
  v_smfmac_f32_16x16x64_bf16 v[16:19], v[116:119], v[40:47], v8
  v_bitop3_b32 v14, v118, v14, s28 bitop3:0xde
  v_smfmac_f32_16x16x64_bf16 v[20:23], v[116:119], v[72:79], v8
  v_bitop3_b32 v14, v120, v14, s28 bitop3:0xde
  v_smfmac_f32_16x16x64_bf16 v[16:19], v[120:123], v[48:55], v8
  v_bitop3_b32 v14, v122, v14, s28 bitop3:0xde
  v_smfmac_f32_16x16x64_bf16 v[20:23], v[120:123], v[80:87], v8
  v_bitop3_b32 v14, v124, v14, s28 bitop3:0xde
  v_smfmac_f32_16x16x64_bf16 v[16:19], v[124:127], v[56:63], v8
  v_bitop3_b32 v14, v126, v14, s28 bitop3:0xde
  v_smfmac_f32_16x16x64_bf16 v[20:23], v[124:127], v[88:95], v8
  v_bitop3_b32 v14, v129, v14, s28 bitop3:0xde
  v_smfmac_f32_16x16x64_bf16 v[16:19], v[128:131], v[96:103], v8
  v_bitop3_b32 v14, v131, v14, s28 bitop3:0xde
  v_smfmac_f32_16x16x64_bf16 v[20:23], v[128:131], v[104:111], v8
  v_and_b32 v14, 1, v14
  v_cmp_ne_u32 vcc, 0, v14
  s_nop 4
  s_cbranch_vccz rok_167
  v_mov_b32 v16, 0
  v_mov_b32 v17, 0
  v_mov_b32 v18, 0
  v_mov_b32 v19, 0
  v_mov_b32 v20, 0
  v_mov_b32 v21, 0
  v_mov_b32 v22, 0
  v_mov_b32 v23, 0
rn_168:
  buffer_load_dwordx4 v[112:115], v1, s[4:7], s58 offen offset:0 sc1
  buffer_load_dwordx4 v[116:119], v1, s[4:7], s58 offen offset:1024 sc1
  buffer_load_dwordx4 v[120:123], v1, s[4:7], s58 offen offset:2048 sc1
  buffer_load_dwordx4 v[124:127], v1, s[4:7], s58 offen offset:3072 sc1
  buffer_load_dwordx4 v[128:131], v1, s[4:7], s63 offen offset:0 sc1
  s_waitcnt vmcnt(5)
  v_bitop3_b32 v14, v148, v150, s28 bitop3:0x7e
  v_and_b32 v14, 1, v14
  v_cmp_ne_u32 vcc, 0, v14
  s_cbranch_vccnz rp_166
  v_smfmac_f32_16x16x64_bf16 v[16:19], v[132:135], v[32:39], v8
  v_bitop3_b32 v14, v132, v134, s28 bitop3:0x7e
  v_smfmac_f32_16x16x64_bf16 v[20:23], v[132:135], v[64:71], v8
  v_bitop3_b32 v14, v136, v14, s28 bitop3:0xde
  v_smfmac_f32_16x16x64_bf16 v[16:19], v[136:139], v[40:47], v8
  v_bitop3_b32 v14, v138, v14, s28 bitop3:0xde
  v_smfmac_f32_16x16x64_bf16 v[20:23], v[136:139], v[72:79], v8
  v_bitop3_b32 v14, v140, v14, s28 bitop3:0xde
  v_smfmac_f32_16x16x64_bf16 v[16:19], v[140:143], v[48:55], v8
  v_bitop3_b32 v14, v142, v14, s28 bitop3:0xde
  v_smfmac_f32_16x16x64_bf16 v[20:23], v[140:143], v[80:87], v8
  v_bitop3_b32 v14, v144, v14, s28 bitop3:0xde
  v_smfmac_f32_16x16x64_bf16 v[16:19], v[144:147], v[56:63], v8
  v_bitop3_b32 v14, v146, v14, s28 bitop3:0xde
  v_smfmac_f32_16x16x64_bf16 v[20:23], v[144:147], v[88:95], v8
  v_bitop3_b32 v14, v149, v14, s28 bitop3:0xde
  v_smfmac_f32_16x16x64_bf16 v[16:19], v[148:151], v[96:103], v8
  v_bitop3_b32 v14, v151, v14, s28 bitop3:0xde
  v_smfmac_f32_16x16x64_bf16 v[20:23], v[148:151], v[104:111], v8
  v_and_b32 v14, 1, v14
  v_cmp_ne_u32 vcc, 0, v14
  s_nop 4
  s_cbranch_vccz rok_167
  v_mov_b32 v16, 0
  v_mov_b32 v17, 0
  v_mov_b32 v18, 0
  v_mov_b32 v19, 0
  v_mov_b32 v20, 0
  v_mov_b32 v21, 0
  v_mov_b32 v22, 0
  v_mov_b32 v23, 0
  s_branch rp_166
rok_167:
  s_mov_b64 vcc, s[54:55]
  v_permlane32_swap_b32 v16, v20
  v_permlane32_swap_b32 v17, v21
  v_permlane32_swap_b32 v18, v22
  v_permlane32_swap_b32 v19, v23
  v_pk_add_f32 v[16:17], v[16:17], v[20:21]
  v_pk_add_f32 v[18:19], v[18:19], v[22:23]
  v_cvt_pk_bf16_f32 v20, v16, v17
  v_cvt_pk_bf16_f32 v21, v18, v19
  s_nop 1
  v_cndmask_b32_dpp v24, v21, v20, vcc quad_perm:[0,0,2,2] row_mask:0xf bank_mask:0xf
  s_not_b64 vcc, vcc
  v_and_or_b32 v24, v24, -2, s29
  v_cndmask_b32_dpp v25, v20, v21, vcc quad_perm:[1,1,3,3] row_mask:0xf bank_mask:0xf
  buffer_store_dwordx2 v[24:25], v240, s[4:7], s34 offen offset:0 sc1
  buffer_store_dwordx2 v[24:25], v241, s[4:7], s34 offen offset:0 sc1
  buffer_store_dwordx2 v[24:25], v242, s[4:7], s34 offen offset:0 sc1
  buffer_store_dwordx2 v[24:25], v243, s[4:7], s34 offen offset:0 sc1
  ds_write_b128 v7, v[96:99] offset:0
  ds_write_b128 v7, v[100:103] offset:1024
  ds_write_b128 v7, v[104:107] offset:2048
  ds_write_b128 v7, v[108:111] offset:3072
  s_nop 0
  v_xor_b32 v7, 8192, v7
  v_lshlrev_b32 v26, 16, v24
  v_and_b32 v27, 0xffff0000, v24
  v_lshlrev_b32 v28, 16, v25
  v_and_b32 v29, 0xffff0000, v25
  ds_write_b128 v6, v[32:35] offset:0
  ds_write_b128 v6, v[64:67] offset:1024
  ds_write_b128 v6, v[36:39] offset:4096
  ds_write_b128 v6, v[68:71] offset:5120
  ds_write_b128 v6, v[40:43] offset:8192
  ds_write_b128 v6, v[72:75] offset:9216
  buffer_load_dwordx2 v[174:175], v240, s[4:7], s35 offen offset:0 sc1
  buffer_load_dwordx2 v[176:177], v240, s[4:7], s36 offen offset:0 sc1
  buffer_load_dwordx2 v[178:179], v240, s[4:7], s37 offen offset:0 sc1
  ds_write_b128 v6, v[44:47] offset:12288
  ds_write_b128 v6, v[76:79] offset:13312
  ds_write_b128 v6, v[48:51] offset:16384
  ds_write_b128 v6, v[80:83] offset:17408
  ds_write_b128 v6, v[52:55] offset:20480
  ds_write_b128 v6, v[84:87] offset:21504
  ds_write_b128 v6, v[56:59] offset:24576
  ds_write_b128 v6, v[88:91] offset:25600
  ds_write_b128 v6, v[60:63] offset:28672
  ds_write_b128 v6, v[92:95] offset:29696
  s_nop 0
  v_xor_b32 v6, 32768, v6
  s_sleep 1
  buffer_load_dwordx2 v[182:183], v241, s[4:7], s35 offen offset:0 sc1
  buffer_load_dwordx2 v[184:185], v241, s[4:7], s36 offen offset:0 sc1
  buffer_load_dwordx2 v[186:187], v241, s[4:7], s37 offen offset:0 sc1
  s_waitcnt vmcnt(3)
  v_bitop3_b32 v14, v174, v176, s29 bitop3:0x7e
  v_bitop3_b32 v14, v178, v14, s29 bitop3:0xde
  v_and_b32 v14, 1, v14
  v_cmp_ne_u32 vcc, 0, v14
  s_cbranch_vccz rgo_172
  buffer_load_dwordx2 v[190:191], v242, s[4:7], s35 offen offset:0 sc1
  buffer_load_dwordx2 v[192:193], v242, s[4:7], s36 offen offset:0 sc1
  buffer_load_dwordx2 v[194:195], v242, s[4:7], s37 offen offset:0 sc1
  s_waitcnt vmcnt(3)
  v_bitop3_b32 v14, v182, v184, s29 bitop3:0x7e
  v_bitop3_b32 v14, v186, v14, s29 bitop3:0xde
  v_and_b32 v14, 1, v14
  v_cmp_ne_u32 vcc, 0, v14
  s_cbranch_vccz rgo_173
  buffer_load_dwordx2 v[198:199], v243, s[4:7], s35 offen offset:0 sc1
  buffer_load_dwordx2 v[200:201], v243, s[4:7], s36 offen offset:0 sc1
  buffer_load_dwordx2 v[202:203], v243, s[4:7], s37 offen offset:0 sc1
  s_waitcnt vmcnt(3)
  v_bitop3_b32 v14, v190, v192, s29 bitop3:0x7e
  v_bitop3_b32 v14, v194, v14, s29 bitop3:0xde
  v_and_b32 v14, 1, v14
  v_cmp_ne_u32 vcc, 0, v14
  s_cbranch_vccz rgo_174
  s_waitcnt vmcnt(0)
  v_bitop3_b32 v14, v198, v200, s29 bitop3:0x7e
  v_bitop3_b32 v14, v202, v14, s29 bitop3:0xde
  v_and_b32 v14, 1, v14
  v_cmp_ne_u32 vcc, 0, v14
  s_cbranch_vccz rgo_175
rg_170:
  buffer_load_dwordx2 v[174:175], v240, s[4:7], s35 offen offset:0 sc1
  buffer_load_dwordx2 v[176:177], v240, s[4:7], s36 offen offset:0 sc1
  buffer_load_dwordx2 v[178:179], v240, s[4:7], s37 offen offset:0 sc1
  s_add_u32 s11, s11, 1
  s_cmp_gt_u32 s11, 131072
  s_cbranch_scc1 mega_done
  s_waitcnt vmcnt(0)
  v_bitop3_b32 v14, v174, v176, s29 bitop3:0x7e
  v_bitop3_b32 v14, v178, v14, s29 bitop3:0xde
  v_and_b32 v14, 1, v14
  v_cmp_ne_u32 vcc, 0, v14
  s_cbranch_vccz rgo_172
  s_branch rg_170
rgo_172:
  v_dot2_f32_bf16 v26, v174, s68, v26
  v_dot2_f32_bf16 v27, v174, s69, v27
  v_dot2_f32_bf16 v28, v175, s68, v28
  v_dot2_f32_bf16 v29, v175, s69, v29
  v_dot2_f32_bf16 v26, v176, s68, v26
  v_dot2_f32_bf16 v27, v176, s69, v27
  v_dot2_f32_bf16 v28, v177, s68, v28
  v_dot2_f32_bf16 v29, v177, s69, v29
  v_dot2_f32_bf16 v26, v178, s68, v26
  v_dot2_f32_bf16 v27, v178, s69, v27
  v_dot2_f32_bf16 v28, v179, s68, v28
  v_dot2_f32_bf16 v29, v179, s69, v29
  s_nop 1
  v_cvt_pk_bf16_f32 v24, v26, v28
  v_cvt_pk_bf16_f32 v25, v27, v29
  v_bfi_b32 v24, v5, s61, v24
  v_bfi_b32 v25, v5, s61, v25
  buffer_store_dword v24, v4, s[4:7], s59 offen offset:0 sc1
  buffer_store_dword v25, v4, s[4:7], s59 offen offset:16 sc1
  s_branch rj_171
rgo_173:
  v_dot2_f32_bf16 v26, v182, s68, v26
  v_dot2_f32_bf16 v27, v182, s69, v27
  v_dot2_f32_bf16 v28, v183, s68, v28
  v_dot2_f32_bf16 v29, v183, s69, v29
  v_dot2_f32_bf16 v26, v184, s68, v26
  v_dot2_f32_bf16 v27, v184, s69, v27
  v_dot2_f32_bf16 v28, v185, s68, v28
  v_dot2_f32_bf16 v29, v185, s69, v29
  v_dot2_f32_bf16 v26, v186, s68, v26
  v_dot2_f32_bf16 v27, v186, s69, v27
  v_dot2_f32_bf16 v28, v187, s68, v28
  v_dot2_f32_bf16 v29, v187, s69, v29
  s_nop 1
  v_cvt_pk_bf16_f32 v24, v26, v28
  v_cvt_pk_bf16_f32 v25, v27, v29
  v_bfi_b32 v24, v5, s61, v24
  v_bfi_b32 v25, v5, s61, v25
  buffer_store_dword v24, v4, s[4:7], s59 offen offset:0 sc1
  buffer_store_dword v25, v4, s[4:7], s59 offen offset:16 sc1
  s_branch rj_171
rgo_174:
  v_dot2_f32_bf16 v26, v190, s68, v26
  v_dot2_f32_bf16 v27, v190, s69, v27
  v_dot2_f32_bf16 v28, v191, s68, v28
  v_dot2_f32_bf16 v29, v191, s69, v29
  v_dot2_f32_bf16 v26, v192, s68, v26
  v_dot2_f32_bf16 v27, v192, s69, v27
  v_dot2_f32_bf16 v28, v193, s68, v28
  v_dot2_f32_bf16 v29, v193, s69, v29
  v_dot2_f32_bf16 v26, v194, s68, v26
  v_dot2_f32_bf16 v27, v194, s69, v27
  v_dot2_f32_bf16 v28, v195, s68, v28
  v_dot2_f32_bf16 v29, v195, s69, v29
  s_nop 1
  v_cvt_pk_bf16_f32 v24, v26, v28
  v_cvt_pk_bf16_f32 v25, v27, v29
  v_bfi_b32 v24, v5, s61, v24
  v_bfi_b32 v25, v5, s61, v25
  buffer_store_dword v24, v4, s[4:7], s59 offen offset:0 sc1
  buffer_store_dword v25, v4, s[4:7], s59 offen offset:16 sc1
  s_branch rj_171
rgo_175:
  v_dot2_f32_bf16 v26, v198, s68, v26
  v_dot2_f32_bf16 v27, v198, s69, v27
  v_dot2_f32_bf16 v28, v199, s68, v28
  v_dot2_f32_bf16 v29, v199, s69, v29
  v_dot2_f32_bf16 v26, v200, s68, v26
  v_dot2_f32_bf16 v27, v200, s69, v27
  v_dot2_f32_bf16 v28, v201, s68, v28
  v_dot2_f32_bf16 v29, v201, s69, v29
  v_dot2_f32_bf16 v26, v202, s68, v26
  v_dot2_f32_bf16 v27, v202, s69, v27
  v_dot2_f32_bf16 v28, v203, s68, v28
  v_dot2_f32_bf16 v29, v203, s69, v29
  s_nop 1
  v_cvt_pk_bf16_f32 v24, v26, v28
  v_cvt_pk_bf16_f32 v25, v27, v29
  v_bfi_b32 v24, v5, s61, v24
  v_bfi_b32 v25, v5, s61, v25
  buffer_store_dword v24, v4, s[4:7], s59 offen offset:0 sc1
  buffer_store_dword v25, v4, s[4:7], s59 offen offset:16 sc1
rj_171:
  s_add_u32 s34, s34, 524288
  s_and_b32 s34, s34, 2097151
  s_add_u32 s35, s35, 524288
  s_and_b32 s35, s35, 2097151
  s_add_u32 s36, s36, 524288
  s_and_b32 s36, s36, 2097151
  s_add_u32 s37, s37, 524288
  s_and_b32 s37, s37, 2097151
  s_add_u32 s10, s10, 1
  s_xor_b32 s28, s28, 1
  s_waitcnt lgkmcnt(0)
  s_barrier
  s_branch r_loop_slow
r_last:
  s_waitcnt vmcnt(0)
  ds_write_b128 v7, v[96:99] offset:0
  ds_write_b128 v7, v[100:103] offset:1024
  ds_write_b128 v7, v[104:107] offset:2048
  ds_write_b128 v7, v[108:111] offset:3072
  s_nop 0
  v_xor_b32 v7, 8192, v7
  s_waitcnt lgkmcnt(0)
  s_barrier
  s_branch mega_wo
r_x:
  s_sub_u32 s12, s3, 2
  s_lshl_b32 s13, s8, 1
  s_add_u32 s13, s13, s12
  s_mul_i32 s56, s13, 163840
  s_lshl_b32 s13, s9, 12
  s_add_u32 s56, s56, s13
  s_add_u32 s56, s56, 81788928
  s_lshl_b32 s62, s12, 14
  s_mov_b32 s57, 0
  s_mov_b32 s60, 0
  s_mul_i32 s58, s12, 10240
  s_add_u32 s58, s58, s27
  s_add_u32 s58, s58, 32768
  s_mul_i32 s59, s12, 81920
  s_lshl_b32 s13, s9, 13
  s_add_u32 s59, s59, s13
  s_lshl_b32 s13, s8, 10
  s_add_u32 s59, s59, s13
  s_add_u32 s59, s59, 165675008
  v_add_u32 v7, 98304, v1
  s_waitcnt vmcnt(0)
  s_barrier
  s_cmp_lg_u32 s3, 0
  s_cbranch_scc1 isk_176
  v_mov_b32 v16, 8
  v_mov_b32 v17, 1
  s_mov_b64 exec, 1
  global_atomic_add v16, v17, s[90:91]
  s_mov_b64 exec, -1
isk_176:
  s_and_b32 s18, s2, 8
  s_lshl_b32 s18, s18, 1
  s_add_u32 s18, s18, 16
  s_load_dwordx4 s[12:15], s[0:1], s18
  s_and_b32 s16, s2, 7
  s_lshl_b32 s17, s8, 3
  s_add_u32 s16, s16, s17
  v_mul_u32_u24 v24, 21846, v0
  v_lshrrev_b32 v24, 16, v24
  v_mul_u32_u24 v25, 3, v24
  v_sub_u32 v25, v0, v25
  v_min_u32 v24, 15, v24
  v_mul_u32_u24 v24, 12288, v24
  v_lshl_add_u32 v24, v25, 7, v24
  s_mul_i32 s17, s16, 384
  s_mul_i32 s19, s3, 196608
  s_add_u32 s17, s17, s19
  s_add_u32 s17, s17, 786432
  s_waitcnt lgkmcnt(0)
  s_mov_b32 exec_hi, 0xffff
  s_add_u32 s12, s12, s17
  s_addc_u32 s13, s13, 0
  global_load_dword v26, v24, s[12:13]
  s_add_u32 s12, s12, 1572864
  s_addc_u32 s13, s13, 0
  global_load_dword v26, v24, s[12:13]
  s_add_u32 s12, s12, 1572864
  s_addc_u32 s13, s13, 0
  global_load_dword v26, v24, s[12:13]
  s_add_u32 s12, s12, 1572864
  s_addc_u32 s13, s13, 0
  global_load_dword v26, v24, s[12:13]
  s_add_u32 s12, s12, 1572864
  s_addc_u32 s13, s13, 0
  global_load_dword v26, v24, s[12:13]
  s_cmp_lg_u32 s18, 16
  s_cbranch_scc1 pf_177
  s_add_u32 s14, s14, s17
  s_addc_u32 s15, s15, 0
  global_load_dword v26, v24, s[14:15]
  s_add_u32 s14, s14, 1572864
  s_addc_u32 s15, s15, 0
  global_load_dword v26, v24, s[14:15]
  s_add_u32 s14, s14, 1572864
  s_addc_u32 s15, s15, 0
  global_load_dword v26, v24, s[14:15]
  s_add_u32 s14, s14, 1572864
  s_addc_u32 s15, s15, 0
  global_load_dword v26, v24, s[14:15]
  s_add_u32 s14, s14, 1572864
  s_addc_u32 s15, s15, 0
  global_load_dword v26, v24, s[14:15]
  s_branch pf_178
pf_177:
  s_mov_b32 exec_hi, 0xff
  v_lshlrev_b32 v24, 7, v0
  s_mul_i32 s17, s16, 245760
  s_mul_i32 s19, s3, 10240
  s_add_u32 s17, s17, s19
  s_add_u32 s17, s17, 40960
  s_add_u32 s14, s14, s17
  s_addc_u32 s15, s15, 0
  global_load_dword v26, v24, s[14:15]
  s_add_u32 s14, s14, 5120
  s_addc_u32 s15, s15, 0
  global_load_dword v26, v24, s[14:15]
  s_add_u32 s14, s14, 76800
  s_addc_u32 s15, s15, 0
  global_load_dword v26, v24, s[14:15]
  s_add_u32 s14, s14, 5120
  s_addc_u32 s15, s15, 0
  global_load_dword v26, v24, s[14:15]
  s_add_u32 s14, s14, 76800
  s_addc_u32 s15, s15, 0
  global_load_dword v26, v24, s[14:15]
  s_add_u32 s14, s14, 5120
  s_addc_u32 s15, s15, 0
  global_load_dword v26, v24, s[14:15]
pf_178:
  s_mov_b64 exec, -1
  v_lshrrev_b32 v16, 2, v1
  v_mov_b32 v17, 0
  s_mov_b32 exec_lo, 0x00030003
  s_mov_b32 exec_hi, 0x00030003
  v_mov_b32 v17, 32
  s_mov_b32 exec_lo, 0x00100010
  s_mov_b32 exec_hi, 0x00100010
  v_mov_b32 v17, 64
  s_mov_b64 exec, 4
  v_mov_b32 v17, 56
  s_mov_b32 exec_lo, 0
  s_mov_b32 exec_hi, 4
  v_mov_b32 v17, 268435456
  s_mov_b64 exec, -1
  s_branch isync_180
isync_179:
  s_sleep 4
  s_add_u32 s11, s11, 1
  s_cmp_gt_u32 s11, 131072
  s_cbranch_scc1 mega_done
isync_180:
  global_load_dword v18, v16, s[90:91] sc1
  s_waitcnt vmcnt(0)
  v_cmp_gt_u32 vcc, v17, v18
  s_cbranch_vccnz isync_179
  v_readlane_b32 s66, v18, 34
  s_nop 0
  s_cmp_lt_u32 s66, 268468224
  s_cselect_b32 s66, 0, 8192
  s_xor_b32 s24, s66, 8192
  s_xor_b32 s24, s24, 0
  s_add_u32 s65, s65, s24
  s_barrier
rx_loop:
  s_bfe_u32 s28, s10, 0x10002
  s_and_b32 s14, s10, 3
  s_lshl_b32 s14, s14, 15
  s_add_u32 s14, s14, s58
  s_add_u32 s15, s14, 4096
  s_add_u32 s16, s14, 8192
  v_add_u32 v2, s60, v1
px_181:
  buffer_load_dwordx4 v[16:19], v1, s[4:7], s14 offen offset:0 sc1
  buffer_load_dwordx4 v[20:23], v1, s[4:7], s14 offen offset:1024 sc1
  buffer_load_dwordx4 v[24:27], v1, s[4:7], s14 offen offset:2048 sc1
  buffer_load_dwordx4 v[28:31], v1, s[4:7], s14 offen offset:3072 sc1
  buffer_load_dwordx4 v[32:35], v1, s[4:7], s15 offen offset:0 sc1
  buffer_load_dwordx4 v[36:39], v1, s[4:7], s15 offen offset:1024 sc1
  buffer_load_dwordx4 v[40:43], v1, s[4:7], s15 offen offset:2048 sc1
  buffer_load_dwordx4 v[44:47], v1, s[4:7], s15 offen offset:3072 sc1
  buffer_load_dwordx4 v[48:51], v1, s[4:7], s16 offen offset:0 sc1
  buffer_load_dwordx4 v[52:55], v1, s[4:7], s16 offen offset:1024 sc1
  s_add_u32 s11, s11, 1
  s_cmp_gt_u32 s11, 131072
  s_cbranch_scc1 mega_done
  s_waitcnt vmcnt(0)
  v_bitop3_b32 v14, v16, v20, s28 bitop3:0x7e
  v_bitop3_b32 v14, v24, v14, s28 bitop3:0xde
  v_bitop3_b32 v14, v28, v14, s28 bitop3:0xde
  v_bitop3_b32 v14, v32, v14, s28 bitop3:0xde
  v_bitop3_b32 v14, v36, v14, s28 bitop3:0xde
  v_bitop3_b32 v14, v40, v14, s28 bitop3:0xde
  v_bitop3_b32 v14, v44, v14, s28 bitop3:0xde
  v_bitop3_b32 v14, v48, v14, s28 bitop3:0xde
  v_bitop3_b32 v14, v52, v14, s28 bitop3:0xde
  v_bitop3_b32 v14, v50, v14, s28 bitop3:0xde
  v_bitop3_b32 v14, v54, v14, s28 bitop3:0xde
  v_and_b32 v14, 1, v14
  v_cmp_ne_u32 vcc, 0, v14
  s_cbranch_vccnz px_181
  s_cmp_ge_u32 s10, 62
  s_cbranch_scc1 xd_182f
  s_cmp_eq_u32 s10, 61
  s_cbranch_scc1 xd_182w
  s_cmp_lg_u32 s3, 2
  s_cbranch_scc1 xd_182f
  v_mov_b32 v12, s57
  v_lshlrev_b32 v13, 6, v0
  s_mov_b64 exec, 3
  buffer_store_dword v12, v13, s[4:7], s65 offen sc1
  s_mov_b64 exec, -1
  s_branch xd_182f
xd_182w:
  v_mov_b32 v12, s57
  s_mov_b64 exec, 1
  buffer_store_dword v12, off, s[4:7], s65 sc1
  s_mov_b64 exec, -1
xd_182f:
  s_sub_u32 s12, s10, 1
  s_cmp_ge_u32 s12, 58
  s_cbranch_scc1 xd_182
  buffer_store_dwordx4 v[112:115], v1, s[4:7], s59 offen offset:0 sc1
  s_add_u32 s59, s59, 4096
  buffer_store_dwordx4 v[116:119], v1, s[4:7], s59 offen offset:0 sc1
  s_add_u32 s59, s59, 159744
xd_182:
  ds_read_b128 v[64:67], v2 offset:0
  ds_read_b128 v[68:71], v2 offset:1024
  ds_read_b128 v[72:75], v2 offset:2048
  ds_read_b128 v[76:79], v2 offset:3072
  ds_read_b128 v[80:83], v2 offset:4096
  ds_read_b128 v[84:87], v2 offset:5120
  ds_read_b128 v[88:91], v2 offset:6144
  ds_read_b128 v[92:95], v2 offset:7168
  s_waitcnt lgkmcnt(7)
  v_mfma_f32_16x16x32_bf16 v[96:99], v[64:67], v[16:19], 0
  ds_read_b128 v[64:67], v2 offset:8192
  s_waitcnt lgkmcnt(7)
  v_mfma_f32_16x16x32_bf16 v[100:103], v[68:71], v[16:19], 0
  ds_read_b128 v[68:71], v2 offset:9216
  s_waitcnt lgkmcnt(7)
  v_mfma_f32_16x16x32_bf16 v[104:107], v[72:75], v[16:19], 0
  ds_read_b128 v[72:75], v2 offset:10240
  s_waitcnt lgkmcnt(7)
  v_mfma_f32_16x16x32_bf16 v[108:111], v[76:79], v[16:19], 0
  ds_read_b128 v[76:79], v2 offset:11264
  s_waitcnt lgkmcnt(7)
  v_mfma_f32_16x16x32_bf16 v[96:99], v[80:83], v[20:23], v[96:99]
  ds_read_b128 v[80:83], v2 offset:12288
  s_waitcnt lgkmcnt(7)
  v_mfma_f32_16x16x32_bf16 v[100:103], v[84:87], v[20:23], v[100:103]
  ds_read_b128 v[84:87], v2 offset:13312
  s_waitcnt lgkmcnt(7)
  v_mfma_f32_16x16x32_bf16 v[104:107], v[88:91], v[20:23], v[104:107]
  ds_read_b128 v[88:91], v2 offset:14336
  s_waitcnt lgkmcnt(7)
  v_mfma_f32_16x16x32_bf16 v[108:111], v[92:95], v[20:23], v[108:111]
  ds_read_b128 v[92:95], v2 offset:15360
  s_waitcnt lgkmcnt(7)
  v_mfma_f32_16x16x32_bf16 v[96:99], v[64:67], v[24:27], v[96:99]
  ds_read_b128 v[64:67], v2 offset:16384
  s_waitcnt lgkmcnt(7)
  v_mfma_f32_16x16x32_bf16 v[100:103], v[68:71], v[24:27], v[100:103]
  ds_read_b128 v[68:71], v2 offset:17408
  s_waitcnt lgkmcnt(7)
  v_mfma_f32_16x16x32_bf16 v[104:107], v[72:75], v[24:27], v[104:107]
  ds_read_b128 v[72:75], v2 offset:18432
  s_waitcnt lgkmcnt(7)
  v_mfma_f32_16x16x32_bf16 v[108:111], v[76:79], v[24:27], v[108:111]
  ds_read_b128 v[76:79], v2 offset:19456
  s_waitcnt lgkmcnt(7)
  v_mfma_f32_16x16x32_bf16 v[96:99], v[80:83], v[28:31], v[96:99]
  ds_read_b128 v[80:83], v2 offset:20480
  s_waitcnt lgkmcnt(7)
  v_mfma_f32_16x16x32_bf16 v[100:103], v[84:87], v[28:31], v[100:103]
  ds_read_b128 v[84:87], v2 offset:21504
  s_waitcnt lgkmcnt(7)
  v_mfma_f32_16x16x32_bf16 v[104:107], v[88:91], v[28:31], v[104:107]
  ds_read_b128 v[88:91], v2 offset:22528
  s_waitcnt lgkmcnt(7)
  v_mfma_f32_16x16x32_bf16 v[108:111], v[92:95], v[28:31], v[108:111]
  ds_read_b128 v[92:95], v2 offset:23552
  s_waitcnt lgkmcnt(7)
  v_mfma_f32_16x16x32_bf16 v[96:99], v[64:67], v[32:35], v[96:99]
  ds_read_b128 v[64:67], v2 offset:24576
  s_waitcnt lgkmcnt(7)
  v_mfma_f32_16x16x32_bf16 v[100:103], v[68:71], v[32:35], v[100:103]
  ds_read_b128 v[68:71], v2 offset:25600
  s_waitcnt lgkmcnt(7)
  v_mfma_f32_16x16x32_bf16 v[104:107], v[72:75], v[32:35], v[104:107]
  ds_read_b128 v[72:75], v2 offset:26624
  s_waitcnt lgkmcnt(7)
  v_mfma_f32_16x16x32_bf16 v[108:111], v[76:79], v[32:35], v[108:111]
  ds_read_b128 v[76:79], v2 offset:27648
  s_waitcnt lgkmcnt(7)
  v_mfma_f32_16x16x32_bf16 v[96:99], v[80:83], v[36:39], v[96:99]
  ds_read_b128 v[80:83], v2 offset:28672
  s_waitcnt lgkmcnt(7)
  v_mfma_f32_16x16x32_bf16 v[100:103], v[84:87], v[36:39], v[100:103]
  ds_read_b128 v[84:87], v2 offset:29696
  s_waitcnt lgkmcnt(7)
  v_mfma_f32_16x16x32_bf16 v[104:107], v[88:91], v[36:39], v[104:107]
  ds_read_b128 v[88:91], v2 offset:30720
  s_waitcnt lgkmcnt(7)
  v_mfma_f32_16x16x32_bf16 v[108:111], v[92:95], v[36:39], v[108:111]
  ds_read_b128 v[92:95], v2 offset:31744
  s_waitcnt lgkmcnt(7)
  v_mfma_f32_16x16x32_bf16 v[96:99], v[64:67], v[40:43], v[96:99]
  ds_read_b128 v[64:67], v7 offset:0
  s_waitcnt lgkmcnt(7)
  v_mfma_f32_16x16x32_bf16 v[100:103], v[68:71], v[40:43], v[100:103]
  ds_read_b128 v[68:71], v7 offset:2048
  s_waitcnt lgkmcnt(7)
  v_mfma_f32_16x16x32_bf16 v[104:107], v[72:75], v[40:43], v[104:107]
  ds_read_b128 v[72:75], v7 offset:4096
  s_waitcnt lgkmcnt(7)
  v_mfma_f32_16x16x32_bf16 v[108:111], v[76:79], v[40:43], v[108:111]
  ds_read_b128 v[76:79], v7 offset:6144
  s_waitcnt lgkmcnt(7)
  v_mfma_f32_16x16x32_bf16 v[96:99], v[80:83], v[44:47], v[96:99]
  ds_read_b128 v[80:83], v7 offset:1024
  s_waitcnt lgkmcnt(7)
  v_mfma_f32_16x16x32_bf16 v[100:103], v[84:87], v[44:47], v[100:103]
  ds_read_b128 v[84:87], v7 offset:3072
  s_waitcnt lgkmcnt(7)
  v_mfma_f32_16x16x32_bf16 v[104:107], v[88:91], v[44:47], v[104:107]
  ds_read_b128 v[88:91], v7 offset:5120
  s_waitcnt lgkmcnt(7)
  v_mfma_f32_16x16x32_bf16 v[108:111], v[92:95], v[44:47], v[108:111]
  ds_read_b128 v[92:95], v7 offset:7168
  s_waitcnt lgkmcnt(7)
  v_mfma_f32_16x16x32_bf16 v[96:99], v[64:67], v[48:51], v[96:99]
  s_waitcnt lgkmcnt(6)
  v_mfma_f32_16x16x32_bf16 v[100:103], v[68:71], v[48:51], v[100:103]
  s_waitcnt lgkmcnt(5)
  v_mfma_f32_16x16x32_bf16 v[104:107], v[72:75], v[48:51], v[104:107]
  s_waitcnt lgkmcnt(4)
  v_mfma_f32_16x16x32_bf16 v[108:111], v[76:79], v[48:51], v[108:111]
  s_waitcnt lgkmcnt(3)
  v_mfma_f32_16x16x32_bf16 v[96:99], v[80:83], v[52:55], v[96:99]
  s_waitcnt lgkmcnt(2)
  v_mfma_f32_16x16x32_bf16 v[100:103], v[84:87], v[52:55], v[100:103]
  s_waitcnt lgkmcnt(1)
  v_mfma_f32_16x16x32_bf16 v[104:107], v[88:91], v[52:55], v[104:107]
  s_waitcnt lgkmcnt(0)
  v_mfma_f32_16x16x32_bf16 v[108:111], v[92:95], v[52:55], v[108:111]
  v_xor_b32 v7, 8192, v7
  s_xor_b32 s60, s60, 32768
  v_cvt_pk_bf16_f32 v112, v96, v97
  v_cvt_pk_bf16_f32 v113, v98, v99
  v_cvt_pk_bf16_f32 v114, v100, v101
  v_cvt_pk_bf16_f32 v115, v102, v103
  v_cvt_pk_bf16_f32 v116, v104, v105
  v_cvt_pk_bf16_f32 v117, v106, v107
  v_cvt_pk_bf16_f32 v118, v108, v109
  v_cvt_pk_bf16_f32 v119, v110, v111
  s_mov_b32 s57, s10
  s_cmp_lt_u32 s10, 58
  s_cbranch_scc1 xd_183
  buffer_store_dwordx4 v[112:115], v1, s[4:7], s59 offen offset:0 sc1
  s_add_u32 s59, s59, 4096
  buffer_store_dwordx4 v[116:119], v1, s[4:7], s59 offen offset:0 sc1
  s_add_u32 s59, s59, 159744
  s_add_u32 s57, s57, 1
xd_183:
  s_add_u32 s10, s10, 1
  s_waitcnt vmcnt(0)
  s_cmp_lt_u32 s10, 62
  s_cbranch_scc1 rx_nf_184
  v_mov_b32 v12, s10
  s_mov_b64 exec, 1
  buffer_store_dword v12, off, s[4:7], s65 sc1
  s_mov_b64 exec, -1
  s_cmp_ge_u32 s10, 64
  s_cbranch_scc1 rx_fin
rx_nf_184:
  s_barrier
  s_branch rx_loop
rx_fin:
  s_branch mega_wo
mega_code_end:
.section .rodata,"a"
.p2align 6
.amdhsa_kernel sequential_preLN__memory_aug_recurrent_mem_tr__mixer_gmlp__prompt_kernel
  .amdhsa_next_free_vgpr 512
  .amdhsa_next_free_sgpr 102
  .amdhsa_accum_offset 256
  .amdhsa_group_segment_fixed_size 0
  .amdhsa_kernarg_size 120
  .amdhsa_user_sgpr_count 2
  .amdhsa_user_sgpr_kernarg_segment_ptr 1
  .amdhsa_system_sgpr_workgroup_id_x 1
  .amdhsa_float_denorm_mode_32 3
.end_amdhsa_kernel
.text
```
